```python
import torch

def _softmax(x, axis=-1):
    return torch.softmax(x, dim=axis)

def _gelu(x):
    return torch.nn.functional.gelu(x, approximate='tanh')

def _silu(x):
    return torch.nn.functional.silu(x)

def _sigmoid(x):
    return torch.sigmoid(x)

def _layernorm(x, axis=-1, eps=1e-05):
    m = x.mean(dim=axis, keepdim=True)
    v = x.var(dim=axis, keepdim=True, unbiased=False)
    return (x - m) / torch.sqrt(v + eps)

def _scatter_add(tgt, idx, src, axis=0):
    return tgt.clone().index_add_(axis, idx, src)

def _segment_sum(src, seg, n):
    out = torch.zeros((n,) + src.shape[1:], dtype=src.dtype)
    return out.index_add_(0, seg, src)

def _pad(x, pw):
    flat = tuple((v for pair in reversed(pw) for v in pair))
    return torch.nn.functional.pad(x, flat)
kernel_name = 'recurrent_scan__memory_aug_recurrent_mem_tr__mixer_s_mlp__prompt'

def setup_inputs():

    _w = lambda a: (lambda t: t.to(torch.bfloat16) if t.is_floating_point() else t)(torch.as_tensor(a))

    def _A_setup():
        B, S, Dm = (1, 2048, 512)
        H, Dh = (32, 128)
        M, seg = (8, 32)
        seg = min(seg, S)
        S = S // seg * seg
        return {'x': _w((lambda *s: torch.randn(*s, dtype=torch.bfloat16) * 0.05)(B, S, Dm)), 'mem0': _w((lambda *s: torch.randn(*s, dtype=torch.bfloat16) * 0.2)(B, M, Dm)), 'Wq': _w((lambda *s: torch.randn(*s, dtype=torch.bfloat16) * 1.6)(Dm, H, Dh) * Dm ** (-0.5)), 'Wk': _w((lambda *s: torch.randn(*s, dtype=torch.bfloat16) * 1.6)(Dm, H, Dh) * Dm ** (-0.5)), 'Wv': _w((lambda *s: torch.randn(*s, dtype=torch.bfloat16) * 0.2)(Dm, H, Dh) * Dm ** (-0.5)), 'Wo': _w((lambda *s: torch.randn(*s, dtype=torch.bfloat16) * 0.2)(H, Dh, Dm) * (H * Dh) ** (-0.5)), 'seg_len': seg}
    _A_in = _A_setup()

    def _B_setup():
        B, S, D, F = (1, 2048, 512, 1376)
        return {'x': _w((lambda *s: torch.randn(*s, dtype=torch.bfloat16) * 0.05)(B, S, D)), 'w1': _w((lambda *s: torch.randn(*s, dtype=torch.bfloat16) * 3.2)(D, D) * D ** (-0.5)), 'w2': _w((lambda *s: torch.randn(*s, dtype=torch.bfloat16) * 3.2)(D, D) * D ** (-0.5)), 'w3': _w((lambda *s: torch.randn(*s, dtype=torch.bfloat16) * 3.2)(D, F) * D ** (-0.5)), 'w4': _w((lambda *s: torch.randn(*s, dtype=torch.bfloat16) * 3.2)(F, D) * F ** (-0.5))}
    _B_in = _B_setup()
    return {'A_x': _A_in['x'], 'A_mem0': _A_in['mem0'], 'A_Wq': _A_in['Wq'], 'A_Wk': _A_in['Wk'], 'A_Wv': _A_in['Wv'], 'A_Wo': _A_in['Wo'], 'A_seg_len': _A_in['seg_len'], 'B_x': _B_in['x'], 'B_w1': _B_in['w1'], 'B_w2': _B_in['w2'], 'B_w3': _B_in['w3'], 'B_w4': _B_in['w4']}

def reference(A_x, A_mem0, A_Wq, A_Wk, A_Wv, A_Wo, A_seg_len, B_x, B_w1, B_w2, B_w3, B_w4):

    def _A_ref(x, mem0, Wq, Wk, Wv, Wo, seg_len):
        B, S, Dm = x.shape
        H, Dh = (Wq.shape[1], Wq.shape[2])
        M = mem0.shape[1]
        scale = Dh ** (-0.5)
        n_seg = S // seg_len
        L = M + seg_len
        idx = torch.arange(L)
        mask = (idx[:, None] < M) | (idx[:, None] >= idx[None, :])
        mem = mem0
        outs = []
        for s in range(n_seg):
            xs = x[:, s * seg_len:(s + 1) * seg_len, :].clone()
            h = torch.concatenate([mem, xs], axis=1)
            q = torch.einsum('btd,dhe->bhte', h, Wq)
            k = torch.einsum('btd,dhe->bhte', h, Wk)
            v = torch.einsum('btd,dhe->bhte', h, Wv)
            scores = torch.einsum('bhqe,bhke->bhqk', q, k) * scale
            scores = torch.where(mask[None, None], scores, -1000000000.0)
            p = _softmax(scores, axis=-1)
            o = torch.einsum('bhqk,bhke->bhqe', p, v)
            o = torch.einsum('bhte,hed->btd', o, Wo)
            mem = o[:, :M, :].clone()
            outs.append(o[:, M:, :])
        return torch.concatenate(outs, axis=1)

    def _B_ref(x, w1, w2, w3, w4):
        B, S, D = x.shape
        h = _gelu(_layernorm(x, axis=-1) @ w1)
        c = D // 4
        g0 = _pad(h[:, :, 0 * c:1 * c], ((0, 0), (1, 0), (0, 0)))[:, :S, :]
        g1 = _pad(h[:, :, 1 * c:2 * c], ((0, 0), (0, 1), (0, 0)))[:, 1:, :]
        g2 = _pad(h[:, :, 2 * c:3 * c], ((0, 0), (2, 0), (0, 0)))[:, :S, :]
        g3 = _pad(h[:, :, 3 * c:], ((0, 0), (0, 2), (0, 0)))[:, 2:, :]
        hs = torch.concatenate([g0, g1, g2, g3], axis=-1) @ w2
        x1 = x + hs
        h2 = _gelu(_layernorm(x1, axis=-1) @ w3) @ w4
        return x1 + h2
    x = A_x
    xn = _layernorm(x, axis=-1)
    s = _A_ref(xn, A_mem0, A_Wq, A_Wk, A_Wv, A_Wo, A_seg_len)
    g = _silu(_B_ref(xn, B_w1, B_w2, B_w3, B_w4))
    return x + s * g
```

```asm
; @launch grid=(256,1,1) block=(256,1,1) lds=163840
.amdgcn_target "amdgcn-amd-amdhsa--gfx950"
.text
.globl recurrent_scan__memory_aug_recurrent_mem_tr__mixer_s_mlp__prompt_kernel
.p2align 8
.type recurrent_scan__memory_aug_recurrent_mem_tr__mixer_s_mlp__prompt_kernel,@function
recurrent_scan__memory_aug_recurrent_mem_tr__mixer_s_mlp__prompt_kernel:
    s_cmp_ge_u32 s2, 256
    s_cbranch_scc1 L_END
    s_load_dwordx16 s[36:51], s[0:1], 0
    s_load_dwordx8 s[52:59], s[0:1], 64
    s_load_dwordx4 s[60:63], s[0:1], 96
    s_load_dwordx2 s[64:65], s[0:1], 112
    s_getreg_b32 s23, hwreg(HW_REG_XCC_ID)
    v_lshrrev_b32 v1, 6, v0
    s_and_b32 s23, s23, 7
    v_readfirstlane_b32 s20, v1
    s_lshl_b32 s3, s23, 1
    s_lshr_b32 s3, 0x79e4, s3
    s_and_b32 s3, s3, 3
    s_lshl_b32 s3, s3, 6
    s_lshl_b32 s22, s23, 2
    s_add_u32 s3, s3, s22
    s_mov_b32 s24, 0x200000
    v_and_b32 v0, 63, v0
    s_waitcnt lgkmcnt(0)
    s_mov_b32 s4, s64
    s_mov_b32 s5, s65
    s_mov_b32 s6, 0x10000000
    s_mov_b32 s7, 0x00020000
    s_mov_b32 s12, s62
    s_mov_b32 s13, s63
    s_mov_b32 s14, 0x100
    s_mov_b32 s15, 0x00020000
    s_mov_b32 s8, s40
    s_mov_b32 s9, s41
    s_mov_b32 s10, 0x400000
    s_mov_b32 s11, 0x00020000
    s_mov_b32 s16, s38
    s_mov_b32 s17, s39
    s_mov_b32 s18, 0x2000
    s_mov_b32 s19, 0x00020000
    v_mov_b32 v2, 0
    s_cmp_lg_u32 s20, 0
    s_cbranch_scc1 L_TK1
    s_mov_b64 exec, 1
    v_mov_b32 v1, 1
    buffer_atomic_add v1, off, s[12:15], s3 sc0 sc1
    s_waitcnt vmcnt(0)
    ds_write_b32 v2, v1
    s_waitcnt lgkmcnt(0)
    s_mov_b64 exec, -1
L_TK1:
    s_barrier
    ds_read_b32 v1, v2
    s_waitcnt lgkmcnt(0)
    v_readfirstlane_b32 s21, v1
    s_barrier
    s_cmp_ge_u32 s21, 32
    s_cbranch_scc1 L_END
    s_cmp_eq_u32 s23, 0
    s_cbranch_scc0 L_NOTC
    s_cmp_lg_u32 s20, 0
    s_cbranch_scc1 L_CLD1
    v_lshlrev_b32 v71, 4, v0
    v_lshlrev_b32 v75, 2, v0
    v_lshrrev_b32 v1, 4, v0
    v_lshlrev_b32 v1, 1, v1
    v_bfe_u32 v2, v0, 2, 1
    v_add_u32 v1, v1, v2
    v_lshlrev_b32 v1, 10, v1
    v_bfe_u32 v2, v0, 3, 1
    v_lshl_add_u32 v1, v2, 2, v1
    v_and_b32 v2, 3, v0
    v_lshl_add_u32 v1, v2, 3, v1
    s_lshl_b32 s30, s21, 5
    buffer_load_dword v5, v1, s[16:19], s30 offen

    v_lshrrev_b32 v1, 4, v0
    v_add_u32 v2, 0, v1
    v_lshlrev_b32 v2, 13, v2
    v_lshlrev_b32 v1, 5, v1
    v_and_b32 v3, 15, v0
    v_lshlrev_b32 v3, 4, v3
    v_xor_b32 v3, v3, v1
    v_add_u32 v64, v2, v3
    v_xor_b32 v65, 128, v64
    v_xor_b32 v70, 0, v71
    v_lshrrev_b32 v2, 4, v0
    v_bfe_u32 v3, v0, 2, 2
    v_lshl_add_u32 v1, v2, 3, v3
    v_and_b32 v2, 1, v2
    v_lshl_or_b32 v2, v2, 2, v3
    v_xor_b32 v2, 0, v2
    v_lshlrev_b32 v2, 5, v2
    v_lshl_add_u32 v1, v1, 8, v2
    v_and_b32 v3, 3, v0
    v_lshl_add_u32 v66, v3, 3, v1
    v_xor_b32 v67, 32, v66
    v_lshrrev_b32 v1, 2, v0
    v_and_b32 v2, 7, v1
    v_or_b32 v2, 0, v2
    v_lshlrev_b32 v2, 5, v2
    v_lshl_add_u32 v1, v1, 10, v2
    v_lshl_add_u32 v72, v3, 3, v1
    s_lshl_b32 s83, s21, 8
    s_lshl_b32 s82, s21, 17
    s_mov_b32 s8, s46
    s_mov_b32 s9, s47
    s_mov_b32 m0, 0x14000
    s_add_u32 s31, s82, 0x10000
    v_xor_b32 v73, 0, v70
    buffer_load_dwordx4 v73, s[8:11], s31 offen nt lds
    s_mov_b32 m0, 0x14400
    s_add_u32 s31, s82, 0x10400
    v_xor_b32 v73, 32, v70
    buffer_load_dwordx4 v73, s[8:11], s31 offen nt lds
    s_mov_b32 m0, 0x14800
    s_add_u32 s31, s82, 0x14000
    v_xor_b32 v73, 64, v70
    buffer_load_dwordx4 v73, s[8:11], s31 offen nt lds
    s_mov_b32 m0, 0x14c00
    s_add_u32 s31, s82, 0x14400
    v_xor_b32 v73, 96, v70
    buffer_load_dwordx4 v73, s[8:11], s31 offen nt lds
    s_mov_b32 m0, 0x18000
    s_add_u32 s31, s82, 0x10800
    v_xor_b32 v73, 0, v70
    buffer_load_dwordx4 v73, s[8:11], s31 offen nt lds
    s_mov_b32 m0, 0x18400
    s_add_u32 s31, s82, 0x10c00
    v_xor_b32 v73, 32, v70
    buffer_load_dwordx4 v73, s[8:11], s31 offen nt lds
    s_mov_b32 m0, 0x18800
    s_add_u32 s31, s82, 0x14800
    v_xor_b32 v73, 64, v70
    buffer_load_dwordx4 v73, s[8:11], s31 offen nt lds
    s_mov_b32 m0, 0x18c00
    s_add_u32 s31, s82, 0x14c00
    v_xor_b32 v73, 96, v70
    buffer_load_dwordx4 v73, s[8:11], s31 offen nt lds
    s_mov_b32 m0, 0x1c000
    s_add_u32 s31, s82, 0x12000
    v_xor_b32 v73, 0, v70
    buffer_load_dwordx4 v73, s[8:11], s31 offen nt lds
    s_mov_b32 m0, 0x1c400
    s_add_u32 s31, s82, 0x12400
    v_xor_b32 v73, 32, v70
    buffer_load_dwordx4 v73, s[8:11], s31 offen nt lds
    s_mov_b32 m0, 0x1c800
    s_add_u32 s31, s82, 0x16000
    v_xor_b32 v73, 64, v70
    buffer_load_dwordx4 v73, s[8:11], s31 offen nt lds
    s_mov_b32 m0, 0x1cc00
    s_add_u32 s31, s82, 0x16400
    v_xor_b32 v73, 96, v70
    buffer_load_dwordx4 v73, s[8:11], s31 offen nt lds
    s_mov_b32 m0, 0x20000
    s_add_u32 s31, s82, 0x12800
    v_xor_b32 v73, 0, v70
    buffer_load_dwordx4 v73, s[8:11], s31 offen nt lds
    s_mov_b32 m0, 0x20400
    s_add_u32 s31, s82, 0x12c00
    v_xor_b32 v73, 32, v70
    buffer_load_dwordx4 v73, s[8:11], s31 offen nt lds
    s_mov_b32 m0, 0x20800
    s_add_u32 s31, s82, 0x16800
    v_xor_b32 v73, 64, v70
    buffer_load_dwordx4 v73, s[8:11], s31 offen nt lds
    s_mov_b32 m0, 0x20c00
    s_add_u32 s31, s82, 0x16c00
    v_xor_b32 v73, 96, v70
    buffer_load_dwordx4 v73, s[8:11], s31 offen nt lds
    s_mov_b32 m0, 0x24000
    s_add_u32 s31, s82, 0x0
    v_xor_b32 v73, 0, v70
    buffer_load_dwordx4 v73, s[8:11], s31 offen nt lds
    s_mov_b32 m0, 0x24400
    s_add_u32 s31, s82, 0x400
    v_xor_b32 v73, 32, v70
    buffer_load_dwordx4 v73, s[8:11], s31 offen nt lds
    s_mov_b32 m0, 0x24800
    s_add_u32 s31, s82, 0x4000
    v_xor_b32 v73, 64, v70
    buffer_load_dwordx4 v73, s[8:11], s31 offen nt lds
    s_mov_b32 m0, 0x24c00
    s_add_u32 s31, s82, 0x4400
    v_xor_b32 v73, 96, v70
    buffer_load_dwordx4 v73, s[8:11], s31 offen nt lds
    s_mov_b32 m0, 0x0
    s_add_u32 s31, s82, 0x800
    v_xor_b32 v73, 0, v70
    buffer_load_dwordx4 v73, s[8:11], s31 offen nt lds
    s_mov_b32 m0, 0x400
    s_add_u32 s31, s82, 0xc00
    v_xor_b32 v73, 32, v70
    buffer_load_dwordx4 v73, s[8:11], s31 offen nt lds
    s_mov_b32 m0, 0x800
    s_add_u32 s31, s82, 0x4800
    v_xor_b32 v73, 64, v70
    buffer_load_dwordx4 v73, s[8:11], s31 offen nt lds
    s_mov_b32 m0, 0xc00
    s_add_u32 s31, s82, 0x4c00
    v_xor_b32 v73, 96, v70
    buffer_load_dwordx4 v73, s[8:11], s31 offen nt lds
    s_mov_b32 m0, 0x8000
    s_add_u32 s31, s82, 0x2000
    v_xor_b32 v73, 0, v70
    buffer_load_dwordx4 v73, s[8:11], s31 offen nt lds
    s_mov_b32 m0, 0x8400
    s_add_u32 s31, s82, 0x2400
    v_xor_b32 v73, 32, v70
    buffer_load_dwordx4 v73, s[8:11], s31 offen nt lds
    s_mov_b32 m0, 0x8800
    s_add_u32 s31, s82, 0x6000
    v_xor_b32 v73, 64, v70
    buffer_load_dwordx4 v73, s[8:11], s31 offen nt lds
    s_mov_b32 m0, 0x8c00
    s_add_u32 s31, s82, 0x6400
    v_xor_b32 v73, 96, v70
    buffer_load_dwordx4 v73, s[8:11], s31 offen nt lds
    s_mov_b32 m0, 0xc000
    s_add_u32 s31, s82, 0x2800
    v_xor_b32 v73, 0, v70
    buffer_load_dwordx4 v73, s[8:11], s31 offen nt lds
    s_mov_b32 m0, 0xc400
    s_add_u32 s31, s82, 0x2c00
    v_xor_b32 v73, 32, v70
    buffer_load_dwordx4 v73, s[8:11], s31 offen nt lds
    s_mov_b32 m0, 0xc800
    s_add_u32 s31, s82, 0x6800
    v_xor_b32 v73, 64, v70
    buffer_load_dwordx4 v73, s[8:11], s31 offen nt lds
    s_mov_b32 m0, 0xcc00
    s_add_u32 s31, s82, 0x6c00
    v_xor_b32 v73, 96, v70
    buffer_load_dwordx4 v73, s[8:11], s31 offen nt lds
    v_mov_b32 v8, -1
    v_mov_b32 v9, -1
    v_mov_b32 v10, -1
    v_mov_b32 v11, -1
    s_lshl_b32 s30, s21, 13
    s_add_u32 s30, s30, 0x4200000
    s_add_u32 s31, s30, 0x40000
    buffer_store_dwordx4 v[8:11], v71, s[4:7], s30 offen
    buffer_store_dwordx4 v[8:11], v71, s[4:7], s30 offen offset:1024
    buffer_store_dwordx4 v[8:11], v71, s[4:7], s31 offen
    buffer_store_dwordx4 v[8:11], v71, s[4:7], s31 offen offset:1024
    v_lshrrev_b32 v14, 4, v0
    v_lshlrev_b32 v14, 13, v14
    v_and_b32 v15, 15, v0
    v_lshl_add_u32 v14, v15, 4, v14
    s_lshl_b32 s30, s21, 8
    s_add_u32 s31, s30, 0x4310000
    buffer_store_dwordx4 v[8:11], v14, s[4:7], s31 offen sc1
    s_add_u32 s31, s30, 0x4318000
    buffer_store_dwordx4 v[8:11], v14, s[4:7], s31 offen sc1
    s_add_u32 s31, s30, 0x4320000
    buffer_store_dwordx4 v[8:11], v14, s[4:7], s31 offen sc1
    s_add_u32 s31, s30, 0x4328000
    buffer_store_dwordx4 v[8:11], v14, s[4:7], s31 offen sc1
    s_lshl_b32 s30, s21, 13
    s_add_u32 s31, s30, 0x4140000
    buffer_store_dwordx4 v[8:11], v71, s[4:7], s31 offen sc1
    buffer_store_dwordx4 v[8:11], v71, s[4:7], s31 offen offset:1024 sc1
    s_add_u32 s31, s30, 0x4180000
    buffer_store_dwordx4 v[8:11], v71, s[4:7], s31 offen sc1
    buffer_store_dwordx4 v[8:11], v71, s[4:7], s31 offen offset:1024 sc1
    s_add_u32 s31, s30, 0x41c0000
    buffer_store_dwordx4 v[8:11], v71, s[4:7], s31 offen sc1
    buffer_store_dwordx4 v[8:11], v71, s[4:7], s31 offen offset:1024 sc1
    v_mov_b32 v12, 0
    v_mov_b32 v13, 0
    v_lshlrev_b32 v14, 3, v0
    v_lshlrev_b32 v15, 7, v0
    s_lshl_b32 s30, s21, 10
    s_add_u32 s30, s30, 0x5600000
    s_lshl_b32 s31, s21, 2
    s_add_u32 s31, s31, 0x5608000
    s_mov_b32 exec_hi, 0x0000ffff
    buffer_store_dwordx2 v[12:13], v14, s[4:7], s30 offen sc1
    s_mov_b32 exec_lo, -1
    s_mov_b32 exec_hi, 0
    buffer_store_dword v12, v15, s[4:7], s31 offen sc1
    s_mov_b64 exec, -1
    s_and_b32 s30, s21, 7
    s_lshl_b32 s30, s30, 5
    v_xor_b32 v76, s30, v72
    v_add_u32 v72, 0, v71
    s_waitcnt vmcnt(47)
    s_lshl_b32 s30, s21, 8
    s_add_u32 s30, s30, 0x4300000
    s_add_u32 s31, s30, 0x4000
    buffer_store_dword v5, v75, s[4:7], s31 offen
    s_add_u32 s31, s30, 0x10000
    buffer_store_dword v5, v75, s[4:7], s31 offen sc1
    s_waitcnt vmcnt(43) lgkmcnt(0)
    s_barrier
    s_mov_b32 s8, s42
    s_mov_b32 s9, s43
    s_mov_b32 m0, 0x10000
    s_add_u32 s31, s83, 0x0
    buffer_load_dwordx4 v64, s[8:11], s31 offen nt lds
    s_mov_b32 m0, 0x10400
    s_add_u32 s31, s83, 0x8000
    buffer_load_dwordx4 v64, s[8:11], s31 offen nt lds
    s_mov_b32 m0, 0x10800
    s_add_u32 s31, s83, 0x10000
    buffer_load_dwordx4 v65, s[8:11], s31 offen nt lds
    s_mov_b32 m0, 0x10c00
    s_add_u32 s31, s83, 0x18000
    buffer_load_dwordx4 v65, s[8:11], s31 offen nt lds
    v_add_u32 v68, 0x14000, v76
    v_xor_b32 v74, 0, v68
    ds_read_b64_tr_b16 v[208:209], v74
    v_xor_b32 v73, 32, v68
    ds_read_b64_tr_b16 v[216:217], v73
    v_xor_b32 v74, 64, v68
    ds_read_b64_tr_b16 v[224:225], v74
    v_xor_b32 v73, 96, v68
    ds_read_b64_tr_b16 v[232:233], v73
    v_xor_b32 v74, 128, v68
    ds_read_b64_tr_b16 v[240:241], v74
    v_xor_b32 v73, 160, v68
    ds_read_b64_tr_b16 v[248:249], v73
    v_xor_b32 v74, 192, v68
    ds_read_b64_tr_b16 v[32:33], v74
    v_xor_b32 v73, 224, v68
    ds_read_b64_tr_b16 v[40:41], v73
    s_waitcnt vmcnt(43) lgkmcnt(0)
    s_barrier
    s_mov_b32 m0, 0x14000
    s_add_u32 s31, s83, 0x80000
    buffer_load_dwordx4 v64, s[8:11], s31 offen nt lds
    s_mov_b32 m0, 0x14400
    s_add_u32 s31, s83, 0x88000
    buffer_load_dwordx4 v64, s[8:11], s31 offen nt lds
    s_mov_b32 m0, 0x14800
    s_add_u32 s31, s83, 0x90000
    buffer_load_dwordx4 v65, s[8:11], s31 offen nt lds
    s_mov_b32 m0, 0x14c00
    s_add_u32 s31, s83, 0x98000
    buffer_load_dwordx4 v65, s[8:11], s31 offen nt lds
    v_add_u32 v68, 0x18000, v76
    v_xor_b32 v74, 0, v68
    ds_read_b64_tr_b16 v[210:211], v74
    v_xor_b32 v73, 32, v68
    ds_read_b64_tr_b16 v[218:219], v73
    v_xor_b32 v74, 64, v68
    ds_read_b64_tr_b16 v[226:227], v74
    v_xor_b32 v73, 96, v68
    ds_read_b64_tr_b16 v[234:235], v73
    v_xor_b32 v74, 128, v68
    ds_read_b64_tr_b16 v[242:243], v74
    v_xor_b32 v73, 160, v68
    ds_read_b64_tr_b16 v[250:251], v73
    v_xor_b32 v74, 192, v68
    ds_read_b64_tr_b16 v[34:35], v74
    v_xor_b32 v73, 224, v68
    ds_read_b64_tr_b16 v[42:43], v73
    s_waitcnt vmcnt(43) lgkmcnt(0)
    s_barrier
    s_mov_b32 m0, 0x18000
    s_add_u32 s31, s83, 0x100000
    buffer_load_dwordx4 v64, s[8:11], s31 offen nt lds
    s_mov_b32 m0, 0x18400
    s_add_u32 s31, s83, 0x108000
    buffer_load_dwordx4 v64, s[8:11], s31 offen nt lds
    s_mov_b32 m0, 0x18800
    s_add_u32 s31, s83, 0x110000
    buffer_load_dwordx4 v65, s[8:11], s31 offen nt lds
    s_mov_b32 m0, 0x18c00
    s_add_u32 s31, s83, 0x118000
    buffer_load_dwordx4 v65, s[8:11], s31 offen nt lds
    v_add_u32 v68, 0x1c000, v76
    v_xor_b32 v74, 0, v68
    ds_read_b64_tr_b16 v[212:213], v74
    v_xor_b32 v73, 32, v68
    ds_read_b64_tr_b16 v[220:221], v73
    v_xor_b32 v74, 64, v68
    ds_read_b64_tr_b16 v[228:229], v74
    v_xor_b32 v73, 96, v68
    ds_read_b64_tr_b16 v[236:237], v73
    v_xor_b32 v74, 128, v68
    ds_read_b64_tr_b16 v[244:245], v74
    v_xor_b32 v73, 160, v68
    ds_read_b64_tr_b16 v[252:253], v73
    v_xor_b32 v74, 192, v68
    ds_read_b64_tr_b16 v[36:37], v74
    v_xor_b32 v73, 224, v68
    ds_read_b64_tr_b16 v[44:45], v73
    s_waitcnt vmcnt(43) lgkmcnt(0)
    s_barrier
    s_mov_b32 m0, 0x1c000
    s_add_u32 s31, s83, 0x180000
    buffer_load_dwordx4 v64, s[8:11], s31 offen nt lds
    s_mov_b32 m0, 0x1c400
    s_add_u32 s31, s83, 0x188000
    buffer_load_dwordx4 v64, s[8:11], s31 offen nt lds
    s_mov_b32 m0, 0x1c800
    s_add_u32 s31, s83, 0x190000
    buffer_load_dwordx4 v65, s[8:11], s31 offen nt lds
    s_mov_b32 m0, 0x1cc00
    s_add_u32 s31, s83, 0x198000
    buffer_load_dwordx4 v65, s[8:11], s31 offen nt lds
    v_add_u32 v68, 0x20000, v76
    v_xor_b32 v74, 0, v68
    ds_read_b64_tr_b16 v[214:215], v74
    v_xor_b32 v73, 32, v68
    ds_read_b64_tr_b16 v[222:223], v73
    v_xor_b32 v74, 64, v68
    ds_read_b64_tr_b16 v[230:231], v74
    v_xor_b32 v73, 96, v68
    ds_read_b64_tr_b16 v[238:239], v73
    v_xor_b32 v74, 128, v68
    ds_read_b64_tr_b16 v[246:247], v74
    v_xor_b32 v73, 160, v68
    ds_read_b64_tr_b16 v[254:255], v73
    v_xor_b32 v74, 192, v68
    ds_read_b64_tr_b16 v[38:39], v74
    v_xor_b32 v73, 224, v68
    ds_read_b64_tr_b16 v[46:47], v73
    s_waitcnt vmcnt(43) lgkmcnt(0)
    s_barrier
    s_mov_b32 m0, 0x20000
    s_add_u32 s31, s83, 0x200000
    buffer_load_dwordx4 v64, s[8:11], s31 offen nt lds
    s_mov_b32 m0, 0x20400
    s_add_u32 s31, s83, 0x208000
    buffer_load_dwordx4 v64, s[8:11], s31 offen nt lds
    s_mov_b32 m0, 0x20800
    s_add_u32 s31, s83, 0x210000
    buffer_load_dwordx4 v65, s[8:11], s31 offen nt lds
    s_mov_b32 m0, 0x20c00
    s_add_u32 s31, s83, 0x218000
    buffer_load_dwordx4 v65, s[8:11], s31 offen nt lds
    ds_write_b128 v72, v[32:35] offset:16384
    ds_write_b128 v72, v[36:39] offset:17408
    ds_write_b128 v72, v[40:43] offset:24576
    ds_write_b128 v72, v[44:47] offset:25600
    v_add_u32 v68, 0x24000, v76
    v_xor_b32 v74, 0, v68
    ds_read_b64_tr_b16 v[0:1], v74
    v_xor_b32 v73, 32, v68
    ds_read_b64_tr_b16 v[8:9], v73
    v_xor_b32 v74, 64, v68
    ds_read_b64_tr_b16 v[16:17], v74
    v_xor_b32 v73, 96, v68
    ds_read_b64_tr_b16 v[24:25], v73
    v_xor_b32 v74, 128, v68
    ds_read_b64_tr_b16 v[32:33], v74
    v_xor_b32 v73, 160, v68
    ds_read_b64_tr_b16 v[40:41], v73
    v_xor_b32 v74, 192, v68
    ds_read_b64_tr_b16 v[48:49], v74
    v_xor_b32 v73, 224, v68
    ds_read_b64_tr_b16 v[56:57], v73
    s_waitcnt vmcnt(43) lgkmcnt(0)
    s_barrier
    s_mov_b32 m0, 0x24000
    s_add_u32 s31, s83, 0x280000
    buffer_load_dwordx4 v64, s[8:11], s31 offen nt lds
    s_mov_b32 m0, 0x24400
    s_add_u32 s31, s83, 0x288000
    buffer_load_dwordx4 v64, s[8:11], s31 offen nt lds
    s_mov_b32 m0, 0x24800
    s_add_u32 s31, s83, 0x290000
    buffer_load_dwordx4 v65, s[8:11], s31 offen nt lds
    s_mov_b32 m0, 0x24c00
    s_add_u32 s31, s83, 0x298000
    buffer_load_dwordx4 v65, s[8:11], s31 offen nt lds
    v_add_u32 v68, 0x0, v76
    v_xor_b32 v74, 0, v68
    ds_read_b64_tr_b16 v[2:3], v74
    v_xor_b32 v73, 32, v68
    ds_read_b64_tr_b16 v[10:11], v73
    v_xor_b32 v74, 64, v68
    ds_read_b64_tr_b16 v[18:19], v74
    v_xor_b32 v73, 96, v68
    ds_read_b64_tr_b16 v[26:27], v73
    v_xor_b32 v74, 128, v68
    ds_read_b64_tr_b16 v[34:35], v74
    v_xor_b32 v73, 160, v68
    ds_read_b64_tr_b16 v[42:43], v73
    v_xor_b32 v74, 192, v68
    ds_read_b64_tr_b16 v[50:51], v74
    v_xor_b32 v73, 224, v68
    ds_read_b64_tr_b16 v[58:59], v73
    s_waitcnt vmcnt(43) lgkmcnt(0)
    s_barrier
    s_mov_b32 m0, 0x0
    s_add_u32 s31, s83, 0x300000
    buffer_load_dwordx4 v64, s[8:11], s31 offen nt lds
    s_mov_b32 m0, 0x400
    s_add_u32 s31, s83, 0x308000
    buffer_load_dwordx4 v64, s[8:11], s31 offen nt lds
    s_mov_b32 m0, 0x800
    s_add_u32 s31, s83, 0x310000
    buffer_load_dwordx4 v65, s[8:11], s31 offen nt lds
    s_mov_b32 m0, 0xc00
    s_add_u32 s31, s83, 0x318000
    buffer_load_dwordx4 v65, s[8:11], s31 offen nt lds
    v_add_u32 v68, 0x8000, v76
    v_xor_b32 v74, 0, v68
    ds_read_b64_tr_b16 v[4:5], v74
    v_xor_b32 v73, 32, v68
    ds_read_b64_tr_b16 v[12:13], v73
    v_xor_b32 v74, 64, v68
    ds_read_b64_tr_b16 v[20:21], v74
    v_xor_b32 v73, 96, v68
    ds_read_b64_tr_b16 v[28:29], v73
    v_xor_b32 v74, 128, v68
    ds_read_b64_tr_b16 v[36:37], v74
    v_xor_b32 v73, 160, v68
    ds_read_b64_tr_b16 v[44:45], v73
    v_xor_b32 v74, 192, v68
    ds_read_b64_tr_b16 v[52:53], v74
    v_xor_b32 v73, 224, v68
    ds_read_b64_tr_b16 v[60:61], v73
    s_waitcnt vmcnt(43) lgkmcnt(0)
    s_barrier
    s_mov_b32 m0, 0x8000
    s_add_u32 s31, s83, 0x380000
    buffer_load_dwordx4 v64, s[8:11], s31 offen nt lds
    s_mov_b32 m0, 0x8400
    s_add_u32 s31, s83, 0x388000
    buffer_load_dwordx4 v64, s[8:11], s31 offen nt lds
    s_mov_b32 m0, 0x8800
    s_add_u32 s31, s83, 0x390000
    buffer_load_dwordx4 v65, s[8:11], s31 offen nt lds
    s_mov_b32 m0, 0x8c00
    s_add_u32 s31, s83, 0x398000
    buffer_load_dwordx4 v65, s[8:11], s31 offen nt lds
    v_add_u32 v68, 0xc000, v76
    v_xor_b32 v74, 0, v68
    ds_read_b64_tr_b16 v[6:7], v74
    v_xor_b32 v73, 32, v68
    ds_read_b64_tr_b16 v[14:15], v73
    v_xor_b32 v74, 64, v68
    ds_read_b64_tr_b16 v[22:23], v74
    v_xor_b32 v73, 96, v68
    ds_read_b64_tr_b16 v[30:31], v73
    v_xor_b32 v74, 128, v68
    ds_read_b64_tr_b16 v[38:39], v74
    v_xor_b32 v73, 160, v68
    ds_read_b64_tr_b16 v[46:47], v73
    v_xor_b32 v74, 192, v68
    ds_read_b64_tr_b16 v[54:55], v74
    v_xor_b32 v73, 224, v68
    ds_read_b64_tr_b16 v[62:63], v73
    s_waitcnt vmcnt(28) lgkmcnt(0)
    s_barrier
    s_mov_b32 s8, s44
    s_mov_b32 s9, s45
    s_mov_b32 m0, 0xc000
    s_add_u32 s31, s83, 0x0
    buffer_load_dwordx4 v64, s[8:11], s31 offen nt lds
    s_mov_b32 m0, 0xc400
    s_add_u32 s31, s83, 0x8000
    buffer_load_dwordx4 v64, s[8:11], s31 offen nt lds
    s_mov_b32 m0, 0xc800
    s_add_u32 s31, s83, 0x10000
    buffer_load_dwordx4 v65, s[8:11], s31 offen nt lds
    s_mov_b32 m0, 0xcc00
    s_add_u32 s31, s83, 0x18000
    buffer_load_dwordx4 v65, s[8:11], s31 offen nt lds
    s_mov_b64 exec, 1
    v_mov_b32 v74, 1
    buffer_atomic_add v74, off, s[12:15], 0 offset:32 sc1
    s_mov_b64 exec, -1
    v_add_u32 v68, 0x10000, v66
    v_add_u32 v69, 0x10000, v67
    ds_read_b64_tr_b16 a[64:65], v68 offset:0
    ds_read_b64_tr_b16 a[66:67], v68 offset:1024
    ds_read_b64_tr_b16 a[68:69], v68 offset:8192
    ds_read_b64_tr_b16 a[70:71], v68 offset:9216
    ds_read_b64_tr_b16 a[128:129], v69 offset:0
    ds_read_b64_tr_b16 a[130:131], v69 offset:1024
    ds_read_b64_tr_b16 a[132:133], v69 offset:8192
    ds_read_b64_tr_b16 a[134:135], v69 offset:9216
    s_waitcnt vmcnt(28) lgkmcnt(0)
    s_barrier
    s_mov_b32 m0, 0x10000
    s_add_u32 s31, s83, 0x80000
    buffer_load_dwordx4 v64, s[8:11], s31 offen nt lds
    s_mov_b32 m0, 0x10400
    s_add_u32 s31, s83, 0x88000
    buffer_load_dwordx4 v64, s[8:11], s31 offen nt lds
    s_mov_b32 m0, 0x10800
    s_add_u32 s31, s83, 0x90000
    buffer_load_dwordx4 v65, s[8:11], s31 offen nt lds
    s_mov_b32 m0, 0x10c00
    s_add_u32 s31, s83, 0x98000
    buffer_load_dwordx4 v65, s[8:11], s31 offen nt lds
    v_add_u32 v68, 0x14000, v66
    v_add_u32 v69, 0x14000, v67
    ds_read_b64_tr_b16 a[72:73], v68 offset:0
    ds_read_b64_tr_b16 a[74:75], v68 offset:1024
    ds_read_b64_tr_b16 a[76:77], v68 offset:8192
    ds_read_b64_tr_b16 a[78:79], v68 offset:9216
    ds_read_b64_tr_b16 a[136:137], v69 offset:0
    ds_read_b64_tr_b16 a[138:139], v69 offset:1024
    ds_read_b64_tr_b16 a[140:141], v69 offset:8192
    ds_read_b64_tr_b16 a[142:143], v69 offset:9216
    s_waitcnt vmcnt(28) lgkmcnt(0)
    s_barrier
    s_mov_b32 m0, 0x14000
    s_add_u32 s31, s83, 0x100000
    buffer_load_dwordx4 v64, s[8:11], s31 offen nt lds
    s_mov_b32 m0, 0x14400
    s_add_u32 s31, s83, 0x108000
    buffer_load_dwordx4 v64, s[8:11], s31 offen nt lds
    s_mov_b32 m0, 0x14800
    s_add_u32 s31, s83, 0x110000
    buffer_load_dwordx4 v65, s[8:11], s31 offen nt lds
    s_mov_b32 m0, 0x14c00
    s_add_u32 s31, s83, 0x118000
    buffer_load_dwordx4 v65, s[8:11], s31 offen nt lds
    v_add_u32 v68, 0x18000, v66
    v_add_u32 v69, 0x18000, v67
    ds_read_b64_tr_b16 a[80:81], v68 offset:0
    ds_read_b64_tr_b16 a[82:83], v68 offset:1024
    ds_read_b64_tr_b16 a[84:85], v68 offset:8192
    ds_read_b64_tr_b16 a[86:87], v68 offset:9216
    ds_read_b64_tr_b16 a[144:145], v69 offset:0
    ds_read_b64_tr_b16 a[146:147], v69 offset:1024
    ds_read_b64_tr_b16 a[148:149], v69 offset:8192
    ds_read_b64_tr_b16 a[150:151], v69 offset:9216
    s_waitcnt vmcnt(28) lgkmcnt(0)
    s_barrier
    s_mov_b32 m0, 0x18000
    s_add_u32 s31, s83, 0x180000
    buffer_load_dwordx4 v64, s[8:11], s31 offen nt lds
    s_mov_b32 m0, 0x18400
    s_add_u32 s31, s83, 0x188000
    buffer_load_dwordx4 v64, s[8:11], s31 offen nt lds
    s_mov_b32 m0, 0x18800
    s_add_u32 s31, s83, 0x190000
    buffer_load_dwordx4 v65, s[8:11], s31 offen nt lds
    s_mov_b32 m0, 0x18c00
    s_add_u32 s31, s83, 0x198000
    buffer_load_dwordx4 v65, s[8:11], s31 offen nt lds
    v_add_u32 v68, 0x1c000, v66
    v_add_u32 v69, 0x1c000, v67
    ds_read_b64_tr_b16 a[88:89], v68 offset:0
    ds_read_b64_tr_b16 a[90:91], v68 offset:1024
    ds_read_b64_tr_b16 a[92:93], v68 offset:8192
    ds_read_b64_tr_b16 a[94:95], v68 offset:9216
    ds_read_b64_tr_b16 a[152:153], v69 offset:0
    ds_read_b64_tr_b16 a[154:155], v69 offset:1024
    ds_read_b64_tr_b16 a[156:157], v69 offset:8192
    ds_read_b64_tr_b16 a[158:159], v69 offset:9216
    s_waitcnt vmcnt(28) lgkmcnt(0)
    s_barrier
    s_mov_b32 m0, 0x1c000
    s_add_u32 s31, s83, 0x200000
    buffer_load_dwordx4 v64, s[8:11], s31 offen nt lds
    s_mov_b32 m0, 0x1c400
    s_add_u32 s31, s83, 0x208000
    buffer_load_dwordx4 v64, s[8:11], s31 offen nt lds
    s_mov_b32 m0, 0x1c800
    s_add_u32 s31, s83, 0x210000
    buffer_load_dwordx4 v65, s[8:11], s31 offen nt lds
    s_mov_b32 m0, 0x1cc00
    s_add_u32 s31, s83, 0x218000
    buffer_load_dwordx4 v65, s[8:11], s31 offen nt lds
    s_mov_b64 exec, 1
    v_mov_b32 v74, 1
    buffer_atomic_add v74, off, s[12:15], 0 offset:36 sc1
    s_mov_b64 exec, -1
    v_add_u32 v68, 0x20000, v66
    v_add_u32 v69, 0x20000, v67
    ds_read_b64_tr_b16 a[96:97], v68 offset:0
    ds_read_b64_tr_b16 a[98:99], v68 offset:1024
    ds_read_b64_tr_b16 a[100:101], v68 offset:8192
    ds_read_b64_tr_b16 a[102:103], v68 offset:9216
    ds_read_b64_tr_b16 a[160:161], v69 offset:0
    ds_read_b64_tr_b16 a[162:163], v69 offset:1024
    ds_read_b64_tr_b16 a[164:165], v69 offset:8192
    ds_read_b64_tr_b16 a[166:167], v69 offset:9216
    s_waitcnt vmcnt(28) lgkmcnt(0)
    s_barrier
    s_mov_b32 m0, 0x20000
    s_add_u32 s31, s83, 0x280000
    buffer_load_dwordx4 v64, s[8:11], s31 offen nt lds
    s_mov_b32 m0, 0x20400
    s_add_u32 s31, s83, 0x288000
    buffer_load_dwordx4 v64, s[8:11], s31 offen nt lds
    s_mov_b32 m0, 0x20800
    s_add_u32 s31, s83, 0x290000
    buffer_load_dwordx4 v65, s[8:11], s31 offen nt lds
    s_mov_b32 m0, 0x20c00
    s_add_u32 s31, s83, 0x298000
    buffer_load_dwordx4 v65, s[8:11], s31 offen nt lds
    v_add_u32 v68, 0x24000, v66
    v_add_u32 v69, 0x24000, v67
    ds_read_b64_tr_b16 a[104:105], v68 offset:0
    ds_read_b64_tr_b16 a[106:107], v68 offset:1024
    ds_read_b64_tr_b16 a[108:109], v68 offset:8192
    ds_read_b64_tr_b16 a[110:111], v68 offset:9216
    ds_read_b64_tr_b16 a[168:169], v69 offset:0
    ds_read_b64_tr_b16 a[170:171], v69 offset:1024
    ds_read_b64_tr_b16 a[172:173], v69 offset:8192
    ds_read_b64_tr_b16 a[174:175], v69 offset:9216
    s_waitcnt vmcnt(28) lgkmcnt(0)
    s_barrier
    s_mov_b32 m0, 0x24000
    s_add_u32 s31, s83, 0x300000
    buffer_load_dwordx4 v64, s[8:11], s31 offen nt lds
    s_mov_b32 m0, 0x24400
    s_add_u32 s31, s83, 0x308000
    buffer_load_dwordx4 v64, s[8:11], s31 offen nt lds
    s_mov_b32 m0, 0x24800
    s_add_u32 s31, s83, 0x310000
    buffer_load_dwordx4 v65, s[8:11], s31 offen nt lds
    s_mov_b32 m0, 0x24c00
    s_add_u32 s31, s83, 0x318000
    buffer_load_dwordx4 v65, s[8:11], s31 offen nt lds
    v_add_u32 v68, 0x0, v66
    v_add_u32 v69, 0x0, v67
    ds_read_b64_tr_b16 a[112:113], v68 offset:0
    ds_read_b64_tr_b16 a[114:115], v68 offset:1024
    ds_read_b64_tr_b16 a[116:117], v68 offset:8192
    ds_read_b64_tr_b16 a[118:119], v68 offset:9216
    ds_read_b64_tr_b16 a[176:177], v69 offset:0
    ds_read_b64_tr_b16 a[178:179], v69 offset:1024
    ds_read_b64_tr_b16 a[180:181], v69 offset:8192
    ds_read_b64_tr_b16 a[182:183], v69 offset:9216
    s_waitcnt vmcnt(28) lgkmcnt(0)
    s_barrier
    s_mov_b32 m0, 0x0
    s_add_u32 s31, s83, 0x380000
    buffer_load_dwordx4 v64, s[8:11], s31 offen nt lds
    s_mov_b32 m0, 0x400
    s_add_u32 s31, s83, 0x388000
    buffer_load_dwordx4 v64, s[8:11], s31 offen nt lds
    s_mov_b32 m0, 0x800
    s_add_u32 s31, s83, 0x390000
    buffer_load_dwordx4 v65, s[8:11], s31 offen nt lds
    s_mov_b32 m0, 0xc00
    s_add_u32 s31, s83, 0x398000
    buffer_load_dwordx4 v65, s[8:11], s31 offen nt lds
    v_add_u32 v68, 0x8000, v66
    v_add_u32 v69, 0x8000, v67
    ds_read_b64_tr_b16 a[120:121], v68 offset:0
    ds_read_b64_tr_b16 a[122:123], v68 offset:1024
    ds_read_b64_tr_b16 a[124:125], v68 offset:8192
    ds_read_b64_tr_b16 a[126:127], v68 offset:9216
    ds_read_b64_tr_b16 a[184:185], v69 offset:0
    ds_read_b64_tr_b16 a[186:187], v69 offset:1024
    ds_read_b64_tr_b16 a[188:189], v69 offset:8192
    ds_read_b64_tr_b16 a[190:191], v69 offset:9216
    s_waitcnt vmcnt(28) lgkmcnt(0)
    s_barrier
    s_mov_b32 s8, s40
    s_mov_b32 s9, s41
    s_mov_b32 m0, 0x8000
    s_add_u32 s31, s83, 0x0
    buffer_load_dwordx4 v64, s[8:11], s31 offen nt lds
    s_mov_b32 m0, 0x8400
    s_add_u32 s31, s83, 0x8000
    buffer_load_dwordx4 v64, s[8:11], s31 offen nt lds
    s_mov_b32 m0, 0x8800
    s_add_u32 s31, s83, 0x10000
    buffer_load_dwordx4 v65, s[8:11], s31 offen nt lds
    s_mov_b32 m0, 0x8c00
    s_add_u32 s31, s83, 0x18000
    buffer_load_dwordx4 v65, s[8:11], s31 offen nt lds
    v_add_u32 v68, 0xc000, v66
    v_add_u32 v69, 0xc000, v67
    ds_read_b64_tr_b16 a[192:193], v68 offset:0
    ds_read_b64_tr_b16 a[194:195], v68 offset:1024
    ds_read_b64_tr_b16 a[196:197], v68 offset:8192
    ds_read_b64_tr_b16 a[198:199], v68 offset:9216
    ds_read_b64_tr_b16 v[144:145], v69 offset:0
    ds_read_b64_tr_b16 v[146:147], v69 offset:1024
    ds_read_b64_tr_b16 v[148:149], v69 offset:8192
    ds_read_b64_tr_b16 v[150:151], v69 offset:9216
    s_waitcnt vmcnt(28) lgkmcnt(0)
    s_barrier
    s_mov_b32 m0, 0xc000
    s_add_u32 s31, s83, 0x80000
    buffer_load_dwordx4 v64, s[8:11], s31 offen nt lds
    s_mov_b32 m0, 0xc400
    s_add_u32 s31, s83, 0x88000
    buffer_load_dwordx4 v64, s[8:11], s31 offen nt lds
    s_mov_b32 m0, 0xc800
    s_add_u32 s31, s83, 0x90000
    buffer_load_dwordx4 v65, s[8:11], s31 offen nt lds
    s_mov_b32 m0, 0xcc00
    s_add_u32 s31, s83, 0x98000
    buffer_load_dwordx4 v65, s[8:11], s31 offen nt lds
    v_add_u32 v68, 0x10000, v66
    v_add_u32 v69, 0x10000, v67
    ds_read_b64_tr_b16 a[200:201], v68 offset:0
    ds_read_b64_tr_b16 a[202:203], v68 offset:1024
    ds_read_b64_tr_b16 a[204:205], v68 offset:8192
    ds_read_b64_tr_b16 a[206:207], v68 offset:9216
    ds_read_b64_tr_b16 v[152:153], v69 offset:0
    ds_read_b64_tr_b16 v[154:155], v69 offset:1024
    ds_read_b64_tr_b16 v[156:157], v69 offset:8192
    ds_read_b64_tr_b16 v[158:159], v69 offset:9216
    s_waitcnt vmcnt(28) lgkmcnt(0)
    s_barrier
    s_mov_b32 m0, 0x10000
    s_add_u32 s31, s83, 0x100000
    buffer_load_dwordx4 v64, s[8:11], s31 offen nt lds
    s_mov_b32 m0, 0x10400
    s_add_u32 s31, s83, 0x108000
    buffer_load_dwordx4 v64, s[8:11], s31 offen nt lds
    s_mov_b32 m0, 0x10800
    s_add_u32 s31, s83, 0x110000
    buffer_load_dwordx4 v65, s[8:11], s31 offen nt lds
    s_mov_b32 m0, 0x10c00
    s_add_u32 s31, s83, 0x118000
    buffer_load_dwordx4 v65, s[8:11], s31 offen nt lds
    v_add_u32 v68, 0x14000, v66
    v_add_u32 v69, 0x14000, v67
    ds_read_b64_tr_b16 a[208:209], v68 offset:0
    ds_read_b64_tr_b16 a[210:211], v68 offset:1024
    ds_read_b64_tr_b16 a[212:213], v68 offset:8192
    ds_read_b64_tr_b16 a[214:215], v68 offset:9216
    ds_read_b64_tr_b16 v[160:161], v69 offset:0
    ds_read_b64_tr_b16 v[162:163], v69 offset:1024
    ds_read_b64_tr_b16 v[164:165], v69 offset:8192
    ds_read_b64_tr_b16 v[166:167], v69 offset:9216
    s_waitcnt vmcnt(28) lgkmcnt(0)
    s_barrier
    s_mov_b32 m0, 0x14000
    s_add_u32 s31, s83, 0x180000
    buffer_load_dwordx4 v64, s[8:11], s31 offen nt lds
    s_mov_b32 m0, 0x14400
    s_add_u32 s31, s83, 0x188000
    buffer_load_dwordx4 v64, s[8:11], s31 offen nt lds
    s_mov_b32 m0, 0x14800
    s_add_u32 s31, s83, 0x190000
    buffer_load_dwordx4 v65, s[8:11], s31 offen nt lds
    s_mov_b32 m0, 0x14c00
    s_add_u32 s31, s83, 0x198000
    buffer_load_dwordx4 v65, s[8:11], s31 offen nt lds
    v_add_u32 v68, 0x18000, v66
    v_add_u32 v69, 0x18000, v67
    ds_read_b64_tr_b16 a[216:217], v68 offset:0
    ds_read_b64_tr_b16 a[218:219], v68 offset:1024
    ds_read_b64_tr_b16 a[220:221], v68 offset:8192
    ds_read_b64_tr_b16 a[222:223], v68 offset:9216
    ds_read_b64_tr_b16 v[168:169], v69 offset:0
    ds_read_b64_tr_b16 v[170:171], v69 offset:1024
    ds_read_b64_tr_b16 v[172:173], v69 offset:8192
    ds_read_b64_tr_b16 v[174:175], v69 offset:9216
    s_waitcnt vmcnt(28) lgkmcnt(0)
    s_barrier
    s_mov_b32 m0, 0x18000
    s_add_u32 s31, s83, 0x200000
    buffer_load_dwordx4 v64, s[8:11], s31 offen nt lds
    s_mov_b32 m0, 0x18400
    s_add_u32 s31, s83, 0x208000
    buffer_load_dwordx4 v64, s[8:11], s31 offen nt lds
    s_mov_b32 m0, 0x18800
    s_add_u32 s31, s83, 0x210000
    buffer_load_dwordx4 v65, s[8:11], s31 offen nt lds
    s_mov_b32 m0, 0x18c00
    s_add_u32 s31, s83, 0x218000
    buffer_load_dwordx4 v65, s[8:11], s31 offen nt lds
    v_add_u32 v68, 0x1c000, v66
    v_add_u32 v69, 0x1c000, v67
    ds_read_b64_tr_b16 a[224:225], v68 offset:0
    ds_read_b64_tr_b16 a[226:227], v68 offset:1024
    ds_read_b64_tr_b16 a[228:229], v68 offset:8192
    ds_read_b64_tr_b16 a[230:231], v68 offset:9216
    ds_read_b64_tr_b16 v[176:177], v69 offset:0
    ds_read_b64_tr_b16 v[178:179], v69 offset:1024
    ds_read_b64_tr_b16 v[180:181], v69 offset:8192
    ds_read_b64_tr_b16 v[182:183], v69 offset:9216
    s_waitcnt vmcnt(28) lgkmcnt(0)
    s_barrier
    s_mov_b32 m0, 0x1c000
    s_add_u32 s31, s83, 0x280000
    buffer_load_dwordx4 v64, s[8:11], s31 offen nt lds
    s_mov_b32 m0, 0x1c400
    s_add_u32 s31, s83, 0x288000
    buffer_load_dwordx4 v64, s[8:11], s31 offen nt lds
    s_mov_b32 m0, 0x1c800
    s_add_u32 s31, s83, 0x290000
    buffer_load_dwordx4 v65, s[8:11], s31 offen nt lds
    s_mov_b32 m0, 0x1cc00
    s_add_u32 s31, s83, 0x298000
    buffer_load_dwordx4 v65, s[8:11], s31 offen nt lds
    v_add_u32 v68, 0x20000, v66
    v_add_u32 v69, 0x20000, v67
    ds_read_b64_tr_b16 a[232:233], v68 offset:0
    ds_read_b64_tr_b16 a[234:235], v68 offset:1024
    ds_read_b64_tr_b16 a[236:237], v68 offset:8192
    ds_read_b64_tr_b16 a[238:239], v68 offset:9216
    ds_read_b64_tr_b16 v[184:185], v69 offset:0
    ds_read_b64_tr_b16 v[186:187], v69 offset:1024
    ds_read_b64_tr_b16 v[188:189], v69 offset:8192
    ds_read_b64_tr_b16 v[190:191], v69 offset:9216
    s_waitcnt vmcnt(28) lgkmcnt(0)
    s_barrier
    s_mov_b32 m0, 0x20000
    s_add_u32 s31, s83, 0x300000
    buffer_load_dwordx4 v64, s[8:11], s31 offen nt lds
    s_mov_b32 m0, 0x20400
    s_add_u32 s31, s83, 0x308000
    buffer_load_dwordx4 v64, s[8:11], s31 offen nt lds
    s_mov_b32 m0, 0x20800
    s_add_u32 s31, s83, 0x310000
    buffer_load_dwordx4 v65, s[8:11], s31 offen nt lds
    s_mov_b32 m0, 0x20c00
    s_add_u32 s31, s83, 0x318000
    buffer_load_dwordx4 v65, s[8:11], s31 offen nt lds
    v_add_u32 v68, 0x24000, v66
    v_add_u32 v69, 0x24000, v67
    ds_read_b64_tr_b16 a[240:241], v68 offset:0
    ds_read_b64_tr_b16 a[242:243], v68 offset:1024
    ds_read_b64_tr_b16 a[244:245], v68 offset:8192
    ds_read_b64_tr_b16 a[246:247], v68 offset:9216
    ds_read_b64_tr_b16 v[192:193], v69 offset:0
    ds_read_b64_tr_b16 v[194:195], v69 offset:1024
    ds_read_b64_tr_b16 v[196:197], v69 offset:8192
    ds_read_b64_tr_b16 v[198:199], v69 offset:9216
    s_waitcnt vmcnt(28) lgkmcnt(0)
    s_barrier
    s_mov_b32 m0, 0x24000
    s_add_u32 s31, s83, 0x380000
    buffer_load_dwordx4 v64, s[8:11], s31 offen nt lds
    s_mov_b32 m0, 0x24400
    s_add_u32 s31, s83, 0x388000
    buffer_load_dwordx4 v64, s[8:11], s31 offen nt lds
    s_mov_b32 m0, 0x24800
    s_add_u32 s31, s83, 0x390000
    buffer_load_dwordx4 v65, s[8:11], s31 offen nt lds
    s_mov_b32 m0, 0x24c00
    s_add_u32 s31, s83, 0x398000
    buffer_load_dwordx4 v65, s[8:11], s31 offen nt lds
    v_add_u32 v68, 0x0, v66
    v_add_u32 v69, 0x0, v67
    ds_read_b64_tr_b16 a[248:249], v68 offset:0
    ds_read_b64_tr_b16 a[250:251], v68 offset:1024
    ds_read_b64_tr_b16 a[252:253], v68 offset:8192
    ds_read_b64_tr_b16 a[254:255], v68 offset:9216
    ds_read_b64_tr_b16 v[200:201], v69 offset:0
    ds_read_b64_tr_b16 v[202:203], v69 offset:1024
    ds_read_b64_tr_b16 v[204:205], v69 offset:8192
    ds_read_b64_tr_b16 v[206:207], v69 offset:9216
    s_waitcnt vmcnt(28) lgkmcnt(0)
    s_barrier
    v_add_u32 v64, 0x8000, v66
    v_add_u32 v65, 0x8000, v67
    ds_read_b64_tr_b16 v[80:81], v64 offset:0
    ds_read_b64_tr_b16 v[82:83], v64 offset:1024
    ds_read_b64_tr_b16 v[84:85], v64 offset:8192
    ds_read_b64_tr_b16 v[86:87], v64 offset:9216
    ds_read_b64_tr_b16 a[0:1], v65 offset:0
    ds_read_b64_tr_b16 a[2:3], v65 offset:1024
    ds_read_b64_tr_b16 a[4:5], v65 offset:8192
    ds_read_b64_tr_b16 a[6:7], v65 offset:9216
    s_waitcnt vmcnt(24) lgkmcnt(0)
    s_barrier
    v_add_u32 v64, 0xc000, v66
    v_add_u32 v65, 0xc000, v67
    ds_read_b64_tr_b16 v[88:89], v64 offset:0
    ds_read_b64_tr_b16 v[90:91], v64 offset:1024
    ds_read_b64_tr_b16 v[92:93], v64 offset:8192
    ds_read_b64_tr_b16 v[94:95], v64 offset:9216
    ds_read_b64_tr_b16 a[8:9], v65 offset:0
    ds_read_b64_tr_b16 a[10:11], v65 offset:1024
    ds_read_b64_tr_b16 a[12:13], v65 offset:8192
    ds_read_b64_tr_b16 a[14:15], v65 offset:9216
    s_waitcnt vmcnt(20) lgkmcnt(0)
    s_barrier
    v_add_u32 v64, 0x10000, v66
    v_add_u32 v65, 0x10000, v67
    ds_read_b64_tr_b16 v[96:97], v64 offset:0
    ds_read_b64_tr_b16 v[98:99], v64 offset:1024
    ds_read_b64_tr_b16 v[100:101], v64 offset:8192
    ds_read_b64_tr_b16 v[102:103], v64 offset:9216
    ds_read_b64_tr_b16 a[16:17], v65 offset:0
    ds_read_b64_tr_b16 a[18:19], v65 offset:1024
    ds_read_b64_tr_b16 a[20:21], v65 offset:8192
    ds_read_b64_tr_b16 a[22:23], v65 offset:9216
    s_waitcnt vmcnt(16) lgkmcnt(0)
    s_barrier
    v_add_u32 v64, 0x14000, v66
    v_add_u32 v65, 0x14000, v67
    ds_read_b64_tr_b16 v[104:105], v64 offset:0
    ds_read_b64_tr_b16 v[106:107], v64 offset:1024
    ds_read_b64_tr_b16 v[108:109], v64 offset:8192
    ds_read_b64_tr_b16 v[110:111], v64 offset:9216
    ds_read_b64_tr_b16 a[24:25], v65 offset:0
    ds_read_b64_tr_b16 a[26:27], v65 offset:1024
    ds_read_b64_tr_b16 a[28:29], v65 offset:8192
    ds_read_b64_tr_b16 a[30:31], v65 offset:9216
    s_waitcnt vmcnt(12) lgkmcnt(0)
    s_barrier
    v_add_u32 v65, 0x10000, v72
    ds_write_b128 v72, v[0:3] offset:32768
    ds_write_b128 v72, v[4:7] offset:33792
    ds_write_b128 v72, v[8:11] offset:40960
    ds_write_b128 v72, v[12:15] offset:41984
    ds_write_b128 v72, v[16:19] offset:49152
    ds_write_b128 v72, v[20:23] offset:50176
    ds_write_b128 v72, v[24:27] offset:57344
    ds_write_b128 v72, v[28:31] offset:58368
    ds_write_b128 v65, v[32:35] offset:0
    ds_write_b128 v65, v[36:39] offset:1024
    ds_write_b128 v65, v[40:43] offset:8192
    ds_write_b128 v65, v[44:47] offset:9216
    ds_write_b128 v65, v[48:51] offset:16384
    ds_write_b128 v65, v[52:55] offset:17408
    ds_write_b128 v65, v[56:59] offset:24576
    ds_write_b128 v65, v[60:63] offset:25600
    v_lshrrev_b32 v0, 4, v71
    v_and_b32 v1, 8, v0
    v_cmp_ne_u32 s[66:67], 0, v1
    v_and_b32 v1, 2, v0
    v_cmp_ne_u32 vcc, 0, v1
    v_mov_b32 v2, 0x4444
    v_mov_b32 v3, 0xeeee
    v_cndmask_b32 v70, v2, v3, vcc
    v_and_b32 v1, 11, v0
    v_cmp_eq_u32 s[70:71], 0, v1
    v_cmp_eq_u32 s[72:73], 1, v1
    v_cmp_eq_u32 s[74:75], 8, v1
    v_cmp_eq_u32 s[76:77], 9, v1
    v_and_b32 v3, 1, v0
    v_lshlrev_b32 v3, 4, v3
    v_mov_b32 v4, 0x3f80
    v_lshlrev_b32 v4, v3, v4
    v_lshrrev_b32 v5, 4, v0
    v_bfe_u32 v1, v0, 1, 2
    v_cmp_eq_u32 vcc, v1, v5
    s_nop 1
    v_cndmask_b32 v68, 0, v4, vcc
    v_cndmask_b32 v69, 0, v4, vcc
    v_bfe_u32 v1, v0, 2, 2
    v_cmp_eq_u32 vcc, v1, v5
    s_nop 1
    v_cndmask_b32 v76, 0, v4, vcc
    v_cndmask_b32 v77, 0, v4, vcc
    v_and_b32 v1, 0x31, v0
    v_bfe_u32 v2, v0, 1, 2
    v_lshl_or_b32 v1, v2, 2, v1
    v_bfe_u32 v2, v0, 3, 1
    v_lshl_or_b32 v1, v2, 1, v1
    v_lshlrev_b32 v1, 4, v1
    s_lshr_b32 s30, s20, 1
    s_lshl_b32 s30, s30, 11
    s_and_b32 s31, s20, 1
    s_lshl_b32 s31, s31, 3
    s_add_u32 s30, s30, s31
    v_add_u32 v78, s30, v1
    s_mov_b32 s35, 0x3e0293ee
    s_lshl_b32 s30, s21, 14
    s_lshl_b32 s31, s20, 12
    s_add_u32 s28, s30, s31
    s_add_u32 s28, s28, 0x1200000
    s_lshr_b32 s30, s30, 1
    s_lshr_b32 s31, s31, 1
    s_add_u32 s29, s30, s31
    s_add_u32 s29, s29, 0x3200000
    s_add_u32 s27, s30, s31
    s_add_u32 s27, s27, 0x4200000
    s_add_u32 s25, s31, 0x4300000
    s_lshl_b32 s30, s21, 10
    s_lshl_b32 s31, s20, 2
    s_add_u32 s82, s30, s31
    s_add_u32 s81, s82, 0x5600080
    s_lshl_b32 s30, s21, 6
    s_lshl_b32 s31, s20, 16
    s_add_u32 s26, s30, s31
    s_add_u32 s26, s26, 0x4200000
    s_add_u32 s80, s82, 0x5600100
    s_lshl_b32 s30, s21, 8
    s_lshl_b32 s31, s20, 6
    s_add_u32 s30, s30, s31
    s_add_u32 s79, s30, 0x4300000
    s_mov_b32 s68, 0x000f000f
    s_mov_b32 s69, 0x000f000f
    s_lshl_b32 s83, s20, 2
    s_mov_b32 s78, 0
    s_mov_b32 s34, 0
    s_mov_b32 s22, 0
    s_and_b32 s30, s21, 7
    s_lshl_b32 s30, s30, 13
    s_add_u32 s26, s26, s30
    s_and_b32 s52, s21, 7
    s_lshl_b32 s52, s52, 6
    s_add_u32 s29, s79, 0x10000
    s_mov_b32 s32, 1
    s_mov_b32 s33, 1
    buffer_load_dword v6, off, s[12:15], 0 offset:36 sc1
    buffer_load_dword v7, off, s[4:7], s81 sc1
    buffer_load_dword v79, off, s[4:7], s81 offset:16 sc1
    s_lshl_b32 s30, s21, 13
    s_add_u32 s30, s30, 0x4200000
    v_lshlrev_b32 v12, 3, v71
    buffer_load_dword v12, v12, s[4:7], s30 offen sc1
    v_mov_b64 v[32:33], 0
    v_mov_b64 v[34:35], 0
    v_mov_b64 v[36:37], 0
    v_mov_b64 v[38:39], 0
    v_mov_b64 v[40:41], 0
    v_mov_b64 v[42:43], 0
    v_mov_b64 v[44:45], 0
    v_mov_b64 v[46:47], 0
    v_mov_b64 v[48:49], 0
    v_mov_b64 v[50:51], 0
    v_mov_b64 v[52:53], 0
    v_mov_b64 v[54:55], 0
    v_add_u32 v73, 2048, v71
    v_add_u32 v74, 4096, v71
    v_add_u32 v75, 6144, v71
    v_add_u32 v64, 0x18000, v66
    v_add_u32 v65, 0x18000, v67
    ds_read_b64_tr_b16 v[112:113], v64 offset:0
    ds_read_b64_tr_b16 v[114:115], v64 offset:1024
    ds_read_b64_tr_b16 v[116:117], v64 offset:8192
    ds_read_b64_tr_b16 v[118:119], v64 offset:9216
    ds_read_b64_tr_b16 a[32:33], v65 offset:0
    ds_read_b64_tr_b16 a[34:35], v65 offset:1024
    ds_read_b64_tr_b16 a[36:37], v65 offset:8192
    ds_read_b64_tr_b16 a[38:39], v65 offset:9216
    s_waitcnt vmcnt(8) lgkmcnt(0)
    s_barrier
    v_add_u32 v64, 0x1c000, v66
    v_add_u32 v65, 0x1c000, v67
    ds_read_b64_tr_b16 v[120:121], v64 offset:0
    ds_read_b64_tr_b16 v[122:123], v64 offset:1024
    ds_read_b64_tr_b16 v[124:125], v64 offset:8192
    ds_read_b64_tr_b16 v[126:127], v64 offset:9216
    ds_read_b64_tr_b16 a[40:41], v65 offset:0
    ds_read_b64_tr_b16 a[42:43], v65 offset:1024
    ds_read_b64_tr_b16 a[44:45], v65 offset:8192
    ds_read_b64_tr_b16 a[46:47], v65 offset:9216
    s_waitcnt vmcnt(4) lgkmcnt(0)
    s_barrier
    v_add_u32 v64, 0x20000, v66
    v_add_u32 v65, 0x20000, v67
    ds_read_b64_tr_b16 v[128:129], v64 offset:0
    ds_read_b64_tr_b16 v[130:131], v64 offset:1024
    ds_read_b64_tr_b16 v[132:133], v64 offset:8192
    ds_read_b64_tr_b16 v[134:135], v64 offset:9216
    ds_read_b64_tr_b16 a[48:49], v65 offset:0
    ds_read_b64_tr_b16 a[50:51], v65 offset:1024
    ds_read_b64_tr_b16 a[52:53], v65 offset:8192
    ds_read_b64_tr_b16 a[54:55], v65 offset:9216
    s_waitcnt vmcnt(0) lgkmcnt(0)
    s_barrier
    v_add_u32 v64, 0x24000, v66
    v_add_u32 v65, 0x24000, v67
    ds_read_b64_tr_b16 v[136:137], v64 offset:0
    ds_read_b64_tr_b16 v[138:139], v64 offset:1024
    ds_read_b64_tr_b16 v[140:141], v64 offset:8192
    ds_read_b64_tr_b16 v[142:143], v64 offset:9216
    ds_read_b64_tr_b16 a[56:57], v65 offset:0
    ds_read_b64_tr_b16 a[58:59], v65 offset:1024
    ds_read_b64_tr_b16 a[60:61], v65 offset:8192
    ds_read_b64_tr_b16 a[62:63], v65 offset:9216
    s_waitcnt vmcnt(0) lgkmcnt(0)
    s_barrier
    s_branch L_CLDONE
L_CLD1:
    s_cmp_lg_u32 s20, 1
    s_cbranch_scc1 L_CLD2
    v_lshlrev_b32 v71, 4, v0
    v_lshlrev_b32 v75, 2, v0
    v_lshrrev_b32 v1, 4, v0
    v_lshlrev_b32 v1, 1, v1
    v_bfe_u32 v2, v0, 2, 1
    v_add_u32 v1, v1, v2
    v_lshlrev_b32 v1, 10, v1
    v_bfe_u32 v2, v0, 3, 1
    v_lshl_add_u32 v1, v2, 2, v1
    v_and_b32 v2, 3, v0
    v_lshl_add_u32 v1, v2, 3, v1
    s_lshl_b32 s30, s21, 5
    buffer_load_dword v5, v1, s[16:19], s30 offen

    v_lshrrev_b32 v1, 4, v0
    v_add_u32 v2, 16, v1
    v_lshlrev_b32 v2, 13, v2
    v_lshlrev_b32 v1, 5, v1
    v_and_b32 v3, 15, v0
    v_lshlrev_b32 v3, 4, v3
    v_xor_b32 v3, v3, v1
    v_add_u32 v64, v2, v3
    v_xor_b32 v65, 128, v64
    v_xor_b32 v70, 128, v71
    v_lshrrev_b32 v2, 4, v0
    v_bfe_u32 v3, v0, 2, 2
    v_lshl_add_u32 v1, v2, 3, v3
    v_and_b32 v2, 1, v2
    v_lshl_or_b32 v2, v2, 2, v3
    v_xor_b32 v2, 2, v2
    v_lshlrev_b32 v2, 5, v2
    v_lshl_add_u32 v1, v1, 8, v2
    v_and_b32 v3, 3, v0
    v_lshl_add_u32 v66, v3, 3, v1
    v_xor_b32 v67, 32, v66
    v_lshrrev_b32 v1, 2, v0
    v_and_b32 v2, 7, v1
    v_or_b32 v2, 8, v2
    v_lshlrev_b32 v2, 5, v2
    v_lshl_add_u32 v1, v1, 10, v2
    v_lshl_add_u32 v72, v3, 3, v1
    s_lshl_b32 s83, s21, 8
    s_lshl_b32 s82, s21, 17
    s_mov_b32 s8, s46
    s_mov_b32 s9, s47
    s_mov_b32 m0, 0x15000
    s_add_u32 s31, s82, 0x18000
    v_xor_b32 v73, 0, v70
    buffer_load_dwordx4 v73, s[8:11], s31 offen nt lds
    s_mov_b32 m0, 0x15400
    s_add_u32 s31, s82, 0x18400
    v_xor_b32 v73, 32, v70
    buffer_load_dwordx4 v73, s[8:11], s31 offen nt lds
    s_mov_b32 m0, 0x15800
    s_add_u32 s31, s82, 0x1c000
    v_xor_b32 v73, 64, v70
    buffer_load_dwordx4 v73, s[8:11], s31 offen nt lds
    s_mov_b32 m0, 0x15c00
    s_add_u32 s31, s82, 0x1c400
    v_xor_b32 v73, 96, v70
    buffer_load_dwordx4 v73, s[8:11], s31 offen nt lds
    s_mov_b32 m0, 0x19000
    s_add_u32 s31, s82, 0x18800
    v_xor_b32 v73, 0, v70
    buffer_load_dwordx4 v73, s[8:11], s31 offen nt lds
    s_mov_b32 m0, 0x19400
    s_add_u32 s31, s82, 0x18c00
    v_xor_b32 v73, 32, v70
    buffer_load_dwordx4 v73, s[8:11], s31 offen nt lds
    s_mov_b32 m0, 0x19800
    s_add_u32 s31, s82, 0x1c800
    v_xor_b32 v73, 64, v70
    buffer_load_dwordx4 v73, s[8:11], s31 offen nt lds
    s_mov_b32 m0, 0x19c00
    s_add_u32 s31, s82, 0x1cc00
    v_xor_b32 v73, 96, v70
    buffer_load_dwordx4 v73, s[8:11], s31 offen nt lds
    s_mov_b32 m0, 0x1d000
    s_add_u32 s31, s82, 0x1a000
    v_xor_b32 v73, 0, v70
    buffer_load_dwordx4 v73, s[8:11], s31 offen nt lds
    s_mov_b32 m0, 0x1d400
    s_add_u32 s31, s82, 0x1a400
    v_xor_b32 v73, 32, v70
    buffer_load_dwordx4 v73, s[8:11], s31 offen nt lds
    s_mov_b32 m0, 0x1d800
    s_add_u32 s31, s82, 0x1e000
    v_xor_b32 v73, 64, v70
    buffer_load_dwordx4 v73, s[8:11], s31 offen nt lds
    s_mov_b32 m0, 0x1dc00
    s_add_u32 s31, s82, 0x1e400
    v_xor_b32 v73, 96, v70
    buffer_load_dwordx4 v73, s[8:11], s31 offen nt lds
    s_mov_b32 m0, 0x21000
    s_add_u32 s31, s82, 0x1a800
    v_xor_b32 v73, 0, v70
    buffer_load_dwordx4 v73, s[8:11], s31 offen nt lds
    s_mov_b32 m0, 0x21400
    s_add_u32 s31, s82, 0x1ac00
    v_xor_b32 v73, 32, v70
    buffer_load_dwordx4 v73, s[8:11], s31 offen nt lds
    s_mov_b32 m0, 0x21800
    s_add_u32 s31, s82, 0x1e800
    v_xor_b32 v73, 64, v70
    buffer_load_dwordx4 v73, s[8:11], s31 offen nt lds
    s_mov_b32 m0, 0x21c00
    s_add_u32 s31, s82, 0x1ec00
    v_xor_b32 v73, 96, v70
    buffer_load_dwordx4 v73, s[8:11], s31 offen nt lds
    s_mov_b32 m0, 0x25000
    s_add_u32 s31, s82, 0x8000
    v_xor_b32 v73, 0, v70
    buffer_load_dwordx4 v73, s[8:11], s31 offen nt lds
    s_mov_b32 m0, 0x25400
    s_add_u32 s31, s82, 0x8400
    v_xor_b32 v73, 32, v70
    buffer_load_dwordx4 v73, s[8:11], s31 offen nt lds
    s_mov_b32 m0, 0x25800
    s_add_u32 s31, s82, 0xc000
    v_xor_b32 v73, 64, v70
    buffer_load_dwordx4 v73, s[8:11], s31 offen nt lds
    s_mov_b32 m0, 0x25c00
    s_add_u32 s31, s82, 0xc400
    v_xor_b32 v73, 96, v70
    buffer_load_dwordx4 v73, s[8:11], s31 offen nt lds
    s_mov_b32 m0, 0x1000
    s_add_u32 s31, s82, 0x8800
    v_xor_b32 v73, 0, v70
    buffer_load_dwordx4 v73, s[8:11], s31 offen nt lds
    s_mov_b32 m0, 0x1400
    s_add_u32 s31, s82, 0x8c00
    v_xor_b32 v73, 32, v70
    buffer_load_dwordx4 v73, s[8:11], s31 offen nt lds
    s_mov_b32 m0, 0x1800
    s_add_u32 s31, s82, 0xc800
    v_xor_b32 v73, 64, v70
    buffer_load_dwordx4 v73, s[8:11], s31 offen nt lds
    s_mov_b32 m0, 0x1c00
    s_add_u32 s31, s82, 0xcc00
    v_xor_b32 v73, 96, v70
    buffer_load_dwordx4 v73, s[8:11], s31 offen nt lds
    s_mov_b32 m0, 0x9000
    s_add_u32 s31, s82, 0xa000
    v_xor_b32 v73, 0, v70
    buffer_load_dwordx4 v73, s[8:11], s31 offen nt lds
    s_mov_b32 m0, 0x9400
    s_add_u32 s31, s82, 0xa400
    v_xor_b32 v73, 32, v70
    buffer_load_dwordx4 v73, s[8:11], s31 offen nt lds
    s_mov_b32 m0, 0x9800
    s_add_u32 s31, s82, 0xe000
    v_xor_b32 v73, 64, v70
    buffer_load_dwordx4 v73, s[8:11], s31 offen nt lds
    s_mov_b32 m0, 0x9c00
    s_add_u32 s31, s82, 0xe400
    v_xor_b32 v73, 96, v70
    buffer_load_dwordx4 v73, s[8:11], s31 offen nt lds
    s_mov_b32 m0, 0xd000
    s_add_u32 s31, s82, 0xa800
    v_xor_b32 v73, 0, v70
    buffer_load_dwordx4 v73, s[8:11], s31 offen nt lds
    s_mov_b32 m0, 0xd400
    s_add_u32 s31, s82, 0xac00
    v_xor_b32 v73, 32, v70
    buffer_load_dwordx4 v73, s[8:11], s31 offen nt lds
    s_mov_b32 m0, 0xd800
    s_add_u32 s31, s82, 0xe800
    v_xor_b32 v73, 64, v70
    buffer_load_dwordx4 v73, s[8:11], s31 offen nt lds
    s_mov_b32 m0, 0xdc00
    s_add_u32 s31, s82, 0xec00
    v_xor_b32 v73, 96, v70
    buffer_load_dwordx4 v73, s[8:11], s31 offen nt lds
    v_mov_b32 v8, -1
    v_mov_b32 v9, -1
    v_mov_b32 v10, -1
    v_mov_b32 v11, -1
    s_lshl_b32 s30, s21, 13
    s_add_u32 s30, s30, 0x4200800
    s_add_u32 s31, s30, 0x40000
    buffer_store_dwordx4 v[8:11], v71, s[4:7], s30 offen
    buffer_store_dwordx4 v[8:11], v71, s[4:7], s30 offen offset:1024
    buffer_store_dwordx4 v[8:11], v71, s[4:7], s31 offen
    buffer_store_dwordx4 v[8:11], v71, s[4:7], s31 offen offset:1024
    v_lshrrev_b32 v14, 4, v0
    v_lshlrev_b32 v14, 13, v14
    v_and_b32 v15, 15, v0
    v_lshl_add_u32 v14, v15, 4, v14
    s_lshl_b32 s30, s21, 8
    s_add_u32 s31, s30, 0x4330000
    buffer_store_dwordx4 v[8:11], v14, s[4:7], s31 offen sc1
    s_add_u32 s31, s30, 0x4338000
    buffer_store_dwordx4 v[8:11], v14, s[4:7], s31 offen sc1
    s_add_u32 s31, s30, 0x4340000
    buffer_store_dwordx4 v[8:11], v14, s[4:7], s31 offen sc1
    s_add_u32 s31, s30, 0x4348000
    buffer_store_dwordx4 v[8:11], v14, s[4:7], s31 offen sc1
    s_lshl_b32 s30, s21, 13
    s_add_u32 s31, s30, 0x4140800
    buffer_store_dwordx4 v[8:11], v71, s[4:7], s31 offen sc1
    buffer_store_dwordx4 v[8:11], v71, s[4:7], s31 offen offset:1024 sc1
    s_add_u32 s31, s30, 0x4180800
    buffer_store_dwordx4 v[8:11], v71, s[4:7], s31 offen sc1
    buffer_store_dwordx4 v[8:11], v71, s[4:7], s31 offen offset:1024 sc1
    s_add_u32 s31, s30, 0x41c0800
    buffer_store_dwordx4 v[8:11], v71, s[4:7], s31 offen sc1
    buffer_store_dwordx4 v[8:11], v71, s[4:7], s31 offen offset:1024 sc1
    s_lshl_b32 s30, s21, 8
    s_add_u32 s30, s30, 0x4302000
    v_mov_b32 v12, -1
    buffer_store_dword v12, v75, s[4:7], s30 offen
    s_and_b32 s30, s21, 7
    s_lshl_b32 s30, s30, 5
    v_xor_b32 v76, s30, v72
    v_add_u32 v72, 2048, v71
    s_waitcnt vmcnt(47)
    s_lshl_b32 s30, s21, 8
    s_add_u32 s30, s30, 0x4300000
    s_waitcnt vmcnt(43) lgkmcnt(0)
    s_barrier
    s_mov_b32 s8, s42
    s_mov_b32 s9, s43
    s_mov_b32 m0, 0x11000
    s_add_u32 s31, s83, 0x0
    buffer_load_dwordx4 v64, s[8:11], s31 offen nt lds
    s_mov_b32 m0, 0x11400
    s_add_u32 s31, s83, 0x8000
    buffer_load_dwordx4 v64, s[8:11], s31 offen nt lds
    s_mov_b32 m0, 0x11800
    s_add_u32 s31, s83, 0x10000
    buffer_load_dwordx4 v65, s[8:11], s31 offen nt lds
    s_mov_b32 m0, 0x11c00
    s_add_u32 s31, s83, 0x18000
    buffer_load_dwordx4 v65, s[8:11], s31 offen nt lds
    v_add_u32 v68, 0x14000, v76
    v_xor_b32 v74, 0, v68
    ds_read_b64_tr_b16 v[208:209], v74
    v_xor_b32 v73, 32, v68
    ds_read_b64_tr_b16 v[216:217], v73
    v_xor_b32 v74, 64, v68
    ds_read_b64_tr_b16 v[224:225], v74
    v_xor_b32 v73, 96, v68
    ds_read_b64_tr_b16 v[232:233], v73
    v_xor_b32 v74, 128, v68
    ds_read_b64_tr_b16 v[240:241], v74
    v_xor_b32 v73, 160, v68
    ds_read_b64_tr_b16 v[248:249], v73
    v_xor_b32 v74, 192, v68
    ds_read_b64_tr_b16 v[32:33], v74
    v_xor_b32 v73, 224, v68
    ds_read_b64_tr_b16 v[40:41], v73
    s_waitcnt vmcnt(43) lgkmcnt(0)
    s_barrier
    s_mov_b32 m0, 0x15000
    s_add_u32 s31, s83, 0x80000
    buffer_load_dwordx4 v64, s[8:11], s31 offen nt lds
    s_mov_b32 m0, 0x15400
    s_add_u32 s31, s83, 0x88000
    buffer_load_dwordx4 v64, s[8:11], s31 offen nt lds
    s_mov_b32 m0, 0x15800
    s_add_u32 s31, s83, 0x90000
    buffer_load_dwordx4 v65, s[8:11], s31 offen nt lds
    s_mov_b32 m0, 0x15c00
    s_add_u32 s31, s83, 0x98000
    buffer_load_dwordx4 v65, s[8:11], s31 offen nt lds
    v_add_u32 v68, 0x18000, v76
    v_xor_b32 v74, 0, v68
    ds_read_b64_tr_b16 v[210:211], v74
    v_xor_b32 v73, 32, v68
    ds_read_b64_tr_b16 v[218:219], v73
    v_xor_b32 v74, 64, v68
    ds_read_b64_tr_b16 v[226:227], v74
    v_xor_b32 v73, 96, v68
    ds_read_b64_tr_b16 v[234:235], v73
    v_xor_b32 v74, 128, v68
    ds_read_b64_tr_b16 v[242:243], v74
    v_xor_b32 v73, 160, v68
    ds_read_b64_tr_b16 v[250:251], v73
    v_xor_b32 v74, 192, v68
    ds_read_b64_tr_b16 v[34:35], v74
    v_xor_b32 v73, 224, v68
    ds_read_b64_tr_b16 v[42:43], v73
    s_waitcnt vmcnt(43) lgkmcnt(0)
    s_barrier
    s_mov_b32 m0, 0x19000
    s_add_u32 s31, s83, 0x100000
    buffer_load_dwordx4 v64, s[8:11], s31 offen nt lds
    s_mov_b32 m0, 0x19400
    s_add_u32 s31, s83, 0x108000
    buffer_load_dwordx4 v64, s[8:11], s31 offen nt lds
    s_mov_b32 m0, 0x19800
    s_add_u32 s31, s83, 0x110000
    buffer_load_dwordx4 v65, s[8:11], s31 offen nt lds
    s_mov_b32 m0, 0x19c00
    s_add_u32 s31, s83, 0x118000
    buffer_load_dwordx4 v65, s[8:11], s31 offen nt lds
    v_add_u32 v68, 0x1c000, v76
    v_xor_b32 v74, 0, v68
    ds_read_b64_tr_b16 v[212:213], v74
    v_xor_b32 v73, 32, v68
    ds_read_b64_tr_b16 v[220:221], v73
    v_xor_b32 v74, 64, v68
    ds_read_b64_tr_b16 v[228:229], v74
    v_xor_b32 v73, 96, v68
    ds_read_b64_tr_b16 v[236:237], v73
    v_xor_b32 v74, 128, v68
    ds_read_b64_tr_b16 v[244:245], v74
    v_xor_b32 v73, 160, v68
    ds_read_b64_tr_b16 v[252:253], v73
    v_xor_b32 v74, 192, v68
    ds_read_b64_tr_b16 v[36:37], v74
    v_xor_b32 v73, 224, v68
    ds_read_b64_tr_b16 v[44:45], v73
    s_waitcnt vmcnt(43) lgkmcnt(0)
    s_barrier
    s_mov_b32 m0, 0x1d000
    s_add_u32 s31, s83, 0x180000
    buffer_load_dwordx4 v64, s[8:11], s31 offen nt lds
    s_mov_b32 m0, 0x1d400
    s_add_u32 s31, s83, 0x188000
    buffer_load_dwordx4 v64, s[8:11], s31 offen nt lds
    s_mov_b32 m0, 0x1d800
    s_add_u32 s31, s83, 0x190000
    buffer_load_dwordx4 v65, s[8:11], s31 offen nt lds
    s_mov_b32 m0, 0x1dc00
    s_add_u32 s31, s83, 0x198000
    buffer_load_dwordx4 v65, s[8:11], s31 offen nt lds
    v_add_u32 v68, 0x20000, v76
    v_xor_b32 v74, 0, v68
    ds_read_b64_tr_b16 v[214:215], v74
    v_xor_b32 v73, 32, v68
    ds_read_b64_tr_b16 v[222:223], v73
    v_xor_b32 v74, 64, v68
    ds_read_b64_tr_b16 v[230:231], v74
    v_xor_b32 v73, 96, v68
    ds_read_b64_tr_b16 v[238:239], v73
    v_xor_b32 v74, 128, v68
    ds_read_b64_tr_b16 v[246:247], v74
    v_xor_b32 v73, 160, v68
    ds_read_b64_tr_b16 v[254:255], v73
    v_xor_b32 v74, 192, v68
    ds_read_b64_tr_b16 v[38:39], v74
    v_xor_b32 v73, 224, v68
    ds_read_b64_tr_b16 v[46:47], v73
    s_waitcnt vmcnt(43) lgkmcnt(0)
    s_barrier
    s_mov_b32 m0, 0x21000
    s_add_u32 s31, s83, 0x200000
    buffer_load_dwordx4 v64, s[8:11], s31 offen nt lds
    s_mov_b32 m0, 0x21400
    s_add_u32 s31, s83, 0x208000
    buffer_load_dwordx4 v64, s[8:11], s31 offen nt lds
    s_mov_b32 m0, 0x21800
    s_add_u32 s31, s83, 0x210000
    buffer_load_dwordx4 v65, s[8:11], s31 offen nt lds
    s_mov_b32 m0, 0x21c00
    s_add_u32 s31, s83, 0x218000
    buffer_load_dwordx4 v65, s[8:11], s31 offen nt lds
    ds_write_b128 v72, v[32:35] offset:16384
    ds_write_b128 v72, v[36:39] offset:17408
    ds_write_b128 v72, v[40:43] offset:24576
    ds_write_b128 v72, v[44:47] offset:25600
    v_add_u32 v68, 0x24000, v76
    v_xor_b32 v74, 0, v68
    ds_read_b64_tr_b16 v[0:1], v74
    v_xor_b32 v73, 32, v68
    ds_read_b64_tr_b16 v[8:9], v73
    v_xor_b32 v74, 64, v68
    ds_read_b64_tr_b16 v[16:17], v74
    v_xor_b32 v73, 96, v68
    ds_read_b64_tr_b16 v[24:25], v73
    v_xor_b32 v74, 128, v68
    ds_read_b64_tr_b16 v[32:33], v74
    v_xor_b32 v73, 160, v68
    ds_read_b64_tr_b16 v[40:41], v73
    v_xor_b32 v74, 192, v68
    ds_read_b64_tr_b16 v[48:49], v74
    v_xor_b32 v73, 224, v68
    ds_read_b64_tr_b16 v[56:57], v73
    s_waitcnt vmcnt(43) lgkmcnt(0)
    s_barrier
    s_mov_b32 m0, 0x25000
    s_add_u32 s31, s83, 0x280000
    buffer_load_dwordx4 v64, s[8:11], s31 offen nt lds
    s_mov_b32 m0, 0x25400
    s_add_u32 s31, s83, 0x288000
    buffer_load_dwordx4 v64, s[8:11], s31 offen nt lds
    s_mov_b32 m0, 0x25800
    s_add_u32 s31, s83, 0x290000
    buffer_load_dwordx4 v65, s[8:11], s31 offen nt lds
    s_mov_b32 m0, 0x25c00
    s_add_u32 s31, s83, 0x298000
    buffer_load_dwordx4 v65, s[8:11], s31 offen nt lds
    v_add_u32 v68, 0x0, v76
    v_xor_b32 v74, 0, v68
    ds_read_b64_tr_b16 v[2:3], v74
    v_xor_b32 v73, 32, v68
    ds_read_b64_tr_b16 v[10:11], v73
    v_xor_b32 v74, 64, v68
    ds_read_b64_tr_b16 v[18:19], v74
    v_xor_b32 v73, 96, v68
    ds_read_b64_tr_b16 v[26:27], v73
    v_xor_b32 v74, 128, v68
    ds_read_b64_tr_b16 v[34:35], v74
    v_xor_b32 v73, 160, v68
    ds_read_b64_tr_b16 v[42:43], v73
    v_xor_b32 v74, 192, v68
    ds_read_b64_tr_b16 v[50:51], v74
    v_xor_b32 v73, 224, v68
    ds_read_b64_tr_b16 v[58:59], v73
    s_waitcnt vmcnt(43) lgkmcnt(0)
    s_barrier
    s_mov_b32 m0, 0x1000
    s_add_u32 s31, s83, 0x300000
    buffer_load_dwordx4 v64, s[8:11], s31 offen nt lds
    s_mov_b32 m0, 0x1400
    s_add_u32 s31, s83, 0x308000
    buffer_load_dwordx4 v64, s[8:11], s31 offen nt lds
    s_mov_b32 m0, 0x1800
    s_add_u32 s31, s83, 0x310000
    buffer_load_dwordx4 v65, s[8:11], s31 offen nt lds
    s_mov_b32 m0, 0x1c00
    s_add_u32 s31, s83, 0x318000
    buffer_load_dwordx4 v65, s[8:11], s31 offen nt lds
    v_add_u32 v68, 0x8000, v76
    v_xor_b32 v74, 0, v68
    ds_read_b64_tr_b16 v[4:5], v74
    v_xor_b32 v73, 32, v68
    ds_read_b64_tr_b16 v[12:13], v73
    v_xor_b32 v74, 64, v68
    ds_read_b64_tr_b16 v[20:21], v74
    v_xor_b32 v73, 96, v68
    ds_read_b64_tr_b16 v[28:29], v73
    v_xor_b32 v74, 128, v68
    ds_read_b64_tr_b16 v[36:37], v74
    v_xor_b32 v73, 160, v68
    ds_read_b64_tr_b16 v[44:45], v73
    v_xor_b32 v74, 192, v68
    ds_read_b64_tr_b16 v[52:53], v74
    v_xor_b32 v73, 224, v68
    ds_read_b64_tr_b16 v[60:61], v73
    s_waitcnt vmcnt(43) lgkmcnt(0)
    s_barrier
    s_mov_b32 m0, 0x9000
    s_add_u32 s31, s83, 0x380000
    buffer_load_dwordx4 v64, s[8:11], s31 offen nt lds
    s_mov_b32 m0, 0x9400
    s_add_u32 s31, s83, 0x388000
    buffer_load_dwordx4 v64, s[8:11], s31 offen nt lds
    s_mov_b32 m0, 0x9800
    s_add_u32 s31, s83, 0x390000
    buffer_load_dwordx4 v65, s[8:11], s31 offen nt lds
    s_mov_b32 m0, 0x9c00
    s_add_u32 s31, s83, 0x398000
    buffer_load_dwordx4 v65, s[8:11], s31 offen nt lds
    v_add_u32 v68, 0xc000, v76
    v_xor_b32 v74, 0, v68
    ds_read_b64_tr_b16 v[6:7], v74
    v_xor_b32 v73, 32, v68
    ds_read_b64_tr_b16 v[14:15], v73
    v_xor_b32 v74, 64, v68
    ds_read_b64_tr_b16 v[22:23], v74
    v_xor_b32 v73, 96, v68
    ds_read_b64_tr_b16 v[30:31], v73
    v_xor_b32 v74, 128, v68
    ds_read_b64_tr_b16 v[38:39], v74
    v_xor_b32 v73, 160, v68
    ds_read_b64_tr_b16 v[46:47], v73
    v_xor_b32 v74, 192, v68
    ds_read_b64_tr_b16 v[54:55], v74
    v_xor_b32 v73, 224, v68
    ds_read_b64_tr_b16 v[62:63], v73
    s_waitcnt vmcnt(28) lgkmcnt(0)
    s_barrier
    s_mov_b32 s8, s44
    s_mov_b32 s9, s45
    s_mov_b32 m0, 0xd000
    s_add_u32 s31, s83, 0x0
    buffer_load_dwordx4 v64, s[8:11], s31 offen nt lds
    s_mov_b32 m0, 0xd400
    s_add_u32 s31, s83, 0x8000
    buffer_load_dwordx4 v64, s[8:11], s31 offen nt lds
    s_mov_b32 m0, 0xd800
    s_add_u32 s31, s83, 0x10000
    buffer_load_dwordx4 v65, s[8:11], s31 offen nt lds
    s_mov_b32 m0, 0xdc00
    s_add_u32 s31, s83, 0x18000
    buffer_load_dwordx4 v65, s[8:11], s31 offen nt lds
    v_add_u32 v68, 0x10000, v66
    v_add_u32 v69, 0x10000, v67
    ds_read_b64_tr_b16 a[112:113], v68 offset:0
    ds_read_b64_tr_b16 a[114:115], v68 offset:1024
    ds_read_b64_tr_b16 a[116:117], v68 offset:8192
    ds_read_b64_tr_b16 a[118:119], v68 offset:9216
    ds_read_b64_tr_b16 a[176:177], v69 offset:0
    ds_read_b64_tr_b16 a[178:179], v69 offset:1024
    ds_read_b64_tr_b16 a[180:181], v69 offset:8192
    ds_read_b64_tr_b16 a[182:183], v69 offset:9216
    s_waitcnt vmcnt(28) lgkmcnt(0)
    s_barrier
    s_mov_b32 m0, 0x11000
    s_add_u32 s31, s83, 0x80000
    buffer_load_dwordx4 v64, s[8:11], s31 offen nt lds
    s_mov_b32 m0, 0x11400
    s_add_u32 s31, s83, 0x88000
    buffer_load_dwordx4 v64, s[8:11], s31 offen nt lds
    s_mov_b32 m0, 0x11800
    s_add_u32 s31, s83, 0x90000
    buffer_load_dwordx4 v65, s[8:11], s31 offen nt lds
    s_mov_b32 m0, 0x11c00
    s_add_u32 s31, s83, 0x98000
    buffer_load_dwordx4 v65, s[8:11], s31 offen nt lds
    v_add_u32 v68, 0x14000, v66
    v_add_u32 v69, 0x14000, v67
    ds_read_b64_tr_b16 a[120:121], v68 offset:0
    ds_read_b64_tr_b16 a[122:123], v68 offset:1024
    ds_read_b64_tr_b16 a[124:125], v68 offset:8192
    ds_read_b64_tr_b16 a[126:127], v68 offset:9216
    ds_read_b64_tr_b16 a[184:185], v69 offset:0
    ds_read_b64_tr_b16 a[186:187], v69 offset:1024
    ds_read_b64_tr_b16 a[188:189], v69 offset:8192
    ds_read_b64_tr_b16 a[190:191], v69 offset:9216
    s_waitcnt vmcnt(28) lgkmcnt(0)
    s_barrier
    s_mov_b32 m0, 0x15000
    s_add_u32 s31, s83, 0x100000
    buffer_load_dwordx4 v64, s[8:11], s31 offen nt lds
    s_mov_b32 m0, 0x15400
    s_add_u32 s31, s83, 0x108000
    buffer_load_dwordx4 v64, s[8:11], s31 offen nt lds
    s_mov_b32 m0, 0x15800
    s_add_u32 s31, s83, 0x110000
    buffer_load_dwordx4 v65, s[8:11], s31 offen nt lds
    s_mov_b32 m0, 0x15c00
    s_add_u32 s31, s83, 0x118000
    buffer_load_dwordx4 v65, s[8:11], s31 offen nt lds
    v_add_u32 v68, 0x18000, v66
    v_add_u32 v69, 0x18000, v67
    ds_read_b64_tr_b16 a[64:65], v68 offset:0
    ds_read_b64_tr_b16 a[66:67], v68 offset:1024
    ds_read_b64_tr_b16 a[68:69], v68 offset:8192
    ds_read_b64_tr_b16 a[70:71], v68 offset:9216
    ds_read_b64_tr_b16 a[128:129], v69 offset:0
    ds_read_b64_tr_b16 a[130:131], v69 offset:1024
    ds_read_b64_tr_b16 a[132:133], v69 offset:8192
    ds_read_b64_tr_b16 a[134:135], v69 offset:9216
    s_waitcnt vmcnt(28) lgkmcnt(0)
    s_barrier
    s_mov_b32 m0, 0x19000
    s_add_u32 s31, s83, 0x180000
    buffer_load_dwordx4 v64, s[8:11], s31 offen nt lds
    s_mov_b32 m0, 0x19400
    s_add_u32 s31, s83, 0x188000
    buffer_load_dwordx4 v64, s[8:11], s31 offen nt lds
    s_mov_b32 m0, 0x19800
    s_add_u32 s31, s83, 0x190000
    buffer_load_dwordx4 v65, s[8:11], s31 offen nt lds
    s_mov_b32 m0, 0x19c00
    s_add_u32 s31, s83, 0x198000
    buffer_load_dwordx4 v65, s[8:11], s31 offen nt lds
    v_add_u32 v68, 0x1c000, v66
    v_add_u32 v69, 0x1c000, v67
    ds_read_b64_tr_b16 a[72:73], v68 offset:0
    ds_read_b64_tr_b16 a[74:75], v68 offset:1024
    ds_read_b64_tr_b16 a[76:77], v68 offset:8192
    ds_read_b64_tr_b16 a[78:79], v68 offset:9216
    ds_read_b64_tr_b16 a[136:137], v69 offset:0
    ds_read_b64_tr_b16 a[138:139], v69 offset:1024
    ds_read_b64_tr_b16 a[140:141], v69 offset:8192
    ds_read_b64_tr_b16 a[142:143], v69 offset:9216
    s_waitcnt vmcnt(28) lgkmcnt(0)
    s_barrier
    s_mov_b32 m0, 0x1d000
    s_add_u32 s31, s83, 0x200000
    buffer_load_dwordx4 v64, s[8:11], s31 offen nt lds
    s_mov_b32 m0, 0x1d400
    s_add_u32 s31, s83, 0x208000
    buffer_load_dwordx4 v64, s[8:11], s31 offen nt lds
    s_mov_b32 m0, 0x1d800
    s_add_u32 s31, s83, 0x210000
    buffer_load_dwordx4 v65, s[8:11], s31 offen nt lds
    s_mov_b32 m0, 0x1dc00
    s_add_u32 s31, s83, 0x218000
    buffer_load_dwordx4 v65, s[8:11], s31 offen nt lds
    v_add_u32 v68, 0x20000, v66
    v_add_u32 v69, 0x20000, v67
    ds_read_b64_tr_b16 a[80:81], v68 offset:0
    ds_read_b64_tr_b16 a[82:83], v68 offset:1024
    ds_read_b64_tr_b16 a[84:85], v68 offset:8192
    ds_read_b64_tr_b16 a[86:87], v68 offset:9216
    ds_read_b64_tr_b16 a[144:145], v69 offset:0
    ds_read_b64_tr_b16 a[146:147], v69 offset:1024
    ds_read_b64_tr_b16 a[148:149], v69 offset:8192
    ds_read_b64_tr_b16 a[150:151], v69 offset:9216
    s_waitcnt vmcnt(28) lgkmcnt(0)
    s_barrier
    s_mov_b32 m0, 0x21000
    s_add_u32 s31, s83, 0x280000
    buffer_load_dwordx4 v64, s[8:11], s31 offen nt lds
    s_mov_b32 m0, 0x21400
    s_add_u32 s31, s83, 0x288000
    buffer_load_dwordx4 v64, s[8:11], s31 offen nt lds
    s_mov_b32 m0, 0x21800
    s_add_u32 s31, s83, 0x290000
    buffer_load_dwordx4 v65, s[8:11], s31 offen nt lds
    s_mov_b32 m0, 0x21c00
    s_add_u32 s31, s83, 0x298000
    buffer_load_dwordx4 v65, s[8:11], s31 offen nt lds
    v_add_u32 v68, 0x24000, v66
    v_add_u32 v69, 0x24000, v67
    ds_read_b64_tr_b16 a[88:89], v68 offset:0
    ds_read_b64_tr_b16 a[90:91], v68 offset:1024
    ds_read_b64_tr_b16 a[92:93], v68 offset:8192
    ds_read_b64_tr_b16 a[94:95], v68 offset:9216
    ds_read_b64_tr_b16 a[152:153], v69 offset:0
    ds_read_b64_tr_b16 a[154:155], v69 offset:1024
    ds_read_b64_tr_b16 a[156:157], v69 offset:8192
    ds_read_b64_tr_b16 a[158:159], v69 offset:9216
    s_waitcnt vmcnt(28) lgkmcnt(0)
    s_barrier
    s_mov_b32 m0, 0x25000
    s_add_u32 s31, s83, 0x300000
    buffer_load_dwordx4 v64, s[8:11], s31 offen nt lds
    s_mov_b32 m0, 0x25400
    s_add_u32 s31, s83, 0x308000
    buffer_load_dwordx4 v64, s[8:11], s31 offen nt lds
    s_mov_b32 m0, 0x25800
    s_add_u32 s31, s83, 0x310000
    buffer_load_dwordx4 v65, s[8:11], s31 offen nt lds
    s_mov_b32 m0, 0x25c00
    s_add_u32 s31, s83, 0x318000
    buffer_load_dwordx4 v65, s[8:11], s31 offen nt lds
    v_add_u32 v68, 0x0, v66
    v_add_u32 v69, 0x0, v67
    ds_read_b64_tr_b16 a[96:97], v68 offset:0
    ds_read_b64_tr_b16 a[98:99], v68 offset:1024
    ds_read_b64_tr_b16 a[100:101], v68 offset:8192
    ds_read_b64_tr_b16 a[102:103], v68 offset:9216
    ds_read_b64_tr_b16 a[160:161], v69 offset:0
    ds_read_b64_tr_b16 a[162:163], v69 offset:1024
    ds_read_b64_tr_b16 a[164:165], v69 offset:8192
    ds_read_b64_tr_b16 a[166:167], v69 offset:9216
    s_waitcnt vmcnt(28) lgkmcnt(0)
    s_barrier
    s_mov_b32 m0, 0x1000
    s_add_u32 s31, s83, 0x380000
    buffer_load_dwordx4 v64, s[8:11], s31 offen nt lds
    s_mov_b32 m0, 0x1400
    s_add_u32 s31, s83, 0x388000
    buffer_load_dwordx4 v64, s[8:11], s31 offen nt lds
    s_mov_b32 m0, 0x1800
    s_add_u32 s31, s83, 0x390000
    buffer_load_dwordx4 v65, s[8:11], s31 offen nt lds
    s_mov_b32 m0, 0x1c00
    s_add_u32 s31, s83, 0x398000
    buffer_load_dwordx4 v65, s[8:11], s31 offen nt lds
    v_add_u32 v68, 0x8000, v66
    v_add_u32 v69, 0x8000, v67
    ds_read_b64_tr_b16 a[104:105], v68 offset:0
    ds_read_b64_tr_b16 a[106:107], v68 offset:1024
    ds_read_b64_tr_b16 a[108:109], v68 offset:8192
    ds_read_b64_tr_b16 a[110:111], v68 offset:9216
    ds_read_b64_tr_b16 a[168:169], v69 offset:0
    ds_read_b64_tr_b16 a[170:171], v69 offset:1024
    ds_read_b64_tr_b16 a[172:173], v69 offset:8192
    ds_read_b64_tr_b16 a[174:175], v69 offset:9216
    s_waitcnt vmcnt(28) lgkmcnt(0)
    s_barrier
    s_mov_b32 s8, s40
    s_mov_b32 s9, s41
    s_mov_b32 m0, 0x9000
    s_add_u32 s31, s83, 0x0
    buffer_load_dwordx4 v64, s[8:11], s31 offen nt lds
    s_mov_b32 m0, 0x9400
    s_add_u32 s31, s83, 0x8000
    buffer_load_dwordx4 v64, s[8:11], s31 offen nt lds
    s_mov_b32 m0, 0x9800
    s_add_u32 s31, s83, 0x10000
    buffer_load_dwordx4 v65, s[8:11], s31 offen nt lds
    s_mov_b32 m0, 0x9c00
    s_add_u32 s31, s83, 0x18000
    buffer_load_dwordx4 v65, s[8:11], s31 offen nt lds
    v_add_u32 v68, 0xc000, v66
    v_add_u32 v69, 0xc000, v67
    ds_read_b64_tr_b16 a[240:241], v68 offset:0
    ds_read_b64_tr_b16 a[242:243], v68 offset:1024
    ds_read_b64_tr_b16 a[244:245], v68 offset:8192
    ds_read_b64_tr_b16 a[246:247], v68 offset:9216
    ds_read_b64_tr_b16 v[192:193], v69 offset:0
    ds_read_b64_tr_b16 v[194:195], v69 offset:1024
    ds_read_b64_tr_b16 v[196:197], v69 offset:8192
    ds_read_b64_tr_b16 v[198:199], v69 offset:9216
    s_waitcnt vmcnt(28) lgkmcnt(0)
    s_barrier
    s_mov_b32 m0, 0xd000
    s_add_u32 s31, s83, 0x80000
    buffer_load_dwordx4 v64, s[8:11], s31 offen nt lds
    s_mov_b32 m0, 0xd400
    s_add_u32 s31, s83, 0x88000
    buffer_load_dwordx4 v64, s[8:11], s31 offen nt lds
    s_mov_b32 m0, 0xd800
    s_add_u32 s31, s83, 0x90000
    buffer_load_dwordx4 v65, s[8:11], s31 offen nt lds
    s_mov_b32 m0, 0xdc00
    s_add_u32 s31, s83, 0x98000
    buffer_load_dwordx4 v65, s[8:11], s31 offen nt lds
    v_add_u32 v68, 0x10000, v66
    v_add_u32 v69, 0x10000, v67
    ds_read_b64_tr_b16 a[248:249], v68 offset:0
    ds_read_b64_tr_b16 a[250:251], v68 offset:1024
    ds_read_b64_tr_b16 a[252:253], v68 offset:8192
    ds_read_b64_tr_b16 a[254:255], v68 offset:9216
    ds_read_b64_tr_b16 v[200:201], v69 offset:0
    ds_read_b64_tr_b16 v[202:203], v69 offset:1024
    ds_read_b64_tr_b16 v[204:205], v69 offset:8192
    ds_read_b64_tr_b16 v[206:207], v69 offset:9216
    s_waitcnt vmcnt(28) lgkmcnt(0)
    s_barrier
    s_mov_b32 m0, 0x11000
    s_add_u32 s31, s83, 0x100000
    buffer_load_dwordx4 v64, s[8:11], s31 offen nt lds
    s_mov_b32 m0, 0x11400
    s_add_u32 s31, s83, 0x108000
    buffer_load_dwordx4 v64, s[8:11], s31 offen nt lds
    s_mov_b32 m0, 0x11800
    s_add_u32 s31, s83, 0x110000
    buffer_load_dwordx4 v65, s[8:11], s31 offen nt lds
    s_mov_b32 m0, 0x11c00
    s_add_u32 s31, s83, 0x118000
    buffer_load_dwordx4 v65, s[8:11], s31 offen nt lds
    v_add_u32 v68, 0x14000, v66
    v_add_u32 v69, 0x14000, v67
    ds_read_b64_tr_b16 a[192:193], v68 offset:0
    ds_read_b64_tr_b16 a[194:195], v68 offset:1024
    ds_read_b64_tr_b16 a[196:197], v68 offset:8192
    ds_read_b64_tr_b16 a[198:199], v68 offset:9216
    ds_read_b64_tr_b16 v[144:145], v69 offset:0
    ds_read_b64_tr_b16 v[146:147], v69 offset:1024
    ds_read_b64_tr_b16 v[148:149], v69 offset:8192
    ds_read_b64_tr_b16 v[150:151], v69 offset:9216
    s_waitcnt vmcnt(28) lgkmcnt(0)
    s_barrier
    s_mov_b32 m0, 0x15000
    s_add_u32 s31, s83, 0x180000
    buffer_load_dwordx4 v64, s[8:11], s31 offen nt lds
    s_mov_b32 m0, 0x15400
    s_add_u32 s31, s83, 0x188000
    buffer_load_dwordx4 v64, s[8:11], s31 offen nt lds
    s_mov_b32 m0, 0x15800
    s_add_u32 s31, s83, 0x190000
    buffer_load_dwordx4 v65, s[8:11], s31 offen nt lds
    s_mov_b32 m0, 0x15c00
    s_add_u32 s31, s83, 0x198000
    buffer_load_dwordx4 v65, s[8:11], s31 offen nt lds
    v_add_u32 v68, 0x18000, v66
    v_add_u32 v69, 0x18000, v67
    ds_read_b64_tr_b16 a[200:201], v68 offset:0
    ds_read_b64_tr_b16 a[202:203], v68 offset:1024
    ds_read_b64_tr_b16 a[204:205], v68 offset:8192
    ds_read_b64_tr_b16 a[206:207], v68 offset:9216
    ds_read_b64_tr_b16 v[152:153], v69 offset:0
    ds_read_b64_tr_b16 v[154:155], v69 offset:1024
    ds_read_b64_tr_b16 v[156:157], v69 offset:8192
    ds_read_b64_tr_b16 v[158:159], v69 offset:9216
    s_waitcnt vmcnt(28) lgkmcnt(0)
    s_barrier
    s_mov_b32 m0, 0x19000
    s_add_u32 s31, s83, 0x200000
    buffer_load_dwordx4 v64, s[8:11], s31 offen nt lds
    s_mov_b32 m0, 0x19400
    s_add_u32 s31, s83, 0x208000
    buffer_load_dwordx4 v64, s[8:11], s31 offen nt lds
    s_mov_b32 m0, 0x19800
    s_add_u32 s31, s83, 0x210000
    buffer_load_dwordx4 v65, s[8:11], s31 offen nt lds
    s_mov_b32 m0, 0x19c00
    s_add_u32 s31, s83, 0x218000
    buffer_load_dwordx4 v65, s[8:11], s31 offen nt lds
    v_add_u32 v68, 0x1c000, v66
    v_add_u32 v69, 0x1c000, v67
    ds_read_b64_tr_b16 a[208:209], v68 offset:0
    ds_read_b64_tr_b16 a[210:211], v68 offset:1024
    ds_read_b64_tr_b16 a[212:213], v68 offset:8192
    ds_read_b64_tr_b16 a[214:215], v68 offset:9216
    ds_read_b64_tr_b16 v[160:161], v69 offset:0
    ds_read_b64_tr_b16 v[162:163], v69 offset:1024
    ds_read_b64_tr_b16 v[164:165], v69 offset:8192
    ds_read_b64_tr_b16 v[166:167], v69 offset:9216
    s_waitcnt vmcnt(28) lgkmcnt(0)
    s_barrier
    s_mov_b32 m0, 0x1d000
    s_add_u32 s31, s83, 0x280000
    buffer_load_dwordx4 v64, s[8:11], s31 offen nt lds
    s_mov_b32 m0, 0x1d400
    s_add_u32 s31, s83, 0x288000
    buffer_load_dwordx4 v64, s[8:11], s31 offen nt lds
    s_mov_b32 m0, 0x1d800
    s_add_u32 s31, s83, 0x290000
    buffer_load_dwordx4 v65, s[8:11], s31 offen nt lds
    s_mov_b32 m0, 0x1dc00
    s_add_u32 s31, s83, 0x298000
    buffer_load_dwordx4 v65, s[8:11], s31 offen nt lds
    v_add_u32 v68, 0x20000, v66
    v_add_u32 v69, 0x20000, v67
    ds_read_b64_tr_b16 a[216:217], v68 offset:0
    ds_read_b64_tr_b16 a[218:219], v68 offset:1024
    ds_read_b64_tr_b16 a[220:221], v68 offset:8192
    ds_read_b64_tr_b16 a[222:223], v68 offset:9216
    ds_read_b64_tr_b16 v[168:169], v69 offset:0
    ds_read_b64_tr_b16 v[170:171], v69 offset:1024
    ds_read_b64_tr_b16 v[172:173], v69 offset:8192
    ds_read_b64_tr_b16 v[174:175], v69 offset:9216
    s_waitcnt vmcnt(28) lgkmcnt(0)
    s_barrier
    s_mov_b32 m0, 0x21000
    s_add_u32 s31, s83, 0x300000
    buffer_load_dwordx4 v64, s[8:11], s31 offen nt lds
    s_mov_b32 m0, 0x21400
    s_add_u32 s31, s83, 0x308000
    buffer_load_dwordx4 v64, s[8:11], s31 offen nt lds
    s_mov_b32 m0, 0x21800
    s_add_u32 s31, s83, 0x310000
    buffer_load_dwordx4 v65, s[8:11], s31 offen nt lds
    s_mov_b32 m0, 0x21c00
    s_add_u32 s31, s83, 0x318000
    buffer_load_dwordx4 v65, s[8:11], s31 offen nt lds
    v_add_u32 v68, 0x24000, v66
    v_add_u32 v69, 0x24000, v67
    ds_read_b64_tr_b16 a[224:225], v68 offset:0
    ds_read_b64_tr_b16 a[226:227], v68 offset:1024
    ds_read_b64_tr_b16 a[228:229], v68 offset:8192
    ds_read_b64_tr_b16 a[230:231], v68 offset:9216
    ds_read_b64_tr_b16 v[176:177], v69 offset:0
    ds_read_b64_tr_b16 v[178:179], v69 offset:1024
    ds_read_b64_tr_b16 v[180:181], v69 offset:8192
    ds_read_b64_tr_b16 v[182:183], v69 offset:9216
    s_waitcnt vmcnt(28) lgkmcnt(0)
    s_barrier
    s_mov_b32 m0, 0x25000
    s_add_u32 s31, s83, 0x380000
    buffer_load_dwordx4 v64, s[8:11], s31 offen nt lds
    s_mov_b32 m0, 0x25400
    s_add_u32 s31, s83, 0x388000
    buffer_load_dwordx4 v64, s[8:11], s31 offen nt lds
    s_mov_b32 m0, 0x25800
    s_add_u32 s31, s83, 0x390000
    buffer_load_dwordx4 v65, s[8:11], s31 offen nt lds
    s_mov_b32 m0, 0x25c00
    s_add_u32 s31, s83, 0x398000
    buffer_load_dwordx4 v65, s[8:11], s31 offen nt lds
    v_add_u32 v68, 0x0, v66
    v_add_u32 v69, 0x0, v67
    ds_read_b64_tr_b16 a[232:233], v68 offset:0
    ds_read_b64_tr_b16 a[234:235], v68 offset:1024
    ds_read_b64_tr_b16 a[236:237], v68 offset:8192
    ds_read_b64_tr_b16 a[238:239], v68 offset:9216
    ds_read_b64_tr_b16 v[184:185], v69 offset:0
    ds_read_b64_tr_b16 v[186:187], v69 offset:1024
    ds_read_b64_tr_b16 v[188:189], v69 offset:8192
    ds_read_b64_tr_b16 v[190:191], v69 offset:9216
    s_waitcnt vmcnt(28) lgkmcnt(0)
    s_barrier
    v_add_u32 v64, 0x8000, v66
    v_add_u32 v65, 0x8000, v67
    ds_read_b64_tr_b16 v[128:129], v64 offset:0
    ds_read_b64_tr_b16 v[130:131], v64 offset:1024
    ds_read_b64_tr_b16 v[132:133], v64 offset:8192
    ds_read_b64_tr_b16 v[134:135], v64 offset:9216
    ds_read_b64_tr_b16 a[48:49], v65 offset:0
    ds_read_b64_tr_b16 a[50:51], v65 offset:1024
    ds_read_b64_tr_b16 a[52:53], v65 offset:8192
    ds_read_b64_tr_b16 a[54:55], v65 offset:9216
    s_waitcnt vmcnt(24) lgkmcnt(0)
    s_barrier
    v_add_u32 v64, 0xc000, v66
    v_add_u32 v65, 0xc000, v67
    ds_read_b64_tr_b16 v[136:137], v64 offset:0
    ds_read_b64_tr_b16 v[138:139], v64 offset:1024
    ds_read_b64_tr_b16 v[140:141], v64 offset:8192
    ds_read_b64_tr_b16 v[142:143], v64 offset:9216
    ds_read_b64_tr_b16 a[56:57], v65 offset:0
    ds_read_b64_tr_b16 a[58:59], v65 offset:1024
    ds_read_b64_tr_b16 a[60:61], v65 offset:8192
    ds_read_b64_tr_b16 a[62:63], v65 offset:9216
    s_waitcnt vmcnt(20) lgkmcnt(0)
    s_barrier
    v_add_u32 v64, 0x10000, v66
    v_add_u32 v65, 0x10000, v67
    ds_read_b64_tr_b16 v[80:81], v64 offset:0
    ds_read_b64_tr_b16 v[82:83], v64 offset:1024
    ds_read_b64_tr_b16 v[84:85], v64 offset:8192
    ds_read_b64_tr_b16 v[86:87], v64 offset:9216
    ds_read_b64_tr_b16 a[0:1], v65 offset:0
    ds_read_b64_tr_b16 a[2:3], v65 offset:1024
    ds_read_b64_tr_b16 a[4:5], v65 offset:8192
    ds_read_b64_tr_b16 a[6:7], v65 offset:9216
    s_waitcnt vmcnt(16) lgkmcnt(0)
    s_barrier
    v_add_u32 v64, 0x14000, v66
    v_add_u32 v65, 0x14000, v67
    ds_read_b64_tr_b16 v[88:89], v64 offset:0
    ds_read_b64_tr_b16 v[90:91], v64 offset:1024
    ds_read_b64_tr_b16 v[92:93], v64 offset:8192
    ds_read_b64_tr_b16 v[94:95], v64 offset:9216
    ds_read_b64_tr_b16 a[8:9], v65 offset:0
    ds_read_b64_tr_b16 a[10:11], v65 offset:1024
    ds_read_b64_tr_b16 a[12:13], v65 offset:8192
    ds_read_b64_tr_b16 a[14:15], v65 offset:9216
    s_waitcnt vmcnt(12) lgkmcnt(0)
    s_barrier
    v_add_u32 v65, 0x10000, v72
    ds_write_b128 v72, v[0:3] offset:32768
    ds_write_b128 v72, v[4:7] offset:33792
    ds_write_b128 v72, v[8:11] offset:40960
    ds_write_b128 v72, v[12:15] offset:41984
    ds_write_b128 v72, v[16:19] offset:49152
    ds_write_b128 v72, v[20:23] offset:50176
    ds_write_b128 v72, v[24:27] offset:57344
    ds_write_b128 v72, v[28:31] offset:58368
    ds_write_b128 v65, v[32:35] offset:0
    ds_write_b128 v65, v[36:39] offset:1024
    ds_write_b128 v65, v[40:43] offset:8192
    ds_write_b128 v65, v[44:47] offset:9216
    ds_write_b128 v65, v[48:51] offset:16384
    ds_write_b128 v65, v[52:55] offset:17408
    ds_write_b128 v65, v[56:59] offset:24576
    ds_write_b128 v65, v[60:63] offset:25600
    v_lshrrev_b32 v0, 4, v71
    v_and_b32 v1, 8, v0
    v_cmp_ne_u32 s[66:67], 0, v1
    v_and_b32 v1, 2, v0
    v_cmp_ne_u32 vcc, 0, v1
    v_mov_b32 v2, 0x4444
    v_mov_b32 v3, 0xeeee
    v_cndmask_b32 v70, v2, v3, vcc
    v_and_b32 v1, 11, v0
    v_cmp_eq_u32 s[70:71], 0, v1
    v_cmp_eq_u32 s[72:73], 1, v1
    v_cmp_eq_u32 s[74:75], 8, v1
    v_cmp_eq_u32 s[76:77], 9, v1
    v_and_b32 v3, 1, v0
    v_lshlrev_b32 v3, 4, v3
    v_mov_b32 v4, 0x3f80
    v_lshlrev_b32 v4, v3, v4
    v_lshrrev_b32 v5, 4, v0
    v_bfe_u32 v1, v0, 1, 2
    v_cmp_eq_u32 vcc, v1, v5
    s_nop 1
    v_cndmask_b32 v68, 0, v4, vcc
    v_cndmask_b32 v69, 0, v4, vcc
    v_bfe_u32 v1, v0, 2, 2
    v_cmp_eq_u32 vcc, v1, v5
    s_nop 1
    v_cndmask_b32 v76, 0, v4, vcc
    v_cndmask_b32 v77, 0, v4, vcc
    v_and_b32 v1, 0x31, v0
    v_bfe_u32 v2, v0, 1, 2
    v_lshl_or_b32 v1, v2, 2, v1
    v_bfe_u32 v2, v0, 3, 1
    v_lshl_or_b32 v1, v2, 1, v1
    v_lshlrev_b32 v1, 4, v1
    s_lshr_b32 s30, s20, 1
    s_lshl_b32 s30, s30, 11
    s_and_b32 s31, s20, 1
    s_lshl_b32 s31, s31, 3
    s_add_u32 s30, s30, s31
    v_add_u32 v78, s30, v1
    s_mov_b32 s35, 0x3e0293ee
    s_lshl_b32 s30, s21, 14
    s_lshl_b32 s31, s20, 12
    s_add_u32 s28, s30, s31
    s_add_u32 s28, s28, 0x1200000
    s_lshr_b32 s30, s30, 1
    s_lshr_b32 s31, s31, 1
    s_add_u32 s29, s30, s31
    s_add_u32 s29, s29, 0x3200000
    s_add_u32 s27, s30, s31
    s_add_u32 s27, s27, 0x4200000
    s_add_u32 s25, s31, 0x4300000
    s_lshl_b32 s30, s21, 10
    s_lshl_b32 s31, s20, 2
    s_add_u32 s82, s30, s31
    s_add_u32 s81, s82, 0x5600080
    s_lshl_b32 s30, s21, 6
    s_lshl_b32 s31, s20, 16
    s_add_u32 s26, s30, s31
    s_add_u32 s26, s26, 0x4200000
    s_add_u32 s80, s82, 0x5600100
    s_lshl_b32 s30, s21, 8
    s_lshl_b32 s31, s20, 6
    s_add_u32 s30, s30, s31
    s_add_u32 s79, s30, 0x4300000
    s_mov_b32 s68, 0x000f000f
    s_mov_b32 s69, 0x000f000f
    s_lshl_b32 s83, s20, 2
    s_mov_b32 s78, 0
    s_mov_b32 s34, 0
    s_mov_b32 s22, 0
    s_and_b32 s30, s21, 7
    s_lshl_b32 s30, s30, 13
    s_add_u32 s26, s26, s30
    s_and_b32 s52, s21, 7
    s_lshl_b32 s52, s52, 6
    s_add_u32 s29, s79, 0x10000
    s_mov_b32 s32, 1
    s_mov_b32 s33, 1
    buffer_load_dword v6, off, s[12:15], 0 offset:36 sc1
    buffer_load_dword v7, off, s[4:7], s81 sc1
    buffer_load_dword v79, off, s[4:7], s81 offset:16 sc1
    s_lshl_b32 s30, s21, 13
    s_add_u32 s30, s30, 0x4240000
    v_lshlrev_b32 v12, 3, v71
    buffer_load_dword v12, v12, s[4:7], s30 offen sc1
    v_mov_b64 v[32:33], 0
    v_mov_b64 v[34:35], 0
    v_mov_b64 v[36:37], 0
    v_mov_b64 v[38:39], 0
    v_mov_b64 v[40:41], 0
    v_mov_b64 v[42:43], 0
    v_mov_b64 v[44:45], 0
    v_mov_b64 v[46:47], 0
    v_mov_b64 v[48:49], 0
    v_mov_b64 v[50:51], 0
    v_mov_b64 v[52:53], 0
    v_mov_b64 v[54:55], 0
    v_add_u32 v73, 4096, v71
    v_add_u32 v74, 6144, v71
    v_add_u32 v75, 0, v71
    v_add_u32 v64, 0x18000, v66
    v_add_u32 v65, 0x18000, v67
    ds_read_b64_tr_b16 v[96:97], v64 offset:0
    ds_read_b64_tr_b16 v[98:99], v64 offset:1024
    ds_read_b64_tr_b16 v[100:101], v64 offset:8192
    ds_read_b64_tr_b16 v[102:103], v64 offset:9216
    ds_read_b64_tr_b16 a[16:17], v65 offset:0
    ds_read_b64_tr_b16 a[18:19], v65 offset:1024
    ds_read_b64_tr_b16 a[20:21], v65 offset:8192
    ds_read_b64_tr_b16 a[22:23], v65 offset:9216
    s_waitcnt vmcnt(8) lgkmcnt(0)
    s_barrier
    v_add_u32 v64, 0x1c000, v66
    v_add_u32 v65, 0x1c000, v67
    ds_read_b64_tr_b16 v[104:105], v64 offset:0
    ds_read_b64_tr_b16 v[106:107], v64 offset:1024
    ds_read_b64_tr_b16 v[108:109], v64 offset:8192
    ds_read_b64_tr_b16 v[110:111], v64 offset:9216
    ds_read_b64_tr_b16 a[24:25], v65 offset:0
    ds_read_b64_tr_b16 a[26:27], v65 offset:1024
    ds_read_b64_tr_b16 a[28:29], v65 offset:8192
    ds_read_b64_tr_b16 a[30:31], v65 offset:9216
    s_waitcnt vmcnt(4) lgkmcnt(0)
    s_barrier
    v_add_u32 v64, 0x20000, v66
    v_add_u32 v65, 0x20000, v67
    ds_read_b64_tr_b16 v[112:113], v64 offset:0
    ds_read_b64_tr_b16 v[114:115], v64 offset:1024
    ds_read_b64_tr_b16 v[116:117], v64 offset:8192
    ds_read_b64_tr_b16 v[118:119], v64 offset:9216
    ds_read_b64_tr_b16 a[32:33], v65 offset:0
    ds_read_b64_tr_b16 a[34:35], v65 offset:1024
    ds_read_b64_tr_b16 a[36:37], v65 offset:8192
    ds_read_b64_tr_b16 a[38:39], v65 offset:9216
    s_waitcnt vmcnt(0) lgkmcnt(0)
    s_barrier
    v_add_u32 v64, 0x24000, v66
    v_add_u32 v65, 0x24000, v67
    ds_read_b64_tr_b16 v[120:121], v64 offset:0
    ds_read_b64_tr_b16 v[122:123], v64 offset:1024
    ds_read_b64_tr_b16 v[124:125], v64 offset:8192
    ds_read_b64_tr_b16 v[126:127], v64 offset:9216
    ds_read_b64_tr_b16 a[40:41], v65 offset:0
    ds_read_b64_tr_b16 a[42:43], v65 offset:1024
    ds_read_b64_tr_b16 a[44:45], v65 offset:8192
    ds_read_b64_tr_b16 a[46:47], v65 offset:9216
    s_waitcnt vmcnt(0) lgkmcnt(0)
    s_barrier
    s_branch L_CLDONE
L_CLD2:
    s_cmp_lg_u32 s20, 2
    s_cbranch_scc1 L_CLD3
    v_lshlrev_b32 v71, 4, v0
    v_lshlrev_b32 v75, 2, v0
    v_lshrrev_b32 v1, 4, v0
    v_lshlrev_b32 v1, 1, v1
    v_bfe_u32 v2, v0, 2, 1
    v_add_u32 v1, v1, v2
    v_lshlrev_b32 v1, 10, v1
    v_bfe_u32 v2, v0, 3, 1
    v_lshl_add_u32 v1, v2, 2, v1
    v_and_b32 v2, 3, v0
    v_lshl_add_u32 v1, v2, 3, v1
    s_lshl_b32 s30, s21, 5
    buffer_load_dword v5, v1, s[16:19], s30 offen

    v_lshrrev_b32 v1, 4, v0
    v_add_u32 v2, 32, v1
    v_lshlrev_b32 v2, 13, v2
    v_lshlrev_b32 v1, 5, v1
    v_and_b32 v3, 15, v0
    v_lshlrev_b32 v3, 4, v3
    v_xor_b32 v3, v3, v1
    v_add_u32 v64, v2, v3
    v_xor_b32 v65, 128, v64
    v_xor_b32 v70, 0, v71
    v_lshrrev_b32 v2, 4, v0
    v_bfe_u32 v3, v0, 2, 2
    v_lshl_add_u32 v1, v2, 3, v3
    v_and_b32 v2, 1, v2
    v_lshl_or_b32 v2, v2, 2, v3
    v_xor_b32 v2, 4, v2
    v_lshlrev_b32 v2, 5, v2
    v_lshl_add_u32 v1, v1, 8, v2
    v_and_b32 v3, 3, v0
    v_lshl_add_u32 v66, v3, 3, v1
    v_xor_b32 v67, 32, v66
    v_lshrrev_b32 v1, 2, v0
    v_and_b32 v2, 7, v1
    v_or_b32 v2, 16, v2
    v_lshlrev_b32 v2, 5, v2
    v_lshl_add_u32 v1, v1, 10, v2
    v_lshl_add_u32 v72, v3, 3, v1
    s_lshl_b32 s83, s21, 8
    s_lshl_b32 s82, s21, 17
    s_mov_b32 s8, s46
    s_mov_b32 s9, s47
    s_mov_b32 m0, 0x16000
    s_add_u32 s31, s82, 0x11000
    v_xor_b32 v73, 0, v70
    buffer_load_dwordx4 v73, s[8:11], s31 offen nt lds
    s_mov_b32 m0, 0x16400
    s_add_u32 s31, s82, 0x11400
    v_xor_b32 v73, 32, v70
    buffer_load_dwordx4 v73, s[8:11], s31 offen nt lds
    s_mov_b32 m0, 0x16800
    s_add_u32 s31, s82, 0x15000
    v_xor_b32 v73, 64, v70
    buffer_load_dwordx4 v73, s[8:11], s31 offen nt lds
    s_mov_b32 m0, 0x16c00
    s_add_u32 s31, s82, 0x15400
    v_xor_b32 v73, 96, v70
    buffer_load_dwordx4 v73, s[8:11], s31 offen nt lds
    s_mov_b32 m0, 0x1a000
    s_add_u32 s31, s82, 0x11800
    v_xor_b32 v73, 0, v70
    buffer_load_dwordx4 v73, s[8:11], s31 offen nt lds
    s_mov_b32 m0, 0x1a400
    s_add_u32 s31, s82, 0x11c00
    v_xor_b32 v73, 32, v70
    buffer_load_dwordx4 v73, s[8:11], s31 offen nt lds
    s_mov_b32 m0, 0x1a800
    s_add_u32 s31, s82, 0x15800
    v_xor_b32 v73, 64, v70
    buffer_load_dwordx4 v73, s[8:11], s31 offen nt lds
    s_mov_b32 m0, 0x1ac00
    s_add_u32 s31, s82, 0x15c00
    v_xor_b32 v73, 96, v70
    buffer_load_dwordx4 v73, s[8:11], s31 offen nt lds
    s_mov_b32 m0, 0x1e000
    s_add_u32 s31, s82, 0x13000
    v_xor_b32 v73, 0, v70
    buffer_load_dwordx4 v73, s[8:11], s31 offen nt lds
    s_mov_b32 m0, 0x1e400
    s_add_u32 s31, s82, 0x13400
    v_xor_b32 v73, 32, v70
    buffer_load_dwordx4 v73, s[8:11], s31 offen nt lds
    s_mov_b32 m0, 0x1e800
    s_add_u32 s31, s82, 0x17000
    v_xor_b32 v73, 64, v70
    buffer_load_dwordx4 v73, s[8:11], s31 offen nt lds
    s_mov_b32 m0, 0x1ec00
    s_add_u32 s31, s82, 0x17400
    v_xor_b32 v73, 96, v70
    buffer_load_dwordx4 v73, s[8:11], s31 offen nt lds
    s_mov_b32 m0, 0x22000
    s_add_u32 s31, s82, 0x13800
    v_xor_b32 v73, 0, v70
    buffer_load_dwordx4 v73, s[8:11], s31 offen nt lds
    s_mov_b32 m0, 0x22400
    s_add_u32 s31, s82, 0x13c00
    v_xor_b32 v73, 32, v70
    buffer_load_dwordx4 v73, s[8:11], s31 offen nt lds
    s_mov_b32 m0, 0x22800
    s_add_u32 s31, s82, 0x17800
    v_xor_b32 v73, 64, v70
    buffer_load_dwordx4 v73, s[8:11], s31 offen nt lds
    s_mov_b32 m0, 0x22c00
    s_add_u32 s31, s82, 0x17c00
    v_xor_b32 v73, 96, v70
    buffer_load_dwordx4 v73, s[8:11], s31 offen nt lds
    s_mov_b32 m0, 0x26000
    s_add_u32 s31, s82, 0x1000
    v_xor_b32 v73, 0, v70
    buffer_load_dwordx4 v73, s[8:11], s31 offen nt lds
    s_mov_b32 m0, 0x26400
    s_add_u32 s31, s82, 0x1400
    v_xor_b32 v73, 32, v70
    buffer_load_dwordx4 v73, s[8:11], s31 offen nt lds
    s_mov_b32 m0, 0x26800
    s_add_u32 s31, s82, 0x5000
    v_xor_b32 v73, 64, v70
    buffer_load_dwordx4 v73, s[8:11], s31 offen nt lds
    s_mov_b32 m0, 0x26c00
    s_add_u32 s31, s82, 0x5400
    v_xor_b32 v73, 96, v70
    buffer_load_dwordx4 v73, s[8:11], s31 offen nt lds
    s_mov_b32 m0, 0x2000
    s_add_u32 s31, s82, 0x1800
    v_xor_b32 v73, 0, v70
    buffer_load_dwordx4 v73, s[8:11], s31 offen nt lds
    s_mov_b32 m0, 0x2400
    s_add_u32 s31, s82, 0x1c00
    v_xor_b32 v73, 32, v70
    buffer_load_dwordx4 v73, s[8:11], s31 offen nt lds
    s_mov_b32 m0, 0x2800
    s_add_u32 s31, s82, 0x5800
    v_xor_b32 v73, 64, v70
    buffer_load_dwordx4 v73, s[8:11], s31 offen nt lds
    s_mov_b32 m0, 0x2c00
    s_add_u32 s31, s82, 0x5c00
    v_xor_b32 v73, 96, v70
    buffer_load_dwordx4 v73, s[8:11], s31 offen nt lds
    s_mov_b32 m0, 0xa000
    s_add_u32 s31, s82, 0x3000
    v_xor_b32 v73, 0, v70
    buffer_load_dwordx4 v73, s[8:11], s31 offen nt lds
    s_mov_b32 m0, 0xa400
    s_add_u32 s31, s82, 0x3400
    v_xor_b32 v73, 32, v70
    buffer_load_dwordx4 v73, s[8:11], s31 offen nt lds
    s_mov_b32 m0, 0xa800
    s_add_u32 s31, s82, 0x7000
    v_xor_b32 v73, 64, v70
    buffer_load_dwordx4 v73, s[8:11], s31 offen nt lds
    s_mov_b32 m0, 0xac00
    s_add_u32 s31, s82, 0x7400
    v_xor_b32 v73, 96, v70
    buffer_load_dwordx4 v73, s[8:11], s31 offen nt lds
    s_mov_b32 m0, 0xe000
    s_add_u32 s31, s82, 0x3800
    v_xor_b32 v73, 0, v70
    buffer_load_dwordx4 v73, s[8:11], s31 offen nt lds
    s_mov_b32 m0, 0xe400
    s_add_u32 s31, s82, 0x3c00
    v_xor_b32 v73, 32, v70
    buffer_load_dwordx4 v73, s[8:11], s31 offen nt lds
    s_mov_b32 m0, 0xe800
    s_add_u32 s31, s82, 0x7800
    v_xor_b32 v73, 64, v70
    buffer_load_dwordx4 v73, s[8:11], s31 offen nt lds
    s_mov_b32 m0, 0xec00
    s_add_u32 s31, s82, 0x7c00
    v_xor_b32 v73, 96, v70
    buffer_load_dwordx4 v73, s[8:11], s31 offen nt lds
    v_mov_b32 v8, -1
    v_mov_b32 v9, -1
    v_mov_b32 v10, -1
    v_mov_b32 v11, -1
    s_lshl_b32 s30, s21, 13
    s_add_u32 s30, s30, 0x4201000
    s_add_u32 s31, s30, 0x40000
    buffer_store_dwordx4 v[8:11], v71, s[4:7], s30 offen
    buffer_store_dwordx4 v[8:11], v71, s[4:7], s30 offen offset:1024
    buffer_store_dwordx4 v[8:11], v71, s[4:7], s31 offen
    buffer_store_dwordx4 v[8:11], v71, s[4:7], s31 offen offset:1024
    v_lshrrev_b32 v14, 4, v0
    v_lshlrev_b32 v14, 13, v14
    v_and_b32 v15, 15, v0
    v_lshl_add_u32 v14, v15, 4, v14
    s_lshl_b32 s30, s21, 8
    s_add_u32 s31, s30, 0x4350000
    buffer_store_dwordx4 v[8:11], v14, s[4:7], s31 offen sc1
    s_add_u32 s31, s30, 0x4358000
    buffer_store_dwordx4 v[8:11], v14, s[4:7], s31 offen sc1
    s_add_u32 s31, s30, 0x4360000
    buffer_store_dwordx4 v[8:11], v14, s[4:7], s31 offen sc1
    s_add_u32 s31, s30, 0x4368000
    buffer_store_dwordx4 v[8:11], v14, s[4:7], s31 offen sc1
    s_lshl_b32 s30, s21, 13
    s_add_u32 s31, s30, 0x4141000
    buffer_store_dwordx4 v[8:11], v71, s[4:7], s31 offen sc1
    buffer_store_dwordx4 v[8:11], v71, s[4:7], s31 offen offset:1024 sc1
    s_add_u32 s31, s30, 0x4181000
    buffer_store_dwordx4 v[8:11], v71, s[4:7], s31 offen sc1
    buffer_store_dwordx4 v[8:11], v71, s[4:7], s31 offen offset:1024 sc1
    s_add_u32 s31, s30, 0x41c1000
    buffer_store_dwordx4 v[8:11], v71, s[4:7], s31 offen sc1
    buffer_store_dwordx4 v[8:11], v71, s[4:7], s31 offen offset:1024 sc1
    s_lshl_b32 s30, s21, 8
    s_add_u32 s30, s30, 0x4300000
    v_mov_b32 v12, 0
    buffer_store_dword v12, v75, s[4:7], s30 offen
    s_and_b32 s30, s21, 7
    s_lshl_b32 s30, s30, 5
    v_xor_b32 v76, s30, v72
    v_add_u32 v72, 4096, v71
    s_waitcnt vmcnt(47)
    s_lshl_b32 s30, s21, 8
    s_add_u32 s30, s30, 0x4300000
    s_waitcnt vmcnt(43) lgkmcnt(0)
    s_barrier
    s_mov_b32 s8, s42
    s_mov_b32 s9, s43
    s_mov_b32 m0, 0x12000
    s_add_u32 s31, s83, 0x0
    buffer_load_dwordx4 v64, s[8:11], s31 offen nt lds
    s_mov_b32 m0, 0x12400
    s_add_u32 s31, s83, 0x8000
    buffer_load_dwordx4 v64, s[8:11], s31 offen nt lds
    s_mov_b32 m0, 0x12800
    s_add_u32 s31, s83, 0x10000
    buffer_load_dwordx4 v65, s[8:11], s31 offen nt lds
    s_mov_b32 m0, 0x12c00
    s_add_u32 s31, s83, 0x18000
    buffer_load_dwordx4 v65, s[8:11], s31 offen nt lds
    v_add_u32 v68, 0x14000, v76
    v_xor_b32 v74, 0, v68
    ds_read_b64_tr_b16 v[208:209], v74
    v_xor_b32 v73, 32, v68
    ds_read_b64_tr_b16 v[216:217], v73
    v_xor_b32 v74, 64, v68
    ds_read_b64_tr_b16 v[224:225], v74
    v_xor_b32 v73, 96, v68
    ds_read_b64_tr_b16 v[232:233], v73
    v_xor_b32 v74, 128, v68
    ds_read_b64_tr_b16 v[240:241], v74
    v_xor_b32 v73, 160, v68
    ds_read_b64_tr_b16 v[248:249], v73
    v_xor_b32 v74, 192, v68
    ds_read_b64_tr_b16 v[32:33], v74
    v_xor_b32 v73, 224, v68
    ds_read_b64_tr_b16 v[40:41], v73
    s_waitcnt vmcnt(43) lgkmcnt(0)
    s_barrier
    s_mov_b32 m0, 0x16000
    s_add_u32 s31, s83, 0x80000
    buffer_load_dwordx4 v64, s[8:11], s31 offen nt lds
    s_mov_b32 m0, 0x16400
    s_add_u32 s31, s83, 0x88000
    buffer_load_dwordx4 v64, s[8:11], s31 offen nt lds
    s_mov_b32 m0, 0x16800
    s_add_u32 s31, s83, 0x90000
    buffer_load_dwordx4 v65, s[8:11], s31 offen nt lds
    s_mov_b32 m0, 0x16c00
    s_add_u32 s31, s83, 0x98000
    buffer_load_dwordx4 v65, s[8:11], s31 offen nt lds
    v_add_u32 v68, 0x18000, v76
    v_xor_b32 v74, 0, v68
    ds_read_b64_tr_b16 v[210:211], v74
    v_xor_b32 v73, 32, v68
    ds_read_b64_tr_b16 v[218:219], v73
    v_xor_b32 v74, 64, v68
    ds_read_b64_tr_b16 v[226:227], v74
    v_xor_b32 v73, 96, v68
    ds_read_b64_tr_b16 v[234:235], v73
    v_xor_b32 v74, 128, v68
    ds_read_b64_tr_b16 v[242:243], v74
    v_xor_b32 v73, 160, v68
    ds_read_b64_tr_b16 v[250:251], v73
    v_xor_b32 v74, 192, v68
    ds_read_b64_tr_b16 v[34:35], v74
    v_xor_b32 v73, 224, v68
    ds_read_b64_tr_b16 v[42:43], v73
    s_waitcnt vmcnt(43) lgkmcnt(0)
    s_barrier
    s_mov_b32 m0, 0x1a000
    s_add_u32 s31, s83, 0x100000
    buffer_load_dwordx4 v64, s[8:11], s31 offen nt lds
    s_mov_b32 m0, 0x1a400
    s_add_u32 s31, s83, 0x108000
    buffer_load_dwordx4 v64, s[8:11], s31 offen nt lds
    s_mov_b32 m0, 0x1a800
    s_add_u32 s31, s83, 0x110000
    buffer_load_dwordx4 v65, s[8:11], s31 offen nt lds
    s_mov_b32 m0, 0x1ac00
    s_add_u32 s31, s83, 0x118000
    buffer_load_dwordx4 v65, s[8:11], s31 offen nt lds
    v_add_u32 v68, 0x1c000, v76
    v_xor_b32 v74, 0, v68
    ds_read_b64_tr_b16 v[212:213], v74
    v_xor_b32 v73, 32, v68
    ds_read_b64_tr_b16 v[220:221], v73
    v_xor_b32 v74, 64, v68
    ds_read_b64_tr_b16 v[228:229], v74
    v_xor_b32 v73, 96, v68
    ds_read_b64_tr_b16 v[236:237], v73
    v_xor_b32 v74, 128, v68
    ds_read_b64_tr_b16 v[244:245], v74
    v_xor_b32 v73, 160, v68
    ds_read_b64_tr_b16 v[252:253], v73
    v_xor_b32 v74, 192, v68
    ds_read_b64_tr_b16 v[36:37], v74
    v_xor_b32 v73, 224, v68
    ds_read_b64_tr_b16 v[44:45], v73
    s_waitcnt vmcnt(43) lgkmcnt(0)
    s_barrier
    s_mov_b32 m0, 0x1e000
    s_add_u32 s31, s83, 0x180000
    buffer_load_dwordx4 v64, s[8:11], s31 offen nt lds
    s_mov_b32 m0, 0x1e400
    s_add_u32 s31, s83, 0x188000
    buffer_load_dwordx4 v64, s[8:11], s31 offen nt lds
    s_mov_b32 m0, 0x1e800
    s_add_u32 s31, s83, 0x190000
    buffer_load_dwordx4 v65, s[8:11], s31 offen nt lds
    s_mov_b32 m0, 0x1ec00
    s_add_u32 s31, s83, 0x198000
    buffer_load_dwordx4 v65, s[8:11], s31 offen nt lds
    v_add_u32 v68, 0x20000, v76
    v_xor_b32 v74, 0, v68
    ds_read_b64_tr_b16 v[214:215], v74
    v_xor_b32 v73, 32, v68
    ds_read_b64_tr_b16 v[222:223], v73
    v_xor_b32 v74, 64, v68
    ds_read_b64_tr_b16 v[230:231], v74
    v_xor_b32 v73, 96, v68
    ds_read_b64_tr_b16 v[238:239], v73
    v_xor_b32 v74, 128, v68
    ds_read_b64_tr_b16 v[246:247], v74
    v_xor_b32 v73, 160, v68
    ds_read_b64_tr_b16 v[254:255], v73
    v_xor_b32 v74, 192, v68
    ds_read_b64_tr_b16 v[38:39], v74
    v_xor_b32 v73, 224, v68
    ds_read_b64_tr_b16 v[46:47], v73
    s_waitcnt vmcnt(43) lgkmcnt(0)
    s_barrier
    s_mov_b32 m0, 0x22000
    s_add_u32 s31, s83, 0x200000
    buffer_load_dwordx4 v64, s[8:11], s31 offen nt lds
    s_mov_b32 m0, 0x22400
    s_add_u32 s31, s83, 0x208000
    buffer_load_dwordx4 v64, s[8:11], s31 offen nt lds
    s_mov_b32 m0, 0x22800
    s_add_u32 s31, s83, 0x210000
    buffer_load_dwordx4 v65, s[8:11], s31 offen nt lds
    s_mov_b32 m0, 0x22c00
    s_add_u32 s31, s83, 0x218000
    buffer_load_dwordx4 v65, s[8:11], s31 offen nt lds
    ds_write_b128 v72, v[32:35] offset:16384
    ds_write_b128 v72, v[36:39] offset:17408
    ds_write_b128 v72, v[40:43] offset:24576
    ds_write_b128 v72, v[44:47] offset:25600
    v_add_u32 v68, 0x24000, v76
    v_xor_b32 v74, 0, v68
    ds_read_b64_tr_b16 v[0:1], v74
    v_xor_b32 v73, 32, v68
    ds_read_b64_tr_b16 v[8:9], v73
    v_xor_b32 v74, 64, v68
    ds_read_b64_tr_b16 v[16:17], v74
    v_xor_b32 v73, 96, v68
    ds_read_b64_tr_b16 v[24:25], v73
    v_xor_b32 v74, 128, v68
    ds_read_b64_tr_b16 v[32:33], v74
    v_xor_b32 v73, 160, v68
    ds_read_b64_tr_b16 v[40:41], v73
    v_xor_b32 v74, 192, v68
    ds_read_b64_tr_b16 v[48:49], v74
    v_xor_b32 v73, 224, v68
    ds_read_b64_tr_b16 v[56:57], v73
    s_waitcnt vmcnt(43) lgkmcnt(0)
    s_barrier
    s_mov_b32 m0, 0x26000
    s_add_u32 s31, s83, 0x280000
    buffer_load_dwordx4 v64, s[8:11], s31 offen nt lds
    s_mov_b32 m0, 0x26400
    s_add_u32 s31, s83, 0x288000
    buffer_load_dwordx4 v64, s[8:11], s31 offen nt lds
    s_mov_b32 m0, 0x26800
    s_add_u32 s31, s83, 0x290000
    buffer_load_dwordx4 v65, s[8:11], s31 offen nt lds
    s_mov_b32 m0, 0x26c00
    s_add_u32 s31, s83, 0x298000
    buffer_load_dwordx4 v65, s[8:11], s31 offen nt lds
    v_add_u32 v68, 0x0, v76
    v_xor_b32 v74, 0, v68
    ds_read_b64_tr_b16 v[2:3], v74
    v_xor_b32 v73, 32, v68
    ds_read_b64_tr_b16 v[10:11], v73
    v_xor_b32 v74, 64, v68
    ds_read_b64_tr_b16 v[18:19], v74
    v_xor_b32 v73, 96, v68
    ds_read_b64_tr_b16 v[26:27], v73
    v_xor_b32 v74, 128, v68
    ds_read_b64_tr_b16 v[34:35], v74
    v_xor_b32 v73, 160, v68
    ds_read_b64_tr_b16 v[42:43], v73
    v_xor_b32 v74, 192, v68
    ds_read_b64_tr_b16 v[50:51], v74
    v_xor_b32 v73, 224, v68
    ds_read_b64_tr_b16 v[58:59], v73
    s_waitcnt vmcnt(43) lgkmcnt(0)
    s_barrier
    s_mov_b32 m0, 0x2000
    s_add_u32 s31, s83, 0x300000
    buffer_load_dwordx4 v64, s[8:11], s31 offen nt lds
    s_mov_b32 m0, 0x2400
    s_add_u32 s31, s83, 0x308000
    buffer_load_dwordx4 v64, s[8:11], s31 offen nt lds
    s_mov_b32 m0, 0x2800
    s_add_u32 s31, s83, 0x310000
    buffer_load_dwordx4 v65, s[8:11], s31 offen nt lds
    s_mov_b32 m0, 0x2c00
    s_add_u32 s31, s83, 0x318000
    buffer_load_dwordx4 v65, s[8:11], s31 offen nt lds
    v_add_u32 v68, 0x8000, v76
    v_xor_b32 v74, 0, v68
    ds_read_b64_tr_b16 v[4:5], v74
    v_xor_b32 v73, 32, v68
    ds_read_b64_tr_b16 v[12:13], v73
    v_xor_b32 v74, 64, v68
    ds_read_b64_tr_b16 v[20:21], v74
    v_xor_b32 v73, 96, v68
    ds_read_b64_tr_b16 v[28:29], v73
    v_xor_b32 v74, 128, v68
    ds_read_b64_tr_b16 v[36:37], v74
    v_xor_b32 v73, 160, v68
    ds_read_b64_tr_b16 v[44:45], v73
    v_xor_b32 v74, 192, v68
    ds_read_b64_tr_b16 v[52:53], v74
    v_xor_b32 v73, 224, v68
    ds_read_b64_tr_b16 v[60:61], v73
    s_waitcnt vmcnt(43) lgkmcnt(0)
    s_barrier
    s_mov_b32 m0, 0xa000
    s_add_u32 s31, s83, 0x380000
    buffer_load_dwordx4 v64, s[8:11], s31 offen nt lds
    s_mov_b32 m0, 0xa400
    s_add_u32 s31, s83, 0x388000
    buffer_load_dwordx4 v64, s[8:11], s31 offen nt lds
    s_mov_b32 m0, 0xa800
    s_add_u32 s31, s83, 0x390000
    buffer_load_dwordx4 v65, s[8:11], s31 offen nt lds
    s_mov_b32 m0, 0xac00
    s_add_u32 s31, s83, 0x398000
    buffer_load_dwordx4 v65, s[8:11], s31 offen nt lds
    v_add_u32 v68, 0xc000, v76
    v_xor_b32 v74, 0, v68
    ds_read_b64_tr_b16 v[6:7], v74
    v_xor_b32 v73, 32, v68
    ds_read_b64_tr_b16 v[14:15], v73
    v_xor_b32 v74, 64, v68
    ds_read_b64_tr_b16 v[22:23], v74
    v_xor_b32 v73, 96, v68
    ds_read_b64_tr_b16 v[30:31], v73
    v_xor_b32 v74, 128, v68
    ds_read_b64_tr_b16 v[38:39], v74
    v_xor_b32 v73, 160, v68
    ds_read_b64_tr_b16 v[46:47], v73
    v_xor_b32 v74, 192, v68
    ds_read_b64_tr_b16 v[54:55], v74
    v_xor_b32 v73, 224, v68
    ds_read_b64_tr_b16 v[62:63], v73
    s_waitcnt vmcnt(28) lgkmcnt(0)
    s_barrier
    s_mov_b32 s8, s44
    s_mov_b32 s9, s45
    s_mov_b32 m0, 0xe000
    s_add_u32 s31, s83, 0x0
    buffer_load_dwordx4 v64, s[8:11], s31 offen nt lds
    s_mov_b32 m0, 0xe400
    s_add_u32 s31, s83, 0x8000
    buffer_load_dwordx4 v64, s[8:11], s31 offen nt lds
    s_mov_b32 m0, 0xe800
    s_add_u32 s31, s83, 0x10000
    buffer_load_dwordx4 v65, s[8:11], s31 offen nt lds
    s_mov_b32 m0, 0xec00
    s_add_u32 s31, s83, 0x18000
    buffer_load_dwordx4 v65, s[8:11], s31 offen nt lds
    v_add_u32 v68, 0x10000, v66
    v_add_u32 v69, 0x10000, v67
    ds_read_b64_tr_b16 a[96:97], v68 offset:0
    ds_read_b64_tr_b16 a[98:99], v68 offset:1024
    ds_read_b64_tr_b16 a[100:101], v68 offset:8192
    ds_read_b64_tr_b16 a[102:103], v68 offset:9216
    ds_read_b64_tr_b16 a[160:161], v69 offset:0
    ds_read_b64_tr_b16 a[162:163], v69 offset:1024
    ds_read_b64_tr_b16 a[164:165], v69 offset:8192
    ds_read_b64_tr_b16 a[166:167], v69 offset:9216
    s_waitcnt vmcnt(28) lgkmcnt(0)
    s_barrier
    s_mov_b32 m0, 0x12000
    s_add_u32 s31, s83, 0x80000
    buffer_load_dwordx4 v64, s[8:11], s31 offen nt lds
    s_mov_b32 m0, 0x12400
    s_add_u32 s31, s83, 0x88000
    buffer_load_dwordx4 v64, s[8:11], s31 offen nt lds
    s_mov_b32 m0, 0x12800
    s_add_u32 s31, s83, 0x90000
    buffer_load_dwordx4 v65, s[8:11], s31 offen nt lds
    s_mov_b32 m0, 0x12c00
    s_add_u32 s31, s83, 0x98000
    buffer_load_dwordx4 v65, s[8:11], s31 offen nt lds
    v_add_u32 v68, 0x14000, v66
    v_add_u32 v69, 0x14000, v67
    ds_read_b64_tr_b16 a[104:105], v68 offset:0
    ds_read_b64_tr_b16 a[106:107], v68 offset:1024
    ds_read_b64_tr_b16 a[108:109], v68 offset:8192
    ds_read_b64_tr_b16 a[110:111], v68 offset:9216
    ds_read_b64_tr_b16 a[168:169], v69 offset:0
    ds_read_b64_tr_b16 a[170:171], v69 offset:1024
    ds_read_b64_tr_b16 a[172:173], v69 offset:8192
    ds_read_b64_tr_b16 a[174:175], v69 offset:9216
    s_waitcnt vmcnt(28) lgkmcnt(0)
    s_barrier
    s_mov_b32 m0, 0x16000
    s_add_u32 s31, s83, 0x100000
    buffer_load_dwordx4 v64, s[8:11], s31 offen nt lds
    s_mov_b32 m0, 0x16400
    s_add_u32 s31, s83, 0x108000
    buffer_load_dwordx4 v64, s[8:11], s31 offen nt lds
    s_mov_b32 m0, 0x16800
    s_add_u32 s31, s83, 0x110000
    buffer_load_dwordx4 v65, s[8:11], s31 offen nt lds
    s_mov_b32 m0, 0x16c00
    s_add_u32 s31, s83, 0x118000
    buffer_load_dwordx4 v65, s[8:11], s31 offen nt lds
    v_add_u32 v68, 0x18000, v66
    v_add_u32 v69, 0x18000, v67
    ds_read_b64_tr_b16 a[112:113], v68 offset:0
    ds_read_b64_tr_b16 a[114:115], v68 offset:1024
    ds_read_b64_tr_b16 a[116:117], v68 offset:8192
    ds_read_b64_tr_b16 a[118:119], v68 offset:9216
    ds_read_b64_tr_b16 a[176:177], v69 offset:0
    ds_read_b64_tr_b16 a[178:179], v69 offset:1024
    ds_read_b64_tr_b16 a[180:181], v69 offset:8192
    ds_read_b64_tr_b16 a[182:183], v69 offset:9216
    s_waitcnt vmcnt(28) lgkmcnt(0)
    s_barrier
    s_mov_b32 m0, 0x1a000
    s_add_u32 s31, s83, 0x180000
    buffer_load_dwordx4 v64, s[8:11], s31 offen nt lds
    s_mov_b32 m0, 0x1a400
    s_add_u32 s31, s83, 0x188000
    buffer_load_dwordx4 v64, s[8:11], s31 offen nt lds
    s_mov_b32 m0, 0x1a800
    s_add_u32 s31, s83, 0x190000
    buffer_load_dwordx4 v65, s[8:11], s31 offen nt lds
    s_mov_b32 m0, 0x1ac00
    s_add_u32 s31, s83, 0x198000
    buffer_load_dwordx4 v65, s[8:11], s31 offen nt lds
    v_add_u32 v68, 0x1c000, v66
    v_add_u32 v69, 0x1c000, v67
    ds_read_b64_tr_b16 a[120:121], v68 offset:0
    ds_read_b64_tr_b16 a[122:123], v68 offset:1024
    ds_read_b64_tr_b16 a[124:125], v68 offset:8192
    ds_read_b64_tr_b16 a[126:127], v68 offset:9216
    ds_read_b64_tr_b16 a[184:185], v69 offset:0
    ds_read_b64_tr_b16 a[186:187], v69 offset:1024
    ds_read_b64_tr_b16 a[188:189], v69 offset:8192
    ds_read_b64_tr_b16 a[190:191], v69 offset:9216
    s_waitcnt vmcnt(28) lgkmcnt(0)
    s_barrier
    s_mov_b32 m0, 0x1e000
    s_add_u32 s31, s83, 0x200000
    buffer_load_dwordx4 v64, s[8:11], s31 offen nt lds
    s_mov_b32 m0, 0x1e400
    s_add_u32 s31, s83, 0x208000
    buffer_load_dwordx4 v64, s[8:11], s31 offen nt lds
    s_mov_b32 m0, 0x1e800
    s_add_u32 s31, s83, 0x210000
    buffer_load_dwordx4 v65, s[8:11], s31 offen nt lds
    s_mov_b32 m0, 0x1ec00
    s_add_u32 s31, s83, 0x218000
    buffer_load_dwordx4 v65, s[8:11], s31 offen nt lds
    v_add_u32 v68, 0x20000, v66
    v_add_u32 v69, 0x20000, v67
    ds_read_b64_tr_b16 a[64:65], v68 offset:0
    ds_read_b64_tr_b16 a[66:67], v68 offset:1024
    ds_read_b64_tr_b16 a[68:69], v68 offset:8192
    ds_read_b64_tr_b16 a[70:71], v68 offset:9216
    ds_read_b64_tr_b16 a[128:129], v69 offset:0
    ds_read_b64_tr_b16 a[130:131], v69 offset:1024
    ds_read_b64_tr_b16 a[132:133], v69 offset:8192
    ds_read_b64_tr_b16 a[134:135], v69 offset:9216
    s_waitcnt vmcnt(28) lgkmcnt(0)
    s_barrier
    s_mov_b32 m0, 0x22000
    s_add_u32 s31, s83, 0x280000
    buffer_load_dwordx4 v64, s[8:11], s31 offen nt lds
    s_mov_b32 m0, 0x22400
    s_add_u32 s31, s83, 0x288000
    buffer_load_dwordx4 v64, s[8:11], s31 offen nt lds
    s_mov_b32 m0, 0x22800
    s_add_u32 s31, s83, 0x290000
    buffer_load_dwordx4 v65, s[8:11], s31 offen nt lds
    s_mov_b32 m0, 0x22c00
    s_add_u32 s31, s83, 0x298000
    buffer_load_dwordx4 v65, s[8:11], s31 offen nt lds
    v_add_u32 v68, 0x24000, v66
    v_add_u32 v69, 0x24000, v67
    ds_read_b64_tr_b16 a[72:73], v68 offset:0
    ds_read_b64_tr_b16 a[74:75], v68 offset:1024
    ds_read_b64_tr_b16 a[76:77], v68 offset:8192
    ds_read_b64_tr_b16 a[78:79], v68 offset:9216
    ds_read_b64_tr_b16 a[136:137], v69 offset:0
    ds_read_b64_tr_b16 a[138:139], v69 offset:1024
    ds_read_b64_tr_b16 a[140:141], v69 offset:8192
    ds_read_b64_tr_b16 a[142:143], v69 offset:9216
    s_waitcnt vmcnt(28) lgkmcnt(0)
    s_barrier
    s_mov_b32 m0, 0x26000
    s_add_u32 s31, s83, 0x300000
    buffer_load_dwordx4 v64, s[8:11], s31 offen nt lds
    s_mov_b32 m0, 0x26400
    s_add_u32 s31, s83, 0x308000
    buffer_load_dwordx4 v64, s[8:11], s31 offen nt lds
    s_mov_b32 m0, 0x26800
    s_add_u32 s31, s83, 0x310000
    buffer_load_dwordx4 v65, s[8:11], s31 offen nt lds
    s_mov_b32 m0, 0x26c00
    s_add_u32 s31, s83, 0x318000
    buffer_load_dwordx4 v65, s[8:11], s31 offen nt lds
    v_add_u32 v68, 0x0, v66
    v_add_u32 v69, 0x0, v67
    ds_read_b64_tr_b16 a[80:81], v68 offset:0
    ds_read_b64_tr_b16 a[82:83], v68 offset:1024
    ds_read_b64_tr_b16 a[84:85], v68 offset:8192
    ds_read_b64_tr_b16 a[86:87], v68 offset:9216
    ds_read_b64_tr_b16 a[144:145], v69 offset:0
    ds_read_b64_tr_b16 a[146:147], v69 offset:1024
    ds_read_b64_tr_b16 a[148:149], v69 offset:8192
    ds_read_b64_tr_b16 a[150:151], v69 offset:9216
    s_waitcnt vmcnt(28) lgkmcnt(0)
    s_barrier
    s_mov_b32 m0, 0x2000
    s_add_u32 s31, s83, 0x380000
    buffer_load_dwordx4 v64, s[8:11], s31 offen nt lds
    s_mov_b32 m0, 0x2400
    s_add_u32 s31, s83, 0x388000
    buffer_load_dwordx4 v64, s[8:11], s31 offen nt lds
    s_mov_b32 m0, 0x2800
    s_add_u32 s31, s83, 0x390000
    buffer_load_dwordx4 v65, s[8:11], s31 offen nt lds
    s_mov_b32 m0, 0x2c00
    s_add_u32 s31, s83, 0x398000
    buffer_load_dwordx4 v65, s[8:11], s31 offen nt lds
    v_add_u32 v68, 0x8000, v66
    v_add_u32 v69, 0x8000, v67
    ds_read_b64_tr_b16 a[88:89], v68 offset:0
    ds_read_b64_tr_b16 a[90:91], v68 offset:1024
    ds_read_b64_tr_b16 a[92:93], v68 offset:8192
    ds_read_b64_tr_b16 a[94:95], v68 offset:9216
    ds_read_b64_tr_b16 a[152:153], v69 offset:0
    ds_read_b64_tr_b16 a[154:155], v69 offset:1024
    ds_read_b64_tr_b16 a[156:157], v69 offset:8192
    ds_read_b64_tr_b16 a[158:159], v69 offset:9216
    s_waitcnt vmcnt(28) lgkmcnt(0)
    s_barrier
    s_mov_b32 s8, s40
    s_mov_b32 s9, s41
    s_mov_b32 m0, 0xa000
    s_add_u32 s31, s83, 0x0
    buffer_load_dwordx4 v64, s[8:11], s31 offen nt lds
    s_mov_b32 m0, 0xa400
    s_add_u32 s31, s83, 0x8000
    buffer_load_dwordx4 v64, s[8:11], s31 offen nt lds
    s_mov_b32 m0, 0xa800
    s_add_u32 s31, s83, 0x10000
    buffer_load_dwordx4 v65, s[8:11], s31 offen nt lds
    s_mov_b32 m0, 0xac00
    s_add_u32 s31, s83, 0x18000
    buffer_load_dwordx4 v65, s[8:11], s31 offen nt lds
    v_add_u32 v68, 0xc000, v66
    v_add_u32 v69, 0xc000, v67
    ds_read_b64_tr_b16 a[224:225], v68 offset:0
    ds_read_b64_tr_b16 a[226:227], v68 offset:1024
    ds_read_b64_tr_b16 a[228:229], v68 offset:8192
    ds_read_b64_tr_b16 a[230:231], v68 offset:9216
    ds_read_b64_tr_b16 v[176:177], v69 offset:0
    ds_read_b64_tr_b16 v[178:179], v69 offset:1024
    ds_read_b64_tr_b16 v[180:181], v69 offset:8192
    ds_read_b64_tr_b16 v[182:183], v69 offset:9216
    s_waitcnt vmcnt(28) lgkmcnt(0)
    s_barrier
    s_mov_b32 m0, 0xe000
    s_add_u32 s31, s83, 0x80000
    buffer_load_dwordx4 v64, s[8:11], s31 offen nt lds
    s_mov_b32 m0, 0xe400
    s_add_u32 s31, s83, 0x88000
    buffer_load_dwordx4 v64, s[8:11], s31 offen nt lds
    s_mov_b32 m0, 0xe800
    s_add_u32 s31, s83, 0x90000
    buffer_load_dwordx4 v65, s[8:11], s31 offen nt lds
    s_mov_b32 m0, 0xec00
    s_add_u32 s31, s83, 0x98000
    buffer_load_dwordx4 v65, s[8:11], s31 offen nt lds
    v_add_u32 v68, 0x10000, v66
    v_add_u32 v69, 0x10000, v67
    ds_read_b64_tr_b16 a[232:233], v68 offset:0
    ds_read_b64_tr_b16 a[234:235], v68 offset:1024
    ds_read_b64_tr_b16 a[236:237], v68 offset:8192
    ds_read_b64_tr_b16 a[238:239], v68 offset:9216
    ds_read_b64_tr_b16 v[184:185], v69 offset:0
    ds_read_b64_tr_b16 v[186:187], v69 offset:1024
    ds_read_b64_tr_b16 v[188:189], v69 offset:8192
    ds_read_b64_tr_b16 v[190:191], v69 offset:9216
    s_waitcnt vmcnt(28) lgkmcnt(0)
    s_barrier
    s_mov_b32 m0, 0x12000
    s_add_u32 s31, s83, 0x100000
    buffer_load_dwordx4 v64, s[8:11], s31 offen nt lds
    s_mov_b32 m0, 0x12400
    s_add_u32 s31, s83, 0x108000
    buffer_load_dwordx4 v64, s[8:11], s31 offen nt lds
    s_mov_b32 m0, 0x12800
    s_add_u32 s31, s83, 0x110000
    buffer_load_dwordx4 v65, s[8:11], s31 offen nt lds
    s_mov_b32 m0, 0x12c00
    s_add_u32 s31, s83, 0x118000
    buffer_load_dwordx4 v65, s[8:11], s31 offen nt lds
    v_add_u32 v68, 0x14000, v66
    v_add_u32 v69, 0x14000, v67
    ds_read_b64_tr_b16 a[240:241], v68 offset:0
    ds_read_b64_tr_b16 a[242:243], v68 offset:1024
    ds_read_b64_tr_b16 a[244:245], v68 offset:8192
    ds_read_b64_tr_b16 a[246:247], v68 offset:9216
    ds_read_b64_tr_b16 v[192:193], v69 offset:0
    ds_read_b64_tr_b16 v[194:195], v69 offset:1024
    ds_read_b64_tr_b16 v[196:197], v69 offset:8192
    ds_read_b64_tr_b16 v[198:199], v69 offset:9216
    s_waitcnt vmcnt(28) lgkmcnt(0)
    s_barrier
    s_mov_b32 m0, 0x16000
    s_add_u32 s31, s83, 0x180000
    buffer_load_dwordx4 v64, s[8:11], s31 offen nt lds
    s_mov_b32 m0, 0x16400
    s_add_u32 s31, s83, 0x188000
    buffer_load_dwordx4 v64, s[8:11], s31 offen nt lds
    s_mov_b32 m0, 0x16800
    s_add_u32 s31, s83, 0x190000
    buffer_load_dwordx4 v65, s[8:11], s31 offen nt lds
    s_mov_b32 m0, 0x16c00
    s_add_u32 s31, s83, 0x198000
    buffer_load_dwordx4 v65, s[8:11], s31 offen nt lds
    v_add_u32 v68, 0x18000, v66
    v_add_u32 v69, 0x18000, v67
    ds_read_b64_tr_b16 a[248:249], v68 offset:0
    ds_read_b64_tr_b16 a[250:251], v68 offset:1024
    ds_read_b64_tr_b16 a[252:253], v68 offset:8192
    ds_read_b64_tr_b16 a[254:255], v68 offset:9216
    ds_read_b64_tr_b16 v[200:201], v69 offset:0
    ds_read_b64_tr_b16 v[202:203], v69 offset:1024
    ds_read_b64_tr_b16 v[204:205], v69 offset:8192
    ds_read_b64_tr_b16 v[206:207], v69 offset:9216
    s_waitcnt vmcnt(28) lgkmcnt(0)
    s_barrier
    s_mov_b32 m0, 0x1a000
    s_add_u32 s31, s83, 0x200000
    buffer_load_dwordx4 v64, s[8:11], s31 offen nt lds
    s_mov_b32 m0, 0x1a400
    s_add_u32 s31, s83, 0x208000
    buffer_load_dwordx4 v64, s[8:11], s31 offen nt lds
    s_mov_b32 m0, 0x1a800
    s_add_u32 s31, s83, 0x210000
    buffer_load_dwordx4 v65, s[8:11], s31 offen nt lds
    s_mov_b32 m0, 0x1ac00
    s_add_u32 s31, s83, 0x218000
    buffer_load_dwordx4 v65, s[8:11], s31 offen nt lds
    v_add_u32 v68, 0x1c000, v66
    v_add_u32 v69, 0x1c000, v67
    ds_read_b64_tr_b16 a[192:193], v68 offset:0
    ds_read_b64_tr_b16 a[194:195], v68 offset:1024
    ds_read_b64_tr_b16 a[196:197], v68 offset:8192
    ds_read_b64_tr_b16 a[198:199], v68 offset:9216
    ds_read_b64_tr_b16 v[144:145], v69 offset:0
    ds_read_b64_tr_b16 v[146:147], v69 offset:1024
    ds_read_b64_tr_b16 v[148:149], v69 offset:8192
    ds_read_b64_tr_b16 v[150:151], v69 offset:9216
    s_waitcnt vmcnt(28) lgkmcnt(0)
    s_barrier
    s_mov_b32 m0, 0x1e000
    s_add_u32 s31, s83, 0x280000
    buffer_load_dwordx4 v64, s[8:11], s31 offen nt lds
    s_mov_b32 m0, 0x1e400
    s_add_u32 s31, s83, 0x288000
    buffer_load_dwordx4 v64, s[8:11], s31 offen nt lds
    s_mov_b32 m0, 0x1e800
    s_add_u32 s31, s83, 0x290000
    buffer_load_dwordx4 v65, s[8:11], s31 offen nt lds
    s_mov_b32 m0, 0x1ec00
    s_add_u32 s31, s83, 0x298000
    buffer_load_dwordx4 v65, s[8:11], s31 offen nt lds
    v_add_u32 v68, 0x20000, v66
    v_add_u32 v69, 0x20000, v67
    ds_read_b64_tr_b16 a[200:201], v68 offset:0
    ds_read_b64_tr_b16 a[202:203], v68 offset:1024
    ds_read_b64_tr_b16 a[204:205], v68 offset:8192
    ds_read_b64_tr_b16 a[206:207], v68 offset:9216
    ds_read_b64_tr_b16 v[152:153], v69 offset:0
    ds_read_b64_tr_b16 v[154:155], v69 offset:1024
    ds_read_b64_tr_b16 v[156:157], v69 offset:8192
    ds_read_b64_tr_b16 v[158:159], v69 offset:9216
    s_waitcnt vmcnt(28) lgkmcnt(0)
    s_barrier
    s_mov_b32 m0, 0x22000
    s_add_u32 s31, s83, 0x300000
    buffer_load_dwordx4 v64, s[8:11], s31 offen nt lds
    s_mov_b32 m0, 0x22400
    s_add_u32 s31, s83, 0x308000
    buffer_load_dwordx4 v64, s[8:11], s31 offen nt lds
    s_mov_b32 m0, 0x22800
    s_add_u32 s31, s83, 0x310000
    buffer_load_dwordx4 v65, s[8:11], s31 offen nt lds
    s_mov_b32 m0, 0x22c00
    s_add_u32 s31, s83, 0x318000
    buffer_load_dwordx4 v65, s[8:11], s31 offen nt lds
    v_add_u32 v68, 0x24000, v66
    v_add_u32 v69, 0x24000, v67
    ds_read_b64_tr_b16 a[208:209], v68 offset:0
    ds_read_b64_tr_b16 a[210:211], v68 offset:1024
    ds_read_b64_tr_b16 a[212:213], v68 offset:8192
    ds_read_b64_tr_b16 a[214:215], v68 offset:9216
    ds_read_b64_tr_b16 v[160:161], v69 offset:0
    ds_read_b64_tr_b16 v[162:163], v69 offset:1024
    ds_read_b64_tr_b16 v[164:165], v69 offset:8192
    ds_read_b64_tr_b16 v[166:167], v69 offset:9216
    s_waitcnt vmcnt(28) lgkmcnt(0)
    s_barrier
    s_mov_b32 m0, 0x26000
    s_add_u32 s31, s83, 0x380000
    buffer_load_dwordx4 v64, s[8:11], s31 offen nt lds
    s_mov_b32 m0, 0x26400
    s_add_u32 s31, s83, 0x388000
    buffer_load_dwordx4 v64, s[8:11], s31 offen nt lds
    s_mov_b32 m0, 0x26800
    s_add_u32 s31, s83, 0x390000
    buffer_load_dwordx4 v65, s[8:11], s31 offen nt lds
    s_mov_b32 m0, 0x26c00
    s_add_u32 s31, s83, 0x398000
    buffer_load_dwordx4 v65, s[8:11], s31 offen nt lds
    v_add_u32 v68, 0x0, v66
    v_add_u32 v69, 0x0, v67
    ds_read_b64_tr_b16 a[216:217], v68 offset:0
    ds_read_b64_tr_b16 a[218:219], v68 offset:1024
    ds_read_b64_tr_b16 a[220:221], v68 offset:8192
    ds_read_b64_tr_b16 a[222:223], v68 offset:9216
    ds_read_b64_tr_b16 v[168:169], v69 offset:0
    ds_read_b64_tr_b16 v[170:171], v69 offset:1024
    ds_read_b64_tr_b16 v[172:173], v69 offset:8192
    ds_read_b64_tr_b16 v[174:175], v69 offset:9216
    s_waitcnt vmcnt(28) lgkmcnt(0)
    s_barrier
    v_add_u32 v64, 0x8000, v66
    v_add_u32 v65, 0x8000, v67
    ds_read_b64_tr_b16 v[112:113], v64 offset:0
    ds_read_b64_tr_b16 v[114:115], v64 offset:1024
    ds_read_b64_tr_b16 v[116:117], v64 offset:8192
    ds_read_b64_tr_b16 v[118:119], v64 offset:9216
    ds_read_b64_tr_b16 a[32:33], v65 offset:0
    ds_read_b64_tr_b16 a[34:35], v65 offset:1024
    ds_read_b64_tr_b16 a[36:37], v65 offset:8192
    ds_read_b64_tr_b16 a[38:39], v65 offset:9216
    s_waitcnt vmcnt(24) lgkmcnt(0)
    s_barrier
    v_add_u32 v64, 0xc000, v66
    v_add_u32 v65, 0xc000, v67
    ds_read_b64_tr_b16 v[120:121], v64 offset:0
    ds_read_b64_tr_b16 v[122:123], v64 offset:1024
    ds_read_b64_tr_b16 v[124:125], v64 offset:8192
    ds_read_b64_tr_b16 v[126:127], v64 offset:9216
    ds_read_b64_tr_b16 a[40:41], v65 offset:0
    ds_read_b64_tr_b16 a[42:43], v65 offset:1024
    ds_read_b64_tr_b16 a[44:45], v65 offset:8192
    ds_read_b64_tr_b16 a[46:47], v65 offset:9216
    s_waitcnt vmcnt(20) lgkmcnt(0)
    s_barrier
    v_add_u32 v64, 0x10000, v66
    v_add_u32 v65, 0x10000, v67
    ds_read_b64_tr_b16 v[128:129], v64 offset:0
    ds_read_b64_tr_b16 v[130:131], v64 offset:1024
    ds_read_b64_tr_b16 v[132:133], v64 offset:8192
    ds_read_b64_tr_b16 v[134:135], v64 offset:9216
    ds_read_b64_tr_b16 a[48:49], v65 offset:0
    ds_read_b64_tr_b16 a[50:51], v65 offset:1024
    ds_read_b64_tr_b16 a[52:53], v65 offset:8192
    ds_read_b64_tr_b16 a[54:55], v65 offset:9216
    s_waitcnt vmcnt(16) lgkmcnt(0)
    s_barrier
    v_add_u32 v64, 0x14000, v66
    v_add_u32 v65, 0x14000, v67
    ds_read_b64_tr_b16 v[136:137], v64 offset:0
    ds_read_b64_tr_b16 v[138:139], v64 offset:1024
    ds_read_b64_tr_b16 v[140:141], v64 offset:8192
    ds_read_b64_tr_b16 v[142:143], v64 offset:9216
    ds_read_b64_tr_b16 a[56:57], v65 offset:0
    ds_read_b64_tr_b16 a[58:59], v65 offset:1024
    ds_read_b64_tr_b16 a[60:61], v65 offset:8192
    ds_read_b64_tr_b16 a[62:63], v65 offset:9216
    s_waitcnt vmcnt(12) lgkmcnt(0)
    s_barrier
    v_add_u32 v65, 0x10000, v72
    ds_write_b128 v72, v[0:3] offset:32768
    ds_write_b128 v72, v[4:7] offset:33792
    ds_write_b128 v72, v[8:11] offset:40960
    ds_write_b128 v72, v[12:15] offset:41984
    ds_write_b128 v72, v[16:19] offset:49152
    ds_write_b128 v72, v[20:23] offset:50176
    ds_write_b128 v72, v[24:27] offset:57344
    ds_write_b128 v72, v[28:31] offset:58368
    ds_write_b128 v65, v[32:35] offset:0
    ds_write_b128 v65, v[36:39] offset:1024
    ds_write_b128 v65, v[40:43] offset:8192
    ds_write_b128 v65, v[44:47] offset:9216
    ds_write_b128 v65, v[48:51] offset:16384
    ds_write_b128 v65, v[52:55] offset:17408
    ds_write_b128 v65, v[56:59] offset:24576
    ds_write_b128 v65, v[60:63] offset:25600
    v_lshrrev_b32 v0, 4, v71
    v_and_b32 v1, 8, v0
    v_cmp_ne_u32 s[66:67], 0, v1
    v_and_b32 v1, 2, v0
    v_cmp_ne_u32 vcc, 0, v1
    v_mov_b32 v2, 0x4444
    v_mov_b32 v3, 0xeeee
    v_cndmask_b32 v70, v2, v3, vcc
    v_and_b32 v1, 11, v0
    v_cmp_eq_u32 s[70:71], 0, v1
    v_cmp_eq_u32 s[72:73], 1, v1
    v_cmp_eq_u32 s[74:75], 8, v1
    v_cmp_eq_u32 s[76:77], 9, v1
    v_and_b32 v3, 1, v0
    v_lshlrev_b32 v3, 4, v3
    v_mov_b32 v4, 0x3f80
    v_lshlrev_b32 v4, v3, v4
    v_lshrrev_b32 v5, 4, v0
    v_bfe_u32 v1, v0, 1, 2
    v_cmp_eq_u32 vcc, v1, v5
    s_nop 1
    v_cndmask_b32 v68, 0, v4, vcc
    v_cndmask_b32 v69, 0, v4, vcc
    v_bfe_u32 v1, v0, 2, 2
    v_cmp_eq_u32 vcc, v1, v5
    s_nop 1
    v_cndmask_b32 v76, 0, v4, vcc
    v_cndmask_b32 v77, 0, v4, vcc
    v_and_b32 v1, 0x31, v0
    v_bfe_u32 v2, v0, 1, 2
    v_lshl_or_b32 v1, v2, 2, v1
    v_bfe_u32 v2, v0, 3, 1
    v_lshl_or_b32 v1, v2, 1, v1
    v_lshlrev_b32 v1, 4, v1
    s_lshr_b32 s30, s20, 1
    s_lshl_b32 s30, s30, 11
    s_and_b32 s31, s20, 1
    s_lshl_b32 s31, s31, 3
    s_add_u32 s30, s30, s31
    v_add_u32 v78, s30, v1
    s_mov_b32 s35, 0x3e0293ee
    s_lshl_b32 s30, s21, 14
    s_lshl_b32 s31, s20, 12
    s_add_u32 s28, s30, s31
    s_add_u32 s28, s28, 0x1200000
    s_lshr_b32 s30, s30, 1
    s_lshr_b32 s31, s31, 1
    s_add_u32 s29, s30, s31
    s_add_u32 s29, s29, 0x3200000
    s_add_u32 s27, s30, s31
    s_add_u32 s27, s27, 0x4200000
    s_add_u32 s25, s31, 0x4300000
    s_lshl_b32 s30, s21, 10
    s_lshl_b32 s31, s20, 2
    s_add_u32 s82, s30, s31
    s_add_u32 s81, s82, 0x5600080
    s_lshl_b32 s30, s21, 6
    s_lshl_b32 s31, s20, 16
    s_add_u32 s26, s30, s31
    s_add_u32 s26, s26, 0x4200000
    s_add_u32 s80, s82, 0x5600100
    s_lshl_b32 s30, s21, 8
    s_lshl_b32 s31, s20, 6
    s_add_u32 s30, s30, s31
    s_add_u32 s79, s30, 0x4300000
    s_mov_b32 s68, 0x000f000f
    s_mov_b32 s69, 0x000f000f
    s_lshl_b32 s83, s20, 2
    s_mov_b32 s78, 0
    s_mov_b32 s34, 0
    s_mov_b32 s22, 0
    s_and_b32 s30, s21, 7
    s_lshl_b32 s30, s30, 13
    s_add_u32 s26, s26, s30
    s_and_b32 s52, s21, 7
    s_lshl_b32 s52, s52, 6
    s_add_u32 s29, s79, 0x10000
    s_mov_b32 s32, 1
    s_mov_b32 s33, 1
    buffer_load_dword v6, off, s[12:15], 0 offset:36 sc1
    buffer_load_dword v7, off, s[4:7], s81 sc1
    buffer_load_dword v79, off, s[4:7], s81 offset:16 sc1
    s_lshl_b32 s30, s21, 8
    s_add_u32 s30, s30, 0x4300000
    v_and_b32 v12, 0x10, v71
    v_and_b32 v13, 0x60, v71
    v_lshlrev_b32 v12, 3, v12
    v_lshl_or_b32 v12, v13, 8, v12
    buffer_load_dword v12, v12, s[4:7], s30 offen sc1
    v_mov_b64 v[32:33], 0
    v_mov_b64 v[34:35], 0
    v_mov_b64 v[36:37], 0
    v_mov_b64 v[38:39], 0
    v_mov_b64 v[40:41], 0
    v_mov_b64 v[42:43], 0
    v_mov_b64 v[44:45], 0
    v_mov_b64 v[46:47], 0
    v_mov_b64 v[48:49], 0
    v_mov_b64 v[50:51], 0
    v_mov_b64 v[52:53], 0
    v_mov_b64 v[54:55], 0
    v_add_u32 v73, 6144, v71
    v_add_u32 v74, 0, v71
    v_add_u32 v75, 2048, v71
    v_add_u32 v64, 0x18000, v66
    v_add_u32 v65, 0x18000, v67
    ds_read_b64_tr_b16 v[80:81], v64 offset:0
    ds_read_b64_tr_b16 v[82:83], v64 offset:1024
    ds_read_b64_tr_b16 v[84:85], v64 offset:8192
    ds_read_b64_tr_b16 v[86:87], v64 offset:9216
    ds_read_b64_tr_b16 a[0:1], v65 offset:0
    ds_read_b64_tr_b16 a[2:3], v65 offset:1024
    ds_read_b64_tr_b16 a[4:5], v65 offset:8192
    ds_read_b64_tr_b16 a[6:7], v65 offset:9216
    s_waitcnt vmcnt(8) lgkmcnt(0)
    s_barrier
    v_add_u32 v64, 0x1c000, v66
    v_add_u32 v65, 0x1c000, v67
    ds_read_b64_tr_b16 v[88:89], v64 offset:0
    ds_read_b64_tr_b16 v[90:91], v64 offset:1024
    ds_read_b64_tr_b16 v[92:93], v64 offset:8192
    ds_read_b64_tr_b16 v[94:95], v64 offset:9216
    ds_read_b64_tr_b16 a[8:9], v65 offset:0
    ds_read_b64_tr_b16 a[10:11], v65 offset:1024
    ds_read_b64_tr_b16 a[12:13], v65 offset:8192
    ds_read_b64_tr_b16 a[14:15], v65 offset:9216
    s_waitcnt vmcnt(4) lgkmcnt(0)
    s_barrier
    v_add_u32 v64, 0x20000, v66
    v_add_u32 v65, 0x20000, v67
    ds_read_b64_tr_b16 v[96:97], v64 offset:0
    ds_read_b64_tr_b16 v[98:99], v64 offset:1024
    ds_read_b64_tr_b16 v[100:101], v64 offset:8192
    ds_read_b64_tr_b16 v[102:103], v64 offset:9216
    ds_read_b64_tr_b16 a[16:17], v65 offset:0
    ds_read_b64_tr_b16 a[18:19], v65 offset:1024
    ds_read_b64_tr_b16 a[20:21], v65 offset:8192
    ds_read_b64_tr_b16 a[22:23], v65 offset:9216
    s_waitcnt vmcnt(0) lgkmcnt(0)
    s_barrier
    v_add_u32 v64, 0x24000, v66
    v_add_u32 v65, 0x24000, v67
    ds_read_b64_tr_b16 v[104:105], v64 offset:0
    ds_read_b64_tr_b16 v[106:107], v64 offset:1024
    ds_read_b64_tr_b16 v[108:109], v64 offset:8192
    ds_read_b64_tr_b16 v[110:111], v64 offset:9216
    ds_read_b64_tr_b16 a[24:25], v65 offset:0
    ds_read_b64_tr_b16 a[26:27], v65 offset:1024
    ds_read_b64_tr_b16 a[28:29], v65 offset:8192
    ds_read_b64_tr_b16 a[30:31], v65 offset:9216
    s_waitcnt vmcnt(0) lgkmcnt(0)
    s_barrier
    s_branch L_CLDONE
L_CLD3:
    v_lshlrev_b32 v71, 4, v0
    v_lshlrev_b32 v75, 2, v0
    v_lshrrev_b32 v1, 4, v0
    v_lshlrev_b32 v1, 1, v1
    v_bfe_u32 v2, v0, 2, 1
    v_add_u32 v1, v1, v2
    v_lshlrev_b32 v1, 10, v1
    v_bfe_u32 v2, v0, 3, 1
    v_lshl_add_u32 v1, v2, 2, v1
    v_and_b32 v2, 3, v0
    v_lshl_add_u32 v1, v2, 3, v1
    s_lshl_b32 s30, s21, 5
    buffer_load_dword v5, v1, s[16:19], s30 offen

    v_lshrrev_b32 v1, 4, v0
    v_add_u32 v2, 48, v1
    v_lshlrev_b32 v2, 13, v2
    v_lshlrev_b32 v1, 5, v1
    v_and_b32 v3, 15, v0
    v_lshlrev_b32 v3, 4, v3
    v_xor_b32 v3, v3, v1
    v_add_u32 v64, v2, v3
    v_xor_b32 v65, 128, v64
    v_xor_b32 v70, 128, v71
    v_lshrrev_b32 v2, 4, v0
    v_bfe_u32 v3, v0, 2, 2
    v_lshl_add_u32 v1, v2, 3, v3
    v_and_b32 v2, 1, v2
    v_lshl_or_b32 v2, v2, 2, v3
    v_xor_b32 v2, 6, v2
    v_lshlrev_b32 v2, 5, v2
    v_lshl_add_u32 v1, v1, 8, v2
    v_and_b32 v3, 3, v0
    v_lshl_add_u32 v66, v3, 3, v1
    v_xor_b32 v67, 32, v66
    v_lshrrev_b32 v1, 2, v0
    v_and_b32 v2, 7, v1
    v_or_b32 v2, 24, v2
    v_lshlrev_b32 v2, 5, v2
    v_lshl_add_u32 v1, v1, 10, v2
    v_lshl_add_u32 v72, v3, 3, v1
    s_lshl_b32 s83, s21, 8
    s_lshl_b32 s82, s21, 17
    s_mov_b32 s8, s46
    s_mov_b32 s9, s47
    s_mov_b32 m0, 0x17000
    s_add_u32 s31, s82, 0x19000
    v_xor_b32 v73, 0, v70
    buffer_load_dwordx4 v73, s[8:11], s31 offen nt lds
    s_mov_b32 m0, 0x17400
    s_add_u32 s31, s82, 0x19400
    v_xor_b32 v73, 32, v70
    buffer_load_dwordx4 v73, s[8:11], s31 offen nt lds
    s_mov_b32 m0, 0x17800
    s_add_u32 s31, s82, 0x1d000
    v_xor_b32 v73, 64, v70
    buffer_load_dwordx4 v73, s[8:11], s31 offen nt lds
    s_mov_b32 m0, 0x17c00
    s_add_u32 s31, s82, 0x1d400
    v_xor_b32 v73, 96, v70
    buffer_load_dwordx4 v73, s[8:11], s31 offen nt lds
    s_mov_b32 m0, 0x1b000
    s_add_u32 s31, s82, 0x19800
    v_xor_b32 v73, 0, v70
    buffer_load_dwordx4 v73, s[8:11], s31 offen nt lds
    s_mov_b32 m0, 0x1b400
    s_add_u32 s31, s82, 0x19c00
    v_xor_b32 v73, 32, v70
    buffer_load_dwordx4 v73, s[8:11], s31 offen nt lds
    s_mov_b32 m0, 0x1b800
    s_add_u32 s31, s82, 0x1d800
    v_xor_b32 v73, 64, v70
    buffer_load_dwordx4 v73, s[8:11], s31 offen nt lds
    s_mov_b32 m0, 0x1bc00
    s_add_u32 s31, s82, 0x1dc00
    v_xor_b32 v73, 96, v70
    buffer_load_dwordx4 v73, s[8:11], s31 offen nt lds
    s_mov_b32 m0, 0x1f000
    s_add_u32 s31, s82, 0x1b000
    v_xor_b32 v73, 0, v70
    buffer_load_dwordx4 v73, s[8:11], s31 offen nt lds
    s_mov_b32 m0, 0x1f400
    s_add_u32 s31, s82, 0x1b400
    v_xor_b32 v73, 32, v70
    buffer_load_dwordx4 v73, s[8:11], s31 offen nt lds
    s_mov_b32 m0, 0x1f800
    s_add_u32 s31, s82, 0x1f000
    v_xor_b32 v73, 64, v70
    buffer_load_dwordx4 v73, s[8:11], s31 offen nt lds
    s_mov_b32 m0, 0x1fc00
    s_add_u32 s31, s82, 0x1f400
    v_xor_b32 v73, 96, v70
    buffer_load_dwordx4 v73, s[8:11], s31 offen nt lds
    s_mov_b32 m0, 0x23000
    s_add_u32 s31, s82, 0x1b800
    v_xor_b32 v73, 0, v70
    buffer_load_dwordx4 v73, s[8:11], s31 offen nt lds
    s_mov_b32 m0, 0x23400
    s_add_u32 s31, s82, 0x1bc00
    v_xor_b32 v73, 32, v70
    buffer_load_dwordx4 v73, s[8:11], s31 offen nt lds
    s_mov_b32 m0, 0x23800
    s_add_u32 s31, s82, 0x1f800
    v_xor_b32 v73, 64, v70
    buffer_load_dwordx4 v73, s[8:11], s31 offen nt lds
    s_mov_b32 m0, 0x23c00
    s_add_u32 s31, s82, 0x1fc00
    v_xor_b32 v73, 96, v70
    buffer_load_dwordx4 v73, s[8:11], s31 offen nt lds
    s_mov_b32 m0, 0x27000
    s_add_u32 s31, s82, 0x9000
    v_xor_b32 v73, 0, v70
    buffer_load_dwordx4 v73, s[8:11], s31 offen nt lds
    s_mov_b32 m0, 0x27400
    s_add_u32 s31, s82, 0x9400
    v_xor_b32 v73, 32, v70
    buffer_load_dwordx4 v73, s[8:11], s31 offen nt lds
    s_mov_b32 m0, 0x27800
    s_add_u32 s31, s82, 0xd000
    v_xor_b32 v73, 64, v70
    buffer_load_dwordx4 v73, s[8:11], s31 offen nt lds
    s_mov_b32 m0, 0x27c00
    s_add_u32 s31, s82, 0xd400
    v_xor_b32 v73, 96, v70
    buffer_load_dwordx4 v73, s[8:11], s31 offen nt lds
    s_mov_b32 m0, 0x3000
    s_add_u32 s31, s82, 0x9800
    v_xor_b32 v73, 0, v70
    buffer_load_dwordx4 v73, s[8:11], s31 offen nt lds
    s_mov_b32 m0, 0x3400
    s_add_u32 s31, s82, 0x9c00
    v_xor_b32 v73, 32, v70
    buffer_load_dwordx4 v73, s[8:11], s31 offen nt lds
    s_mov_b32 m0, 0x3800
    s_add_u32 s31, s82, 0xd800
    v_xor_b32 v73, 64, v70
    buffer_load_dwordx4 v73, s[8:11], s31 offen nt lds
    s_mov_b32 m0, 0x3c00
    s_add_u32 s31, s82, 0xdc00
    v_xor_b32 v73, 96, v70
    buffer_load_dwordx4 v73, s[8:11], s31 offen nt lds
    s_mov_b32 m0, 0xb000
    s_add_u32 s31, s82, 0xb000
    v_xor_b32 v73, 0, v70
    buffer_load_dwordx4 v73, s[8:11], s31 offen nt lds
    s_mov_b32 m0, 0xb400
    s_add_u32 s31, s82, 0xb400
    v_xor_b32 v73, 32, v70
    buffer_load_dwordx4 v73, s[8:11], s31 offen nt lds
    s_mov_b32 m0, 0xb800
    s_add_u32 s31, s82, 0xf000
    v_xor_b32 v73, 64, v70
    buffer_load_dwordx4 v73, s[8:11], s31 offen nt lds
    s_mov_b32 m0, 0xbc00
    s_add_u32 s31, s82, 0xf400
    v_xor_b32 v73, 96, v70
    buffer_load_dwordx4 v73, s[8:11], s31 offen nt lds
    s_mov_b32 m0, 0xf000
    s_add_u32 s31, s82, 0xb800
    v_xor_b32 v73, 0, v70
    buffer_load_dwordx4 v73, s[8:11], s31 offen nt lds
    s_mov_b32 m0, 0xf400
    s_add_u32 s31, s82, 0xbc00
    v_xor_b32 v73, 32, v70
    buffer_load_dwordx4 v73, s[8:11], s31 offen nt lds
    s_mov_b32 m0, 0xf800
    s_add_u32 s31, s82, 0xf800
    v_xor_b32 v73, 64, v70
    buffer_load_dwordx4 v73, s[8:11], s31 offen nt lds
    s_mov_b32 m0, 0xfc00
    s_add_u32 s31, s82, 0xfc00
    v_xor_b32 v73, 96, v70
    buffer_load_dwordx4 v73, s[8:11], s31 offen nt lds
    v_mov_b32 v8, -1
    v_mov_b32 v9, -1
    v_mov_b32 v10, -1
    v_mov_b32 v11, -1
    s_lshl_b32 s30, s21, 13
    s_add_u32 s30, s30, 0x4201800
    s_add_u32 s31, s30, 0x40000
    buffer_store_dwordx4 v[8:11], v71, s[4:7], s30 offen
    buffer_store_dwordx4 v[8:11], v71, s[4:7], s30 offen offset:1024
    buffer_store_dwordx4 v[8:11], v71, s[4:7], s31 offen
    buffer_store_dwordx4 v[8:11], v71, s[4:7], s31 offen offset:1024
    v_lshrrev_b32 v14, 4, v0
    v_lshlrev_b32 v14, 13, v14
    v_and_b32 v15, 15, v0
    v_lshl_add_u32 v14, v15, 4, v14
    s_lshl_b32 s30, s21, 8
    s_add_u32 s31, s30, 0x4370000
    buffer_store_dwordx4 v[8:11], v14, s[4:7], s31 offen sc1
    s_add_u32 s31, s30, 0x4378000
    buffer_store_dwordx4 v[8:11], v14, s[4:7], s31 offen sc1
    s_add_u32 s31, s30, 0x4380000
    buffer_store_dwordx4 v[8:11], v14, s[4:7], s31 offen sc1
    s_add_u32 s31, s30, 0x4388000
    buffer_store_dwordx4 v[8:11], v14, s[4:7], s31 offen sc1
    s_lshl_b32 s30, s21, 13
    s_add_u32 s31, s30, 0x4141800
    buffer_store_dwordx4 v[8:11], v71, s[4:7], s31 offen sc1
    buffer_store_dwordx4 v[8:11], v71, s[4:7], s31 offen offset:1024 sc1
    s_add_u32 s31, s30, 0x4181800
    buffer_store_dwordx4 v[8:11], v71, s[4:7], s31 offen sc1
    buffer_store_dwordx4 v[8:11], v71, s[4:7], s31 offen offset:1024 sc1
    s_add_u32 s31, s30, 0x41c1800
    buffer_store_dwordx4 v[8:11], v71, s[4:7], s31 offen sc1
    buffer_store_dwordx4 v[8:11], v71, s[4:7], s31 offen offset:1024 sc1
    s_lshl_b32 s30, s21, 8
    s_add_u32 s30, s30, 0x4306000
    v_mov_b32 v12, -1
    buffer_store_dword v12, v75, s[4:7], s30 offen
    s_and_b32 s30, s21, 7
    s_lshl_b32 s30, s30, 5
    v_xor_b32 v76, s30, v72
    v_add_u32 v72, 6144, v71
    s_waitcnt vmcnt(47)
    s_lshl_b32 s30, s21, 8
    s_add_u32 s30, s30, 0x4300000
    s_waitcnt vmcnt(43) lgkmcnt(0)
    s_barrier
    s_mov_b32 s8, s42
    s_mov_b32 s9, s43
    s_mov_b32 m0, 0x13000
    s_add_u32 s31, s83, 0x0
    buffer_load_dwordx4 v64, s[8:11], s31 offen nt lds
    s_mov_b32 m0, 0x13400
    s_add_u32 s31, s83, 0x8000
    buffer_load_dwordx4 v64, s[8:11], s31 offen nt lds
    s_mov_b32 m0, 0x13800
    s_add_u32 s31, s83, 0x10000
    buffer_load_dwordx4 v65, s[8:11], s31 offen nt lds
    s_mov_b32 m0, 0x13c00
    s_add_u32 s31, s83, 0x18000
    buffer_load_dwordx4 v65, s[8:11], s31 offen nt lds
    v_add_u32 v68, 0x14000, v76
    v_xor_b32 v74, 0, v68
    ds_read_b64_tr_b16 v[208:209], v74
    v_xor_b32 v73, 32, v68
    ds_read_b64_tr_b16 v[216:217], v73
    v_xor_b32 v74, 64, v68
    ds_read_b64_tr_b16 v[224:225], v74
    v_xor_b32 v73, 96, v68
    ds_read_b64_tr_b16 v[232:233], v73
    v_xor_b32 v74, 128, v68
    ds_read_b64_tr_b16 v[240:241], v74
    v_xor_b32 v73, 160, v68
    ds_read_b64_tr_b16 v[248:249], v73
    v_xor_b32 v74, 192, v68
    ds_read_b64_tr_b16 v[32:33], v74
    v_xor_b32 v73, 224, v68
    ds_read_b64_tr_b16 v[40:41], v73
    s_waitcnt vmcnt(43) lgkmcnt(0)
    s_barrier
    s_mov_b32 m0, 0x17000
    s_add_u32 s31, s83, 0x80000
    buffer_load_dwordx4 v64, s[8:11], s31 offen nt lds
    s_mov_b32 m0, 0x17400
    s_add_u32 s31, s83, 0x88000
    buffer_load_dwordx4 v64, s[8:11], s31 offen nt lds
    s_mov_b32 m0, 0x17800
    s_add_u32 s31, s83, 0x90000
    buffer_load_dwordx4 v65, s[8:11], s31 offen nt lds
    s_mov_b32 m0, 0x17c00
    s_add_u32 s31, s83, 0x98000
    buffer_load_dwordx4 v65, s[8:11], s31 offen nt lds
    v_add_u32 v68, 0x18000, v76
    v_xor_b32 v74, 0, v68
    ds_read_b64_tr_b16 v[210:211], v74
    v_xor_b32 v73, 32, v68
    ds_read_b64_tr_b16 v[218:219], v73
    v_xor_b32 v74, 64, v68
    ds_read_b64_tr_b16 v[226:227], v74
    v_xor_b32 v73, 96, v68
    ds_read_b64_tr_b16 v[234:235], v73
    v_xor_b32 v74, 128, v68
    ds_read_b64_tr_b16 v[242:243], v74
    v_xor_b32 v73, 160, v68
    ds_read_b64_tr_b16 v[250:251], v73
    v_xor_b32 v74, 192, v68
    ds_read_b64_tr_b16 v[34:35], v74
    v_xor_b32 v73, 224, v68
    ds_read_b64_tr_b16 v[42:43], v73
    s_waitcnt vmcnt(43) lgkmcnt(0)
    s_barrier
    s_mov_b32 m0, 0x1b000
    s_add_u32 s31, s83, 0x100000
    buffer_load_dwordx4 v64, s[8:11], s31 offen nt lds
    s_mov_b32 m0, 0x1b400
    s_add_u32 s31, s83, 0x108000
    buffer_load_dwordx4 v64, s[8:11], s31 offen nt lds
    s_mov_b32 m0, 0x1b800
    s_add_u32 s31, s83, 0x110000
    buffer_load_dwordx4 v65, s[8:11], s31 offen nt lds
    s_mov_b32 m0, 0x1bc00
    s_add_u32 s31, s83, 0x118000
    buffer_load_dwordx4 v65, s[8:11], s31 offen nt lds
    v_add_u32 v68, 0x1c000, v76
    v_xor_b32 v74, 0, v68
    ds_read_b64_tr_b16 v[212:213], v74
    v_xor_b32 v73, 32, v68
    ds_read_b64_tr_b16 v[220:221], v73
    v_xor_b32 v74, 64, v68
    ds_read_b64_tr_b16 v[228:229], v74
    v_xor_b32 v73, 96, v68
    ds_read_b64_tr_b16 v[236:237], v73
    v_xor_b32 v74, 128, v68
    ds_read_b64_tr_b16 v[244:245], v74
    v_xor_b32 v73, 160, v68
    ds_read_b64_tr_b16 v[252:253], v73
    v_xor_b32 v74, 192, v68
    ds_read_b64_tr_b16 v[36:37], v74
    v_xor_b32 v73, 224, v68
    ds_read_b64_tr_b16 v[44:45], v73
    s_waitcnt vmcnt(43) lgkmcnt(0)
    s_barrier
    s_mov_b32 m0, 0x1f000
    s_add_u32 s31, s83, 0x180000
    buffer_load_dwordx4 v64, s[8:11], s31 offen nt lds
    s_mov_b32 m0, 0x1f400
    s_add_u32 s31, s83, 0x188000
    buffer_load_dwordx4 v64, s[8:11], s31 offen nt lds
    s_mov_b32 m0, 0x1f800
    s_add_u32 s31, s83, 0x190000
    buffer_load_dwordx4 v65, s[8:11], s31 offen nt lds
    s_mov_b32 m0, 0x1fc00
    s_add_u32 s31, s83, 0x198000
    buffer_load_dwordx4 v65, s[8:11], s31 offen nt lds
    v_add_u32 v68, 0x20000, v76
    v_xor_b32 v74, 0, v68
    ds_read_b64_tr_b16 v[214:215], v74
    v_xor_b32 v73, 32, v68
    ds_read_b64_tr_b16 v[222:223], v73
    v_xor_b32 v74, 64, v68
    ds_read_b64_tr_b16 v[230:231], v74
    v_xor_b32 v73, 96, v68
    ds_read_b64_tr_b16 v[238:239], v73
    v_xor_b32 v74, 128, v68
    ds_read_b64_tr_b16 v[246:247], v74
    v_xor_b32 v73, 160, v68
    ds_read_b64_tr_b16 v[254:255], v73
    v_xor_b32 v74, 192, v68
    ds_read_b64_tr_b16 v[38:39], v74
    v_xor_b32 v73, 224, v68
    ds_read_b64_tr_b16 v[46:47], v73
    s_waitcnt vmcnt(43) lgkmcnt(0)
    s_barrier
    s_mov_b32 m0, 0x23000
    s_add_u32 s31, s83, 0x200000
    buffer_load_dwordx4 v64, s[8:11], s31 offen nt lds
    s_mov_b32 m0, 0x23400
    s_add_u32 s31, s83, 0x208000
    buffer_load_dwordx4 v64, s[8:11], s31 offen nt lds
    s_mov_b32 m0, 0x23800
    s_add_u32 s31, s83, 0x210000
    buffer_load_dwordx4 v65, s[8:11], s31 offen nt lds
    s_mov_b32 m0, 0x23c00
    s_add_u32 s31, s83, 0x218000
    buffer_load_dwordx4 v65, s[8:11], s31 offen nt lds
    ds_write_b128 v72, v[32:35] offset:16384
    ds_write_b128 v72, v[36:39] offset:17408
    ds_write_b128 v72, v[40:43] offset:24576
    ds_write_b128 v72, v[44:47] offset:25600
    v_add_u32 v68, 0x24000, v76
    v_xor_b32 v74, 0, v68
    ds_read_b64_tr_b16 v[0:1], v74
    v_xor_b32 v73, 32, v68
    ds_read_b64_tr_b16 v[8:9], v73
    v_xor_b32 v74, 64, v68
    ds_read_b64_tr_b16 v[16:17], v74
    v_xor_b32 v73, 96, v68
    ds_read_b64_tr_b16 v[24:25], v73
    v_xor_b32 v74, 128, v68
    ds_read_b64_tr_b16 v[32:33], v74
    v_xor_b32 v73, 160, v68
    ds_read_b64_tr_b16 v[40:41], v73
    v_xor_b32 v74, 192, v68
    ds_read_b64_tr_b16 v[48:49], v74
    v_xor_b32 v73, 224, v68
    ds_read_b64_tr_b16 v[56:57], v73
    s_waitcnt vmcnt(43) lgkmcnt(0)
    s_barrier
    s_mov_b32 m0, 0x27000
    s_add_u32 s31, s83, 0x280000
    buffer_load_dwordx4 v64, s[8:11], s31 offen nt lds
    s_mov_b32 m0, 0x27400
    s_add_u32 s31, s83, 0x288000
    buffer_load_dwordx4 v64, s[8:11], s31 offen nt lds
    s_mov_b32 m0, 0x27800
    s_add_u32 s31, s83, 0x290000
    buffer_load_dwordx4 v65, s[8:11], s31 offen nt lds
    s_mov_b32 m0, 0x27c00
    s_add_u32 s31, s83, 0x298000
    buffer_load_dwordx4 v65, s[8:11], s31 offen nt lds
    v_add_u32 v68, 0x0, v76
    v_xor_b32 v74, 0, v68
    ds_read_b64_tr_b16 v[2:3], v74
    v_xor_b32 v73, 32, v68
    ds_read_b64_tr_b16 v[10:11], v73
    v_xor_b32 v74, 64, v68
    ds_read_b64_tr_b16 v[18:19], v74
    v_xor_b32 v73, 96, v68
    ds_read_b64_tr_b16 v[26:27], v73
    v_xor_b32 v74, 128, v68
    ds_read_b64_tr_b16 v[34:35], v74
    v_xor_b32 v73, 160, v68
    ds_read_b64_tr_b16 v[42:43], v73
    v_xor_b32 v74, 192, v68
    ds_read_b64_tr_b16 v[50:51], v74
    v_xor_b32 v73, 224, v68
    ds_read_b64_tr_b16 v[58:59], v73
    s_waitcnt vmcnt(43) lgkmcnt(0)
    s_barrier
    s_mov_b32 m0, 0x3000
    s_add_u32 s31, s83, 0x300000
    buffer_load_dwordx4 v64, s[8:11], s31 offen nt lds
    s_mov_b32 m0, 0x3400
    s_add_u32 s31, s83, 0x308000
    buffer_load_dwordx4 v64, s[8:11], s31 offen nt lds
    s_mov_b32 m0, 0x3800
    s_add_u32 s31, s83, 0x310000
    buffer_load_dwordx4 v65, s[8:11], s31 offen nt lds
    s_mov_b32 m0, 0x3c00
    s_add_u32 s31, s83, 0x318000
    buffer_load_dwordx4 v65, s[8:11], s31 offen nt lds
    v_add_u32 v68, 0x8000, v76
    v_xor_b32 v74, 0, v68
    ds_read_b64_tr_b16 v[4:5], v74
    v_xor_b32 v73, 32, v68
    ds_read_b64_tr_b16 v[12:13], v73
    v_xor_b32 v74, 64, v68
    ds_read_b64_tr_b16 v[20:21], v74
    v_xor_b32 v73, 96, v68
    ds_read_b64_tr_b16 v[28:29], v73
    v_xor_b32 v74, 128, v68
    ds_read_b64_tr_b16 v[36:37], v74
    v_xor_b32 v73, 160, v68
    ds_read_b64_tr_b16 v[44:45], v73
    v_xor_b32 v74, 192, v68
    ds_read_b64_tr_b16 v[52:53], v74
    v_xor_b32 v73, 224, v68
    ds_read_b64_tr_b16 v[60:61], v73
    s_waitcnt vmcnt(43) lgkmcnt(0)
    s_barrier
    s_mov_b32 m0, 0xb000
    s_add_u32 s31, s83, 0x380000
    buffer_load_dwordx4 v64, s[8:11], s31 offen nt lds
    s_mov_b32 m0, 0xb400
    s_add_u32 s31, s83, 0x388000
    buffer_load_dwordx4 v64, s[8:11], s31 offen nt lds
    s_mov_b32 m0, 0xb800
    s_add_u32 s31, s83, 0x390000
    buffer_load_dwordx4 v65, s[8:11], s31 offen nt lds
    s_mov_b32 m0, 0xbc00
    s_add_u32 s31, s83, 0x398000
    buffer_load_dwordx4 v65, s[8:11], s31 offen nt lds
    v_add_u32 v68, 0xc000, v76
    v_xor_b32 v74, 0, v68
    ds_read_b64_tr_b16 v[6:7], v74
    v_xor_b32 v73, 32, v68
    ds_read_b64_tr_b16 v[14:15], v73
    v_xor_b32 v74, 64, v68
    ds_read_b64_tr_b16 v[22:23], v74
    v_xor_b32 v73, 96, v68
    ds_read_b64_tr_b16 v[30:31], v73
    v_xor_b32 v74, 128, v68
    ds_read_b64_tr_b16 v[38:39], v74
    v_xor_b32 v73, 160, v68
    ds_read_b64_tr_b16 v[46:47], v73
    v_xor_b32 v74, 192, v68
    ds_read_b64_tr_b16 v[54:55], v74
    v_xor_b32 v73, 224, v68
    ds_read_b64_tr_b16 v[62:63], v73
    s_waitcnt vmcnt(28) lgkmcnt(0)
    s_barrier
    s_mov_b32 s8, s44
    s_mov_b32 s9, s45
    s_mov_b32 m0, 0xf000
    s_add_u32 s31, s83, 0x0
    buffer_load_dwordx4 v64, s[8:11], s31 offen nt lds
    s_mov_b32 m0, 0xf400
    s_add_u32 s31, s83, 0x8000
    buffer_load_dwordx4 v64, s[8:11], s31 offen nt lds
    s_mov_b32 m0, 0xf800
    s_add_u32 s31, s83, 0x10000
    buffer_load_dwordx4 v65, s[8:11], s31 offen nt lds
    s_mov_b32 m0, 0xfc00
    s_add_u32 s31, s83, 0x18000
    buffer_load_dwordx4 v65, s[8:11], s31 offen nt lds
    v_add_u32 v68, 0x10000, v66
    v_add_u32 v69, 0x10000, v67
    ds_read_b64_tr_b16 a[80:81], v68 offset:0
    ds_read_b64_tr_b16 a[82:83], v68 offset:1024
    ds_read_b64_tr_b16 a[84:85], v68 offset:8192
    ds_read_b64_tr_b16 a[86:87], v68 offset:9216
    ds_read_b64_tr_b16 a[144:145], v69 offset:0
    ds_read_b64_tr_b16 a[146:147], v69 offset:1024
    ds_read_b64_tr_b16 a[148:149], v69 offset:8192
    ds_read_b64_tr_b16 a[150:151], v69 offset:9216
    s_waitcnt vmcnt(28) lgkmcnt(0)
    s_barrier
    s_mov_b32 m0, 0x13000
    s_add_u32 s31, s83, 0x80000
    buffer_load_dwordx4 v64, s[8:11], s31 offen nt lds
    s_mov_b32 m0, 0x13400
    s_add_u32 s31, s83, 0x88000
    buffer_load_dwordx4 v64, s[8:11], s31 offen nt lds
    s_mov_b32 m0, 0x13800
    s_add_u32 s31, s83, 0x90000
    buffer_load_dwordx4 v65, s[8:11], s31 offen nt lds
    s_mov_b32 m0, 0x13c00
    s_add_u32 s31, s83, 0x98000
    buffer_load_dwordx4 v65, s[8:11], s31 offen nt lds
    v_add_u32 v68, 0x14000, v66
    v_add_u32 v69, 0x14000, v67
    ds_read_b64_tr_b16 a[88:89], v68 offset:0
    ds_read_b64_tr_b16 a[90:91], v68 offset:1024
    ds_read_b64_tr_b16 a[92:93], v68 offset:8192
    ds_read_b64_tr_b16 a[94:95], v68 offset:9216
    ds_read_b64_tr_b16 a[152:153], v69 offset:0
    ds_read_b64_tr_b16 a[154:155], v69 offset:1024
    ds_read_b64_tr_b16 a[156:157], v69 offset:8192
    ds_read_b64_tr_b16 a[158:159], v69 offset:9216
    s_waitcnt vmcnt(28) lgkmcnt(0)
    s_barrier
    s_mov_b32 m0, 0x17000
    s_add_u32 s31, s83, 0x100000
    buffer_load_dwordx4 v64, s[8:11], s31 offen nt lds
    s_mov_b32 m0, 0x17400
    s_add_u32 s31, s83, 0x108000
    buffer_load_dwordx4 v64, s[8:11], s31 offen nt lds
    s_mov_b32 m0, 0x17800
    s_add_u32 s31, s83, 0x110000
    buffer_load_dwordx4 v65, s[8:11], s31 offen nt lds
    s_mov_b32 m0, 0x17c00
    s_add_u32 s31, s83, 0x118000
    buffer_load_dwordx4 v65, s[8:11], s31 offen nt lds
    v_add_u32 v68, 0x18000, v66
    v_add_u32 v69, 0x18000, v67
    ds_read_b64_tr_b16 a[96:97], v68 offset:0
    ds_read_b64_tr_b16 a[98:99], v68 offset:1024
    ds_read_b64_tr_b16 a[100:101], v68 offset:8192
    ds_read_b64_tr_b16 a[102:103], v68 offset:9216
    ds_read_b64_tr_b16 a[160:161], v69 offset:0
    ds_read_b64_tr_b16 a[162:163], v69 offset:1024
    ds_read_b64_tr_b16 a[164:165], v69 offset:8192
    ds_read_b64_tr_b16 a[166:167], v69 offset:9216
    s_waitcnt vmcnt(28) lgkmcnt(0)
    s_barrier
    s_mov_b32 m0, 0x1b000
    s_add_u32 s31, s83, 0x180000
    buffer_load_dwordx4 v64, s[8:11], s31 offen nt lds
    s_mov_b32 m0, 0x1b400
    s_add_u32 s31, s83, 0x188000
    buffer_load_dwordx4 v64, s[8:11], s31 offen nt lds
    s_mov_b32 m0, 0x1b800
    s_add_u32 s31, s83, 0x190000
    buffer_load_dwordx4 v65, s[8:11], s31 offen nt lds
    s_mov_b32 m0, 0x1bc00
    s_add_u32 s31, s83, 0x198000
    buffer_load_dwordx4 v65, s[8:11], s31 offen nt lds
    v_add_u32 v68, 0x1c000, v66
    v_add_u32 v69, 0x1c000, v67
    ds_read_b64_tr_b16 a[104:105], v68 offset:0
    ds_read_b64_tr_b16 a[106:107], v68 offset:1024
    ds_read_b64_tr_b16 a[108:109], v68 offset:8192
    ds_read_b64_tr_b16 a[110:111], v68 offset:9216
    ds_read_b64_tr_b16 a[168:169], v69 offset:0
    ds_read_b64_tr_b16 a[170:171], v69 offset:1024
    ds_read_b64_tr_b16 a[172:173], v69 offset:8192
    ds_read_b64_tr_b16 a[174:175], v69 offset:9216
    s_waitcnt vmcnt(28) lgkmcnt(0)
    s_barrier
    s_mov_b32 m0, 0x1f000
    s_add_u32 s31, s83, 0x200000
    buffer_load_dwordx4 v64, s[8:11], s31 offen nt lds
    s_mov_b32 m0, 0x1f400
    s_add_u32 s31, s83, 0x208000
    buffer_load_dwordx4 v64, s[8:11], s31 offen nt lds
    s_mov_b32 m0, 0x1f800
    s_add_u32 s31, s83, 0x210000
    buffer_load_dwordx4 v65, s[8:11], s31 offen nt lds
    s_mov_b32 m0, 0x1fc00
    s_add_u32 s31, s83, 0x218000
    buffer_load_dwordx4 v65, s[8:11], s31 offen nt lds
    v_add_u32 v68, 0x20000, v66
    v_add_u32 v69, 0x20000, v67
    ds_read_b64_tr_b16 a[112:113], v68 offset:0
    ds_read_b64_tr_b16 a[114:115], v68 offset:1024
    ds_read_b64_tr_b16 a[116:117], v68 offset:8192
    ds_read_b64_tr_b16 a[118:119], v68 offset:9216
    ds_read_b64_tr_b16 a[176:177], v69 offset:0
    ds_read_b64_tr_b16 a[178:179], v69 offset:1024
    ds_read_b64_tr_b16 a[180:181], v69 offset:8192
    ds_read_b64_tr_b16 a[182:183], v69 offset:9216
    s_waitcnt vmcnt(28) lgkmcnt(0)
    s_barrier
    s_mov_b32 m0, 0x23000
    s_add_u32 s31, s83, 0x280000
    buffer_load_dwordx4 v64, s[8:11], s31 offen nt lds
    s_mov_b32 m0, 0x23400
    s_add_u32 s31, s83, 0x288000
    buffer_load_dwordx4 v64, s[8:11], s31 offen nt lds
    s_mov_b32 m0, 0x23800
    s_add_u32 s31, s83, 0x290000
    buffer_load_dwordx4 v65, s[8:11], s31 offen nt lds
    s_mov_b32 m0, 0x23c00
    s_add_u32 s31, s83, 0x298000
    buffer_load_dwordx4 v65, s[8:11], s31 offen nt lds
    v_add_u32 v68, 0x24000, v66
    v_add_u32 v69, 0x24000, v67
    ds_read_b64_tr_b16 a[120:121], v68 offset:0
    ds_read_b64_tr_b16 a[122:123], v68 offset:1024
    ds_read_b64_tr_b16 a[124:125], v68 offset:8192
    ds_read_b64_tr_b16 a[126:127], v68 offset:9216
    ds_read_b64_tr_b16 a[184:185], v69 offset:0
    ds_read_b64_tr_b16 a[186:187], v69 offset:1024
    ds_read_b64_tr_b16 a[188:189], v69 offset:8192
    ds_read_b64_tr_b16 a[190:191], v69 offset:9216
    s_waitcnt vmcnt(28) lgkmcnt(0)
    s_barrier
    s_mov_b32 m0, 0x27000
    s_add_u32 s31, s83, 0x300000
    buffer_load_dwordx4 v64, s[8:11], s31 offen nt lds
    s_mov_b32 m0, 0x27400
    s_add_u32 s31, s83, 0x308000
    buffer_load_dwordx4 v64, s[8:11], s31 offen nt lds
    s_mov_b32 m0, 0x27800
    s_add_u32 s31, s83, 0x310000
    buffer_load_dwordx4 v65, s[8:11], s31 offen nt lds
    s_mov_b32 m0, 0x27c00
    s_add_u32 s31, s83, 0x318000
    buffer_load_dwordx4 v65, s[8:11], s31 offen nt lds
    v_add_u32 v68, 0x0, v66
    v_add_u32 v69, 0x0, v67
    ds_read_b64_tr_b16 a[64:65], v68 offset:0
    ds_read_b64_tr_b16 a[66:67], v68 offset:1024
    ds_read_b64_tr_b16 a[68:69], v68 offset:8192
    ds_read_b64_tr_b16 a[70:71], v68 offset:9216
    ds_read_b64_tr_b16 a[128:129], v69 offset:0
    ds_read_b64_tr_b16 a[130:131], v69 offset:1024
    ds_read_b64_tr_b16 a[132:133], v69 offset:8192
    ds_read_b64_tr_b16 a[134:135], v69 offset:9216
    s_waitcnt vmcnt(28) lgkmcnt(0)
    s_barrier
    s_mov_b32 m0, 0x3000
    s_add_u32 s31, s83, 0x380000
    buffer_load_dwordx4 v64, s[8:11], s31 offen nt lds
    s_mov_b32 m0, 0x3400
    s_add_u32 s31, s83, 0x388000
    buffer_load_dwordx4 v64, s[8:11], s31 offen nt lds
    s_mov_b32 m0, 0x3800
    s_add_u32 s31, s83, 0x390000
    buffer_load_dwordx4 v65, s[8:11], s31 offen nt lds
    s_mov_b32 m0, 0x3c00
    s_add_u32 s31, s83, 0x398000
    buffer_load_dwordx4 v65, s[8:11], s31 offen nt lds
    v_add_u32 v68, 0x8000, v66
    v_add_u32 v69, 0x8000, v67
    ds_read_b64_tr_b16 a[72:73], v68 offset:0
    ds_read_b64_tr_b16 a[74:75], v68 offset:1024
    ds_read_b64_tr_b16 a[76:77], v68 offset:8192
    ds_read_b64_tr_b16 a[78:79], v68 offset:9216
    ds_read_b64_tr_b16 a[136:137], v69 offset:0
    ds_read_b64_tr_b16 a[138:139], v69 offset:1024
    ds_read_b64_tr_b16 a[140:141], v69 offset:8192
    ds_read_b64_tr_b16 a[142:143], v69 offset:9216
    s_waitcnt vmcnt(28) lgkmcnt(0)
    s_barrier
    s_mov_b32 s8, s40
    s_mov_b32 s9, s41
    s_mov_b32 m0, 0xb000
    s_add_u32 s31, s83, 0x0
    buffer_load_dwordx4 v64, s[8:11], s31 offen nt lds
    s_mov_b32 m0, 0xb400
    s_add_u32 s31, s83, 0x8000
    buffer_load_dwordx4 v64, s[8:11], s31 offen nt lds
    s_mov_b32 m0, 0xb800
    s_add_u32 s31, s83, 0x10000
    buffer_load_dwordx4 v65, s[8:11], s31 offen nt lds
    s_mov_b32 m0, 0xbc00
    s_add_u32 s31, s83, 0x18000
    buffer_load_dwordx4 v65, s[8:11], s31 offen nt lds
    v_add_u32 v68, 0xc000, v66
    v_add_u32 v69, 0xc000, v67
    ds_read_b64_tr_b16 a[208:209], v68 offset:0
    ds_read_b64_tr_b16 a[210:211], v68 offset:1024
    ds_read_b64_tr_b16 a[212:213], v68 offset:8192
    ds_read_b64_tr_b16 a[214:215], v68 offset:9216
    ds_read_b64_tr_b16 v[160:161], v69 offset:0
    ds_read_b64_tr_b16 v[162:163], v69 offset:1024
    ds_read_b64_tr_b16 v[164:165], v69 offset:8192
    ds_read_b64_tr_b16 v[166:167], v69 offset:9216
    s_waitcnt vmcnt(28) lgkmcnt(0)
    s_barrier
    s_mov_b32 m0, 0xf000
    s_add_u32 s31, s83, 0x80000
    buffer_load_dwordx4 v64, s[8:11], s31 offen nt lds
    s_mov_b32 m0, 0xf400
    s_add_u32 s31, s83, 0x88000
    buffer_load_dwordx4 v64, s[8:11], s31 offen nt lds
    s_mov_b32 m0, 0xf800
    s_add_u32 s31, s83, 0x90000
    buffer_load_dwordx4 v65, s[8:11], s31 offen nt lds
    s_mov_b32 m0, 0xfc00
    s_add_u32 s31, s83, 0x98000
    buffer_load_dwordx4 v65, s[8:11], s31 offen nt lds
    v_add_u32 v68, 0x10000, v66
    v_add_u32 v69, 0x10000, v67
    ds_read_b64_tr_b16 a[216:217], v68 offset:0
    ds_read_b64_tr_b16 a[218:219], v68 offset:1024
    ds_read_b64_tr_b16 a[220:221], v68 offset:8192
    ds_read_b64_tr_b16 a[222:223], v68 offset:9216
    ds_read_b64_tr_b16 v[168:169], v69 offset:0
    ds_read_b64_tr_b16 v[170:171], v69 offset:1024
    ds_read_b64_tr_b16 v[172:173], v69 offset:8192
    ds_read_b64_tr_b16 v[174:175], v69 offset:9216
    s_waitcnt vmcnt(28) lgkmcnt(0)
    s_barrier
    s_mov_b32 m0, 0x13000
    s_add_u32 s31, s83, 0x100000
    buffer_load_dwordx4 v64, s[8:11], s31 offen nt lds
    s_mov_b32 m0, 0x13400
    s_add_u32 s31, s83, 0x108000
    buffer_load_dwordx4 v64, s[8:11], s31 offen nt lds
    s_mov_b32 m0, 0x13800
    s_add_u32 s31, s83, 0x110000
    buffer_load_dwordx4 v65, s[8:11], s31 offen nt lds
    s_mov_b32 m0, 0x13c00
    s_add_u32 s31, s83, 0x118000
    buffer_load_dwordx4 v65, s[8:11], s31 offen nt lds
    v_add_u32 v68, 0x14000, v66
    v_add_u32 v69, 0x14000, v67
    ds_read_b64_tr_b16 a[224:225], v68 offset:0
    ds_read_b64_tr_b16 a[226:227], v68 offset:1024
    ds_read_b64_tr_b16 a[228:229], v68 offset:8192
    ds_read_b64_tr_b16 a[230:231], v68 offset:9216
    ds_read_b64_tr_b16 v[176:177], v69 offset:0
    ds_read_b64_tr_b16 v[178:179], v69 offset:1024
    ds_read_b64_tr_b16 v[180:181], v69 offset:8192
    ds_read_b64_tr_b16 v[182:183], v69 offset:9216
    s_waitcnt vmcnt(28) lgkmcnt(0)
    s_barrier
    s_mov_b32 m0, 0x17000
    s_add_u32 s31, s83, 0x180000
    buffer_load_dwordx4 v64, s[8:11], s31 offen nt lds
    s_mov_b32 m0, 0x17400
    s_add_u32 s31, s83, 0x188000
    buffer_load_dwordx4 v64, s[8:11], s31 offen nt lds
    s_mov_b32 m0, 0x17800
    s_add_u32 s31, s83, 0x190000
    buffer_load_dwordx4 v65, s[8:11], s31 offen nt lds
    s_mov_b32 m0, 0x17c00
    s_add_u32 s31, s83, 0x198000
    buffer_load_dwordx4 v65, s[8:11], s31 offen nt lds
    v_add_u32 v68, 0x18000, v66
    v_add_u32 v69, 0x18000, v67
    ds_read_b64_tr_b16 a[232:233], v68 offset:0
    ds_read_b64_tr_b16 a[234:235], v68 offset:1024
    ds_read_b64_tr_b16 a[236:237], v68 offset:8192
    ds_read_b64_tr_b16 a[238:239], v68 offset:9216
    ds_read_b64_tr_b16 v[184:185], v69 offset:0
    ds_read_b64_tr_b16 v[186:187], v69 offset:1024
    ds_read_b64_tr_b16 v[188:189], v69 offset:8192
    ds_read_b64_tr_b16 v[190:191], v69 offset:9216
    s_waitcnt vmcnt(28) lgkmcnt(0)
    s_barrier
    s_mov_b32 m0, 0x1b000
    s_add_u32 s31, s83, 0x200000
    buffer_load_dwordx4 v64, s[8:11], s31 offen nt lds
    s_mov_b32 m0, 0x1b400
    s_add_u32 s31, s83, 0x208000
    buffer_load_dwordx4 v64, s[8:11], s31 offen nt lds
    s_mov_b32 m0, 0x1b800
    s_add_u32 s31, s83, 0x210000
    buffer_load_dwordx4 v65, s[8:11], s31 offen nt lds
    s_mov_b32 m0, 0x1bc00
    s_add_u32 s31, s83, 0x218000
    buffer_load_dwordx4 v65, s[8:11], s31 offen nt lds
    v_add_u32 v68, 0x1c000, v66
    v_add_u32 v69, 0x1c000, v67
    ds_read_b64_tr_b16 a[240:241], v68 offset:0
    ds_read_b64_tr_b16 a[242:243], v68 offset:1024
    ds_read_b64_tr_b16 a[244:245], v68 offset:8192
    ds_read_b64_tr_b16 a[246:247], v68 offset:9216
    ds_read_b64_tr_b16 v[192:193], v69 offset:0
    ds_read_b64_tr_b16 v[194:195], v69 offset:1024
    ds_read_b64_tr_b16 v[196:197], v69 offset:8192
    ds_read_b64_tr_b16 v[198:199], v69 offset:9216
    s_waitcnt vmcnt(28) lgkmcnt(0)
    s_barrier
    s_mov_b32 m0, 0x1f000
    s_add_u32 s31, s83, 0x280000
    buffer_load_dwordx4 v64, s[8:11], s31 offen nt lds
    s_mov_b32 m0, 0x1f400
    s_add_u32 s31, s83, 0x288000
    buffer_load_dwordx4 v64, s[8:11], s31 offen nt lds
    s_mov_b32 m0, 0x1f800
    s_add_u32 s31, s83, 0x290000
    buffer_load_dwordx4 v65, s[8:11], s31 offen nt lds
    s_mov_b32 m0, 0x1fc00
    s_add_u32 s31, s83, 0x298000
    buffer_load_dwordx4 v65, s[8:11], s31 offen nt lds
    v_add_u32 v68, 0x20000, v66
    v_add_u32 v69, 0x20000, v67
    ds_read_b64_tr_b16 a[248:249], v68 offset:0
    ds_read_b64_tr_b16 a[250:251], v68 offset:1024
    ds_read_b64_tr_b16 a[252:253], v68 offset:8192
    ds_read_b64_tr_b16 a[254:255], v68 offset:9216
    ds_read_b64_tr_b16 v[200:201], v69 offset:0
    ds_read_b64_tr_b16 v[202:203], v69 offset:1024
    ds_read_b64_tr_b16 v[204:205], v69 offset:8192
    ds_read_b64_tr_b16 v[206:207], v69 offset:9216
    s_waitcnt vmcnt(28) lgkmcnt(0)
    s_barrier
    s_mov_b32 m0, 0x23000
    s_add_u32 s31, s83, 0x300000
    buffer_load_dwordx4 v64, s[8:11], s31 offen nt lds
    s_mov_b32 m0, 0x23400
    s_add_u32 s31, s83, 0x308000
    buffer_load_dwordx4 v64, s[8:11], s31 offen nt lds
    s_mov_b32 m0, 0x23800
    s_add_u32 s31, s83, 0x310000
    buffer_load_dwordx4 v65, s[8:11], s31 offen nt lds
    s_mov_b32 m0, 0x23c00
    s_add_u32 s31, s83, 0x318000
    buffer_load_dwordx4 v65, s[8:11], s31 offen nt lds
    v_add_u32 v68, 0x24000, v66
    v_add_u32 v69, 0x24000, v67
    ds_read_b64_tr_b16 a[192:193], v68 offset:0
    ds_read_b64_tr_b16 a[194:195], v68 offset:1024
    ds_read_b64_tr_b16 a[196:197], v68 offset:8192
    ds_read_b64_tr_b16 a[198:199], v68 offset:9216
    ds_read_b64_tr_b16 v[144:145], v69 offset:0
    ds_read_b64_tr_b16 v[146:147], v69 offset:1024
    ds_read_b64_tr_b16 v[148:149], v69 offset:8192
    ds_read_b64_tr_b16 v[150:151], v69 offset:9216
    s_waitcnt vmcnt(28) lgkmcnt(0)
    s_barrier
    s_mov_b32 m0, 0x27000
    s_add_u32 s31, s83, 0x380000
    buffer_load_dwordx4 v64, s[8:11], s31 offen nt lds
    s_mov_b32 m0, 0x27400
    s_add_u32 s31, s83, 0x388000
    buffer_load_dwordx4 v64, s[8:11], s31 offen nt lds
    s_mov_b32 m0, 0x27800
    s_add_u32 s31, s83, 0x390000
    buffer_load_dwordx4 v65, s[8:11], s31 offen nt lds
    s_mov_b32 m0, 0x27c00
    s_add_u32 s31, s83, 0x398000
    buffer_load_dwordx4 v65, s[8:11], s31 offen nt lds
    v_add_u32 v68, 0x0, v66
    v_add_u32 v69, 0x0, v67
    ds_read_b64_tr_b16 a[200:201], v68 offset:0
    ds_read_b64_tr_b16 a[202:203], v68 offset:1024
    ds_read_b64_tr_b16 a[204:205], v68 offset:8192
    ds_read_b64_tr_b16 a[206:207], v68 offset:9216
    ds_read_b64_tr_b16 v[152:153], v69 offset:0
    ds_read_b64_tr_b16 v[154:155], v69 offset:1024
    ds_read_b64_tr_b16 v[156:157], v69 offset:8192
    ds_read_b64_tr_b16 v[158:159], v69 offset:9216
    s_waitcnt vmcnt(28) lgkmcnt(0)
    s_barrier
    v_add_u32 v64, 0x8000, v66
    v_add_u32 v65, 0x8000, v67
    ds_read_b64_tr_b16 v[96:97], v64 offset:0
    ds_read_b64_tr_b16 v[98:99], v64 offset:1024
    ds_read_b64_tr_b16 v[100:101], v64 offset:8192
    ds_read_b64_tr_b16 v[102:103], v64 offset:9216
    ds_read_b64_tr_b16 a[16:17], v65 offset:0
    ds_read_b64_tr_b16 a[18:19], v65 offset:1024
    ds_read_b64_tr_b16 a[20:21], v65 offset:8192
    ds_read_b64_tr_b16 a[22:23], v65 offset:9216
    s_waitcnt vmcnt(24) lgkmcnt(0)
    s_barrier
    v_add_u32 v64, 0xc000, v66
    v_add_u32 v65, 0xc000, v67
    ds_read_b64_tr_b16 v[104:105], v64 offset:0
    ds_read_b64_tr_b16 v[106:107], v64 offset:1024
    ds_read_b64_tr_b16 v[108:109], v64 offset:8192
    ds_read_b64_tr_b16 v[110:111], v64 offset:9216
    ds_read_b64_tr_b16 a[24:25], v65 offset:0
    ds_read_b64_tr_b16 a[26:27], v65 offset:1024
    ds_read_b64_tr_b16 a[28:29], v65 offset:8192
    ds_read_b64_tr_b16 a[30:31], v65 offset:9216
    s_waitcnt vmcnt(20) lgkmcnt(0)
    s_barrier
    v_add_u32 v64, 0x10000, v66
    v_add_u32 v65, 0x10000, v67
    ds_read_b64_tr_b16 v[112:113], v64 offset:0
    ds_read_b64_tr_b16 v[114:115], v64 offset:1024
    ds_read_b64_tr_b16 v[116:117], v64 offset:8192
    ds_read_b64_tr_b16 v[118:119], v64 offset:9216
    ds_read_b64_tr_b16 a[32:33], v65 offset:0
    ds_read_b64_tr_b16 a[34:35], v65 offset:1024
    ds_read_b64_tr_b16 a[36:37], v65 offset:8192
    ds_read_b64_tr_b16 a[38:39], v65 offset:9216
    s_waitcnt vmcnt(16) lgkmcnt(0)
    s_barrier
    v_add_u32 v64, 0x14000, v66
    v_add_u32 v65, 0x14000, v67
    ds_read_b64_tr_b16 v[120:121], v64 offset:0
    ds_read_b64_tr_b16 v[122:123], v64 offset:1024
    ds_read_b64_tr_b16 v[124:125], v64 offset:8192
    ds_read_b64_tr_b16 v[126:127], v64 offset:9216
    ds_read_b64_tr_b16 a[40:41], v65 offset:0
    ds_read_b64_tr_b16 a[42:43], v65 offset:1024
    ds_read_b64_tr_b16 a[44:45], v65 offset:8192
    ds_read_b64_tr_b16 a[46:47], v65 offset:9216
    s_waitcnt vmcnt(12) lgkmcnt(0)
    s_barrier
    v_add_u32 v65, 0x10000, v72
    ds_write_b128 v72, v[0:3] offset:32768
    ds_write_b128 v72, v[4:7] offset:33792
    ds_write_b128 v72, v[8:11] offset:40960
    ds_write_b128 v72, v[12:15] offset:41984
    ds_write_b128 v72, v[16:19] offset:49152
    ds_write_b128 v72, v[20:23] offset:50176
    ds_write_b128 v72, v[24:27] offset:57344
    ds_write_b128 v72, v[28:31] offset:58368
    ds_write_b128 v65, v[32:35] offset:0
    ds_write_b128 v65, v[36:39] offset:1024
    ds_write_b128 v65, v[40:43] offset:8192
    ds_write_b128 v65, v[44:47] offset:9216
    ds_write_b128 v65, v[48:51] offset:16384
    ds_write_b128 v65, v[52:55] offset:17408
    ds_write_b128 v65, v[56:59] offset:24576
    ds_write_b128 v65, v[60:63] offset:25600
    v_lshrrev_b32 v0, 4, v71
    v_and_b32 v1, 8, v0
    v_cmp_ne_u32 s[66:67], 0, v1
    v_and_b32 v1, 2, v0
    v_cmp_ne_u32 vcc, 0, v1
    v_mov_b32 v2, 0x4444
    v_mov_b32 v3, 0xeeee
    v_cndmask_b32 v70, v2, v3, vcc
    v_and_b32 v1, 11, v0
    v_cmp_eq_u32 s[70:71], 0, v1
    v_cmp_eq_u32 s[72:73], 1, v1
    v_cmp_eq_u32 s[74:75], 8, v1
    v_cmp_eq_u32 s[76:77], 9, v1
    v_and_b32 v3, 1, v0
    v_lshlrev_b32 v3, 4, v3
    v_mov_b32 v4, 0x3f80
    v_lshlrev_b32 v4, v3, v4
    v_lshrrev_b32 v5, 4, v0
    v_bfe_u32 v1, v0, 1, 2
    v_cmp_eq_u32 vcc, v1, v5
    s_nop 1
    v_cndmask_b32 v68, 0, v4, vcc
    v_cndmask_b32 v69, 0, v4, vcc
    v_bfe_u32 v1, v0, 2, 2
    v_cmp_eq_u32 vcc, v1, v5
    s_nop 1
    v_cndmask_b32 v76, 0, v4, vcc
    v_cndmask_b32 v77, 0, v4, vcc
    v_and_b32 v1, 0x31, v0
    v_bfe_u32 v2, v0, 1, 2
    v_lshl_or_b32 v1, v2, 2, v1
    v_bfe_u32 v2, v0, 3, 1
    v_lshl_or_b32 v1, v2, 1, v1
    v_lshlrev_b32 v1, 4, v1
    s_lshr_b32 s30, s20, 1
    s_lshl_b32 s30, s30, 11
    s_and_b32 s31, s20, 1
    s_lshl_b32 s31, s31, 3
    s_add_u32 s30, s30, s31
    v_add_u32 v78, s30, v1
    s_mov_b32 s35, 0x3e0293ee
    s_lshl_b32 s30, s21, 14
    s_lshl_b32 s31, s20, 12
    s_add_u32 s28, s30, s31
    s_add_u32 s28, s28, 0x1200000
    s_lshr_b32 s30, s30, 1
    s_lshr_b32 s31, s31, 1
    s_add_u32 s29, s30, s31
    s_add_u32 s29, s29, 0x3200000
    s_add_u32 s27, s30, s31
    s_add_u32 s27, s27, 0x4200000
    s_add_u32 s25, s31, 0x4300000
    s_lshl_b32 s30, s21, 10
    s_lshl_b32 s31, s20, 2
    s_add_u32 s82, s30, s31
    s_add_u32 s81, s82, 0x5600080
    s_lshl_b32 s30, s21, 6
    s_lshl_b32 s31, s20, 16
    s_add_u32 s26, s30, s31
    s_add_u32 s26, s26, 0x4200000
    s_add_u32 s80, s82, 0x5600100
    s_lshl_b32 s30, s21, 8
    s_lshl_b32 s31, s20, 6
    s_add_u32 s30, s30, s31
    s_add_u32 s79, s30, 0x4300000
    s_mov_b32 s68, 0x000f000f
    s_mov_b32 s69, 0x000f000f
    s_lshl_b32 s83, s20, 2
    s_mov_b32 s78, 0
    s_mov_b32 s34, 0
    s_mov_b32 s22, 0
    s_and_b32 s30, s21, 7
    s_lshl_b32 s30, s30, 13
    s_add_u32 s26, s26, s30
    s_and_b32 s52, s21, 7
    s_lshl_b32 s52, s52, 6
    s_add_u32 s29, s79, 0x10000
    s_mov_b32 s32, 1
    s_mov_b32 s33, 1
    buffer_load_dword v6, off, s[12:15], 0 offset:36 sc1
    buffer_load_dword v7, off, s[4:7], s81 sc1
    buffer_load_dword v79, off, s[4:7], s81 offset:16 sc1
    v_mov_b64 v[32:33], 0
    v_mov_b64 v[34:35], 0
    v_mov_b64 v[36:37], 0
    v_mov_b64 v[38:39], 0
    v_mov_b64 v[40:41], 0
    v_mov_b64 v[42:43], 0
    v_mov_b64 v[44:45], 0
    v_mov_b64 v[46:47], 0
    v_mov_b64 v[48:49], 0
    v_mov_b64 v[50:51], 0
    v_mov_b64 v[52:53], 0
    v_mov_b64 v[54:55], 0
    v_add_u32 v73, 0, v71
    v_add_u32 v74, 2048, v71
    v_add_u32 v75, 4096, v71
    v_add_u32 v64, 0x18000, v66
    v_add_u32 v65, 0x18000, v67
    ds_read_b64_tr_b16 v[128:129], v64 offset:0
    ds_read_b64_tr_b16 v[130:131], v64 offset:1024
    ds_read_b64_tr_b16 v[132:133], v64 offset:8192
    ds_read_b64_tr_b16 v[134:135], v64 offset:9216
    ds_read_b64_tr_b16 a[48:49], v65 offset:0
    ds_read_b64_tr_b16 a[50:51], v65 offset:1024
    ds_read_b64_tr_b16 a[52:53], v65 offset:8192
    ds_read_b64_tr_b16 a[54:55], v65 offset:9216
    s_waitcnt vmcnt(8) lgkmcnt(0)
    s_barrier
    v_add_u32 v64, 0x1c000, v66
    v_add_u32 v65, 0x1c000, v67
    ds_read_b64_tr_b16 v[136:137], v64 offset:0
    ds_read_b64_tr_b16 v[138:139], v64 offset:1024
    ds_read_b64_tr_b16 v[140:141], v64 offset:8192
    ds_read_b64_tr_b16 v[142:143], v64 offset:9216
    ds_read_b64_tr_b16 a[56:57], v65 offset:0
    ds_read_b64_tr_b16 a[58:59], v65 offset:1024
    ds_read_b64_tr_b16 a[60:61], v65 offset:8192
    ds_read_b64_tr_b16 a[62:63], v65 offset:9216
    s_waitcnt vmcnt(4) lgkmcnt(0)
    s_barrier
    v_add_u32 v64, 0x20000, v66
    v_add_u32 v65, 0x20000, v67
    ds_read_b64_tr_b16 v[80:81], v64 offset:0
    ds_read_b64_tr_b16 v[82:83], v64 offset:1024
    ds_read_b64_tr_b16 v[84:85], v64 offset:8192
    ds_read_b64_tr_b16 v[86:87], v64 offset:9216
    ds_read_b64_tr_b16 a[0:1], v65 offset:0
    ds_read_b64_tr_b16 a[2:3], v65 offset:1024
    ds_read_b64_tr_b16 a[4:5], v65 offset:8192
    ds_read_b64_tr_b16 a[6:7], v65 offset:9216
    s_waitcnt vmcnt(0) lgkmcnt(0)
    s_barrier
    v_add_u32 v64, 0x24000, v66
    v_add_u32 v65, 0x24000, v67
    ds_read_b64_tr_b16 v[88:89], v64 offset:0
    ds_read_b64_tr_b16 v[90:91], v64 offset:1024
    ds_read_b64_tr_b16 v[92:93], v64 offset:8192
    ds_read_b64_tr_b16 v[94:95], v64 offset:9216
    ds_read_b64_tr_b16 a[8:9], v65 offset:0
    ds_read_b64_tr_b16 a[10:11], v65 offset:1024
    ds_read_b64_tr_b16 a[12:13], v65 offset:8192
    ds_read_b64_tr_b16 a[14:15], v65 offset:9216
    s_waitcnt vmcnt(0) lgkmcnt(0)
    s_barrier
L_CLDONE:
L_CRDY:
    v_readfirstlane_b32 s30, v6
    v_readfirstlane_b32 s31, v7
    s_cmp_lt_u32 s30, 32
    s_cbranch_scc1 L_CRDY_R
    s_cmp_ge_u32 s31, 1
    s_cbranch_scc0 L_CRDY_R
    v_mov_b32 v67, 0x7ffffff0
    s_waitcnt lgkmcnt(0)
    s_lshl_b32 m0, s20, 11
    s_nop 0
    s_add_u32 s30, s25, 0x4000
    buffer_load_dwordx4 v[0:3], v71, s[4:7], s30 offen offset:0 sc1
    buffer_load_dwordx4 v[4:7], v71, s[4:7], s30 offen offset:1024 sc1
    v_add_u32 v8, 0x10000, v72
    v_add_u32 v9, 0x20000, v72
    ds_write_b128 v8, v[80:83] offset:32768
    ds_write_b128 v8, v[84:87] offset:33792
    ds_write_b128 v8, v[88:91] offset:40960
    ds_write_b128 v8, v[92:95] offset:41984
    ds_write_b128 v8, v[96:99] offset:49152
    ds_write_b128 v8, v[100:103] offset:50176
    ds_write_b128 v8, v[104:107] offset:57344
    ds_write_b128 v8, v[108:111] offset:58368
    ds_write_b128 v9, v[112:115] offset:0
    ds_write_b128 v9, v[116:119] offset:1024
    ds_write_b128 v9, v[120:123] offset:8192
    ds_write_b128 v9, v[124:127] offset:9216
    ds_write_b128 v9, v[128:131] offset:16384
    ds_write_b128 v9, v[132:135] offset:17408
    ds_write_b128 v9, v[136:139] offset:24576
    ds_write_b128 v9, v[140:143] offset:25600
    s_waitcnt vmcnt(0)
    s_branch L_GOT
.p2align 6
    s_nop 0
    s_nop 0
    s_nop 0
    s_nop 0
    s_nop 0
    s_nop 0
    s_nop 0
    s_nop 0
L_STEP:
    s_waitcnt vmcnt(2)
    v_bitop3_b32 v64, v0, v4, s34 bitop3:0x7e
    v_and_b32 v64, 1, v64
    v_cmp_ne_u32 vcc, 0, v64
    s_cbranch_vccnz L_H2R
L_GOT:
    ds_write_b128 v72, v[0:3] offset:0
    v_smfmac_f32_16x16x64_bf16 v[32:35], v[0:3], v[80:87], v70
    v_smfmac_f32_16x16x64_bf16 v[36:39], v[0:3], a[0:7], v70
    v_smfmac_f32_16x16x64_bf16 v[40:43], v[0:3], a[64:71], v70
    ds_write_b128 v72, v[4:7] offset:1024
    v_smfmac_f32_16x16x64_bf16 v[44:47], v[0:3], a[128:135], v70
    v_smfmac_f32_16x16x64_bf16 v[32:35], v[4:7], v[88:95], v70
    v_smfmac_f32_16x16x64_bf16 v[36:39], v[4:7], a[8:15], v70
    v_smfmac_f32_16x16x64_bf16 v[40:43], v[4:7], a[72:79], v70
    s_waitcnt lgkmcnt(0)
    s_barrier
    ds_read_b128 v[8:11], v73 offset:0
    ds_read_b128 v[12:15], v73 offset:1024
    v_smfmac_f32_16x16x64_bf16 v[44:47], v[4:7], a[136:143], v70
    ds_read_b128 v[16:19], v74 offset:0
    ds_read_b128 v[20:23], v74 offset:1024
    v_smfmac_f32_16x16x64_bf16 v[48:51], v[0:3], a[192:199], v70
    ds_read_b128 v[24:27], v75 offset:0
    ds_read_b128 v[28:31], v75 offset:1024
    v_smfmac_f32_16x16x64_bf16 v[52:55], v[0:3], v[144:151], v70
    buffer_load_dwordx4 v[56:59], v71, s[4:7], s28 offen offset:0 sc1
    v_smfmac_f32_16x16x64_bf16 v[48:51], v[4:7], a[200:207], v70
    v_smfmac_f32_16x16x64_bf16 v[52:55], v[4:7], v[152:159], v70
    s_waitcnt lgkmcnt(5)
    v_smfmac_f32_16x16x64_bf16 v[32:35], v[8:11], v[96:103], v70
    buffer_load_dwordx4 v[60:63], v71, s[4:7], s28 offen offset:1024 sc1
    v_smfmac_f32_16x16x64_bf16 v[36:39], v[8:11], a[16:23], v70
    s_waitcnt lgkmcnt(4)
    v_cmp_gt_u32 vcc, s33, v79
    v_smfmac_f32_16x16x64_bf16 v[32:35], v[12:15], v[104:111], v70
    buffer_load_dwordx4 v[0:3], v71, s[4:7], s28 offen offset:2048 sc1
    v_smfmac_f32_16x16x64_bf16 v[36:39], v[12:15], a[24:31], v70
    s_waitcnt lgkmcnt(2)
    s_cmp_ge_u32 s22, 63
    s_cbranch_scc1 L_NOPF
    v_smfmac_f32_16x16x64_bf16 v[32:35], v[16:19], v[112:119], v70
    buffer_load_dwordx4 v[4:7], v71, s[4:7], s28 offen offset:3072 sc1
    v_smfmac_f32_16x16x64_bf16 v[36:39], v[16:19], a[32:39], v70
    s_bitcmp1_b32 vcc_hi, 31
        s_cbranch_scc1 L_KVW
    L_KVOK:
    v_smfmac_f32_16x16x64_bf16 v[32:35], v[20:23], v[120:127], v70
    s_add_u32 s32, s32, 1
    s_cmp_eq_u32 s32, 6
    v_lshlrev_b32 v79, 2, v71
    v_smfmac_f32_16x16x64_bf16 v[36:39], v[20:23], a[40:47], v70
    s_waitcnt lgkmcnt(0)
    s_cselect_b32 s32, 0, s32
    s_addc_u32 s33, s33, 0
    v_smfmac_f32_16x16x64_bf16 v[32:35], v[24:27], v[128:135], v70
    s_lshl_b32 s31, s32, 4
    s_add_u32 s31, s31, s81
    s_add_u32 s30, s28, 0x80000
    v_smfmac_f32_16x16x64_bf16 v[36:39], v[24:27], a[48:55], v70
    s_sub_u32 s31, s31, s30
    v_writelane_b32 v79, s31, 63
    v_smfmac_f32_16x16x64_bf16 v[32:35], v[28:31], v[136:143], v70
    buffer_load_dword v79, v79, s[4:7], s30 offen sc1
    v_smfmac_f32_16x16x64_bf16 v[36:39], v[28:31], a[56:63], v70
    s_mov_b64 exec, s[68:69]
    buffer_store_dword v66, v67, s[4:7], s29 offen sc1
    s_mov_b64 exec, -1
L_PFD:
    v_smfmac_f32_16x16x64_bf16 v[40:43], v[8:11], a[80:87], v70
    ds_read_b128 v[80:83], v72 offset:32768
    v_cvt_pk_bf16_f32 v32, v32, v33
    v_cvt_pk_bf16_f32 v33, v34, v35
    v_smfmac_f32_16x16x64_bf16 v[44:47], v[8:11], a[144:151], v70
    ds_read_b128 v[84:87], v72 offset:33792
    v_cvt_pk_bf16_f32 v34, v36, v37
    v_cvt_pk_bf16_f32 v35, v38, v39
    v_mfma_f32_16x16x16_bf16 v[64:67], v[32:33], v[68:69], 0
    ds_read_b128 v[88:91], v72 offset:40960
    v_mfma_f32_16x16x16_bf16 v[36:39], v[34:35], v[68:69], 0
    ds_read_b128 v[92:95], v72 offset:41984
    v_smfmac_f32_16x16x64_bf16 v[40:43], v[12:15], a[88:95], v70
    ds_read_b128 v[96:99], v72 offset:49152
    v_cvt_pk_bf16_f32 v32, v64, v65
    v_smfmac_f32_16x16x64_bf16 v[44:47], v[12:15], a[152:159], v70
    ds_read_b128 v[100:103], v72 offset:50176
    v_cvt_pk_bf16_f32 v33, v66, v67
    v_cvt_pk_bf16_f32 v34, v36, v37
    v_smfmac_f32_16x16x64_bf16 v[40:43], v[16:19], a[96:103], v70
    ds_read_b128 v[104:107], v72 offset:57344
    v_cvt_pk_bf16_f32 v35, v38, v39
    v_smfmac_f32_16x16x64_bf16 v[44:47], v[16:19], a[160:167], v70
    s_waitcnt vmcnt(4)
    v_mfma_f32_16x16x32_bf16 v[36:39], v[56:59], v[32:35], 0
    ds_read_b128 v[108:111], v72 offset:58368
    v_mfma_f32_16x16x32_bf16 v[64:67], v[60:63], v[32:35], 0
    v_add_u32 v63, 0x10000, v72
    v_smfmac_f32_16x16x64_bf16 v[40:43], v[20:23], a[104:111], v70
    ds_read_b128 v[112:115], v63 offset:0
    v_smfmac_f32_16x16x64_bf16 v[44:47], v[20:23], a[168:175], v70
    ds_read_b128 v[116:119], v63 offset:1024
    v_cndmask_b32 v36, v36, v64, s[66:67]
    v_smfmac_f32_16x16x64_bf16 v[40:43], v[24:27], a[112:119], v70
    ds_read_b128 v[120:123], v63 offset:8192
    v_cndmask_b32 v37, v37, v65, s[66:67]
    v_cndmask_b32 v38, v38, v66, s[66:67]
    v_smfmac_f32_16x16x64_bf16 v[44:47], v[24:27], a[176:183], v70
    ds_read_b128 v[124:127], v63 offset:9216
    v_cndmask_b32 v39, v39, v67, s[66:67]
    v_smfmac_f32_16x16x64_bf16 v[40:43], v[28:31], a[120:127], v70
    ds_write_b128 v72, v[36:39] offset:8192
    v_smfmac_f32_16x16x64_bf16 v[44:47], v[28:31], a[184:191], v70
    ds_read_b128 v[128:131], v63 offset:16384
    v_add_u32 v62, s83, v71
    v_smfmac_f32_16x16x64_bf16 v[48:51], v[8:11], a[208:215], v70
    ds_read_b128 v[132:135], v63 offset:17408
    v_cvt_pk_bf16_f32 v40, v40, v41
    v_cvt_pk_bf16_f32 v41, v42, v43
    s_nop 0
    v_cvt_pk_bf16_f32 v42, v44, v45
    v_cvt_pk_bf16_f32 v43, v46, v47
    v_mfma_f32_16x16x16_bf16 v[64:67], v[40:41], v[76:77], 0
    s_mov_b64 vcc, s[66:67]
    v_mfma_f32_16x16x16_bf16 v[44:47], v[42:43], v[76:77], 0
    v_smfmac_f32_16x16x64_bf16 v[52:55], v[8:11], v[160:167], v70
    ds_read_b128 v[136:139], v63 offset:24576
    v_cvt_pk_bf16_f32 v40, v64, v65
    v_cvt_pk_bf16_f32 v41, v66, v67
    s_nop 0
    v_cvt_pk_bf16_f32 v42, v44, v45
    v_cvt_pk_bf16_f32 v43, v46, v47
    ds_read_b128 v[140:143], v63 offset:25600
    s_nop 0
    v_mfma_f32_16x16x32_bf16 v[44:47], v[40:43], v[32:35], 0
    v_smfmac_f32_16x16x64_bf16 v[48:51], v[12:15], a[216:223], v70
    s_nop 3
    v_cndmask_b32 v44, v44, v45, vcc
    ds_write_b32 v62, v44 offset:9216
    v_smfmac_f32_16x16x64_bf16 v[52:55], v[12:15], v[168:175], v70
    s_not_b64 vcc, vcc
    v_smfmac_f32_16x16x64_bf16 v[48:51], v[16:19], a[224:231], v70
    v_smfmac_f32_16x16x64_bf16 v[52:55], v[16:19], v[176:183], v70
    v_smfmac_f32_16x16x64_bf16 v[48:51], v[20:23], a[232:239], v70
    s_waitcnt lgkmcnt(0)
    s_barrier
    ds_read_b128 v[32:35], v73 offset:8192
    ds_read_b128 v[8:11], v71 offset:9216
    ds_read_b128 v[64:67], v74 offset:8192
    ds_read_b128 v[56:59], v75 offset:8192
    v_smfmac_f32_16x16x64_bf16 v[52:55], v[20:23], v[184:191], v70
    v_smfmac_f32_16x16x64_bf16 v[48:51], v[24:27], a[240:247], v70
    v_smfmac_f32_16x16x64_bf16 v[52:55], v[24:27], v[192:199], v70
    v_smfmac_f32_16x16x64_bf16 v[48:51], v[28:31], a[248:255], v70
    v_smfmac_f32_16x16x64_bf16 v[52:55], v[28:31], v[200:207], v70
    s_waitcnt lgkmcnt(3)
    v_add_f32 v36, v36, v32
    v_add_f32 v37, v37, v33
    v_add_f32 v38, v38, v34
    v_add_f32 v39, v39, v35
    s_waitcnt lgkmcnt(2)
    v_add_f32 v8, v8, v9
    v_add_f32 v10, v10, v11
    s_waitcnt lgkmcnt(1)
    v_add_f32 v36, v36, v64
    v_add_f32 v37, v37, v65
    v_add_f32 v44, v8, v10
    v_add_f32 v38, v38, v66
    v_add_f32 v39, v39, v67
    s_waitcnt lgkmcnt(0)
    v_add_f32 v36, v36, v56
    v_add_f32 v37, v37, v57
    v_add_f32 v38, v38, v58
    v_add_f32 v39, v39, v59
    v_max3_f32 v64, v36, v37, v38
    v_max3_f32 v64, v64, v39, v44
    v_cvt_pk_bf16_f32 v48, v48, v49
    v_cvt_pk_bf16_f32 v49, v50, v51
    v_max_f32_dpp v66, v64, v64 row_ror:8 row_mask:0xf bank_mask:0xf
    v_max_f32_dpp v67, v64, v64 row_ror:8 row_mask:0xf bank_mask:0xf
    v_cvt_pk_bf16_f32 v50, v52, v53
    v_cvt_pk_bf16_f32 v51, v54, v55
    v_permlane16_swap_b32 v66, v67
    v_max_f32 v64, v66, v67
    v_max_f32 v65, v66, v67
    s_cmp_eq_u32 s22, 63
    s_cbranch_scc1 L_CFIN
    v_permlane32_swap_b32 v64, v65
    v_max_f32 v64, v64, v65
    v_mul_f32 v64, s35, v64
    v_fma_f32 v44, v44, s35, -v64
    v_fma_f32 v36, v36, s35, -v64
    v_fma_f32 v37, v37, s35, -v64
    v_fma_f32 v38, v38, s35, -v64
    v_fma_f32 v39, v39, s35, -v64
    v_exp_f32 v44, v44
    v_exp_f32 v36, v36
    v_exp_f32 v37, v37
    v_exp_f32 v38, v38
    v_exp_f32 v39, v39
    v_cvt_pk_bf16_f32 v64, v36, v37
    v_cndmask_b32_dpp v66, v44, v44, vcc row_ror:8 row_mask:0xf bank_mask:0xf
    v_cvt_pk_bf16_f32 v65, v38, v39
    v_cndmask_b32_dpp v32, v64, v64, vcc row_ror:8 row_mask:0xf bank_mask:0xf
    v_add_f32 v8, v36, v37
    v_cndmask_b32_dpp v33, v65, v65, vcc row_ror:8 row_mask:0xf bank_mask:0xf
    s_not_b64 vcc, vcc
    v_cndmask_b32_dpp v34, v64, v64, vcc row_ror:8 row_mask:0xf bank_mask:0xf
    v_cndmask_b32_dpp v35, v65, v65, vcc row_ror:8 row_mask:0xf bank_mask:0xf
    v_cndmask_b32_dpp v67, v44, v44, vcc row_ror:8 row_mask:0xf bank_mask:0xf
    s_waitcnt vmcnt(2)
    v_mfma_f32_16x16x32_bf16 v[40:43], v[0:3], v[32:35], 0
    v_add_f32 v9, v38, v39
    v_add_f32 v8, v8, v44
    v_mfma_f32_16x16x32_bf16 v[56:59], v[4:7], v[32:35], 0
    v_add_f32 v8, v8, v9
    v_cvt_pk_bf16_f32 v46, v66, v67
    v_cvt_pk_bf16_f32 v47, v66, v67
    v_add_f32_dpp v10, v8, v8 row_ror:8 row_mask:0xf bank_mask:0xf
    v_add_f32_dpp v11, v8, v8 row_ror:8 row_mask:0xf bank_mask:0xf
    v_mfma_f32_16x16x16_bf16 v[40:43], v[48:49], v[46:47], v[40:43]
    v_mov_b64 v[12:13], 0
    v_permlane16_swap_b32 v10, v11
    v_mfma_f32_16x16x16_bf16 v[56:59], v[50:51], v[46:47], v[56:59]
    v_add_f32 v8, v10, v11
    v_add_f32 v9, v10, v11
    v_mfma_f32_32x32x8_bf16 v[16:31], v[12:13], v[12:13], 0
    s_nop 0
    v_permlane32_swap_b32 v8, v9
    v_add_f32 v8, v8, v9
    v_rcp_f32 v8, v8
    v_cndmask_b32 v36, v40, v56, vcc
    v_cndmask_b32 v37, v41, v57, vcc
    v_cndmask_b32 v38, v42, v58, vcc
    v_cndmask_b32 v39, v43, v59, vcc
    v_mul_f32 v36, v8, v36
    v_mul_f32 v37, v8, v37
    v_mul_f32 v38, v8, v38
    v_mul_f32 v39, v8, v39
    v_cvt_pk_bf16_f32 v56, v36, v37
    v_cvt_pk_bf16_f32 v57, v38, v39
    ds_write_b64 v78, v[56:57] offset:11264
    v_mov_b64 v[64:65], 0
    v_and_b32 v59, 0x30, v71
    v_cmp_eq_u32 vcc, 0, v59
    v_mfma_f32_32x32x8_bf16 v[0:15], v[64:65], v[64:65], 0
    v_mov_b32 v60, s78
    v_bfe_u32 v58, v71, 2, 6
    v_cndmask_b32 v60, 0, v60, vcc
    v_cndmask_b32 v59, -1, -2, vcc
    v_add_u32 v61, 0x10000, v72
    v_add_u32 v62, 0x20000, v72
    s_waitcnt lgkmcnt(0)
    s_barrier
    ds_read_b128 v[48:51], v71 offset:11264
    ds_read_b128 v[52:55], v71 offset:13312
    v_and_b32 v56, 0x300, v71
    v_lshl_or_b32 v58, v56, 3, v58
    s_waitcnt lgkmcnt(1)
    v_smfmac_f32_16x16x64_bf16 v[16:19], v[48:51], v[80:87], v70
    s_waitcnt lgkmcnt(0)
    v_smfmac_f32_16x16x64_bf16 v[16:19], v[52:55], v[208:215], v70
    ds_read_b128 v[32:35], v72 offset:16384
    v_smfmac_f32_16x16x64_bf16 v[20:23], v[48:51], v[88:95], v70
    ds_read_b128 v[36:39], v72 offset:17408
    v_smfmac_f32_16x16x64_bf16 v[20:23], v[52:55], v[216:223], v70
    ds_read_b128 v[40:43], v72 offset:24576
    v_add_f32 v16, v16, v18
    v_add_f32 v17, v17, v19
    v_smfmac_f32_16x16x64_bf16 v[24:27], v[48:51], v[96:103], v70
    s_xor_b32 s31, s26, 0x0
    v_cvt_pk_bf16_f32 v18, v16, v17
    v_and_or_b32 v18, v18, v59, v60
    v_smfmac_f32_16x16x64_bf16 v[24:27], v[52:55], v[224:231], v70
    buffer_store_dword v18, v58, s[4:7], s31 offen
    v_add_f32 v20, v20, v22
    v_add_f32 v21, v21, v23
    v_smfmac_f32_16x16x64_bf16 v[28:31], v[48:51], v[104:111], v70
    ds_read_b128 v[44:47], v72 offset:25600
    s_xor_b32 s31, s26, 0x2000
    v_cvt_pk_bf16_f32 v22, v20, v21
    v_and_or_b32 v22, v22, v59, v60
    v_smfmac_f32_16x16x64_bf16 v[28:31], v[52:55], v[232:239], v70
    buffer_store_dword v22, v58, s[4:7], s31 offen
    v_add_f32 v24, v24, v26
    v_add_f32 v25, v25, v27
    v_smfmac_f32_16x16x64_bf16 v[0:3], v[48:51], v[112:119], v70
    s_xor_b32 s31, s26, 0x4000
    v_cvt_pk_bf16_f32 v26, v24, v25
    v_and_or_b32 v26, v26, v59, v60
    v_smfmac_f32_16x16x64_bf16 v[0:3], v[52:55], v[240:247], v70
    buffer_store_dword v26, v58, s[4:7], s31 offen
    v_add_f32 v28, v28, v30
    v_add_f32 v29, v29, v31
    v_smfmac_f32_16x16x64_bf16 v[4:7], v[48:51], v[120:127], v70
    s_xor_b32 s31, s26, 0x6000
    v_cvt_pk_bf16_f32 v30, v28, v29
    v_and_or_b32 v30, v30, v59, v60
    v_smfmac_f32_16x16x64_bf16 v[4:7], v[52:55], v[248:255], v70
    buffer_store_dword v30, v58, s[4:7], s31 offen
    v_add_f32 v0, v0, v2
    v_add_f32 v1, v1, v3
    v_smfmac_f32_16x16x64_bf16 v[8:11], v[48:51], v[128:135], v70
    s_xor_b32 s31, s26, 0x8000
    s_waitcnt lgkmcnt(0)
    v_cvt_pk_bf16_f32 v2, v0, v1
    v_and_or_b32 v2, v2, v59, v60
    v_smfmac_f32_16x16x64_bf16 v[8:11], v[52:55], v[32:39], v70
    buffer_store_dword v2, v58, s[4:7], s31 offen
    v_add_f32 v4, v4, v6
    v_add_f32 v5, v5, v7
    v_smfmac_f32_16x16x64_bf16 v[12:15], v[48:51], v[136:143], v70
    s_xor_b32 s31, s26, 0xa000
    v_cvt_pk_bf16_f32 v6, v4, v5
    v_and_or_b32 v6, v6, v59, v60
    v_smfmac_f32_16x16x64_bf16 v[12:15], v[52:55], v[40:47], v70
    buffer_store_dword v6, v58, s[4:7], s31 offen
    v_add_f32 v8, v8, v10
    v_add_f32 v9, v9, v11
    s_xor_b32 s31, s26, 0xc000
    v_cvt_pk_bf16_f32 v10, v8, v9
    v_and_or_b32 v10, v10, v59, v60
    buffer_store_dword v10, v58, s[4:7], s31 offen
    s_nop 0
    v_pk_add_f32 v[12:13], v[12:13], v[14:15]
    s_xor_b32 s31, s26, 0xe000
    v_cvt_pk_bf16_f32 v14, v12, v13
    v_and_or_b32 v14, v14, v59, v60
    buffer_store_dword v14, v58, s[4:7], s31 offen
L_NOCOMP:
    v_lshlrev_b32 v56, 1, v56
    v_and_b32 v57, 0xf0, v71
    v_xor_b32 v57, s52, v57
    v_or_b32 v56, v56, v57
    v_xor_b32 v57, 0x100, v56
    s_add_u32 s31, s22, 1
    s_bfe_u32 s34, s31, 0x10001
    s_xor_b32 s25, s25, 0x2000
    s_xor_b32 s79, s79, 0x2000
    v_and_b32 v22, 64, v71
    v_lshrrev_b32 v22, 2, v22
    v_xor_b32 v22, 16, v22
    buffer_load_dwordx4 v[24:27], v56, s[4:7], s27 offen offset:0 sc1
    v_cndmask_b32 v16, 0, 1.0, s[70:71]
    v_cndmask_b32 v17, 0, 1.0, s[72:73]
    v_cndmask_b32 v18, 0, 1.0, s[74:75]
    v_cndmask_b32 v19, 0, 1.0, s[76:77]
    v_lshrrev_b32 v16, v22, v16
    v_lshrrev_b32 v17, v22, v17
    v_lshrrev_b32 v18, v22, v18
    v_lshrrev_b32 v19, v22, v19
    v_lshrrev_b32 v22, 4, v71
    v_and_b32 v22, 0x30, v22
    buffer_load_dwordx4 v[28:31], v57, s[4:7], s27 offen offset:0 sc1
    v_bfe_u32 v67, v71, 4, 2
    v_lshl_or_b32 v67, v67, 2, v22
    v_not_b32 v21, v59
    v_and_b32 v21, s34, v21
    v_mov_b64 v[8:9], 0
    ds_read_b128 v[80:83], v61 offset:32768
    ds_read_b128 v[84:87], v61 offset:33792
    ds_read_b128 v[88:91], v61 offset:40960
    ds_read_b128 v[92:95], v61 offset:41984
    ds_read_b128 v[96:99], v61 offset:49152
    ds_read_b128 v[100:103], v61 offset:50176
    ds_read_b128 v[104:107], v61 offset:57344
    ds_read_b128 v[108:111], v61 offset:58368
    ds_read_b128 v[112:115], v62 offset:0
    ds_read_b128 v[116:119], v62 offset:1024
    buffer_load_dwordx4 v[28:31], v57, s[4:7], s27 offen offset:0 sc1
    ds_read_b128 v[120:123], v62 offset:8192
    ds_read_b128 v[124:127], v62 offset:9216
    ds_read_b128 v[128:131], v62 offset:16384
    ds_read_b128 v[132:135], v62 offset:17408
    ds_read_b128 v[136:139], v62 offset:24576
    ds_read_b128 v[140:143], v62 offset:25600
    s_waitcnt vmcnt(1)
    v_bitop3_b32 v64, v24, v28, s78 bitop3:0x7e
    v_and_b32 v64, 1, v64
    v_cmp_ne_u32 vcc, 0, v64
    s_cbranch_vccz L_H1OK
L_H1W:
    s_waitcnt vmcnt(0)
    v_bitop3_b32 v64, v24, v28, s78 bitop3:0x7e
    v_and_b32 v64, 1, v64
    v_cmp_ne_u32 vcc, 0, v64
    s_cbranch_vccnz L_H1R
L_H1OK:
    v_mfma_f32_16x16x32_bf16 v[12:15], v[16:19], v[24:27], 0
    v_mfma_f32_16x16x32_bf16 v[12:15], v[16:19], v[28:31], v[12:15]
    s_add_u32 s22, s22, 1
    s_add_u32 s28, s28, 0x80000
    s_add_u32 s29, s29, 0x2000
    s_xor_b32 s27, s27, 0x40000
    s_xor_b32 s26, s26, 0x40000
    s_bfe_u32 s78, s22, 0x10001
    s_nop 1
    v_add_f32_dpp v14, v12, v12 row_ror:4 row_mask:0xf bank_mask:0xf
    v_add_f32_dpp v15, v13, v13 row_ror:4 row_mask:0xf bank_mask:0xf
    s_nop 0
    v_add_f32_dpp v12, v14, v14 row_ror:8 row_mask:0xf bank_mask:0xf
    v_add_f32_dpp v13, v15, v15 row_ror:8 row_mask:0xf bank_mask:0xf
    s_mov_b64 exec, s[68:69]
    v_cvt_pk_bf16_f32 v66, v12, v13
    v_and_or_b32 v66, v66, v59, v21
    buffer_store_dword v66, v67, s[4:7], s79 offen
    s_mov_b64 exec, -1
    v_mfma_f32_32x32x8_bf16 v[32:47], v[8:9], v[8:9], 0
    v_mfma_f32_32x32x8_bf16 v[48:63], v[8:9], v[8:9], 0
    s_nop 9
    buffer_load_dwordx4 v[0:3], v71, s[4:7], s25 offen offset:0 sc1
    buffer_load_dwordx4 v[4:7], v71, s[4:7], s25 offen offset:1024 sc1
    s_nop 15
    s_nop 15
    s_nop 5
    buffer_load_dwordx4 v[0:3], v71, s[4:7], s25 offen offset:0 sc1
    buffer_load_dwordx4 v[4:7], v71, s[4:7], s25 offen offset:1024 sc1
    s_waitcnt lgkmcnt(0)
    s_branch L_STEP
L_CRDY_R:
    buffer_load_dword v6, off, s[12:15], 0 offset:36 sc1
    buffer_load_dword v7, off, s[4:7], s81 sc1
    s_waitcnt vmcnt(0)
    s_sub_u32 s24, s24, 1
    s_cbranch_scc1 L_ABORT
    s_branch L_CRDY
L_H1Z:
    s_branch L_H1OK
L_H2R:
    s_mov_b64 exec, vcc
    buffer_load_dwordx4 v[0:3], v71, s[4:7], s25 offen offset:0 sc1
    buffer_load_dwordx4 v[4:7], v71, s[4:7], s25 offen offset:1024 sc1
    s_mov_b64 exec, -1
    s_sub_u32 s24, s24, 1
    s_cbranch_scc1 L_ABORT
    s_branch L_STEP
L_H1R:
    s_mov_b64 exec, vcc
    buffer_load_dwordx4 v[24:27], v56, s[4:7], s27 offen offset:0 sc1
    buffer_load_dwordx4 v[28:31], v57, s[4:7], s27 offen offset:0 sc1
    s_mov_b64 exec, -1
    s_sub_u32 s24, s24, 1
    s_cbranch_scc1 L_ABORT
    s_branch L_H1W
L_NOPF:
    s_waitcnt vmcnt(0) lgkmcnt(0)
    s_branch L_PFD
L_KVW:
    s_lshl_b32 s31, s32, 4
    s_add_u32 s31, s31, s81
    buffer_load_dword v79, off, s[4:7], s31 sc1
    s_waitcnt vmcnt(0)
    v_readfirstlane_b32 s82, v79
    s_nop 0
    s_cmp_ge_u32 s82, s33
    s_cbranch_scc1 L_KVOK
    s_sub_u32 s24, s24, 1
    s_cbranch_scc1 L_ABORT
    s_branch L_KVW
L_CFIN:
    s_lshl_b32 s30, s21, 13
    s_lshl_b32 s31, s20, 11
    s_add_u32 s30, s30, s31
    s_add_u32 s30, s30, 0x41c0000
    buffer_store_dwordx4 v[40:43], v71, s[4:7], s30 offen sc1
    buffer_store_dwordx4 v[48:51], v71, s[4:7], s30 offen offset:1024 sc1
    s_mov_b64 exec, 1
    s_waitcnt vmcnt(0)
    s_endpgm
L_NOTC:
    s_cmp_eq_u32 s23, 1
    s_cbranch_scc1 L_ROLEB
    s_sub_u32 s30, s23, 2
    s_lshl_b32 s30, s30, 5
    s_add_u32 s25, s30, s21
    s_mul_i32 s26, s25, 52429
    s_lshr_b32 s26, s26, 18
    s_mul_i32 s30, s26, 5
    s_sub_u32 s27, s25, s30
    s_cmp_eq_u32 s23, 7
    s_cselect_b32 s26, s21, s26
    s_cselect_b32 s27, 5, s27
    s_cmp_lt_u32 s27, 4
    s_cselect_b32 s28, 11, 10
    s_lshl_b32 s33, s20, 12
    s_lshl_b32 s68, s26, 8
    s_mov_b32 s16, s36
    s_mov_b32 s17, s37
    s_mov_b32 s18, 0x200000
    s_mov_b32 s19, 0x00020000
    v_lshlrev_b32 v112, 4, v0
    v_lshrrev_b32 v1, 4, v0
    v_and_b32 v2, 15, v0
    v_lshlrev_b32 v3, 4, v2
    v_lshl_add_u32 v3, v1, 10, v3
    s_lshl_b32 s30, s27, 15
    s_lshl_b32 s31, s20, 13
    s_add_u32 s30, s30, s31
    buffer_load_dwordx4 v[16:19], v3, s[16:19], s30 offen offset:0
    buffer_load_dwordx4 v[20:23], v3, s[16:19], s30 offen offset:256
    buffer_load_dwordx4 v[24:27], v3, s[16:19], s30 offen offset:512
    buffer_load_dwordx4 v[28:31], v3, s[16:19], s30 offen offset:768
    s_add_u32 s30, s30, 4096
    buffer_load_dwordx4 v[32:35], v3, s[16:19], s30 offen offset:0
    buffer_load_dwordx4 v[36:39], v3, s[16:19], s30 offen offset:256
    buffer_load_dwordx4 v[40:43], v3, s[16:19], s30 offen offset:512
    buffer_load_dwordx4 v[44:47], v3, s[16:19], s30 offen offset:768
    s_add_u32 s30, s25, 12
    s_min_u32 s30, s30, 127
    s_lshl_b32 s67, s30, 14
    s_add_u32 s30, s67, s33
    buffer_load_dwordx4 v[48:51], v3, s[16:19], s30 offen offset:0
    buffer_load_dwordx4 v[52:55], v3, s[16:19], s30 offen offset:256
    buffer_load_dwordx4 v[56:59], v3, s[16:19], s30 offen offset:512
    buffer_load_dwordx4 v[60:63], v3, s[16:19], s30 offen offset:768
    v_lshrrev_b32 v4, 2, v2
    v_lshlrev_b32 v4, 10, v4
    v_and_b32 v5, 3, v0
    v_lshl_add_u32 v4, v5, 8, v4
    v_lshl_add_u32 v120, v1, 4, v4
    s_lshl_b32 s30, s20, 4
    v_add_u32 v4, s30, v1
    v_lshlrev_b32 v4, 13, v4
    v_lshlrev_b32 v6, 5, v1
    v_lshlrev_b32 v7, 4, v2
    v_xor_b32 v6, v6, v7
    v_add_u32 v113, v4, v6
    v_xor_b32 v114, 128, v113
    v_bfe_u32 v6, v0, 2, 2
    v_lshl_add_u32 v4, v1, 3, v6
    v_and_b32 v7, 1, v1
    v_lshl_or_b32 v7, v7, 2, v6
    s_lshl_b32 s30, s20, 1
    v_xor_b32 v7, s30, v7
    v_lshlrev_b32 v7, 5, v7
    v_lshl_add_u32 v4, v4, 8, v7
    v_lshl_add_u32 v115, v5, 3, v4
    v_xor_b32 v116, 32, v115
    s_mov_b32 s8, s42
    s_mov_b32 s9, s43
    s_add_u32 m0, s33, 0x0
    s_add_u32 s31, s68, 0x0
    buffer_load_dwordx4 v113, s[8:11], s31 offen lds
    s_add_u32 m0, s33, 0x400
    s_add_u32 s31, s68, 0x8000
    buffer_load_dwordx4 v113, s[8:11], s31 offen lds
    s_add_u32 m0, s33, 0x800
    s_add_u32 s31, s68, 0x10000
    buffer_load_dwordx4 v114, s[8:11], s31 offen lds
    s_add_u32 m0, s33, 0xc00
    s_add_u32 s31, s68, 0x18000
    buffer_load_dwordx4 v114, s[8:11], s31 offen lds
    s_add_u32 m0, s33, 0x4000
    s_add_u32 s31, s68, 0x80000
    buffer_load_dwordx4 v113, s[8:11], s31 offen lds
    s_add_u32 m0, s33, 0x4400
    s_add_u32 s31, s68, 0x88000
    buffer_load_dwordx4 v113, s[8:11], s31 offen lds
    s_add_u32 m0, s33, 0x4800
    s_add_u32 s31, s68, 0x90000
    buffer_load_dwordx4 v114, s[8:11], s31 offen lds
    s_add_u32 m0, s33, 0x4c00
    s_add_u32 s31, s68, 0x98000
    buffer_load_dwordx4 v114, s[8:11], s31 offen lds
    s_add_u32 m0, s33, 0x8000
    s_add_u32 s31, s68, 0x100000
    buffer_load_dwordx4 v113, s[8:11], s31 offen lds
    s_add_u32 m0, s33, 0x8400
    s_add_u32 s31, s68, 0x108000
    buffer_load_dwordx4 v113, s[8:11], s31 offen lds
    s_add_u32 m0, s33, 0x8800
    s_add_u32 s31, s68, 0x110000
    buffer_load_dwordx4 v114, s[8:11], s31 offen lds
    s_add_u32 m0, s33, 0x8c00
    s_add_u32 s31, s68, 0x118000
    buffer_load_dwordx4 v114, s[8:11], s31 offen lds
    s_add_u32 m0, s33, 0xc000
    s_add_u32 s31, s68, 0x180000
    buffer_load_dwordx4 v113, s[8:11], s31 offen lds
    s_add_u32 m0, s33, 0xc400
    s_add_u32 s31, s68, 0x188000
    buffer_load_dwordx4 v113, s[8:11], s31 offen lds
    s_add_u32 m0, s33, 0xc800
    s_add_u32 s31, s68, 0x190000
    buffer_load_dwordx4 v114, s[8:11], s31 offen lds
    s_add_u32 m0, s33, 0xcc00
    s_add_u32 s31, s68, 0x198000
    buffer_load_dwordx4 v114, s[8:11], s31 offen lds
    s_add_u32 m0, s33, 0x10000
    s_add_u32 s31, s68, 0x200000
    buffer_load_dwordx4 v113, s[8:11], s31 offen lds
    s_add_u32 m0, s33, 0x10400
    s_add_u32 s31, s68, 0x208000
    buffer_load_dwordx4 v113, s[8:11], s31 offen lds
    s_add_u32 m0, s33, 0x10800
    s_add_u32 s31, s68, 0x210000
    buffer_load_dwordx4 v114, s[8:11], s31 offen lds
    s_add_u32 m0, s33, 0x10c00
    s_add_u32 s31, s68, 0x218000
    buffer_load_dwordx4 v114, s[8:11], s31 offen lds
    s_add_u32 m0, s33, 0x14000
    s_add_u32 s31, s68, 0x280000
    buffer_load_dwordx4 v113, s[8:11], s31 offen lds
    s_add_u32 m0, s33, 0x14400
    s_add_u32 s31, s68, 0x288000
    buffer_load_dwordx4 v113, s[8:11], s31 offen lds
    s_add_u32 m0, s33, 0x14800
    s_add_u32 s31, s68, 0x290000
    buffer_load_dwordx4 v114, s[8:11], s31 offen lds
    s_add_u32 m0, s33, 0x14c00
    s_add_u32 s31, s68, 0x298000
    buffer_load_dwordx4 v114, s[8:11], s31 offen lds
    s_add_u32 m0, s33, 0x18000
    s_add_u32 s31, s68, 0x300000
    buffer_load_dwordx4 v113, s[8:11], s31 offen lds
    s_add_u32 m0, s33, 0x18400
    s_add_u32 s31, s68, 0x308000
    buffer_load_dwordx4 v113, s[8:11], s31 offen lds
    s_add_u32 m0, s33, 0x18800
    s_add_u32 s31, s68, 0x310000
    buffer_load_dwordx4 v114, s[8:11], s31 offen lds
    s_add_u32 m0, s33, 0x18c00
    s_add_u32 s31, s68, 0x318000
    buffer_load_dwordx4 v114, s[8:11], s31 offen lds
    s_waitcnt vmcnt(28)
    s_lshr_b32 s30, s20, 1
    s_lshl_b32 s30, s30, 14
    s_and_b32 s31, s20, 1
    s_lshl_b32 s31, s31, 7
    s_add_u32 s30, s30, s31
    s_add_u32 s30, s30, 0x20000
    v_add_u32 v117, s30, v120
    v_lshlrev_b32 v64, 16, v16
    v_and_b32 v65, 0xffff0000, v16
    v_lshlrev_b32 v66, 16, v17
    v_and_b32 v67, 0xffff0000, v17
    v_lshlrev_b32 v68, 16, v18
    v_and_b32 v69, 0xffff0000, v18
    v_lshlrev_b32 v70, 16, v19
    v_and_b32 v71, 0xffff0000, v19
    v_lshlrev_b32 v72, 16, v20
    v_and_b32 v73, 0xffff0000, v20
    v_lshlrev_b32 v74, 16, v21
    v_and_b32 v75, 0xffff0000, v21
    v_lshlrev_b32 v76, 16, v22
    v_and_b32 v77, 0xffff0000, v22
    v_lshlrev_b32 v78, 16, v23
    v_and_b32 v79, 0xffff0000, v23
    v_lshlrev_b32 v80, 16, v24
    v_and_b32 v81, 0xffff0000, v24
    v_lshlrev_b32 v82, 16, v25
    v_and_b32 v83, 0xffff0000, v25
    v_lshlrev_b32 v84, 16, v26
    v_and_b32 v85, 0xffff0000, v26
    v_lshlrev_b32 v86, 16, v27
    v_and_b32 v87, 0xffff0000, v27
    v_lshlrev_b32 v88, 16, v28
    v_and_b32 v89, 0xffff0000, v28
    v_lshlrev_b32 v90, 16, v29
    v_and_b32 v91, 0xffff0000, v29
    v_lshlrev_b32 v92, 16, v30
    v_and_b32 v93, 0xffff0000, v30
    v_lshlrev_b32 v94, 16, v31
    v_and_b32 v95, 0xffff0000, v31
    v_pk_add_f32 v[96:97], v[64:65], v[66:67]
    v_pk_add_f32 v[98:99], v[68:69], v[70:71]
    v_pk_add_f32 v[96:97], v[96:97], v[72:73]
    v_pk_add_f32 v[98:99], v[98:99], v[74:75]
    v_pk_add_f32 v[96:97], v[96:97], v[76:77]
    v_pk_add_f32 v[98:99], v[98:99], v[78:79]
    v_pk_add_f32 v[96:97], v[96:97], v[80:81]
    v_pk_add_f32 v[98:99], v[98:99], v[82:83]
    v_pk_add_f32 v[96:97], v[96:97], v[84:85]
    v_pk_add_f32 v[98:99], v[98:99], v[86:87]
    v_pk_add_f32 v[96:97], v[96:97], v[88:89]
    v_pk_add_f32 v[98:99], v[98:99], v[90:91]
    v_pk_add_f32 v[96:97], v[96:97], v[92:93]
    v_pk_add_f32 v[98:99], v[98:99], v[94:95]
    v_pk_add_f32 v[96:97], v[96:97], v[98:99]
    v_add_f32 v96, v96, v97
    s_nop 1
    v_add_f32_dpp v96, v96, v96 row_ror:8 row_mask:0xf bank_mask:0xf
    s_nop 1
    v_add_f32_dpp v96, v96, v96 row_ror:4 row_mask:0xf bank_mask:0xf
    s_nop 1
    v_add_f32_dpp v96, v96, v96 row_ror:2 row_mask:0xf bank_mask:0xf
    s_nop 1
    v_add_f32_dpp v96, v96, v96 row_ror:1 row_mask:0xf bank_mask:0xf
    v_mul_f32 v96, 0x3b000000, v96
    v_pk_add_f32 v[98:99], v[64:65], v[96:97] op_sel_hi:[1,0] neg_lo:[0,1] neg_hi:[0,1]
    v_pk_mul_f32 v[100:101], v[98:99], v[98:99]
    v_pk_add_f32 v[98:99], v[66:67], v[96:97] op_sel_hi:[1,0] neg_lo:[0,1] neg_hi:[0,1]
    v_pk_mul_f32 v[102:103], v[98:99], v[98:99]
    v_pk_add_f32 v[98:99], v[68:69], v[96:97] op_sel_hi:[1,0] neg_lo:[0,1] neg_hi:[0,1]
    v_pk_fma_f32 v[100:101], v[98:99], v[98:99], v[100:101]
    v_pk_add_f32 v[98:99], v[70:71], v[96:97] op_sel_hi:[1,0] neg_lo:[0,1] neg_hi:[0,1]
    v_pk_fma_f32 v[102:103], v[98:99], v[98:99], v[102:103]
    v_pk_add_f32 v[98:99], v[72:73], v[96:97] op_sel_hi:[1,0] neg_lo:[0,1] neg_hi:[0,1]
    v_pk_fma_f32 v[100:101], v[98:99], v[98:99], v[100:101]
    v_pk_add_f32 v[98:99], v[74:75], v[96:97] op_sel_hi:[1,0] neg_lo:[0,1] neg_hi:[0,1]
    v_pk_fma_f32 v[102:103], v[98:99], v[98:99], v[102:103]
    v_pk_add_f32 v[98:99], v[76:77], v[96:97] op_sel_hi:[1,0] neg_lo:[0,1] neg_hi:[0,1]
    v_pk_fma_f32 v[100:101], v[98:99], v[98:99], v[100:101]
    v_pk_add_f32 v[98:99], v[78:79], v[96:97] op_sel_hi:[1,0] neg_lo:[0,1] neg_hi:[0,1]
    v_pk_fma_f32 v[102:103], v[98:99], v[98:99], v[102:103]
    v_pk_add_f32 v[98:99], v[80:81], v[96:97] op_sel_hi:[1,0] neg_lo:[0,1] neg_hi:[0,1]
    v_pk_fma_f32 v[100:101], v[98:99], v[98:99], v[100:101]
    v_pk_add_f32 v[98:99], v[82:83], v[96:97] op_sel_hi:[1,0] neg_lo:[0,1] neg_hi:[0,1]
    v_pk_fma_f32 v[102:103], v[98:99], v[98:99], v[102:103]
    v_pk_add_f32 v[98:99], v[84:85], v[96:97] op_sel_hi:[1,0] neg_lo:[0,1] neg_hi:[0,1]
    v_pk_fma_f32 v[100:101], v[98:99], v[98:99], v[100:101]
    v_pk_add_f32 v[98:99], v[86:87], v[96:97] op_sel_hi:[1,0] neg_lo:[0,1] neg_hi:[0,1]
    v_pk_fma_f32 v[102:103], v[98:99], v[98:99], v[102:103]
    v_pk_add_f32 v[98:99], v[88:89], v[96:97] op_sel_hi:[1,0] neg_lo:[0,1] neg_hi:[0,1]
    v_pk_fma_f32 v[100:101], v[98:99], v[98:99], v[100:101]
    v_pk_add_f32 v[98:99], v[90:91], v[96:97] op_sel_hi:[1,0] neg_lo:[0,1] neg_hi:[0,1]
    v_pk_fma_f32 v[102:103], v[98:99], v[98:99], v[102:103]
    v_pk_add_f32 v[98:99], v[92:93], v[96:97] op_sel_hi:[1,0] neg_lo:[0,1] neg_hi:[0,1]
    v_pk_fma_f32 v[100:101], v[98:99], v[98:99], v[100:101]
    v_pk_add_f32 v[98:99], v[94:95], v[96:97] op_sel_hi:[1,0] neg_lo:[0,1] neg_hi:[0,1]
    v_pk_fma_f32 v[102:103], v[98:99], v[98:99], v[102:103]
    v_pk_add_f32 v[100:101], v[100:101], v[102:103]
    v_add_f32 v100, v100, v101
    s_nop 1
    v_add_f32_dpp v100, v100, v100 row_ror:8 row_mask:0xf bank_mask:0xf
    s_nop 1
    v_add_f32_dpp v100, v100, v100 row_ror:4 row_mask:0xf bank_mask:0xf
    s_nop 1
    v_add_f32_dpp v100, v100, v100 row_ror:2 row_mask:0xf bank_mask:0xf
    s_nop 1
    v_add_f32_dpp v100, v100, v100 row_ror:1 row_mask:0xf bank_mask:0xf
    v_mul_f32 v100, 0x3b000000, v100
    v_cvt_pk_bf16_f32 v96, v96, v96
    v_lshlrev_b32 v96, 16, v96
    v_cvt_pk_bf16_f32 v100, v100, v100
    v_lshlrev_b32 v100, 16, v100
    v_add_f32 v100, 0x3727c5ac, v100
    v_cvt_pk_bf16_f32 v100, v100, v100
    v_lshlrev_b32 v100, 16, v100
    v_sqrt_f32 v100, v100
    s_nop 0
    v_cvt_pk_bf16_f32 v100, v100, v100
    v_lshlrev_b32 v100, 16, v100
    v_rcp_f32 v100, v100
    v_pk_add_f32 v[98:99], v[64:65], v[96:97] op_sel_hi:[1,0] neg_lo:[0,1] neg_hi:[0,1]
    v_cvt_pk_bf16_f32 v99, v98, v99
    v_lshlrev_b32 v98, 16, v99
    v_and_b32 v99, 0xffff0000, v99
    v_pk_mul_f32 v[98:99], v[98:99], v[100:101] op_sel_hi:[1,0]
    v_cvt_pk_bf16_f32 v16, v98, v99
    v_pk_add_f32 v[102:103], v[66:67], v[96:97] op_sel_hi:[1,0] neg_lo:[0,1] neg_hi:[0,1]
    v_cvt_pk_bf16_f32 v103, v102, v103
    v_lshlrev_b32 v102, 16, v103
    v_and_b32 v103, 0xffff0000, v103
    v_pk_mul_f32 v[102:103], v[102:103], v[100:101] op_sel_hi:[1,0]
    v_cvt_pk_bf16_f32 v17, v102, v103
    v_pk_add_f32 v[98:99], v[68:69], v[96:97] op_sel_hi:[1,0] neg_lo:[0,1] neg_hi:[0,1]
    v_cvt_pk_bf16_f32 v99, v98, v99
    v_lshlrev_b32 v98, 16, v99
    v_and_b32 v99, 0xffff0000, v99
    v_pk_mul_f32 v[98:99], v[98:99], v[100:101] op_sel_hi:[1,0]
    v_cvt_pk_bf16_f32 v18, v98, v99
    v_pk_add_f32 v[102:103], v[70:71], v[96:97] op_sel_hi:[1,0] neg_lo:[0,1] neg_hi:[0,1]
    v_cvt_pk_bf16_f32 v103, v102, v103
    v_lshlrev_b32 v102, 16, v103
    v_and_b32 v103, 0xffff0000, v103
    v_pk_mul_f32 v[102:103], v[102:103], v[100:101] op_sel_hi:[1,0]
    v_cvt_pk_bf16_f32 v19, v102, v103
    v_pk_add_f32 v[98:99], v[72:73], v[96:97] op_sel_hi:[1,0] neg_lo:[0,1] neg_hi:[0,1]
    v_cvt_pk_bf16_f32 v99, v98, v99
    v_lshlrev_b32 v98, 16, v99
    v_and_b32 v99, 0xffff0000, v99
    v_pk_mul_f32 v[98:99], v[98:99], v[100:101] op_sel_hi:[1,0]
    v_cvt_pk_bf16_f32 v20, v98, v99
    v_pk_add_f32 v[102:103], v[74:75], v[96:97] op_sel_hi:[1,0] neg_lo:[0,1] neg_hi:[0,1]
    v_cvt_pk_bf16_f32 v103, v102, v103
    v_lshlrev_b32 v102, 16, v103
    v_and_b32 v103, 0xffff0000, v103
    v_pk_mul_f32 v[102:103], v[102:103], v[100:101] op_sel_hi:[1,0]
    v_cvt_pk_bf16_f32 v21, v102, v103
    v_pk_add_f32 v[98:99], v[76:77], v[96:97] op_sel_hi:[1,0] neg_lo:[0,1] neg_hi:[0,1]
    v_cvt_pk_bf16_f32 v99, v98, v99
    v_lshlrev_b32 v98, 16, v99
    v_and_b32 v99, 0xffff0000, v99
    v_pk_mul_f32 v[98:99], v[98:99], v[100:101] op_sel_hi:[1,0]
    v_cvt_pk_bf16_f32 v22, v98, v99
    v_pk_add_f32 v[102:103], v[78:79], v[96:97] op_sel_hi:[1,0] neg_lo:[0,1] neg_hi:[0,1]
    v_cvt_pk_bf16_f32 v103, v102, v103
    v_lshlrev_b32 v102, 16, v103
    v_and_b32 v103, 0xffff0000, v103
    v_pk_mul_f32 v[102:103], v[102:103], v[100:101] op_sel_hi:[1,0]
    v_cvt_pk_bf16_f32 v23, v102, v103
    v_pk_add_f32 v[98:99], v[80:81], v[96:97] op_sel_hi:[1,0] neg_lo:[0,1] neg_hi:[0,1]
    v_cvt_pk_bf16_f32 v99, v98, v99
    v_lshlrev_b32 v98, 16, v99
    v_and_b32 v99, 0xffff0000, v99
    v_pk_mul_f32 v[98:99], v[98:99], v[100:101] op_sel_hi:[1,0]
    v_cvt_pk_bf16_f32 v24, v98, v99
    v_pk_add_f32 v[102:103], v[82:83], v[96:97] op_sel_hi:[1,0] neg_lo:[0,1] neg_hi:[0,1]
    v_cvt_pk_bf16_f32 v103, v102, v103
    v_lshlrev_b32 v102, 16, v103
    v_and_b32 v103, 0xffff0000, v103
    v_pk_mul_f32 v[102:103], v[102:103], v[100:101] op_sel_hi:[1,0]
    v_cvt_pk_bf16_f32 v25, v102, v103
    v_pk_add_f32 v[98:99], v[84:85], v[96:97] op_sel_hi:[1,0] neg_lo:[0,1] neg_hi:[0,1]
    v_cvt_pk_bf16_f32 v99, v98, v99
    v_lshlrev_b32 v98, 16, v99
    v_and_b32 v99, 0xffff0000, v99
    v_pk_mul_f32 v[98:99], v[98:99], v[100:101] op_sel_hi:[1,0]
    v_cvt_pk_bf16_f32 v26, v98, v99
    v_pk_add_f32 v[102:103], v[86:87], v[96:97] op_sel_hi:[1,0] neg_lo:[0,1] neg_hi:[0,1]
    v_cvt_pk_bf16_f32 v103, v102, v103
    v_lshlrev_b32 v102, 16, v103
    v_and_b32 v103, 0xffff0000, v103
    v_pk_mul_f32 v[102:103], v[102:103], v[100:101] op_sel_hi:[1,0]
    v_cvt_pk_bf16_f32 v27, v102, v103
    v_pk_add_f32 v[98:99], v[88:89], v[96:97] op_sel_hi:[1,0] neg_lo:[0,1] neg_hi:[0,1]
    v_cvt_pk_bf16_f32 v99, v98, v99
    v_lshlrev_b32 v98, 16, v99
    v_and_b32 v99, 0xffff0000, v99
    v_pk_mul_f32 v[98:99], v[98:99], v[100:101] op_sel_hi:[1,0]
    v_cvt_pk_bf16_f32 v28, v98, v99
    v_pk_add_f32 v[102:103], v[90:91], v[96:97] op_sel_hi:[1,0] neg_lo:[0,1] neg_hi:[0,1]
    v_cvt_pk_bf16_f32 v103, v102, v103
    v_lshlrev_b32 v102, 16, v103
    v_and_b32 v103, 0xffff0000, v103
    v_pk_mul_f32 v[102:103], v[102:103], v[100:101] op_sel_hi:[1,0]
    v_cvt_pk_bf16_f32 v29, v102, v103
    v_pk_add_f32 v[98:99], v[92:93], v[96:97] op_sel_hi:[1,0] neg_lo:[0,1] neg_hi:[0,1]
    v_cvt_pk_bf16_f32 v99, v98, v99
    v_lshlrev_b32 v98, 16, v99
    v_and_b32 v99, 0xffff0000, v99
    v_pk_mul_f32 v[98:99], v[98:99], v[100:101] op_sel_hi:[1,0]
    v_cvt_pk_bf16_f32 v30, v98, v99
    v_pk_add_f32 v[102:103], v[94:95], v[96:97] op_sel_hi:[1,0] neg_lo:[0,1] neg_hi:[0,1]
    v_cvt_pk_bf16_f32 v103, v102, v103
    v_lshlrev_b32 v102, 16, v103
    v_and_b32 v103, 0xffff0000, v103
    v_pk_mul_f32 v[102:103], v[102:103], v[100:101] op_sel_hi:[1,0]
    v_cvt_pk_bf16_f32 v31, v102, v103
    ds_write_b128 v117, v[16:19] offset:0
    ds_write_b128 v117, v[20:23] offset:4096
    ds_write_b128 v117, v[24:27] offset:8192
    ds_write_b128 v117, v[28:31] offset:12288
    v_lshlrev_b32 v64, 16, v32
    v_and_b32 v65, 0xffff0000, v32
    v_lshlrev_b32 v66, 16, v33
    v_and_b32 v67, 0xffff0000, v33
    v_lshlrev_b32 v68, 16, v34
    v_and_b32 v69, 0xffff0000, v34
    v_lshlrev_b32 v70, 16, v35
    v_and_b32 v71, 0xffff0000, v35
    v_lshlrev_b32 v72, 16, v36
    v_and_b32 v73, 0xffff0000, v36
    v_lshlrev_b32 v74, 16, v37
    v_and_b32 v75, 0xffff0000, v37
    v_lshlrev_b32 v76, 16, v38
    v_and_b32 v77, 0xffff0000, v38
    v_lshlrev_b32 v78, 16, v39
    v_and_b32 v79, 0xffff0000, v39
    v_lshlrev_b32 v80, 16, v40
    v_and_b32 v81, 0xffff0000, v40
    v_lshlrev_b32 v82, 16, v41
    v_and_b32 v83, 0xffff0000, v41
    v_lshlrev_b32 v84, 16, v42
    v_and_b32 v85, 0xffff0000, v42
    v_lshlrev_b32 v86, 16, v43
    v_and_b32 v87, 0xffff0000, v43
    v_lshlrev_b32 v88, 16, v44
    v_and_b32 v89, 0xffff0000, v44
    v_lshlrev_b32 v90, 16, v45
    v_and_b32 v91, 0xffff0000, v45
    v_lshlrev_b32 v92, 16, v46
    v_and_b32 v93, 0xffff0000, v46
    v_lshlrev_b32 v94, 16, v47
    v_and_b32 v95, 0xffff0000, v47
    v_pk_add_f32 v[96:97], v[64:65], v[66:67]
    v_pk_add_f32 v[98:99], v[68:69], v[70:71]
    v_pk_add_f32 v[96:97], v[96:97], v[72:73]
    v_pk_add_f32 v[98:99], v[98:99], v[74:75]
    v_pk_add_f32 v[96:97], v[96:97], v[76:77]
    v_pk_add_f32 v[98:99], v[98:99], v[78:79]
    v_pk_add_f32 v[96:97], v[96:97], v[80:81]
    v_pk_add_f32 v[98:99], v[98:99], v[82:83]
    v_pk_add_f32 v[96:97], v[96:97], v[84:85]
    v_pk_add_f32 v[98:99], v[98:99], v[86:87]
    v_pk_add_f32 v[96:97], v[96:97], v[88:89]
    v_pk_add_f32 v[98:99], v[98:99], v[90:91]
    v_pk_add_f32 v[96:97], v[96:97], v[92:93]
    v_pk_add_f32 v[98:99], v[98:99], v[94:95]
    v_pk_add_f32 v[96:97], v[96:97], v[98:99]
    v_add_f32 v96, v96, v97
    s_nop 1
    v_add_f32_dpp v96, v96, v96 row_ror:8 row_mask:0xf bank_mask:0xf
    s_nop 1
    v_add_f32_dpp v96, v96, v96 row_ror:4 row_mask:0xf bank_mask:0xf
    s_nop 1
    v_add_f32_dpp v96, v96, v96 row_ror:2 row_mask:0xf bank_mask:0xf
    s_nop 1
    v_add_f32_dpp v96, v96, v96 row_ror:1 row_mask:0xf bank_mask:0xf
    v_mul_f32 v96, 0x3b000000, v96
    v_pk_add_f32 v[98:99], v[64:65], v[96:97] op_sel_hi:[1,0] neg_lo:[0,1] neg_hi:[0,1]
    v_pk_mul_f32 v[100:101], v[98:99], v[98:99]
    v_pk_add_f32 v[98:99], v[66:67], v[96:97] op_sel_hi:[1,0] neg_lo:[0,1] neg_hi:[0,1]
    v_pk_mul_f32 v[102:103], v[98:99], v[98:99]
    v_pk_add_f32 v[98:99], v[68:69], v[96:97] op_sel_hi:[1,0] neg_lo:[0,1] neg_hi:[0,1]
    v_pk_fma_f32 v[100:101], v[98:99], v[98:99], v[100:101]
    v_pk_add_f32 v[98:99], v[70:71], v[96:97] op_sel_hi:[1,0] neg_lo:[0,1] neg_hi:[0,1]
    v_pk_fma_f32 v[102:103], v[98:99], v[98:99], v[102:103]
    v_pk_add_f32 v[98:99], v[72:73], v[96:97] op_sel_hi:[1,0] neg_lo:[0,1] neg_hi:[0,1]
    v_pk_fma_f32 v[100:101], v[98:99], v[98:99], v[100:101]
    v_pk_add_f32 v[98:99], v[74:75], v[96:97] op_sel_hi:[1,0] neg_lo:[0,1] neg_hi:[0,1]
    v_pk_fma_f32 v[102:103], v[98:99], v[98:99], v[102:103]
    v_pk_add_f32 v[98:99], v[76:77], v[96:97] op_sel_hi:[1,0] neg_lo:[0,1] neg_hi:[0,1]
    v_pk_fma_f32 v[100:101], v[98:99], v[98:99], v[100:101]
    v_pk_add_f32 v[98:99], v[78:79], v[96:97] op_sel_hi:[1,0] neg_lo:[0,1] neg_hi:[0,1]
    v_pk_fma_f32 v[102:103], v[98:99], v[98:99], v[102:103]
    v_pk_add_f32 v[98:99], v[80:81], v[96:97] op_sel_hi:[1,0] neg_lo:[0,1] neg_hi:[0,1]
    v_pk_fma_f32 v[100:101], v[98:99], v[98:99], v[100:101]
    v_pk_add_f32 v[98:99], v[82:83], v[96:97] op_sel_hi:[1,0] neg_lo:[0,1] neg_hi:[0,1]
    v_pk_fma_f32 v[102:103], v[98:99], v[98:99], v[102:103]
    v_pk_add_f32 v[98:99], v[84:85], v[96:97] op_sel_hi:[1,0] neg_lo:[0,1] neg_hi:[0,1]
    v_pk_fma_f32 v[100:101], v[98:99], v[98:99], v[100:101]
    v_pk_add_f32 v[98:99], v[86:87], v[96:97] op_sel_hi:[1,0] neg_lo:[0,1] neg_hi:[0,1]
    v_pk_fma_f32 v[102:103], v[98:99], v[98:99], v[102:103]
    v_pk_add_f32 v[98:99], v[88:89], v[96:97] op_sel_hi:[1,0] neg_lo:[0,1] neg_hi:[0,1]
    v_pk_fma_f32 v[100:101], v[98:99], v[98:99], v[100:101]
    v_pk_add_f32 v[98:99], v[90:91], v[96:97] op_sel_hi:[1,0] neg_lo:[0,1] neg_hi:[0,1]
    v_pk_fma_f32 v[102:103], v[98:99], v[98:99], v[102:103]
    v_pk_add_f32 v[98:99], v[92:93], v[96:97] op_sel_hi:[1,0] neg_lo:[0,1] neg_hi:[0,1]
    v_pk_fma_f32 v[100:101], v[98:99], v[98:99], v[100:101]
    v_pk_add_f32 v[98:99], v[94:95], v[96:97] op_sel_hi:[1,0] neg_lo:[0,1] neg_hi:[0,1]
    v_pk_fma_f32 v[102:103], v[98:99], v[98:99], v[102:103]
    v_pk_add_f32 v[100:101], v[100:101], v[102:103]
    v_add_f32 v100, v100, v101
    s_nop 1
    v_add_f32_dpp v100, v100, v100 row_ror:8 row_mask:0xf bank_mask:0xf
    s_nop 1
    v_add_f32_dpp v100, v100, v100 row_ror:4 row_mask:0xf bank_mask:0xf
    s_nop 1
    v_add_f32_dpp v100, v100, v100 row_ror:2 row_mask:0xf bank_mask:0xf
    s_nop 1
    v_add_f32_dpp v100, v100, v100 row_ror:1 row_mask:0xf bank_mask:0xf
    v_mul_f32 v100, 0x3b000000, v100
    v_cvt_pk_bf16_f32 v96, v96, v96
    v_lshlrev_b32 v96, 16, v96
    v_cvt_pk_bf16_f32 v100, v100, v100
    v_lshlrev_b32 v100, 16, v100
    v_add_f32 v100, 0x3727c5ac, v100
    v_cvt_pk_bf16_f32 v100, v100, v100
    v_lshlrev_b32 v100, 16, v100
    v_sqrt_f32 v100, v100
    s_nop 0
    v_cvt_pk_bf16_f32 v100, v100, v100
    v_lshlrev_b32 v100, 16, v100
    v_rcp_f32 v100, v100
    v_pk_add_f32 v[98:99], v[64:65], v[96:97] op_sel_hi:[1,0] neg_lo:[0,1] neg_hi:[0,1]
    v_cvt_pk_bf16_f32 v99, v98, v99
    v_lshlrev_b32 v98, 16, v99
    v_and_b32 v99, 0xffff0000, v99
    v_pk_mul_f32 v[98:99], v[98:99], v[100:101] op_sel_hi:[1,0]
    v_cvt_pk_bf16_f32 v32, v98, v99
    v_pk_add_f32 v[102:103], v[66:67], v[96:97] op_sel_hi:[1,0] neg_lo:[0,1] neg_hi:[0,1]
    v_cvt_pk_bf16_f32 v103, v102, v103
    v_lshlrev_b32 v102, 16, v103
    v_and_b32 v103, 0xffff0000, v103
    v_pk_mul_f32 v[102:103], v[102:103], v[100:101] op_sel_hi:[1,0]
    v_cvt_pk_bf16_f32 v33, v102, v103
    v_pk_add_f32 v[98:99], v[68:69], v[96:97] op_sel_hi:[1,0] neg_lo:[0,1] neg_hi:[0,1]
    v_cvt_pk_bf16_f32 v99, v98, v99
    v_lshlrev_b32 v98, 16, v99
    v_and_b32 v99, 0xffff0000, v99
    v_pk_mul_f32 v[98:99], v[98:99], v[100:101] op_sel_hi:[1,0]
    v_cvt_pk_bf16_f32 v34, v98, v99
    v_pk_add_f32 v[102:103], v[70:71], v[96:97] op_sel_hi:[1,0] neg_lo:[0,1] neg_hi:[0,1]
    v_cvt_pk_bf16_f32 v103, v102, v103
    v_lshlrev_b32 v102, 16, v103
    v_and_b32 v103, 0xffff0000, v103
    v_pk_mul_f32 v[102:103], v[102:103], v[100:101] op_sel_hi:[1,0]
    v_cvt_pk_bf16_f32 v35, v102, v103
    v_pk_add_f32 v[98:99], v[72:73], v[96:97] op_sel_hi:[1,0] neg_lo:[0,1] neg_hi:[0,1]
    v_cvt_pk_bf16_f32 v99, v98, v99
    v_lshlrev_b32 v98, 16, v99
    v_and_b32 v99, 0xffff0000, v99
    v_pk_mul_f32 v[98:99], v[98:99], v[100:101] op_sel_hi:[1,0]
    v_cvt_pk_bf16_f32 v36, v98, v99
    v_pk_add_f32 v[102:103], v[74:75], v[96:97] op_sel_hi:[1,0] neg_lo:[0,1] neg_hi:[0,1]
    v_cvt_pk_bf16_f32 v103, v102, v103
    v_lshlrev_b32 v102, 16, v103
    v_and_b32 v103, 0xffff0000, v103
    v_pk_mul_f32 v[102:103], v[102:103], v[100:101] op_sel_hi:[1,0]
    v_cvt_pk_bf16_f32 v37, v102, v103
    v_pk_add_f32 v[98:99], v[76:77], v[96:97] op_sel_hi:[1,0] neg_lo:[0,1] neg_hi:[0,1]
    v_cvt_pk_bf16_f32 v99, v98, v99
    v_lshlrev_b32 v98, 16, v99
    v_and_b32 v99, 0xffff0000, v99
    v_pk_mul_f32 v[98:99], v[98:99], v[100:101] op_sel_hi:[1,0]
    v_cvt_pk_bf16_f32 v38, v98, v99
    v_pk_add_f32 v[102:103], v[78:79], v[96:97] op_sel_hi:[1,0] neg_lo:[0,1] neg_hi:[0,1]
    v_cvt_pk_bf16_f32 v103, v102, v103
    v_lshlrev_b32 v102, 16, v103
    v_and_b32 v103, 0xffff0000, v103
    v_pk_mul_f32 v[102:103], v[102:103], v[100:101] op_sel_hi:[1,0]
    v_cvt_pk_bf16_f32 v39, v102, v103
    v_pk_add_f32 v[98:99], v[80:81], v[96:97] op_sel_hi:[1,0] neg_lo:[0,1] neg_hi:[0,1]
    v_cvt_pk_bf16_f32 v99, v98, v99
    v_lshlrev_b32 v98, 16, v99
    v_and_b32 v99, 0xffff0000, v99
    v_pk_mul_f32 v[98:99], v[98:99], v[100:101] op_sel_hi:[1,0]
    v_cvt_pk_bf16_f32 v40, v98, v99
    v_pk_add_f32 v[102:103], v[82:83], v[96:97] op_sel_hi:[1,0] neg_lo:[0,1] neg_hi:[0,1]
    v_cvt_pk_bf16_f32 v103, v102, v103
    v_lshlrev_b32 v102, 16, v103
    v_and_b32 v103, 0xffff0000, v103
    v_pk_mul_f32 v[102:103], v[102:103], v[100:101] op_sel_hi:[1,0]
    v_cvt_pk_bf16_f32 v41, v102, v103
    v_pk_add_f32 v[98:99], v[84:85], v[96:97] op_sel_hi:[1,0] neg_lo:[0,1] neg_hi:[0,1]
    v_cvt_pk_bf16_f32 v99, v98, v99
    v_lshlrev_b32 v98, 16, v99
    v_and_b32 v99, 0xffff0000, v99
    v_pk_mul_f32 v[98:99], v[98:99], v[100:101] op_sel_hi:[1,0]
    v_cvt_pk_bf16_f32 v42, v98, v99
    v_pk_add_f32 v[102:103], v[86:87], v[96:97] op_sel_hi:[1,0] neg_lo:[0,1] neg_hi:[0,1]
    v_cvt_pk_bf16_f32 v103, v102, v103
    v_lshlrev_b32 v102, 16, v103
    v_and_b32 v103, 0xffff0000, v103
    v_pk_mul_f32 v[102:103], v[102:103], v[100:101] op_sel_hi:[1,0]
    v_cvt_pk_bf16_f32 v43, v102, v103
    v_pk_add_f32 v[98:99], v[88:89], v[96:97] op_sel_hi:[1,0] neg_lo:[0,1] neg_hi:[0,1]
    v_cvt_pk_bf16_f32 v99, v98, v99
    v_lshlrev_b32 v98, 16, v99
    v_and_b32 v99, 0xffff0000, v99
    v_pk_mul_f32 v[98:99], v[98:99], v[100:101] op_sel_hi:[1,0]
    v_cvt_pk_bf16_f32 v44, v98, v99
    v_pk_add_f32 v[102:103], v[90:91], v[96:97] op_sel_hi:[1,0] neg_lo:[0,1] neg_hi:[0,1]
    v_cvt_pk_bf16_f32 v103, v102, v103
    v_lshlrev_b32 v102, 16, v103
    v_and_b32 v103, 0xffff0000, v103
    v_pk_mul_f32 v[102:103], v[102:103], v[100:101] op_sel_hi:[1,0]
    v_cvt_pk_bf16_f32 v45, v102, v103
    v_pk_add_f32 v[98:99], v[92:93], v[96:97] op_sel_hi:[1,0] neg_lo:[0,1] neg_hi:[0,1]
    v_cvt_pk_bf16_f32 v99, v98, v99
    v_lshlrev_b32 v98, 16, v99
    v_and_b32 v99, 0xffff0000, v99
    v_pk_mul_f32 v[98:99], v[98:99], v[100:101] op_sel_hi:[1,0]
    v_cvt_pk_bf16_f32 v46, v98, v99
    v_pk_add_f32 v[102:103], v[94:95], v[96:97] op_sel_hi:[1,0] neg_lo:[0,1] neg_hi:[0,1]
    v_cvt_pk_bf16_f32 v103, v102, v103
    v_lshlrev_b32 v102, 16, v103
    v_and_b32 v103, 0xffff0000, v103
    v_pk_mul_f32 v[102:103], v[102:103], v[100:101] op_sel_hi:[1,0]
    v_cvt_pk_bf16_f32 v47, v102, v103
    ds_write_b128 v117, v[32:35] offset:64
    ds_write_b128 v117, v[36:39] offset:4160
    ds_write_b128 v117, v[40:43] offset:8256
    ds_write_b128 v117, v[44:47] offset:12352
    s_cmp_ge_u32 s25, 116
    s_cbranch_scc1 L_GNOLN
    v_lshlrev_b32 v64, 16, v48
    v_and_b32 v65, 0xffff0000, v48
    v_lshlrev_b32 v66, 16, v49
    v_and_b32 v67, 0xffff0000, v49
    v_lshlrev_b32 v68, 16, v50
    v_and_b32 v69, 0xffff0000, v50
    v_lshlrev_b32 v70, 16, v51
    v_and_b32 v71, 0xffff0000, v51
    v_lshlrev_b32 v72, 16, v52
    v_and_b32 v73, 0xffff0000, v52
    v_lshlrev_b32 v74, 16, v53
    v_and_b32 v75, 0xffff0000, v53
    v_lshlrev_b32 v76, 16, v54
    v_and_b32 v77, 0xffff0000, v54
    v_lshlrev_b32 v78, 16, v55
    v_and_b32 v79, 0xffff0000, v55
    v_lshlrev_b32 v80, 16, v56
    v_and_b32 v81, 0xffff0000, v56
    v_lshlrev_b32 v82, 16, v57
    v_and_b32 v83, 0xffff0000, v57
    v_lshlrev_b32 v84, 16, v58
    v_and_b32 v85, 0xffff0000, v58
    v_lshlrev_b32 v86, 16, v59
    v_and_b32 v87, 0xffff0000, v59
    v_lshlrev_b32 v88, 16, v60
    v_and_b32 v89, 0xffff0000, v60
    v_lshlrev_b32 v90, 16, v61
    v_and_b32 v91, 0xffff0000, v61
    v_lshlrev_b32 v92, 16, v62
    v_and_b32 v93, 0xffff0000, v62
    v_lshlrev_b32 v94, 16, v63
    v_and_b32 v95, 0xffff0000, v63
    v_pk_add_f32 v[96:97], v[64:65], v[66:67]
    v_pk_add_f32 v[98:99], v[68:69], v[70:71]
    v_pk_add_f32 v[96:97], v[96:97], v[72:73]
    v_pk_add_f32 v[98:99], v[98:99], v[74:75]
    v_pk_add_f32 v[96:97], v[96:97], v[76:77]
    v_pk_add_f32 v[98:99], v[98:99], v[78:79]
    v_pk_add_f32 v[96:97], v[96:97], v[80:81]
    v_pk_add_f32 v[98:99], v[98:99], v[82:83]
    v_pk_add_f32 v[96:97], v[96:97], v[84:85]
    v_pk_add_f32 v[98:99], v[98:99], v[86:87]
    v_pk_add_f32 v[96:97], v[96:97], v[88:89]
    v_pk_add_f32 v[98:99], v[98:99], v[90:91]
    v_pk_add_f32 v[96:97], v[96:97], v[92:93]
    v_pk_add_f32 v[98:99], v[98:99], v[94:95]
    v_pk_add_f32 v[96:97], v[96:97], v[98:99]
    v_add_f32 v96, v96, v97
    s_nop 1
    v_add_f32_dpp v96, v96, v96 row_ror:8 row_mask:0xf bank_mask:0xf
    s_nop 1
    v_add_f32_dpp v96, v96, v96 row_ror:4 row_mask:0xf bank_mask:0xf
    s_nop 1
    v_add_f32_dpp v96, v96, v96 row_ror:2 row_mask:0xf bank_mask:0xf
    s_nop 1
    v_add_f32_dpp v96, v96, v96 row_ror:1 row_mask:0xf bank_mask:0xf
    v_mul_f32 v96, 0x3b000000, v96
    v_pk_add_f32 v[98:99], v[64:65], v[96:97] op_sel_hi:[1,0] neg_lo:[0,1] neg_hi:[0,1]
    v_pk_mul_f32 v[100:101], v[98:99], v[98:99]
    v_pk_add_f32 v[98:99], v[66:67], v[96:97] op_sel_hi:[1,0] neg_lo:[0,1] neg_hi:[0,1]
    v_pk_mul_f32 v[102:103], v[98:99], v[98:99]
    v_pk_add_f32 v[98:99], v[68:69], v[96:97] op_sel_hi:[1,0] neg_lo:[0,1] neg_hi:[0,1]
    v_pk_fma_f32 v[100:101], v[98:99], v[98:99], v[100:101]
    v_pk_add_f32 v[98:99], v[70:71], v[96:97] op_sel_hi:[1,0] neg_lo:[0,1] neg_hi:[0,1]
    v_pk_fma_f32 v[102:103], v[98:99], v[98:99], v[102:103]
    v_pk_add_f32 v[98:99], v[72:73], v[96:97] op_sel_hi:[1,0] neg_lo:[0,1] neg_hi:[0,1]
    v_pk_fma_f32 v[100:101], v[98:99], v[98:99], v[100:101]
    v_pk_add_f32 v[98:99], v[74:75], v[96:97] op_sel_hi:[1,0] neg_lo:[0,1] neg_hi:[0,1]
    v_pk_fma_f32 v[102:103], v[98:99], v[98:99], v[102:103]
    v_pk_add_f32 v[98:99], v[76:77], v[96:97] op_sel_hi:[1,0] neg_lo:[0,1] neg_hi:[0,1]
    v_pk_fma_f32 v[100:101], v[98:99], v[98:99], v[100:101]
    v_pk_add_f32 v[98:99], v[78:79], v[96:97] op_sel_hi:[1,0] neg_lo:[0,1] neg_hi:[0,1]
    v_pk_fma_f32 v[102:103], v[98:99], v[98:99], v[102:103]
    v_pk_add_f32 v[98:99], v[80:81], v[96:97] op_sel_hi:[1,0] neg_lo:[0,1] neg_hi:[0,1]
    v_pk_fma_f32 v[100:101], v[98:99], v[98:99], v[100:101]
    v_pk_add_f32 v[98:99], v[82:83], v[96:97] op_sel_hi:[1,0] neg_lo:[0,1] neg_hi:[0,1]
    v_pk_fma_f32 v[102:103], v[98:99], v[98:99], v[102:103]
    v_pk_add_f32 v[98:99], v[84:85], v[96:97] op_sel_hi:[1,0] neg_lo:[0,1] neg_hi:[0,1]
    v_pk_fma_f32 v[100:101], v[98:99], v[98:99], v[100:101]
    v_pk_add_f32 v[98:99], v[86:87], v[96:97] op_sel_hi:[1,0] neg_lo:[0,1] neg_hi:[0,1]
    v_pk_fma_f32 v[102:103], v[98:99], v[98:99], v[102:103]
    v_pk_add_f32 v[98:99], v[88:89], v[96:97] op_sel_hi:[1,0] neg_lo:[0,1] neg_hi:[0,1]
    v_pk_fma_f32 v[100:101], v[98:99], v[98:99], v[100:101]
    v_pk_add_f32 v[98:99], v[90:91], v[96:97] op_sel_hi:[1,0] neg_lo:[0,1] neg_hi:[0,1]
    v_pk_fma_f32 v[102:103], v[98:99], v[98:99], v[102:103]
    v_pk_add_f32 v[98:99], v[92:93], v[96:97] op_sel_hi:[1,0] neg_lo:[0,1] neg_hi:[0,1]
    v_pk_fma_f32 v[100:101], v[98:99], v[98:99], v[100:101]
    v_pk_add_f32 v[98:99], v[94:95], v[96:97] op_sel_hi:[1,0] neg_lo:[0,1] neg_hi:[0,1]
    v_pk_fma_f32 v[102:103], v[98:99], v[98:99], v[102:103]
    v_pk_add_f32 v[100:101], v[100:101], v[102:103]
    v_add_f32 v100, v100, v101
    s_nop 1
    v_add_f32_dpp v100, v100, v100 row_ror:8 row_mask:0xf bank_mask:0xf
    s_nop 1
    v_add_f32_dpp v100, v100, v100 row_ror:4 row_mask:0xf bank_mask:0xf
    s_nop 1
    v_add_f32_dpp v100, v100, v100 row_ror:2 row_mask:0xf bank_mask:0xf
    s_nop 1
    v_add_f32_dpp v100, v100, v100 row_ror:1 row_mask:0xf bank_mask:0xf
    v_mul_f32 v100, 0x3b000000, v100
    v_cvt_pk_bf16_f32 v96, v96, v96
    v_lshlrev_b32 v96, 16, v96
    v_cvt_pk_bf16_f32 v100, v100, v100
    v_lshlrev_b32 v100, 16, v100
    v_add_f32 v100, 0x3727c5ac, v100
    v_cvt_pk_bf16_f32 v100, v100, v100
    v_lshlrev_b32 v100, 16, v100
    v_sqrt_f32 v100, v100
    s_nop 0
    v_cvt_pk_bf16_f32 v100, v100, v100
    v_lshlrev_b32 v100, 16, v100
    v_rcp_f32 v100, v100
    v_pk_add_f32 v[98:99], v[64:65], v[96:97] op_sel_hi:[1,0] neg_lo:[0,1] neg_hi:[0,1]
    v_cvt_pk_bf16_f32 v99, v98, v99
    v_lshlrev_b32 v98, 16, v99
    v_and_b32 v99, 0xffff0000, v99
    v_pk_mul_f32 v[98:99], v[98:99], v[100:101] op_sel_hi:[1,0]
    v_cvt_pk_bf16_f32 v48, v98, v99
    v_pk_add_f32 v[102:103], v[66:67], v[96:97] op_sel_hi:[1,0] neg_lo:[0,1] neg_hi:[0,1]
    v_cvt_pk_bf16_f32 v103, v102, v103
    v_lshlrev_b32 v102, 16, v103
    v_and_b32 v103, 0xffff0000, v103
    v_pk_mul_f32 v[102:103], v[102:103], v[100:101] op_sel_hi:[1,0]
    v_cvt_pk_bf16_f32 v49, v102, v103
    v_pk_add_f32 v[98:99], v[68:69], v[96:97] op_sel_hi:[1,0] neg_lo:[0,1] neg_hi:[0,1]
    v_cvt_pk_bf16_f32 v99, v98, v99
    v_lshlrev_b32 v98, 16, v99
    v_and_b32 v99, 0xffff0000, v99
    v_pk_mul_f32 v[98:99], v[98:99], v[100:101] op_sel_hi:[1,0]
    v_cvt_pk_bf16_f32 v50, v98, v99
    v_pk_add_f32 v[102:103], v[70:71], v[96:97] op_sel_hi:[1,0] neg_lo:[0,1] neg_hi:[0,1]
    v_cvt_pk_bf16_f32 v103, v102, v103
    v_lshlrev_b32 v102, 16, v103
    v_and_b32 v103, 0xffff0000, v103
    v_pk_mul_f32 v[102:103], v[102:103], v[100:101] op_sel_hi:[1,0]
    v_cvt_pk_bf16_f32 v51, v102, v103
    v_pk_add_f32 v[98:99], v[72:73], v[96:97] op_sel_hi:[1,0] neg_lo:[0,1] neg_hi:[0,1]
    v_cvt_pk_bf16_f32 v99, v98, v99
    v_lshlrev_b32 v98, 16, v99
    v_and_b32 v99, 0xffff0000, v99
    v_pk_mul_f32 v[98:99], v[98:99], v[100:101] op_sel_hi:[1,0]
    v_cvt_pk_bf16_f32 v52, v98, v99
    v_pk_add_f32 v[102:103], v[74:75], v[96:97] op_sel_hi:[1,0] neg_lo:[0,1] neg_hi:[0,1]
    v_cvt_pk_bf16_f32 v103, v102, v103
    v_lshlrev_b32 v102, 16, v103
    v_and_b32 v103, 0xffff0000, v103
    v_pk_mul_f32 v[102:103], v[102:103], v[100:101] op_sel_hi:[1,0]
    v_cvt_pk_bf16_f32 v53, v102, v103
    v_pk_add_f32 v[98:99], v[76:77], v[96:97] op_sel_hi:[1,0] neg_lo:[0,1] neg_hi:[0,1]
    v_cvt_pk_bf16_f32 v99, v98, v99
    v_lshlrev_b32 v98, 16, v99
    v_and_b32 v99, 0xffff0000, v99
    v_pk_mul_f32 v[98:99], v[98:99], v[100:101] op_sel_hi:[1,0]
    v_cvt_pk_bf16_f32 v54, v98, v99
    v_pk_add_f32 v[102:103], v[78:79], v[96:97] op_sel_hi:[1,0] neg_lo:[0,1] neg_hi:[0,1]
    v_cvt_pk_bf16_f32 v103, v102, v103
    v_lshlrev_b32 v102, 16, v103
    v_and_b32 v103, 0xffff0000, v103
    v_pk_mul_f32 v[102:103], v[102:103], v[100:101] op_sel_hi:[1,0]
    v_cvt_pk_bf16_f32 v55, v102, v103
    v_pk_add_f32 v[98:99], v[80:81], v[96:97] op_sel_hi:[1,0] neg_lo:[0,1] neg_hi:[0,1]
    v_cvt_pk_bf16_f32 v99, v98, v99
    v_lshlrev_b32 v98, 16, v99
    v_and_b32 v99, 0xffff0000, v99
    v_pk_mul_f32 v[98:99], v[98:99], v[100:101] op_sel_hi:[1,0]
    v_cvt_pk_bf16_f32 v56, v98, v99
    v_pk_add_f32 v[102:103], v[82:83], v[96:97] op_sel_hi:[1,0] neg_lo:[0,1] neg_hi:[0,1]
    v_cvt_pk_bf16_f32 v103, v102, v103
    v_lshlrev_b32 v102, 16, v103
    v_and_b32 v103, 0xffff0000, v103
    v_pk_mul_f32 v[102:103], v[102:103], v[100:101] op_sel_hi:[1,0]
    v_cvt_pk_bf16_f32 v57, v102, v103
    v_pk_add_f32 v[98:99], v[84:85], v[96:97] op_sel_hi:[1,0] neg_lo:[0,1] neg_hi:[0,1]
    v_cvt_pk_bf16_f32 v99, v98, v99
    v_lshlrev_b32 v98, 16, v99
    v_and_b32 v99, 0xffff0000, v99
    v_pk_mul_f32 v[98:99], v[98:99], v[100:101] op_sel_hi:[1,0]
    v_cvt_pk_bf16_f32 v58, v98, v99
    v_pk_add_f32 v[102:103], v[86:87], v[96:97] op_sel_hi:[1,0] neg_lo:[0,1] neg_hi:[0,1]
    v_cvt_pk_bf16_f32 v103, v102, v103
    v_lshlrev_b32 v102, 16, v103
    v_and_b32 v103, 0xffff0000, v103
    v_pk_mul_f32 v[102:103], v[102:103], v[100:101] op_sel_hi:[1,0]
    v_cvt_pk_bf16_f32 v59, v102, v103
    v_pk_add_f32 v[98:99], v[88:89], v[96:97] op_sel_hi:[1,0] neg_lo:[0,1] neg_hi:[0,1]
    v_cvt_pk_bf16_f32 v99, v98, v99
    v_lshlrev_b32 v98, 16, v99
    v_and_b32 v99, 0xffff0000, v99
    v_pk_mul_f32 v[98:99], v[98:99], v[100:101] op_sel_hi:[1,0]
    v_cvt_pk_bf16_f32 v60, v98, v99
    v_pk_add_f32 v[102:103], v[90:91], v[96:97] op_sel_hi:[1,0] neg_lo:[0,1] neg_hi:[0,1]
    v_cvt_pk_bf16_f32 v103, v102, v103
    v_lshlrev_b32 v102, 16, v103
    v_and_b32 v103, 0xffff0000, v103
    v_pk_mul_f32 v[102:103], v[102:103], v[100:101] op_sel_hi:[1,0]
    v_cvt_pk_bf16_f32 v61, v102, v103
    v_pk_add_f32 v[98:99], v[92:93], v[96:97] op_sel_hi:[1,0] neg_lo:[0,1] neg_hi:[0,1]
    v_cvt_pk_bf16_f32 v99, v98, v99
    v_lshlrev_b32 v98, 16, v99
    v_and_b32 v99, 0xffff0000, v99
    v_pk_mul_f32 v[98:99], v[98:99], v[100:101] op_sel_hi:[1,0]
    v_cvt_pk_bf16_f32 v62, v98, v99
    v_pk_add_f32 v[102:103], v[94:95], v[96:97] op_sel_hi:[1,0] neg_lo:[0,1] neg_hi:[0,1]
    v_cvt_pk_bf16_f32 v103, v102, v103
    v_lshlrev_b32 v102, 16, v103
    v_and_b32 v103, 0xffff0000, v103
    v_pk_mul_f32 v[102:103], v[102:103], v[100:101] op_sel_hi:[1,0]
    v_cvt_pk_bf16_f32 v63, v102, v103
    s_lshl_b32 s30, s20, 6
    s_add_u32 s30, s30, s67
    buffer_store_dwordx4 v[48:51], v120, s[4:7], s30 offen sc1
    s_add_u32 s30, s30, 4096
    buffer_store_dwordx4 v[52:55], v120, s[4:7], s30 offen sc1
    s_add_u32 s30, s30, 4096
    buffer_store_dwordx4 v[56:59], v120, s[4:7], s30 offen sc1
    s_add_u32 s30, s30, 4096
    buffer_store_dwordx4 v[60:63], v120, s[4:7], s30 offen sc1
L_GNOLN:
    s_waitcnt vmcnt(24) lgkmcnt(0)
    s_barrier
    s_add_u32 m0, s33, 0x1c000
    s_add_u32 s31, s68, 0x380000
    buffer_load_dwordx4 v113, s[8:11], s31 offen lds
    s_add_u32 m0, s33, 0x1c400
    s_add_u32 s31, s68, 0x388000
    buffer_load_dwordx4 v113, s[8:11], s31 offen lds
    s_add_u32 m0, s33, 0x1c800
    s_add_u32 s31, s68, 0x390000
    buffer_load_dwordx4 v114, s[8:11], s31 offen lds
    s_add_u32 m0, s33, 0x1cc00
    s_add_u32 s31, s68, 0x398000
    buffer_load_dwordx4 v114, s[8:11], s31 offen lds
    v_add_u32 v117, 0x0, v115
    v_add_u32 v118, 0x0, v116
    ds_read_b64_tr_b16 a[128:129], v117 offset:0
    ds_read_b64_tr_b16 a[130:131], v117 offset:1024
    ds_read_b64_tr_b16 a[132:133], v117 offset:8192
    ds_read_b64_tr_b16 a[134:135], v117 offset:9216
    ds_read_b64_tr_b16 a[192:193], v118 offset:0
    ds_read_b64_tr_b16 a[194:195], v118 offset:1024
    ds_read_b64_tr_b16 a[196:197], v118 offset:8192
    ds_read_b64_tr_b16 a[198:199], v118 offset:9216
    s_waitcnt vmcnt(24) lgkmcnt(0)
    s_barrier
    s_mov_b32 s8, s44
    s_mov_b32 s9, s45
    s_add_u32 m0, s33, 0x0
    s_add_u32 s31, s68, 0x0
    buffer_load_dwordx4 v113, s[8:11], s31 offen lds
    s_add_u32 m0, s33, 0x400
    s_add_u32 s31, s68, 0x8000
    buffer_load_dwordx4 v113, s[8:11], s31 offen lds
    s_add_u32 m0, s33, 0x800
    s_add_u32 s31, s68, 0x10000
    buffer_load_dwordx4 v114, s[8:11], s31 offen lds
    s_add_u32 m0, s33, 0xc00
    s_add_u32 s31, s68, 0x18000
    buffer_load_dwordx4 v114, s[8:11], s31 offen lds
    v_add_u32 v117, 0x4000, v115
    v_add_u32 v118, 0x4000, v116
    ds_read_b64_tr_b16 a[136:137], v117 offset:0
    ds_read_b64_tr_b16 a[138:139], v117 offset:1024
    ds_read_b64_tr_b16 a[140:141], v117 offset:8192
    ds_read_b64_tr_b16 a[142:143], v117 offset:9216
    ds_read_b64_tr_b16 a[200:201], v118 offset:0
    ds_read_b64_tr_b16 a[202:203], v118 offset:1024
    ds_read_b64_tr_b16 a[204:205], v118 offset:8192
    ds_read_b64_tr_b16 a[206:207], v118 offset:9216
    s_waitcnt vmcnt(24) lgkmcnt(0)
    s_barrier
    s_add_u32 m0, s33, 0x4000
    s_add_u32 s31, s68, 0x80000
    buffer_load_dwordx4 v113, s[8:11], s31 offen lds
    s_add_u32 m0, s33, 0x4400
    s_add_u32 s31, s68, 0x88000
    buffer_load_dwordx4 v113, s[8:11], s31 offen lds
    s_add_u32 m0, s33, 0x4800
    s_add_u32 s31, s68, 0x90000
    buffer_load_dwordx4 v114, s[8:11], s31 offen lds
    s_add_u32 m0, s33, 0x4c00
    s_add_u32 s31, s68, 0x98000
    buffer_load_dwordx4 v114, s[8:11], s31 offen lds
    v_add_u32 v117, 0x8000, v115
    v_add_u32 v118, 0x8000, v116
    ds_read_b64_tr_b16 a[144:145], v117 offset:0
    ds_read_b64_tr_b16 a[146:147], v117 offset:1024
    ds_read_b64_tr_b16 a[148:149], v117 offset:8192
    ds_read_b64_tr_b16 a[150:151], v117 offset:9216
    ds_read_b64_tr_b16 a[208:209], v118 offset:0
    ds_read_b64_tr_b16 a[210:211], v118 offset:1024
    ds_read_b64_tr_b16 a[212:213], v118 offset:8192
    ds_read_b64_tr_b16 a[214:215], v118 offset:9216
    s_waitcnt vmcnt(24) lgkmcnt(0)
    s_barrier
    s_add_u32 m0, s33, 0x8000
    s_add_u32 s31, s68, 0x100000
    buffer_load_dwordx4 v113, s[8:11], s31 offen lds
    s_add_u32 m0, s33, 0x8400
    s_add_u32 s31, s68, 0x108000
    buffer_load_dwordx4 v113, s[8:11], s31 offen lds
    s_add_u32 m0, s33, 0x8800
    s_add_u32 s31, s68, 0x110000
    buffer_load_dwordx4 v114, s[8:11], s31 offen lds
    s_add_u32 m0, s33, 0x8c00
    s_add_u32 s31, s68, 0x118000
    buffer_load_dwordx4 v114, s[8:11], s31 offen lds
    v_add_u32 v117, 0xc000, v115
    v_add_u32 v118, 0xc000, v116
    ds_read_b64_tr_b16 a[152:153], v117 offset:0
    ds_read_b64_tr_b16 a[154:155], v117 offset:1024
    ds_read_b64_tr_b16 a[156:157], v117 offset:8192
    ds_read_b64_tr_b16 a[158:159], v117 offset:9216
    ds_read_b64_tr_b16 a[216:217], v118 offset:0
    ds_read_b64_tr_b16 a[218:219], v118 offset:1024
    ds_read_b64_tr_b16 a[220:221], v118 offset:8192
    ds_read_b64_tr_b16 a[222:223], v118 offset:9216
    s_waitcnt vmcnt(24) lgkmcnt(0)
    s_barrier
    s_add_u32 m0, s33, 0xc000
    s_add_u32 s31, s68, 0x180000
    buffer_load_dwordx4 v113, s[8:11], s31 offen lds
    s_add_u32 m0, s33, 0xc400
    s_add_u32 s31, s68, 0x188000
    buffer_load_dwordx4 v113, s[8:11], s31 offen lds
    s_add_u32 m0, s33, 0xc800
    s_add_u32 s31, s68, 0x190000
    buffer_load_dwordx4 v114, s[8:11], s31 offen lds
    s_add_u32 m0, s33, 0xcc00
    s_add_u32 s31, s68, 0x198000
    buffer_load_dwordx4 v114, s[8:11], s31 offen lds
    v_add_u32 v117, 0x10000, v115
    v_add_u32 v118, 0x10000, v116
    ds_read_b64_tr_b16 a[160:161], v117 offset:0
    ds_read_b64_tr_b16 a[162:163], v117 offset:1024
    ds_read_b64_tr_b16 a[164:165], v117 offset:8192
    ds_read_b64_tr_b16 a[166:167], v117 offset:9216
    ds_read_b64_tr_b16 a[224:225], v118 offset:0
    ds_read_b64_tr_b16 a[226:227], v118 offset:1024
    ds_read_b64_tr_b16 a[228:229], v118 offset:8192
    ds_read_b64_tr_b16 a[230:231], v118 offset:9216
    s_waitcnt vmcnt(24) lgkmcnt(0)
    s_barrier
    s_add_u32 m0, s33, 0x10000
    s_add_u32 s31, s68, 0x200000
    buffer_load_dwordx4 v113, s[8:11], s31 offen lds
    s_add_u32 m0, s33, 0x10400
    s_add_u32 s31, s68, 0x208000
    buffer_load_dwordx4 v113, s[8:11], s31 offen lds
    s_add_u32 m0, s33, 0x10800
    s_add_u32 s31, s68, 0x210000
    buffer_load_dwordx4 v114, s[8:11], s31 offen lds
    s_add_u32 m0, s33, 0x10c00
    s_add_u32 s31, s68, 0x218000
    buffer_load_dwordx4 v114, s[8:11], s31 offen lds
    v_add_u32 v117, 0x14000, v115
    v_add_u32 v118, 0x14000, v116
    ds_read_b64_tr_b16 a[168:169], v117 offset:0
    ds_read_b64_tr_b16 a[170:171], v117 offset:1024
    ds_read_b64_tr_b16 a[172:173], v117 offset:8192
    ds_read_b64_tr_b16 a[174:175], v117 offset:9216
    ds_read_b64_tr_b16 a[232:233], v118 offset:0
    ds_read_b64_tr_b16 a[234:235], v118 offset:1024
    ds_read_b64_tr_b16 a[236:237], v118 offset:8192
    ds_read_b64_tr_b16 a[238:239], v118 offset:9216
    s_waitcnt vmcnt(24) lgkmcnt(0)
    s_barrier
    s_add_u32 m0, s33, 0x14000
    s_add_u32 s31, s68, 0x280000
    buffer_load_dwordx4 v113, s[8:11], s31 offen lds
    s_add_u32 m0, s33, 0x14400
    s_add_u32 s31, s68, 0x288000
    buffer_load_dwordx4 v113, s[8:11], s31 offen lds
    s_add_u32 m0, s33, 0x14800
    s_add_u32 s31, s68, 0x290000
    buffer_load_dwordx4 v114, s[8:11], s31 offen lds
    s_add_u32 m0, s33, 0x14c00
    s_add_u32 s31, s68, 0x298000
    buffer_load_dwordx4 v114, s[8:11], s31 offen lds
    v_add_u32 v117, 0x18000, v115
    v_add_u32 v118, 0x18000, v116
    ds_read_b64_tr_b16 a[176:177], v117 offset:0
    ds_read_b64_tr_b16 a[178:179], v117 offset:1024
    ds_read_b64_tr_b16 a[180:181], v117 offset:8192
    ds_read_b64_tr_b16 a[182:183], v117 offset:9216
    ds_read_b64_tr_b16 a[240:241], v118 offset:0
    ds_read_b64_tr_b16 a[242:243], v118 offset:1024
    ds_read_b64_tr_b16 a[244:245], v118 offset:8192
    ds_read_b64_tr_b16 a[246:247], v118 offset:9216
    s_waitcnt vmcnt(24) lgkmcnt(0)
    s_barrier
    s_add_u32 m0, s33, 0x18000
    s_add_u32 s31, s68, 0x300000
    buffer_load_dwordx4 v113, s[8:11], s31 offen lds
    s_add_u32 m0, s33, 0x18400
    s_add_u32 s31, s68, 0x308000
    buffer_load_dwordx4 v113, s[8:11], s31 offen lds
    s_add_u32 m0, s33, 0x18800
    s_add_u32 s31, s68, 0x310000
    buffer_load_dwordx4 v114, s[8:11], s31 offen lds
    s_add_u32 m0, s33, 0x18c00
    s_add_u32 s31, s68, 0x318000
    buffer_load_dwordx4 v114, s[8:11], s31 offen lds
    v_add_u32 v117, 0x1c000, v115
    v_add_u32 v118, 0x1c000, v116
    ds_read_b64_tr_b16 a[184:185], v117 offset:0
    ds_read_b64_tr_b16 a[186:187], v117 offset:1024
    ds_read_b64_tr_b16 a[188:189], v117 offset:8192
    ds_read_b64_tr_b16 a[190:191], v117 offset:9216
    ds_read_b64_tr_b16 a[248:249], v118 offset:0
    ds_read_b64_tr_b16 a[250:251], v118 offset:1024
    ds_read_b64_tr_b16 a[252:253], v118 offset:8192
    ds_read_b64_tr_b16 a[254:255], v118 offset:9216
    s_waitcnt vmcnt(24) lgkmcnt(0)
    s_barrier
    s_add_u32 m0, s33, 0x1c000
    s_add_u32 s31, s68, 0x380000
    buffer_load_dwordx4 v113, s[8:11], s31 offen lds
    s_add_u32 m0, s33, 0x1c400
    s_add_u32 s31, s68, 0x388000
    buffer_load_dwordx4 v113, s[8:11], s31 offen lds
    s_add_u32 m0, s33, 0x1c800
    s_add_u32 s31, s68, 0x390000
    buffer_load_dwordx4 v114, s[8:11], s31 offen lds
    s_add_u32 m0, s33, 0x1cc00
    s_add_u32 s31, s68, 0x398000
    buffer_load_dwordx4 v114, s[8:11], s31 offen lds
    v_add_u32 v117, 0x0, v115
    v_add_u32 v118, 0x0, v116
    ds_read_b64_tr_b16 v[128:129], v117 offset:0
    ds_read_b64_tr_b16 v[130:131], v117 offset:1024
    ds_read_b64_tr_b16 v[132:133], v117 offset:8192
    ds_read_b64_tr_b16 v[134:135], v117 offset:9216
    ds_read_b64_tr_b16 v[192:193], v118 offset:0
    ds_read_b64_tr_b16 v[194:195], v118 offset:1024
    ds_read_b64_tr_b16 v[196:197], v118 offset:8192
    ds_read_b64_tr_b16 v[198:199], v118 offset:9216
    s_waitcnt vmcnt(24) lgkmcnt(0)
    s_barrier
    s_mov_b32 s8, s40
    s_mov_b32 s9, s41
    s_add_u32 m0, s33, 0x0
    s_add_u32 s31, s68, 0x0
    buffer_load_dwordx4 v113, s[8:11], s31 offen lds
    s_add_u32 m0, s33, 0x400
    s_add_u32 s31, s68, 0x8000
    buffer_load_dwordx4 v113, s[8:11], s31 offen lds
    s_add_u32 m0, s33, 0x800
    s_add_u32 s31, s68, 0x10000
    buffer_load_dwordx4 v114, s[8:11], s31 offen lds
    s_add_u32 m0, s33, 0xc00
    s_add_u32 s31, s68, 0x18000
    buffer_load_dwordx4 v114, s[8:11], s31 offen lds
    v_add_u32 v117, 0x4000, v115
    v_add_u32 v118, 0x4000, v116
    ds_read_b64_tr_b16 v[136:137], v117 offset:0
    ds_read_b64_tr_b16 v[138:139], v117 offset:1024
    ds_read_b64_tr_b16 v[140:141], v117 offset:8192
    ds_read_b64_tr_b16 v[142:143], v117 offset:9216
    ds_read_b64_tr_b16 v[200:201], v118 offset:0
    ds_read_b64_tr_b16 v[202:203], v118 offset:1024
    ds_read_b64_tr_b16 v[204:205], v118 offset:8192
    ds_read_b64_tr_b16 v[206:207], v118 offset:9216
    s_waitcnt vmcnt(24) lgkmcnt(0)
    s_barrier
    buffer_load_dword v124, off, s[12:15], 0 offset:32 sc1
    s_add_u32 m0, s33, 0x4000
    s_add_u32 s31, s68, 0x80000
    buffer_load_dwordx4 v113, s[8:11], s31 offen lds
    s_add_u32 m0, s33, 0x4400
    s_add_u32 s31, s68, 0x88000
    buffer_load_dwordx4 v113, s[8:11], s31 offen lds
    s_add_u32 m0, s33, 0x4800
    s_add_u32 s31, s68, 0x90000
    buffer_load_dwordx4 v114, s[8:11], s31 offen lds
    s_add_u32 m0, s33, 0x4c00
    s_add_u32 s31, s68, 0x98000
    buffer_load_dwordx4 v114, s[8:11], s31 offen lds
    v_add_u32 v117, 0x8000, v115
    v_add_u32 v118, 0x8000, v116
    ds_read_b64_tr_b16 v[144:145], v117 offset:0
    ds_read_b64_tr_b16 v[146:147], v117 offset:1024
    ds_read_b64_tr_b16 v[148:149], v117 offset:8192
    ds_read_b64_tr_b16 v[150:151], v117 offset:9216
    ds_read_b64_tr_b16 v[208:209], v118 offset:0
    ds_read_b64_tr_b16 v[210:211], v118 offset:1024
    ds_read_b64_tr_b16 v[212:213], v118 offset:8192
    ds_read_b64_tr_b16 v[214:215], v118 offset:9216
    s_waitcnt vmcnt(24) lgkmcnt(0)
    s_barrier
    s_add_u32 m0, s33, 0x8000
    s_add_u32 s31, s68, 0x100000
    buffer_load_dwordx4 v113, s[8:11], s31 offen lds
    s_add_u32 m0, s33, 0x8400
    s_add_u32 s31, s68, 0x108000
    buffer_load_dwordx4 v113, s[8:11], s31 offen lds
    s_add_u32 m0, s33, 0x8800
    s_add_u32 s31, s68, 0x110000
    buffer_load_dwordx4 v114, s[8:11], s31 offen lds
    s_add_u32 m0, s33, 0x8c00
    s_add_u32 s31, s68, 0x118000
    buffer_load_dwordx4 v114, s[8:11], s31 offen lds
    v_add_u32 v117, 0xc000, v115
    v_add_u32 v118, 0xc000, v116
    ds_read_b64_tr_b16 v[152:153], v117 offset:0
    ds_read_b64_tr_b16 v[154:155], v117 offset:1024
    ds_read_b64_tr_b16 v[156:157], v117 offset:8192
    ds_read_b64_tr_b16 v[158:159], v117 offset:9216
    ds_read_b64_tr_b16 v[216:217], v118 offset:0
    ds_read_b64_tr_b16 v[218:219], v118 offset:1024
    ds_read_b64_tr_b16 v[220:221], v118 offset:8192
    ds_read_b64_tr_b16 v[222:223], v118 offset:9216
    s_waitcnt vmcnt(24) lgkmcnt(0)
    s_barrier
    s_add_u32 m0, s33, 0xc000
    s_add_u32 s31, s68, 0x180000
    buffer_load_dwordx4 v113, s[8:11], s31 offen lds
    s_add_u32 m0, s33, 0xc400
    s_add_u32 s31, s68, 0x188000
    buffer_load_dwordx4 v113, s[8:11], s31 offen lds
    s_add_u32 m0, s33, 0xc800
    s_add_u32 s31, s68, 0x190000
    buffer_load_dwordx4 v114, s[8:11], s31 offen lds
    s_add_u32 m0, s33, 0xcc00
    s_add_u32 s31, s68, 0x198000
    buffer_load_dwordx4 v114, s[8:11], s31 offen lds
    v_add_u32 v117, 0x10000, v115
    v_add_u32 v118, 0x10000, v116
    ds_read_b64_tr_b16 v[160:161], v117 offset:0
    ds_read_b64_tr_b16 v[162:163], v117 offset:1024
    ds_read_b64_tr_b16 v[164:165], v117 offset:8192
    ds_read_b64_tr_b16 v[166:167], v117 offset:9216
    ds_read_b64_tr_b16 v[224:225], v118 offset:0
    ds_read_b64_tr_b16 v[226:227], v118 offset:1024
    ds_read_b64_tr_b16 v[228:229], v118 offset:8192
    ds_read_b64_tr_b16 v[230:231], v118 offset:9216
    s_waitcnt vmcnt(24) lgkmcnt(0)
    s_barrier
    s_add_u32 m0, s33, 0x10000
    s_add_u32 s31, s68, 0x200000
    buffer_load_dwordx4 v113, s[8:11], s31 offen lds
    s_add_u32 m0, s33, 0x10400
    s_add_u32 s31, s68, 0x208000
    buffer_load_dwordx4 v113, s[8:11], s31 offen lds
    s_add_u32 m0, s33, 0x10800
    s_add_u32 s31, s68, 0x210000
    buffer_load_dwordx4 v114, s[8:11], s31 offen lds
    s_add_u32 m0, s33, 0x10c00
    s_add_u32 s31, s68, 0x218000
    buffer_load_dwordx4 v114, s[8:11], s31 offen lds
    v_add_u32 v117, 0x14000, v115
    v_add_u32 v118, 0x14000, v116
    ds_read_b64_tr_b16 v[168:169], v117 offset:0
    ds_read_b64_tr_b16 v[170:171], v117 offset:1024
    ds_read_b64_tr_b16 v[172:173], v117 offset:8192
    ds_read_b64_tr_b16 v[174:175], v117 offset:9216
    ds_read_b64_tr_b16 v[232:233], v118 offset:0
    ds_read_b64_tr_b16 v[234:235], v118 offset:1024
    ds_read_b64_tr_b16 v[236:237], v118 offset:8192
    ds_read_b64_tr_b16 v[238:239], v118 offset:9216
    s_waitcnt vmcnt(24) lgkmcnt(0)
    s_barrier
    s_add_u32 m0, s33, 0x14000
    s_add_u32 s31, s68, 0x280000
    buffer_load_dwordx4 v113, s[8:11], s31 offen lds
    s_add_u32 m0, s33, 0x14400
    s_add_u32 s31, s68, 0x288000
    buffer_load_dwordx4 v113, s[8:11], s31 offen lds
    s_add_u32 m0, s33, 0x14800
    s_add_u32 s31, s68, 0x290000
    buffer_load_dwordx4 v114, s[8:11], s31 offen lds
    s_add_u32 m0, s33, 0x14c00
    s_add_u32 s31, s68, 0x298000
    buffer_load_dwordx4 v114, s[8:11], s31 offen lds
    v_add_u32 v117, 0x18000, v115
    v_add_u32 v118, 0x18000, v116
    ds_read_b64_tr_b16 v[176:177], v117 offset:0
    ds_read_b64_tr_b16 v[178:179], v117 offset:1024
    ds_read_b64_tr_b16 v[180:181], v117 offset:8192
    ds_read_b64_tr_b16 v[182:183], v117 offset:9216
    ds_read_b64_tr_b16 v[240:241], v118 offset:0
    ds_read_b64_tr_b16 v[242:243], v118 offset:1024
    ds_read_b64_tr_b16 v[244:245], v118 offset:8192
    ds_read_b64_tr_b16 v[246:247], v118 offset:9216
    s_waitcnt vmcnt(24) lgkmcnt(0)
    s_barrier
    s_add_u32 m0, s33, 0x18000
    s_add_u32 s31, s68, 0x300000
    buffer_load_dwordx4 v113, s[8:11], s31 offen lds
    s_add_u32 m0, s33, 0x18400
    s_add_u32 s31, s68, 0x308000
    buffer_load_dwordx4 v113, s[8:11], s31 offen lds
    s_add_u32 m0, s33, 0x18800
    s_add_u32 s31, s68, 0x310000
    buffer_load_dwordx4 v114, s[8:11], s31 offen lds
    s_add_u32 m0, s33, 0x18c00
    s_add_u32 s31, s68, 0x318000
    buffer_load_dwordx4 v114, s[8:11], s31 offen lds
    v_add_u32 v117, 0x1c000, v115
    v_add_u32 v118, 0x1c000, v116
    ds_read_b64_tr_b16 v[184:185], v117 offset:0
    ds_read_b64_tr_b16 v[186:187], v117 offset:1024
    ds_read_b64_tr_b16 v[188:189], v117 offset:8192
    ds_read_b64_tr_b16 v[190:191], v117 offset:9216
    ds_read_b64_tr_b16 v[248:249], v118 offset:0
    ds_read_b64_tr_b16 v[250:251], v118 offset:1024
    ds_read_b64_tr_b16 v[252:253], v118 offset:8192
    ds_read_b64_tr_b16 v[254:255], v118 offset:9216
    s_waitcnt vmcnt(24) lgkmcnt(0)
    s_barrier
    s_add_u32 m0, s33, 0x1c000
    s_add_u32 s31, s68, 0x380000
    buffer_load_dwordx4 v113, s[8:11], s31 offen lds
    s_add_u32 m0, s33, 0x1c400
    s_add_u32 s31, s68, 0x388000
    buffer_load_dwordx4 v113, s[8:11], s31 offen lds
    s_add_u32 m0, s33, 0x1c800
    s_add_u32 s31, s68, 0x390000
    buffer_load_dwordx4 v114, s[8:11], s31 offen lds
    s_add_u32 m0, s33, 0x1cc00
    s_add_u32 s31, s68, 0x398000
    buffer_load_dwordx4 v114, s[8:11], s31 offen lds
    v_add_u32 v117, 0x0, v115
    v_add_u32 v118, 0x0, v116
    ds_read_b64_tr_b16 a[0:1], v117 offset:0
    ds_read_b64_tr_b16 a[2:3], v117 offset:1024
    ds_read_b64_tr_b16 a[4:5], v117 offset:8192
    ds_read_b64_tr_b16 a[6:7], v117 offset:9216
    ds_read_b64_tr_b16 a[64:65], v118 offset:0
    ds_read_b64_tr_b16 a[66:67], v118 offset:1024
    ds_read_b64_tr_b16 a[68:69], v118 offset:8192
    ds_read_b64_tr_b16 a[70:71], v118 offset:9216
    v_add_u32 v119, 0x20000, v112
    s_lshl_b32 s30, s27, 5
    s_add_u32 s30, s30, s26
    s_lshl_b32 s35, s30, 14
    s_add_u32 s35, s35, s33
    s_add_u32 s35, s35, 0x1200000
    ds_read_b128 v[48:51], v119 offset:0
    ds_read_b128 v[52:55], v119 offset:16384
    s_waitcnt lgkmcnt(0)
    v_mfma_f32_16x16x32_bf16 v[16:19], a[128:131], v[48:51], 0
    ds_read_b128 v[56:59], v119 offset:1024
    v_mfma_f32_16x16x32_bf16 v[20:23], a[128:131], v[52:55], 0
    ds_read_b128 v[60:63], v119 offset:17408
    v_mfma_f32_16x16x32_bf16 v[24:27], a[192:195], v[48:51], 0
    v_mfma_f32_16x16x32_bf16 v[28:31], a[192:195], v[52:55], 0
    v_mfma_f32_16x16x32_bf16 v[32:35], v[48:51], v[128:131], 0
    v_mfma_f32_16x16x32_bf16 v[36:39], v[52:55], v[128:131], 0
    v_mfma_f32_16x16x32_bf16 v[40:43], v[48:51], v[192:195], 0
    v_mfma_f32_16x16x32_bf16 v[44:47], v[52:55], v[192:195], 0
    s_waitcnt lgkmcnt(0)
    v_mfma_f32_16x16x32_bf16 v[16:19], a[132:135], v[56:59], v[16:19]
    ds_read_b128 v[48:51], v119 offset:2048
    v_mfma_f32_16x16x32_bf16 v[20:23], a[132:135], v[60:63], v[20:23]
    ds_read_b128 v[52:55], v119 offset:18432
    v_mfma_f32_16x16x32_bf16 v[24:27], a[196:199], v[56:59], v[24:27]
    v_mfma_f32_16x16x32_bf16 v[28:31], a[196:199], v[60:63], v[28:31]
    v_mfma_f32_16x16x32_bf16 v[32:35], v[56:59], v[132:135], v[32:35]
    v_mfma_f32_16x16x32_bf16 v[36:39], v[60:63], v[132:135], v[36:39]
    v_mfma_f32_16x16x32_bf16 v[40:43], v[56:59], v[196:199], v[40:43]
    v_mfma_f32_16x16x32_bf16 v[44:47], v[60:63], v[196:199], v[44:47]
    s_waitcnt lgkmcnt(0)
    v_mfma_f32_16x16x32_bf16 v[16:19], a[136:139], v[48:51], v[16:19]
    ds_read_b128 v[56:59], v119 offset:3072
    v_mfma_f32_16x16x32_bf16 v[20:23], a[136:139], v[52:55], v[20:23]
    ds_read_b128 v[60:63], v119 offset:19456
    v_mfma_f32_16x16x32_bf16 v[24:27], a[200:203], v[48:51], v[24:27]
    v_mfma_f32_16x16x32_bf16 v[28:31], a[200:203], v[52:55], v[28:31]
    v_mfma_f32_16x16x32_bf16 v[32:35], v[48:51], v[136:139], v[32:35]
    v_mfma_f32_16x16x32_bf16 v[36:39], v[52:55], v[136:139], v[36:39]
    v_mfma_f32_16x16x32_bf16 v[40:43], v[48:51], v[200:203], v[40:43]
    v_mfma_f32_16x16x32_bf16 v[44:47], v[52:55], v[200:203], v[44:47]
    s_waitcnt lgkmcnt(0)
    v_mfma_f32_16x16x32_bf16 v[16:19], a[140:143], v[56:59], v[16:19]
    ds_read_b128 v[48:51], v119 offset:4096
    v_mfma_f32_16x16x32_bf16 v[20:23], a[140:143], v[60:63], v[20:23]
    ds_read_b128 v[52:55], v119 offset:20480
    v_mfma_f32_16x16x32_bf16 v[24:27], a[204:207], v[56:59], v[24:27]
    v_mfma_f32_16x16x32_bf16 v[28:31], a[204:207], v[60:63], v[28:31]
    v_mfma_f32_16x16x32_bf16 v[32:35], v[56:59], v[140:143], v[32:35]
    v_mfma_f32_16x16x32_bf16 v[36:39], v[60:63], v[140:143], v[36:39]
    v_mfma_f32_16x16x32_bf16 v[40:43], v[56:59], v[204:207], v[40:43]
    v_mfma_f32_16x16x32_bf16 v[44:47], v[60:63], v[204:207], v[44:47]
    s_waitcnt lgkmcnt(0)
    v_mfma_f32_16x16x32_bf16 v[16:19], a[144:147], v[48:51], v[16:19]
    ds_read_b128 v[56:59], v119 offset:5120
    v_mfma_f32_16x16x32_bf16 v[20:23], a[144:147], v[52:55], v[20:23]
    ds_read_b128 v[60:63], v119 offset:21504
    v_mfma_f32_16x16x32_bf16 v[24:27], a[208:211], v[48:51], v[24:27]
    v_mfma_f32_16x16x32_bf16 v[28:31], a[208:211], v[52:55], v[28:31]
    v_mfma_f32_16x16x32_bf16 v[32:35], v[48:51], v[144:147], v[32:35]
    v_mfma_f32_16x16x32_bf16 v[36:39], v[52:55], v[144:147], v[36:39]
    v_mfma_f32_16x16x32_bf16 v[40:43], v[48:51], v[208:211], v[40:43]
    v_mfma_f32_16x16x32_bf16 v[44:47], v[52:55], v[208:211], v[44:47]
    s_waitcnt lgkmcnt(0)
    v_mfma_f32_16x16x32_bf16 v[16:19], a[148:151], v[56:59], v[16:19]
    ds_read_b128 v[48:51], v119 offset:6144
    v_mfma_f32_16x16x32_bf16 v[20:23], a[148:151], v[60:63], v[20:23]
    ds_read_b128 v[52:55], v119 offset:22528
    v_mfma_f32_16x16x32_bf16 v[24:27], a[212:215], v[56:59], v[24:27]
    v_mfma_f32_16x16x32_bf16 v[28:31], a[212:215], v[60:63], v[28:31]
    v_mfma_f32_16x16x32_bf16 v[32:35], v[56:59], v[148:151], v[32:35]
    v_mfma_f32_16x16x32_bf16 v[36:39], v[60:63], v[148:151], v[36:39]
    v_mfma_f32_16x16x32_bf16 v[40:43], v[56:59], v[212:215], v[40:43]
    v_mfma_f32_16x16x32_bf16 v[44:47], v[60:63], v[212:215], v[44:47]
    s_waitcnt lgkmcnt(0)
    v_mfma_f32_16x16x32_bf16 v[16:19], a[152:155], v[48:51], v[16:19]
    ds_read_b128 v[56:59], v119 offset:7168
    v_mfma_f32_16x16x32_bf16 v[20:23], a[152:155], v[52:55], v[20:23]
    ds_read_b128 v[60:63], v119 offset:23552
    v_mfma_f32_16x16x32_bf16 v[24:27], a[216:219], v[48:51], v[24:27]
    v_mfma_f32_16x16x32_bf16 v[28:31], a[216:219], v[52:55], v[28:31]
    v_mfma_f32_16x16x32_bf16 v[32:35], v[48:51], v[152:155], v[32:35]
    v_mfma_f32_16x16x32_bf16 v[36:39], v[52:55], v[152:155], v[36:39]
    v_mfma_f32_16x16x32_bf16 v[40:43], v[48:51], v[216:219], v[40:43]
    v_mfma_f32_16x16x32_bf16 v[44:47], v[52:55], v[216:219], v[44:47]
    s_waitcnt lgkmcnt(0)
    v_mfma_f32_16x16x32_bf16 v[16:19], a[156:159], v[56:59], v[16:19]
    ds_read_b128 v[48:51], v119 offset:8192
    v_mfma_f32_16x16x32_bf16 v[20:23], a[156:159], v[60:63], v[20:23]
    ds_read_b128 v[52:55], v119 offset:24576
    v_mfma_f32_16x16x32_bf16 v[24:27], a[220:223], v[56:59], v[24:27]
    v_mfma_f32_16x16x32_bf16 v[28:31], a[220:223], v[60:63], v[28:31]
    v_mfma_f32_16x16x32_bf16 v[32:35], v[56:59], v[156:159], v[32:35]
    v_mfma_f32_16x16x32_bf16 v[36:39], v[60:63], v[156:159], v[36:39]
    v_mfma_f32_16x16x32_bf16 v[40:43], v[56:59], v[220:223], v[40:43]
    v_mfma_f32_16x16x32_bf16 v[44:47], v[60:63], v[220:223], v[44:47]
    s_waitcnt lgkmcnt(0)
    v_mfma_f32_16x16x32_bf16 v[16:19], a[160:163], v[48:51], v[16:19]
    ds_read_b128 v[56:59], v119 offset:9216
    v_mfma_f32_16x16x32_bf16 v[20:23], a[160:163], v[52:55], v[20:23]
    ds_read_b128 v[60:63], v119 offset:25600
    v_mfma_f32_16x16x32_bf16 v[24:27], a[224:227], v[48:51], v[24:27]
    v_mfma_f32_16x16x32_bf16 v[28:31], a[224:227], v[52:55], v[28:31]
    v_mfma_f32_16x16x32_bf16 v[32:35], v[48:51], v[160:163], v[32:35]
    v_mfma_f32_16x16x32_bf16 v[36:39], v[52:55], v[160:163], v[36:39]
    v_mfma_f32_16x16x32_bf16 v[40:43], v[48:51], v[224:227], v[40:43]
    v_mfma_f32_16x16x32_bf16 v[44:47], v[52:55], v[224:227], v[44:47]
    s_waitcnt lgkmcnt(0)
    v_mfma_f32_16x16x32_bf16 v[16:19], a[164:167], v[56:59], v[16:19]
    ds_read_b128 v[48:51], v119 offset:10240
    v_mfma_f32_16x16x32_bf16 v[20:23], a[164:167], v[60:63], v[20:23]
    ds_read_b128 v[52:55], v119 offset:26624
    v_mfma_f32_16x16x32_bf16 v[24:27], a[228:231], v[56:59], v[24:27]
    v_mfma_f32_16x16x32_bf16 v[28:31], a[228:231], v[60:63], v[28:31]
    v_mfma_f32_16x16x32_bf16 v[32:35], v[56:59], v[164:167], v[32:35]
    v_mfma_f32_16x16x32_bf16 v[36:39], v[60:63], v[164:167], v[36:39]
    v_mfma_f32_16x16x32_bf16 v[40:43], v[56:59], v[228:231], v[40:43]
    v_mfma_f32_16x16x32_bf16 v[44:47], v[60:63], v[228:231], v[44:47]
    s_waitcnt lgkmcnt(0)
    v_mfma_f32_16x16x32_bf16 v[16:19], a[168:171], v[48:51], v[16:19]
    ds_read_b128 v[56:59], v119 offset:11264
    v_mfma_f32_16x16x32_bf16 v[20:23], a[168:171], v[52:55], v[20:23]
    ds_read_b128 v[60:63], v119 offset:27648
    v_mfma_f32_16x16x32_bf16 v[24:27], a[232:235], v[48:51], v[24:27]
    v_mfma_f32_16x16x32_bf16 v[28:31], a[232:235], v[52:55], v[28:31]
    v_mfma_f32_16x16x32_bf16 v[32:35], v[48:51], v[168:171], v[32:35]
    v_mfma_f32_16x16x32_bf16 v[36:39], v[52:55], v[168:171], v[36:39]
    v_mfma_f32_16x16x32_bf16 v[40:43], v[48:51], v[232:235], v[40:43]
    v_mfma_f32_16x16x32_bf16 v[44:47], v[52:55], v[232:235], v[44:47]
    s_waitcnt lgkmcnt(0)
    v_mfma_f32_16x16x32_bf16 v[16:19], a[172:175], v[56:59], v[16:19]
    ds_read_b128 v[48:51], v119 offset:12288
    v_mfma_f32_16x16x32_bf16 v[20:23], a[172:175], v[60:63], v[20:23]
    ds_read_b128 v[52:55], v119 offset:28672
    v_mfma_f32_16x16x32_bf16 v[24:27], a[236:239], v[56:59], v[24:27]
    v_mfma_f32_16x16x32_bf16 v[28:31], a[236:239], v[60:63], v[28:31]
    v_mfma_f32_16x16x32_bf16 v[32:35], v[56:59], v[172:175], v[32:35]
    v_mfma_f32_16x16x32_bf16 v[36:39], v[60:63], v[172:175], v[36:39]
    v_mfma_f32_16x16x32_bf16 v[40:43], v[56:59], v[236:239], v[40:43]
    v_mfma_f32_16x16x32_bf16 v[44:47], v[60:63], v[236:239], v[44:47]
    s_waitcnt lgkmcnt(0)
    v_mfma_f32_16x16x32_bf16 v[16:19], a[176:179], v[48:51], v[16:19]
    ds_read_b128 v[56:59], v119 offset:13312
    v_mfma_f32_16x16x32_bf16 v[20:23], a[176:179], v[52:55], v[20:23]
    ds_read_b128 v[60:63], v119 offset:29696
    v_mfma_f32_16x16x32_bf16 v[24:27], a[240:243], v[48:51], v[24:27]
    v_mfma_f32_16x16x32_bf16 v[28:31], a[240:243], v[52:55], v[28:31]
    v_mfma_f32_16x16x32_bf16 v[32:35], v[48:51], v[176:179], v[32:35]
    v_mfma_f32_16x16x32_bf16 v[36:39], v[52:55], v[176:179], v[36:39]
    v_mfma_f32_16x16x32_bf16 v[40:43], v[48:51], v[240:243], v[40:43]
    v_mfma_f32_16x16x32_bf16 v[44:47], v[52:55], v[240:243], v[44:47]
    s_waitcnt lgkmcnt(0)
    v_mfma_f32_16x16x32_bf16 v[16:19], a[180:183], v[56:59], v[16:19]
    ds_read_b128 v[48:51], v119 offset:14336
    v_mfma_f32_16x16x32_bf16 v[20:23], a[180:183], v[60:63], v[20:23]
    ds_read_b128 v[52:55], v119 offset:30720
    v_mfma_f32_16x16x32_bf16 v[24:27], a[244:247], v[56:59], v[24:27]
    v_mfma_f32_16x16x32_bf16 v[28:31], a[244:247], v[60:63], v[28:31]
    v_mfma_f32_16x16x32_bf16 v[32:35], v[56:59], v[180:183], v[32:35]
    v_mfma_f32_16x16x32_bf16 v[36:39], v[60:63], v[180:183], v[36:39]
    v_mfma_f32_16x16x32_bf16 v[40:43], v[56:59], v[244:247], v[40:43]
    v_mfma_f32_16x16x32_bf16 v[44:47], v[60:63], v[244:247], v[44:47]
    s_waitcnt lgkmcnt(0)
    v_mfma_f32_16x16x32_bf16 v[16:19], a[184:187], v[48:51], v[16:19]
    ds_read_b128 v[56:59], v119 offset:15360
    v_mfma_f32_16x16x32_bf16 v[20:23], a[184:187], v[52:55], v[20:23]
    ds_read_b128 v[60:63], v119 offset:31744
    v_mfma_f32_16x16x32_bf16 v[24:27], a[248:251], v[48:51], v[24:27]
    v_mfma_f32_16x16x32_bf16 v[28:31], a[248:251], v[52:55], v[28:31]
    v_mfma_f32_16x16x32_bf16 v[32:35], v[48:51], v[184:187], v[32:35]
    v_mfma_f32_16x16x32_bf16 v[36:39], v[52:55], v[184:187], v[36:39]
    v_mfma_f32_16x16x32_bf16 v[40:43], v[48:51], v[248:251], v[40:43]
    v_mfma_f32_16x16x32_bf16 v[44:47], v[52:55], v[248:251], v[44:47]
    s_waitcnt lgkmcnt(0)
    v_mfma_f32_16x16x32_bf16 v[16:19], a[188:191], v[56:59], v[16:19]
    v_mfma_f32_16x16x32_bf16 v[20:23], a[188:191], v[60:63], v[20:23]
    v_mfma_f32_16x16x32_bf16 v[24:27], a[252:255], v[56:59], v[24:27]
    v_mfma_f32_16x16x32_bf16 v[28:31], a[252:255], v[60:63], v[28:31]
    v_mfma_f32_16x16x32_bf16 v[32:35], v[56:59], v[188:191], v[32:35]
    v_mfma_f32_16x16x32_bf16 v[36:39], v[60:63], v[188:191], v[36:39]
    v_mfma_f32_16x16x32_bf16 v[40:43], v[56:59], v[252:255], v[40:43]
    v_mfma_f32_16x16x32_bf16 v[44:47], v[60:63], v[252:255], v[44:47]
    v_cvt_pk_bf16_f32 v64, v16, v17
    v_cvt_pk_bf16_f32 v65, v18, v19
    v_cvt_pk_bf16_f32 v66, v24, v25
    v_cvt_pk_bf16_f32 v67, v26, v27
    buffer_store_dwordx4 v[64:67], v112, s[4:7], s35 offen offset:0 sc1
    v_cvt_pk_bf16_f32 v68, v20, v21
    v_cvt_pk_bf16_f32 v69, v22, v23
    v_cvt_pk_bf16_f32 v70, v28, v29
    v_cvt_pk_bf16_f32 v71, v30, v31
    buffer_store_dwordx4 v[68:71], v112, s[4:7], s35 offen offset:1024 sc1
    v_cvt_pk_bf16_f32 v80, v32, v33
    v_cvt_pk_bf16_f32 v81, v34, v35
    v_cvt_pk_bf16_f32 v82, v36, v37
    v_cvt_pk_bf16_f32 v83, v38, v39
    buffer_store_dwordx4 v[80:83], v112, s[4:7], s35 offen offset:2048 sc1
    v_cvt_pk_bf16_f32 v84, v40, v41
    v_cvt_pk_bf16_f32 v85, v42, v43
    v_cvt_pk_bf16_f32 v86, v44, v45
    v_cvt_pk_bf16_f32 v87, v46, v47
    buffer_store_dwordx4 v[84:87], v112, s[4:7], s35 offen offset:3072 sc1
    s_waitcnt vmcnt(24) lgkmcnt(0)
    s_barrier
    v_add_u32 v117, 0x4000, v115
    v_add_u32 v118, 0x4000, v116
    ds_read_b64_tr_b16 a[8:9], v117 offset:0
    ds_read_b64_tr_b16 a[10:11], v117 offset:1024
    ds_read_b64_tr_b16 a[12:13], v117 offset:8192
    ds_read_b64_tr_b16 a[14:15], v117 offset:9216
    ds_read_b64_tr_b16 a[72:73], v118 offset:0
    ds_read_b64_tr_b16 a[74:75], v118 offset:1024
    ds_read_b64_tr_b16 a[76:77], v118 offset:8192
    ds_read_b64_tr_b16 a[78:79], v118 offset:9216
    s_waitcnt vmcnt(20) lgkmcnt(0)
    s_barrier
    v_add_u32 v117, 0x8000, v115
    v_add_u32 v118, 0x8000, v116
    ds_read_b64_tr_b16 a[16:17], v117 offset:0
    ds_read_b64_tr_b16 a[18:19], v117 offset:1024
    ds_read_b64_tr_b16 a[20:21], v117 offset:8192
    ds_read_b64_tr_b16 a[22:23], v117 offset:9216
    ds_read_b64_tr_b16 a[80:81], v118 offset:0
    ds_read_b64_tr_b16 a[82:83], v118 offset:1024
    ds_read_b64_tr_b16 a[84:85], v118 offset:8192
    ds_read_b64_tr_b16 a[86:87], v118 offset:9216
    s_waitcnt vmcnt(16) lgkmcnt(0)
    s_barrier
    v_add_u32 v117, 0xc000, v115
    v_add_u32 v118, 0xc000, v116
    ds_read_b64_tr_b16 a[24:25], v117 offset:0
    ds_read_b64_tr_b16 a[26:27], v117 offset:1024
    ds_read_b64_tr_b16 a[28:29], v117 offset:8192
    ds_read_b64_tr_b16 a[30:31], v117 offset:9216
    ds_read_b64_tr_b16 a[88:89], v118 offset:0
    ds_read_b64_tr_b16 a[90:91], v118 offset:1024
    ds_read_b64_tr_b16 a[92:93], v118 offset:8192
    ds_read_b64_tr_b16 a[94:95], v118 offset:9216
    s_waitcnt vmcnt(12) lgkmcnt(0)
    s_barrier
    v_add_u32 v117, 0x10000, v115
    v_add_u32 v118, 0x10000, v116
    ds_read_b64_tr_b16 a[32:33], v117 offset:0
    ds_read_b64_tr_b16 a[34:35], v117 offset:1024
    ds_read_b64_tr_b16 a[36:37], v117 offset:8192
    ds_read_b64_tr_b16 a[38:39], v117 offset:9216
    ds_read_b64_tr_b16 a[96:97], v118 offset:0
    ds_read_b64_tr_b16 a[98:99], v118 offset:1024
    ds_read_b64_tr_b16 a[100:101], v118 offset:8192
    ds_read_b64_tr_b16 a[102:103], v118 offset:9216
    s_waitcnt vmcnt(8) lgkmcnt(0)
    s_barrier
    v_add_u32 v117, 0x14000, v115
    v_add_u32 v118, 0x14000, v116
    ds_read_b64_tr_b16 a[40:41], v117 offset:0
    ds_read_b64_tr_b16 a[42:43], v117 offset:1024
    ds_read_b64_tr_b16 a[44:45], v117 offset:8192
    ds_read_b64_tr_b16 a[46:47], v117 offset:9216
    ds_read_b64_tr_b16 a[104:105], v118 offset:0
    ds_read_b64_tr_b16 a[106:107], v118 offset:1024
    ds_read_b64_tr_b16 a[108:109], v118 offset:8192
    ds_read_b64_tr_b16 a[110:111], v118 offset:9216
    s_waitcnt vmcnt(4) lgkmcnt(0)
    s_barrier
    v_add_u32 v117, 0x18000, v115
    v_add_u32 v118, 0x18000, v116
    ds_read_b64_tr_b16 a[48:49], v117 offset:0
    ds_read_b64_tr_b16 a[50:51], v117 offset:1024
    ds_read_b64_tr_b16 a[52:53], v117 offset:8192
    ds_read_b64_tr_b16 a[54:55], v117 offset:9216
    ds_read_b64_tr_b16 a[112:113], v118 offset:0
    ds_read_b64_tr_b16 a[114:115], v118 offset:1024
    ds_read_b64_tr_b16 a[116:117], v118 offset:8192
    ds_read_b64_tr_b16 a[118:119], v118 offset:9216
    s_waitcnt vmcnt(0) lgkmcnt(0)
    s_barrier
    v_add_u32 v117, 0x1c000, v115
    v_add_u32 v118, 0x1c000, v116
    ds_read_b64_tr_b16 a[56:57], v117 offset:0
    ds_read_b64_tr_b16 a[58:59], v117 offset:1024
    ds_read_b64_tr_b16 a[60:61], v117 offset:8192
    ds_read_b64_tr_b16 a[62:63], v117 offset:9216
    ds_read_b64_tr_b16 a[120:121], v118 offset:0
    ds_read_b64_tr_b16 a[122:123], v118 offset:1024
    ds_read_b64_tr_b16 a[124:125], v118 offset:8192
    ds_read_b64_tr_b16 a[126:127], v118 offset:9216
    s_waitcnt lgkmcnt(0)
    s_barrier
L_GINI:
    v_readfirstlane_b32 s30, v124
    s_nop 0
    s_cmp_ge_u32 s30, 32
    s_cbranch_scc1 L_GINI2
    buffer_load_dword v124, off, s[12:15], 0 offset:32 sc1
    s_waitcnt vmcnt(0)
    s_sub_u32 s24, s24, 1
    s_cbranch_scc1 L_ABORT
    s_branch L_GINI
L_GINI2:
    s_cmp_ge_u32 s25, 116
    s_cbranch_scc1 L_GNOF
    s_cmp_lg_u32 s20, 0
    s_cbranch_scc1 L_GNOF
    s_add_u32 s30, s25, 12
    s_lshr_b32 s31, s30, 2
    s_lshl_b32 s31, s31, 10
    s_and_b32 s82, s30, 2
    s_lshl_b32 s82, s82, 5
    s_add_u32 s31, s31, s82
    s_and_b32 s82, s30, 1
    s_lshl_b32 s82, s82, 2
    s_add_u32 s31, s31, s82
    s_add_u32 s31, s31, 0x5600000
    v_mov_b32 v1, 1
    s_mov_b64 exec, 1
    buffer_store_dword v1, off, s[4:7], s31 sc1
    s_mov_b64 exec, -1
L_GNOF:
    v_min_u32 v1, 9, v0
    v_mul_u32_u24 v1, 6, v1
    s_add_u32 s30, s27, 6
    v_add_u32 v1, s30, v1
    v_cmp_lt_u32 vcc, 63, v1
    v_subrev_u32 v2, 6, v1
    s_nop 0
    v_cndmask_b32 v1, v1, v2, vcc
    v_lshrrev_b32 v2, 1, v1
    v_lshlrev_b32 v2, 10, v2
    v_and_b32 v1, 1, v1
    v_lshl_add_u32 v124, v1, 6, v2
    s_mov_b32 s82, 0x5600000
    buffer_load_dwordx2 v[122:123], v124, s[4:7], s82 offen sc1
    v_add_u32 v119, 0x20000, v112
    s_mov_b32 s29, 0
    s_mov_b32 s32, 0
    s_lshl_b32 s30, s27, 5
    s_add_u32 s30, s30, s26
    s_lshl_b32 s34, s30, 13
    s_lshl_b32 s35, s30, 14
    s_lshl_b32 s31, s20, 10
    s_add_u32 s34, s34, s31
    s_add_u32 s34, s34, 0x200000
    s_add_u32 s35, s35, s33
    s_add_u32 s35, s35, 0x1200000
    s_lshl_b32 s30, s26, 10
    s_lshl_b32 s31, s27, 4
    s_add_u32 s30, s30, s31
    s_lshl_b32 s31, s20, 2
    s_add_u32 s30, s30, s31
    s_add_u32 s66, s30, 0x5600080
    s_add_u32 s30, s27, 6
    s_lshl_b32 s67, s30, 15
    s_lshl_b32 s31, s20, 13
    s_add_u32 s67, s67, s31
    s_mov_b32 s69, s31
    v_mov_b32 v1, 1
    s_mov_b64 exec, 1
    buffer_store_dword v1, off, s[4:7], s66 sc1
    s_mov_b64 exec, -1
L_GSEG:
    ds_read_b128 v[48:51], v119 offset:0
    ds_read_b128 v[52:55], v119 offset:16384
    s_waitcnt lgkmcnt(0)
    v_mfma_f32_16x16x32_bf16 v[0:3], a[0:3], v[48:51], 0
    ds_read_b128 v[56:59], v119 offset:1024
    v_mfma_f32_16x16x32_bf16 v[4:7], a[0:3], v[52:55], 0
    ds_read_b128 v[60:63], v119 offset:17408
    v_mfma_f32_16x16x32_bf16 v[8:11], a[64:67], v[48:51], 0
    v_mfma_f32_16x16x32_bf16 v[12:15], a[64:67], v[52:55], 0
    v_mfma_f32_16x16x32_bf16 v[16:19], a[128:131], v[48:51], 0
    v_mfma_f32_16x16x32_bf16 v[20:23], a[128:131], v[52:55], 0
    v_mfma_f32_16x16x32_bf16 v[24:27], a[192:195], v[48:51], 0
    v_mfma_f32_16x16x32_bf16 v[28:31], a[192:195], v[52:55], 0
    v_mfma_f32_16x16x32_bf16 v[32:35], v[48:51], v[128:131], 0
    v_mfma_f32_16x16x32_bf16 v[36:39], v[52:55], v[128:131], 0
    v_mfma_f32_16x16x32_bf16 v[40:43], v[48:51], v[192:195], 0
    v_mfma_f32_16x16x32_bf16 v[44:47], v[52:55], v[192:195], 0
    s_waitcnt lgkmcnt(0)
    v_mfma_f32_16x16x32_bf16 v[0:3], a[4:7], v[56:59], v[0:3]
    ds_read_b128 v[48:51], v119 offset:2048
    v_mfma_f32_16x16x32_bf16 v[4:7], a[4:7], v[60:63], v[4:7]
    ds_read_b128 v[52:55], v119 offset:18432
    s_add_u32 s30, s29, 1
    s_cmp_ge_u32 s30, s28
    s_cbranch_scc1 L_GND
    s_cmp_eq_u32 s29, 0
    s_cbranch_scc1 L_GXF
L_GXF2:
    s_add_u32 m0, s69, 0
    v_mfma_f32_16x16x32_bf16 v[8:11], a[68:71], v[56:59], v[8:11]
    buffer_load_dwordx4 v112, s[4:7], s67 offen sc1 lds
    s_add_u32 s67, s67, 1024
    s_add_u32 m0, s69, 1024
    v_mfma_f32_16x16x32_bf16 v[12:15], a[68:71], v[60:63], v[12:15]
    buffer_load_dwordx4 v112, s[4:7], s67 offen sc1 lds
    s_add_u32 s67, s67, 1024
    s_add_u32 m0, s69, 2048
    v_mfma_f32_16x16x32_bf16 v[16:19], a[132:135], v[56:59], v[16:19]
    buffer_load_dwordx4 v112, s[4:7], s67 offen sc1 lds
    s_add_u32 s67, s67, 1024
    s_add_u32 m0, s69, 3072
    v_mfma_f32_16x16x32_bf16 v[20:23], a[132:135], v[60:63], v[20:23]
    buffer_load_dwordx4 v112, s[4:7], s67 offen sc1 lds
    s_add_u32 s67, s67, 1024
    s_add_u32 m0, s69, 4096
    v_mfma_f32_16x16x32_bf16 v[24:27], a[196:199], v[56:59], v[24:27]
    buffer_load_dwordx4 v112, s[4:7], s67 offen sc1 lds
    s_add_u32 s67, s67, 1024
    s_add_u32 m0, s69, 5120
    v_mfma_f32_16x16x32_bf16 v[28:31], a[196:199], v[60:63], v[28:31]
    buffer_load_dwordx4 v112, s[4:7], s67 offen sc1 lds
    s_add_u32 s67, s67, 1024
    s_add_u32 m0, s69, 6144
    v_mfma_f32_16x16x32_bf16 v[32:35], v[56:59], v[132:135], v[32:35]
    buffer_load_dwordx4 v112, s[4:7], s67 offen sc1 lds
    s_add_u32 s67, s67, 1024
    s_add_u32 m0, s69, 7168
    v_mfma_f32_16x16x32_bf16 v[36:39], v[60:63], v[132:135], v[36:39]
    buffer_load_dwordx4 v112, s[4:7], s67 offen sc1 lds
    s_add_u32 s67, s67, 1024
L_GND2:
    v_mfma_f32_16x16x32_bf16 v[40:43], v[56:59], v[196:199], v[40:43]
    v_mfma_f32_16x16x32_bf16 v[44:47], v[60:63], v[196:199], v[44:47]
    s_cmp_le_u32 s29, 1
    s_waitcnt lgkmcnt(0)
    v_mfma_f32_16x16x32_bf16 v[0:3], a[8:11], v[48:51], v[0:3]
    ds_read_b128 v[56:59], v119 offset:3072
    v_mfma_f32_16x16x32_bf16 v[4:7], a[8:11], v[52:55], v[4:7]
    ds_read_b128 v[60:63], v119 offset:19456
    v_mfma_f32_16x16x32_bf16 v[8:11], a[72:75], v[48:51], v[8:11]
    v_mfma_f32_16x16x32_bf16 v[12:15], a[72:75], v[52:55], v[12:15]
    v_mfma_f32_16x16x32_bf16 v[16:19], a[136:139], v[48:51], v[16:19]
    s_cbranch_scc1 L_GS2
    buffer_store_dwordx4 v[64:67], v112, s[4:7], s35 offen offset:0 sc1
L_GS2:
    v_mfma_f32_16x16x32_bf16 v[20:23], a[136:139], v[52:55], v[20:23]
    v_mfma_f32_16x16x32_bf16 v[24:27], a[200:203], v[48:51], v[24:27]
    v_mfma_f32_16x16x32_bf16 v[28:31], a[200:203], v[52:55], v[28:31]
    v_mfma_f32_16x16x32_bf16 v[32:35], v[48:51], v[136:139], v[32:35]
    v_mfma_f32_16x16x32_bf16 v[36:39], v[52:55], v[136:139], v[36:39]
    v_mfma_f32_16x16x32_bf16 v[40:43], v[48:51], v[200:203], v[40:43]
    v_mfma_f32_16x16x32_bf16 v[44:47], v[52:55], v[200:203], v[44:47]
    s_waitcnt lgkmcnt(0)
    v_mfma_f32_16x16x32_bf16 v[0:3], a[12:15], v[56:59], v[0:3]
    ds_read_b128 v[48:51], v119 offset:4096
    v_mfma_f32_16x16x32_bf16 v[4:7], a[12:15], v[60:63], v[4:7]
    ds_read_b128 v[52:55], v119 offset:20480
    v_mfma_f32_16x16x32_bf16 v[8:11], a[76:79], v[56:59], v[8:11]
    v_mfma_f32_16x16x32_bf16 v[12:15], a[76:79], v[60:63], v[12:15]
    v_mfma_f32_16x16x32_bf16 v[16:19], a[140:143], v[56:59], v[16:19]
    s_cbranch_scc1 L_GS3
    buffer_store_dwordx4 v[68:71], v112, s[4:7], s35 offen offset:1024 sc1
L_GS3:
    v_mfma_f32_16x16x32_bf16 v[20:23], a[140:143], v[60:63], v[20:23]
    v_mfma_f32_16x16x32_bf16 v[24:27], a[204:207], v[56:59], v[24:27]
    v_mfma_f32_16x16x32_bf16 v[28:31], a[204:207], v[60:63], v[28:31]
    v_mfma_f32_16x16x32_bf16 v[32:35], v[56:59], v[140:143], v[32:35]
    v_mfma_f32_16x16x32_bf16 v[36:39], v[60:63], v[140:143], v[36:39]
    v_mfma_f32_16x16x32_bf16 v[40:43], v[56:59], v[204:207], v[40:43]
    v_mfma_f32_16x16x32_bf16 v[44:47], v[60:63], v[204:207], v[44:47]
    s_waitcnt lgkmcnt(0)
    v_mfma_f32_16x16x32_bf16 v[0:3], a[16:19], v[48:51], v[0:3]
    ds_read_b128 v[56:59], v119 offset:5120
    v_mfma_f32_16x16x32_bf16 v[4:7], a[16:19], v[52:55], v[4:7]
    ds_read_b128 v[60:63], v119 offset:21504
    v_mfma_f32_16x16x32_bf16 v[8:11], a[80:83], v[48:51], v[8:11]
    v_mfma_f32_16x16x32_bf16 v[12:15], a[80:83], v[52:55], v[12:15]
    v_mfma_f32_16x16x32_bf16 v[16:19], a[144:147], v[48:51], v[16:19]
    s_cbranch_scc1 L_GS4
    buffer_store_dwordx4 v[80:83], v112, s[4:7], s35 offen offset:2048 sc1
L_GS4:
    v_mfma_f32_16x16x32_bf16 v[20:23], a[144:147], v[52:55], v[20:23]
    v_mfma_f32_16x16x32_bf16 v[24:27], a[208:211], v[48:51], v[24:27]
    v_mfma_f32_16x16x32_bf16 v[28:31], a[208:211], v[52:55], v[28:31]
    v_mfma_f32_16x16x32_bf16 v[32:35], v[48:51], v[144:147], v[32:35]
    v_mfma_f32_16x16x32_bf16 v[36:39], v[52:55], v[144:147], v[36:39]
    v_mfma_f32_16x16x32_bf16 v[40:43], v[48:51], v[208:211], v[40:43]
    v_mfma_f32_16x16x32_bf16 v[44:47], v[52:55], v[208:211], v[44:47]
    s_waitcnt lgkmcnt(0)
    v_mfma_f32_16x16x32_bf16 v[0:3], a[20:23], v[56:59], v[0:3]
    ds_read_b128 v[48:51], v119 offset:6144
    v_mfma_f32_16x16x32_bf16 v[4:7], a[20:23], v[60:63], v[4:7]
    ds_read_b128 v[52:55], v119 offset:22528
    v_mfma_f32_16x16x32_bf16 v[8:11], a[84:87], v[56:59], v[8:11]
    v_mfma_f32_16x16x32_bf16 v[12:15], a[84:87], v[60:63], v[12:15]
    v_mfma_f32_16x16x32_bf16 v[16:19], a[148:151], v[56:59], v[16:19]
    s_cbranch_scc1 L_GS5
    buffer_store_dwordx4 v[84:87], v112, s[4:7], s35 offen offset:3072 sc1
L_GS5:
    s_cmp_eq_u32 s29, 0
    v_mfma_f32_16x16x32_bf16 v[20:23], a[148:151], v[60:63], v[20:23]
    v_mfma_f32_16x16x32_bf16 v[24:27], a[212:215], v[56:59], v[24:27]
    v_mfma_f32_16x16x32_bf16 v[28:31], a[212:215], v[60:63], v[28:31]
    v_mfma_f32_16x16x32_bf16 v[32:35], v[56:59], v[148:151], v[32:35]
    v_mfma_f32_16x16x32_bf16 v[36:39], v[60:63], v[148:151], v[36:39]
    v_mfma_f32_16x16x32_bf16 v[40:43], v[56:59], v[212:215], v[40:43]
    v_mfma_f32_16x16x32_bf16 v[44:47], v[60:63], v[212:215], v[44:47]
    s_waitcnt lgkmcnt(0)
    v_mfma_f32_16x16x32_bf16 v[0:3], a[24:27], v[48:51], v[0:3]
    ds_read_b128 v[56:59], v119 offset:7168
    v_mfma_f32_16x16x32_bf16 v[4:7], a[24:27], v[52:55], v[4:7]
    ds_read_b128 v[60:63], v119 offset:23552
    v_mfma_f32_16x16x32_bf16 v[8:11], a[88:91], v[48:51], v[8:11]
    v_mfma_f32_16x16x32_bf16 v[12:15], a[88:91], v[52:55], v[12:15]
    v_mfma_f32_16x16x32_bf16 v[16:19], a[152:155], v[48:51], v[16:19]
    s_cbranch_scc1 L_GS6
    buffer_store_dwordx4 v[72:75], v112, s[4:7], s34 offen offset:0 sc1
L_GS6:
    v_mfma_f32_16x16x32_bf16 v[20:23], a[152:155], v[52:55], v[20:23]
    v_mfma_f32_16x16x32_bf16 v[24:27], a[216:219], v[48:51], v[24:27]
    v_mfma_f32_16x16x32_bf16 v[28:31], a[216:219], v[52:55], v[28:31]
    v_mfma_f32_16x16x32_bf16 v[32:35], v[48:51], v[152:155], v[32:35]
    v_mfma_f32_16x16x32_bf16 v[36:39], v[52:55], v[152:155], v[36:39]
    v_mfma_f32_16x16x32_bf16 v[40:43], v[48:51], v[216:219], v[40:43]
    v_mfma_f32_16x16x32_bf16 v[44:47], v[52:55], v[216:219], v[44:47]
    s_waitcnt lgkmcnt(0)
    v_mfma_f32_16x16x32_bf16 v[0:3], a[28:31], v[56:59], v[0:3]
    ds_read_b128 v[48:51], v119 offset:8192
    v_mfma_f32_16x16x32_bf16 v[4:7], a[28:31], v[60:63], v[4:7]
    ds_read_b128 v[52:55], v119 offset:24576
    v_mfma_f32_16x16x32_bf16 v[8:11], a[92:95], v[56:59], v[8:11]
    v_mfma_f32_16x16x32_bf16 v[12:15], a[92:95], v[60:63], v[12:15]
    v_mfma_f32_16x16x32_bf16 v[16:19], a[156:159], v[56:59], v[16:19]
    s_cbranch_scc1 L_GS7
    buffer_store_dwordx4 v[76:79], v112, s[4:7], s83 offen offset:0 sc1
L_GS7:
    v_mfma_f32_16x16x32_bf16 v[20:23], a[156:159], v[60:63], v[20:23]
    v_mfma_f32_16x16x32_bf16 v[24:27], a[220:223], v[56:59], v[24:27]
    v_mfma_f32_16x16x32_bf16 v[28:31], a[220:223], v[60:63], v[28:31]
    v_mfma_f32_16x16x32_bf16 v[32:35], v[56:59], v[156:159], v[32:35]
    v_mfma_f32_16x16x32_bf16 v[36:39], v[60:63], v[156:159], v[36:39]
    v_mfma_f32_16x16x32_bf16 v[40:43], v[56:59], v[220:223], v[40:43]
    v_mfma_f32_16x16x32_bf16 v[44:47], v[60:63], v[220:223], v[44:47]
    s_waitcnt lgkmcnt(0)
    v_mfma_f32_16x16x32_bf16 v[0:3], a[32:35], v[48:51], v[0:3]
    ds_read_b128 v[56:59], v119 offset:9216
    v_mfma_f32_16x16x32_bf16 v[4:7], a[32:35], v[52:55], v[4:7]
    ds_read_b128 v[60:63], v119 offset:25600
    v_mfma_f32_16x16x32_bf16 v[8:11], a[96:99], v[48:51], v[8:11]
    v_mfma_f32_16x16x32_bf16 v[12:15], a[96:99], v[52:55], v[12:15]
    v_mfma_f32_16x16x32_bf16 v[16:19], a[160:163], v[48:51], v[16:19]
    v_mfma_f32_16x16x32_bf16 v[20:23], a[160:163], v[52:55], v[20:23]
    v_mfma_f32_16x16x32_bf16 v[24:27], a[224:227], v[48:51], v[24:27]
    v_mfma_f32_16x16x32_bf16 v[28:31], a[224:227], v[52:55], v[28:31]
    v_mfma_f32_16x16x32_bf16 v[32:35], v[48:51], v[160:163], v[32:35]
    v_mfma_f32_16x16x32_bf16 v[36:39], v[52:55], v[160:163], v[36:39]
    v_mfma_f32_16x16x32_bf16 v[40:43], v[48:51], v[224:227], v[40:43]
    v_mfma_f32_16x16x32_bf16 v[44:47], v[52:55], v[224:227], v[44:47]
    s_waitcnt lgkmcnt(0)
    v_mfma_f32_16x16x32_bf16 v[0:3], a[36:39], v[56:59], v[0:3]
    ds_read_b128 v[48:51], v119 offset:10240
    v_mfma_f32_16x16x32_bf16 v[4:7], a[36:39], v[60:63], v[4:7]
    ds_read_b128 v[52:55], v119 offset:26624
    v_mfma_f32_16x16x32_bf16 v[8:11], a[100:103], v[56:59], v[8:11]
    v_mfma_f32_16x16x32_bf16 v[12:15], a[100:103], v[60:63], v[12:15]
    v_mfma_f32_16x16x32_bf16 v[16:19], a[164:167], v[56:59], v[16:19]
    v_mfma_f32_16x16x32_bf16 v[20:23], a[164:167], v[60:63], v[20:23]
    v_mfma_f32_16x16x32_bf16 v[24:27], a[228:231], v[56:59], v[24:27]
    v_mfma_f32_16x16x32_bf16 v[28:31], a[228:231], v[60:63], v[28:31]
    v_mfma_f32_16x16x32_bf16 v[32:35], v[56:59], v[164:167], v[32:35]
    v_mfma_f32_16x16x32_bf16 v[36:39], v[60:63], v[164:167], v[36:39]
    v_mfma_f32_16x16x32_bf16 v[40:43], v[56:59], v[228:231], v[40:43]
    v_mfma_f32_16x16x32_bf16 v[44:47], v[60:63], v[228:231], v[44:47]
    s_waitcnt lgkmcnt(0)
    v_mfma_f32_16x16x32_bf16 v[0:3], a[40:43], v[48:51], v[0:3]
    ds_read_b128 v[56:59], v119 offset:11264
    v_mfma_f32_16x16x32_bf16 v[4:7], a[40:43], v[52:55], v[4:7]
    ds_read_b128 v[60:63], v119 offset:27648
    v_mfma_f32_16x16x32_bf16 v[8:11], a[104:107], v[48:51], v[8:11]
    v_mfma_f32_16x16x32_bf16 v[12:15], a[104:107], v[52:55], v[12:15]
    v_mfma_f32_16x16x32_bf16 v[16:19], a[168:171], v[48:51], v[16:19]
    v_mfma_f32_16x16x32_bf16 v[20:23], a[168:171], v[52:55], v[20:23]
    v_mfma_f32_16x16x32_bf16 v[24:27], a[232:235], v[48:51], v[24:27]
    v_mfma_f32_16x16x32_bf16 v[28:31], a[232:235], v[52:55], v[28:31]
    v_mfma_f32_16x16x32_bf16 v[32:35], v[48:51], v[168:171], v[32:35]
    v_mfma_f32_16x16x32_bf16 v[36:39], v[52:55], v[168:171], v[36:39]
    v_mfma_f32_16x16x32_bf16 v[40:43], v[48:51], v[232:235], v[40:43]
    v_mfma_f32_16x16x32_bf16 v[44:47], v[52:55], v[232:235], v[44:47]
    s_waitcnt lgkmcnt(0)
    v_mfma_f32_16x16x32_bf16 v[0:3], a[44:47], v[56:59], v[0:3]
    ds_read_b128 v[48:51], v119 offset:12288
    v_mfma_f32_16x16x32_bf16 v[4:7], a[44:47], v[60:63], v[4:7]
    ds_read_b128 v[52:55], v119 offset:28672
    v_mfma_f32_16x16x32_bf16 v[8:11], a[108:111], v[56:59], v[8:11]
    v_mfma_f32_16x16x32_bf16 v[12:15], a[108:111], v[60:63], v[12:15]
    v_mfma_f32_16x16x32_bf16 v[16:19], a[172:175], v[56:59], v[16:19]
    v_mfma_f32_16x16x32_bf16 v[20:23], a[172:175], v[60:63], v[20:23]
    v_mfma_f32_16x16x32_bf16 v[24:27], a[236:239], v[56:59], v[24:27]
    v_mfma_f32_16x16x32_bf16 v[28:31], a[236:239], v[60:63], v[28:31]
    v_mfma_f32_16x16x32_bf16 v[32:35], v[56:59], v[172:175], v[32:35]
    v_mfma_f32_16x16x32_bf16 v[36:39], v[60:63], v[172:175], v[36:39]
    v_mfma_f32_16x16x32_bf16 v[40:43], v[56:59], v[236:239], v[40:43]
    v_mfma_f32_16x16x32_bf16 v[44:47], v[60:63], v[236:239], v[44:47]
    s_waitcnt lgkmcnt(0)
    v_mfma_f32_16x16x32_bf16 v[0:3], a[48:51], v[48:51], v[0:3]
    ds_read_b128 v[56:59], v119 offset:13312
    v_mfma_f32_16x16x32_bf16 v[4:7], a[48:51], v[52:55], v[4:7]
    ds_read_b128 v[60:63], v119 offset:29696
    v_mfma_f32_16x16x32_bf16 v[8:11], a[112:115], v[48:51], v[8:11]
    s_waitcnt vmcnt(0)
    s_max_u32 s30, s29, 1
    v_mov_b32 v124, s30
    s_mov_b64 exec, 1
    buffer_store_dword v124, off, s[4:7], s66 sc1
    s_mov_b64 exec, -1
    v_mfma_f32_16x16x32_bf16 v[12:15], a[112:115], v[52:55], v[12:15]
    v_mfma_f32_16x16x32_bf16 v[16:19], a[176:179], v[48:51], v[16:19]
    v_mfma_f32_16x16x32_bf16 v[20:23], a[176:179], v[52:55], v[20:23]
    v_mfma_f32_16x16x32_bf16 v[24:27], a[240:243], v[48:51], v[24:27]
    v_mfma_f32_16x16x32_bf16 v[28:31], a[240:243], v[52:55], v[28:31]
    v_mfma_f32_16x16x32_bf16 v[32:35], v[48:51], v[176:179], v[32:35]
    v_mfma_f32_16x16x32_bf16 v[36:39], v[52:55], v[176:179], v[36:39]
    v_mfma_f32_16x16x32_bf16 v[40:43], v[48:51], v[240:243], v[40:43]
    v_mfma_f32_16x16x32_bf16 v[44:47], v[52:55], v[240:243], v[44:47]
    s_waitcnt lgkmcnt(0)
    v_mfma_f32_16x16x32_bf16 v[0:3], a[52:55], v[56:59], v[0:3]
    ds_read_b128 v[48:51], v119 offset:14336
    v_mfma_f32_16x16x32_bf16 v[4:7], a[52:55], v[60:63], v[4:7]
    ds_read_b128 v[52:55], v119 offset:30720
    v_mfma_f32_16x16x32_bf16 v[8:11], a[116:119], v[56:59], v[8:11]
    v_mfma_f32_16x16x32_bf16 v[12:15], a[116:119], v[60:63], v[12:15]
    v_mfma_f32_16x16x32_bf16 v[16:19], a[180:183], v[56:59], v[16:19]
    v_mfma_f32_16x16x32_bf16 v[20:23], a[180:183], v[60:63], v[20:23]
    v_mfma_f32_16x16x32_bf16 v[24:27], a[244:247], v[56:59], v[24:27]
    v_mfma_f32_16x16x32_bf16 v[28:31], a[244:247], v[60:63], v[28:31]
    v_mfma_f32_16x16x32_bf16 v[32:35], v[56:59], v[180:183], v[32:35]
    v_mfma_f32_16x16x32_bf16 v[36:39], v[60:63], v[180:183], v[36:39]
    v_mfma_f32_16x16x32_bf16 v[40:43], v[56:59], v[244:247], v[40:43]
    v_mfma_f32_16x16x32_bf16 v[44:47], v[60:63], v[244:247], v[44:47]
    s_waitcnt lgkmcnt(0)
    v_mfma_f32_16x16x32_bf16 v[0:3], a[56:59], v[48:51], v[0:3]
    ds_read_b128 v[56:59], v119 offset:15360
    v_mfma_f32_16x16x32_bf16 v[4:7], a[56:59], v[52:55], v[4:7]
    ds_read_b128 v[60:63], v119 offset:31744
    v_mfma_f32_16x16x32_bf16 v[8:11], a[120:123], v[48:51], v[8:11]
    v_mfma_f32_16x16x32_bf16 v[12:15], a[120:123], v[52:55], v[12:15]
    v_mfma_f32_16x16x32_bf16 v[16:19], a[184:187], v[48:51], v[16:19]
    v_mfma_f32_16x16x32_bf16 v[20:23], a[184:187], v[52:55], v[20:23]
    v_mfma_f32_16x16x32_bf16 v[24:27], a[248:251], v[48:51], v[24:27]
    v_mfma_f32_16x16x32_bf16 v[28:31], a[248:251], v[52:55], v[28:31]
    v_mfma_f32_16x16x32_bf16 v[32:35], v[48:51], v[184:187], v[32:35]
    v_mfma_f32_16x16x32_bf16 v[36:39], v[52:55], v[184:187], v[36:39]
    v_mfma_f32_16x16x32_bf16 v[40:43], v[48:51], v[248:251], v[40:43]
    v_mfma_f32_16x16x32_bf16 v[44:47], v[52:55], v[248:251], v[44:47]
    s_waitcnt lgkmcnt(0)
    v_mfma_f32_16x16x32_bf16 v[0:3], a[60:63], v[56:59], v[0:3]
    v_mfma_f32_16x16x32_bf16 v[4:7], a[60:63], v[60:63], v[4:7]
    v_mfma_f32_16x16x32_bf16 v[8:11], a[124:127], v[56:59], v[8:11]
    v_mfma_f32_16x16x32_bf16 v[12:15], a[124:127], v[60:63], v[12:15]
    v_mfma_f32_16x16x32_bf16 v[16:19], a[188:191], v[56:59], v[16:19]
    v_mfma_f32_16x16x32_bf16 v[20:23], a[188:191], v[60:63], v[20:23]
    v_mfma_f32_16x16x32_bf16 v[24:27], a[252:255], v[56:59], v[24:27]
    v_mfma_f32_16x16x32_bf16 v[28:31], a[252:255], v[60:63], v[28:31]
    v_mfma_f32_16x16x32_bf16 v[32:35], v[56:59], v[188:191], v[32:35]
    v_mfma_f32_16x16x32_bf16 v[36:39], v[60:63], v[188:191], v[36:39]
    v_mfma_f32_16x16x32_bf16 v[40:43], v[56:59], v[252:255], v[40:43]
    v_mfma_f32_16x16x32_bf16 v[44:47], v[60:63], v[252:255], v[44:47]
    s_cmp_eq_u32 s29, 0
    s_cselect_b32 s30, 0, 0x180000
    s_cselect_b32 s31, 0, 0x300000
    s_add_u32 s34, s34, s30
    s_add_u32 s35, s35, s31
    s_add_u32 s83, s34, 4096
    v_cvt_pk_bf16_f32 v72, v0, v1
    v_cvt_pk_bf16_f32 v73, v2, v3
    v_cvt_pk_bf16_f32 v74, v8, v9
    v_cvt_pk_bf16_f32 v75, v10, v11
    v_cvt_pk_bf16_f32 v76, v4, v5
    v_cvt_pk_bf16_f32 v77, v6, v7
    v_cvt_pk_bf16_f32 v78, v12, v13
    v_cvt_pk_bf16_f32 v79, v14, v15
    v_cvt_pk_bf16_f32 v64, v16, v17
    v_cvt_pk_bf16_f32 v65, v18, v19
    v_cvt_pk_bf16_f32 v66, v24, v25
    v_cvt_pk_bf16_f32 v67, v26, v27
    v_cvt_pk_bf16_f32 v68, v20, v21
    v_cvt_pk_bf16_f32 v69, v22, v23
    v_cvt_pk_bf16_f32 v70, v28, v29
    v_cvt_pk_bf16_f32 v71, v30, v31
    v_cvt_pk_bf16_f32 v80, v32, v33
    v_cvt_pk_bf16_f32 v81, v34, v35
    v_cvt_pk_bf16_f32 v82, v36, v37
    v_cvt_pk_bf16_f32 v83, v38, v39
    v_cvt_pk_bf16_f32 v84, v40, v41
    v_cvt_pk_bf16_f32 v85, v42, v43
    v_cvt_pk_bf16_f32 v86, v44, v45
    v_cvt_pk_bf16_f32 v87, v46, v47
    s_add_u32 s29, s29, 1
    s_add_u32 s67, s67, 0x2e000
    s_xor_b32 s69, s69, 0x20000
    v_xor_b32 v119, 0x20000, v119
    s_cmp_ge_u32 s29, s28
    s_cbranch_scc1 L_GFIN
    s_barrier
    s_branch L_GSEG
L_GND:
    v_mfma_f32_16x16x32_bf16 v[8:11], a[68:71], v[56:59], v[8:11]
    v_mfma_f32_16x16x32_bf16 v[12:15], a[68:71], v[60:63], v[12:15]
    v_mfma_f32_16x16x32_bf16 v[16:19], a[132:135], v[56:59], v[16:19]
    v_mfma_f32_16x16x32_bf16 v[20:23], a[132:135], v[60:63], v[20:23]
    v_mfma_f32_16x16x32_bf16 v[24:27], a[196:199], v[56:59], v[24:27]
    v_mfma_f32_16x16x32_bf16 v[28:31], a[196:199], v[60:63], v[28:31]
    v_mfma_f32_16x16x32_bf16 v[32:35], v[56:59], v[132:135], v[32:35]
    v_mfma_f32_16x16x32_bf16 v[36:39], v[60:63], v[132:135], v[36:39]
    s_branch L_GND2
L_GXF:
    s_waitcnt vmcnt(0)
    v_and_b32 v122, v122, v123
    v_cmp_eq_u32 vcc, 0, v122
    s_cbranch_vccz L_GXF2
    buffer_load_dwordx2 v[122:123], v124, s[4:7], s82 offen sc1
    s_sub_u32 s24, s24, 1
    s_cbranch_scc1 L_ABORT
    s_branch L_GXF
L_GFIN:
    buffer_store_dwordx4 v[64:67], v112, s[4:7], s35 offen offset:0 sc1
    buffer_store_dwordx4 v[68:71], v112, s[4:7], s35 offen offset:1024 sc1
    buffer_store_dwordx4 v[80:83], v112, s[4:7], s35 offen offset:2048 sc1
    buffer_store_dwordx4 v[84:87], v112, s[4:7], s35 offen offset:3072 sc1
    buffer_store_dwordx4 v[72:75], v112, s[4:7], s34 offen offset:0 sc1
    buffer_store_dwordx4 v[76:79], v112, s[4:7], s83 offen offset:0 sc1
    s_waitcnt vmcnt(0)
    v_mov_b32 v124, s29
    s_mov_b64 exec, 1
    buffer_store_dword v124, off, s[4:7], s66 sc1
    s_mov_b64 exec, -1
    s_cmp_eq_u32 s23, 7
    s_cbranch_scc0 L_ROLEA
    s_barrier
    v_lshrrev_b32 v0, 4, v112
    v_and_b32 v1, 2, v0
    v_cmp_ne_u32 vcc, 0, v1
    v_mov_b32 v2, 0x4444
    v_mov_b32 v3, 0xeeee
    v_cndmask_b32 v113, v2, v3, vcc
    v_and_b32 v3, 1, v0
    v_lshlrev_b32 v3, 4, v3
    v_mov_b32 v4, 0x3f80
    v_lshlrev_b32 v4, v3, v4
    v_lshrrev_b32 v5, 4, v0
    v_bfe_u32 v1, v0, 2, 2
    v_cmp_eq_u32 vcc, v1, v5
    s_nop 1
    v_cndmask_b32 v114, 0, v4, vcc
    v_cndmask_b32 v115, 0, v4, vcc
    v_mov_b64 v[120:121], 0
    s_lshl_b32 s30, s20, 11
    s_mov_b32 m0, s30
    s_add_u32 s26, s30, 0x4310000
    s_lshl_b32 s31, s21, 13
    s_add_u32 s27, s30, s31
    s_add_u32 s27, s27, 0x3200000
    s_lshl_b32 s30, s21, 10
    s_lshl_b32 s31, s20, 2
    s_add_u32 s28, s30, s31
    s_add_u32 s28, s28, 0x5600100
    s_mov_b32 s25, 0
    buffer_load_dwordx4 v112, s[4:7], s26 offen sc1 lds
    buffer_load_dwordx4 v112, s[4:7], s26 offen offset:1024 sc1 lds
L_KS:
    s_waitcnt vmcnt(0)
    v_mov_b32 v116, s25
    s_mov_b64 exec, 1
    buffer_store_dword v116, off, s[4:7], s28 sc1
    s_mov_b64 exec, -1
L_KS2:
    s_barrier
    ds_read_b128 v[0:3], v112 offset:0
    ds_read_b128 v[4:7], v112 offset:1024
    ds_read_b128 v[8:11], v112 offset:2048
    ds_read_b128 v[12:15], v112 offset:3072
    ds_read_b128 v[16:19], v112 offset:4096
    ds_read_b128 v[20:23], v112 offset:5120
    ds_read_b128 v[24:27], v112 offset:6144
    ds_read_b128 v[28:31], v112 offset:7168
    v_mfma_f32_32x32x8_bf16 v[32:47], v[120:121], v[120:121], 0
    s_waitcnt lgkmcnt(0)
    s_barrier
    v_max3_u32 v116, v0, v4, v8
    v_max3_u32 v117, v12, v16, v20
    v_max3_u32 v116, v116, v24, v28
    v_max_u32 v116, v116, v117
    v_cmp_eq_u32 vcc, -1, v116
    s_cbranch_vccnz L_KR
    s_add_u32 s26, s26, 0x2000
    buffer_load_dwordx4 v112, s[4:7], s26 offen sc1 lds
    buffer_load_dwordx4 v112, s[4:7], s26 offen offset:1024 sc1 lds
    v_smfmac_f32_16x16x64_bf16 v[32:35], v[0:3], a[128:135], v113
    v_smfmac_f32_16x16x64_bf16 v[36:39], v[0:3], a[192:199], v113
    v_smfmac_f32_16x16x64_bf16 v[32:35], v[4:7], a[136:143], v113
    v_smfmac_f32_16x16x64_bf16 v[36:39], v[4:7], a[200:207], v113
    v_smfmac_f32_16x16x64_bf16 v[32:35], v[8:11], a[144:151], v113
    v_smfmac_f32_16x16x64_bf16 v[36:39], v[8:11], a[208:215], v113
    v_smfmac_f32_16x16x64_bf16 v[32:35], v[12:15], a[152:159], v113
    v_smfmac_f32_16x16x64_bf16 v[36:39], v[12:15], a[216:223], v113
    v_smfmac_f32_16x16x64_bf16 v[32:35], v[16:19], a[160:167], v113
    v_smfmac_f32_16x16x64_bf16 v[36:39], v[16:19], a[224:231], v113
    v_smfmac_f32_16x16x64_bf16 v[32:35], v[20:23], a[168:175], v113
    v_smfmac_f32_16x16x64_bf16 v[36:39], v[20:23], a[232:239], v113
    v_smfmac_f32_16x16x64_bf16 v[32:35], v[24:27], a[176:183], v113
    v_smfmac_f32_16x16x64_bf16 v[36:39], v[24:27], a[240:247], v113
    v_smfmac_f32_16x16x64_bf16 v[32:35], v[28:31], a[184:191], v113
    v_smfmac_f32_16x16x64_bf16 v[36:39], v[28:31], a[248:255], v113
    v_smfmac_f32_16x16x64_bf16 v[40:43], v[0:3], v[128:135], v113
    v_smfmac_f32_16x16x64_bf16 v[44:47], v[0:3], v[192:199], v113
    v_cvt_pk_bf16_f32 v32, v32, v33
    v_cvt_pk_bf16_f32 v33, v34, v35
    v_smfmac_f32_16x16x64_bf16 v[40:43], v[4:7], v[136:143], v113
    v_cvt_pk_bf16_f32 v34, v36, v37
    v_cvt_pk_bf16_f32 v35, v38, v39
    v_smfmac_f32_16x16x64_bf16 v[44:47], v[4:7], v[200:207], v113
    v_mfma_f32_16x16x16_bf16 v[48:51], v[32:33], v[114:115], 0
    v_mfma_f32_16x16x16_bf16 v[52:55], v[34:35], v[114:115], 0
    v_smfmac_f32_16x16x64_bf16 v[40:43], v[8:11], v[144:151], v113
    v_smfmac_f32_16x16x64_bf16 v[44:47], v[8:11], v[208:215], v113
    v_smfmac_f32_16x16x64_bf16 v[40:43], v[12:15], v[152:159], v113
    v_cvt_pk_bf16_f32 v32, v48, v49
    v_cvt_pk_bf16_f32 v33, v50, v51
    v_smfmac_f32_16x16x64_bf16 v[44:47], v[12:15], v[216:223], v113
    v_cvt_pk_bf16_f32 v34, v52, v53
    v_cvt_pk_bf16_f32 v35, v54, v55
    v_smfmac_f32_16x16x64_bf16 v[40:43], v[16:19], v[160:167], v113
    buffer_store_dwordx4 v[32:35], v112, s[4:7], s27 offen sc1
    v_smfmac_f32_16x16x64_bf16 v[44:47], v[16:19], v[224:231], v113
    v_smfmac_f32_16x16x64_bf16 v[40:43], v[20:23], v[168:175], v113
    v_smfmac_f32_16x16x64_bf16 v[44:47], v[20:23], v[232:239], v113
    v_smfmac_f32_16x16x64_bf16 v[40:43], v[24:27], v[176:183], v113
    v_smfmac_f32_16x16x64_bf16 v[44:47], v[24:27], v[240:247], v113
    v_smfmac_f32_16x16x64_bf16 v[40:43], v[28:31], v[184:191], v113
    v_smfmac_f32_16x16x64_bf16 v[44:47], v[28:31], v[248:255], v113
    s_nop 3
    v_cvt_pk_bf16_f32 v48, v40, v41
    v_cvt_pk_bf16_f32 v49, v42, v43
    s_nop 1
    v_cvt_pk_bf16_f32 v50, v44, v45
    v_cvt_pk_bf16_f32 v51, v46, v47
    buffer_store_dwordx4 v[48:51], v112, s[4:7], s27 offen offset:1024 sc1
    s_add_u32 s27, s27, 0x40000
    s_add_u32 s25, s25, 1
    s_cmp_lt_u32 s25, 63
    s_cbranch_scc1 L_KS
    s_waitcnt vmcnt(0)
    v_mov_b32 v116, 63
    s_mov_b64 exec, 1
    buffer_store_dword v116, off, s[4:7], s28 sc1
    s_waitcnt vmcnt(0)
    s_endpgm
L_KR:
    buffer_load_dwordx4 v112, s[4:7], s26 offen sc1 lds
    buffer_load_dwordx4 v112, s[4:7], s26 offen offset:1024 sc1 lds
    s_waitcnt vmcnt(0)
    s_sub_u32 s24, s24, 1
    s_cbranch_scc1 L_ABORT
    s_branch L_KS2
L_ROLEA:
    s_barrier
    v_mbcnt_lo_u32_b32 v0, -1, 0
    v_mbcnt_hi_u32_b32 v0, -1, v0
    s_mov_b32 s8, s46
    s_mov_b32 s9, s47
    v_lshlrev_b32 v240, 4, v0
    s_and_b32 s30, s20, 1
    s_lshl_b32 s30, s30, 7
    v_xor_b32 v1, s30, v240
    s_lshl_b32 s82, s21, 17
    s_lshl_b32 s83, s20, 12
    s_add_u32 s82, s82, s83
    v_xor_b32 v2, 0, v1
    v_xor_b32 v3, 32, v1
    v_xor_b32 v4, 64, v1
    v_xor_b32 v5, 96, v1
    s_add_u32 m0, s83, 0x0
    s_add_u32 s31, s82, 0x0
    buffer_load_dwordx4 v2, s[8:11], s31 offen lds
    s_add_u32 m0, s83, 0x400
    s_add_u32 s31, s82, 0x400
    buffer_load_dwordx4 v3, s[8:11], s31 offen lds
    s_add_u32 m0, s83, 0x800
    s_add_u32 s31, s82, 0x800
    buffer_load_dwordx4 v4, s[8:11], s31 offen lds
    s_add_u32 m0, s83, 0xc00
    s_add_u32 s31, s82, 0xc00
    buffer_load_dwordx4 v5, s[8:11], s31 offen lds
    s_add_u32 m0, s83, 0x4000
    s_add_u32 s31, s82, 0x4000
    buffer_load_dwordx4 v2, s[8:11], s31 offen lds
    s_add_u32 m0, s83, 0x4400
    s_add_u32 s31, s82, 0x4400
    buffer_load_dwordx4 v3, s[8:11], s31 offen lds
    s_add_u32 m0, s83, 0x4800
    s_add_u32 s31, s82, 0x4800
    buffer_load_dwordx4 v4, s[8:11], s31 offen lds
    s_add_u32 m0, s83, 0x4c00
    s_add_u32 s31, s82, 0x4c00
    buffer_load_dwordx4 v5, s[8:11], s31 offen lds
    s_add_u32 m0, s83, 0x8000
    s_add_u32 s31, s82, 0x8000
    buffer_load_dwordx4 v2, s[8:11], s31 offen lds
    s_add_u32 m0, s83, 0x8400
    s_add_u32 s31, s82, 0x8400
    buffer_load_dwordx4 v3, s[8:11], s31 offen lds
    s_add_u32 m0, s83, 0x8800
    s_add_u32 s31, s82, 0x8800
    buffer_load_dwordx4 v4, s[8:11], s31 offen lds
    s_add_u32 m0, s83, 0x8c00
    s_add_u32 s31, s82, 0x8c00
    buffer_load_dwordx4 v5, s[8:11], s31 offen lds
    s_add_u32 m0, s83, 0xc000
    s_add_u32 s31, s82, 0xc000
    buffer_load_dwordx4 v2, s[8:11], s31 offen lds
    s_add_u32 m0, s83, 0xc400
    s_add_u32 s31, s82, 0xc400
    buffer_load_dwordx4 v3, s[8:11], s31 offen lds
    s_add_u32 m0, s83, 0xc800
    s_add_u32 s31, s82, 0xc800
    buffer_load_dwordx4 v4, s[8:11], s31 offen lds
    s_add_u32 m0, s83, 0xcc00
    s_add_u32 s31, s82, 0xcc00
    buffer_load_dwordx4 v5, s[8:11], s31 offen lds
    s_add_u32 m0, s83, 0x10000
    s_add_u32 s31, s82, 0x10000
    buffer_load_dwordx4 v2, s[8:11], s31 offen lds
    s_add_u32 m0, s83, 0x10400
    s_add_u32 s31, s82, 0x10400
    buffer_load_dwordx4 v3, s[8:11], s31 offen lds
    s_add_u32 m0, s83, 0x10800
    s_add_u32 s31, s82, 0x10800
    buffer_load_dwordx4 v4, s[8:11], s31 offen lds
    s_add_u32 m0, s83, 0x10c00
    s_add_u32 s31, s82, 0x10c00
    buffer_load_dwordx4 v5, s[8:11], s31 offen lds
    s_add_u32 m0, s83, 0x14000
    s_add_u32 s31, s82, 0x14000
    buffer_load_dwordx4 v2, s[8:11], s31 offen lds
    s_add_u32 m0, s83, 0x14400
    s_add_u32 s31, s82, 0x14400
    buffer_load_dwordx4 v3, s[8:11], s31 offen lds
    s_add_u32 m0, s83, 0x14800
    s_add_u32 s31, s82, 0x14800
    buffer_load_dwordx4 v4, s[8:11], s31 offen lds
    s_add_u32 m0, s83, 0x14c00
    s_add_u32 s31, s82, 0x14c00
    buffer_load_dwordx4 v5, s[8:11], s31 offen lds
    s_add_u32 m0, s83, 0x18000
    s_add_u32 s31, s82, 0x18000
    buffer_load_dwordx4 v2, s[8:11], s31 offen lds
    s_add_u32 m0, s83, 0x18400
    s_add_u32 s31, s82, 0x18400
    buffer_load_dwordx4 v3, s[8:11], s31 offen lds
    s_add_u32 m0, s83, 0x18800
    s_add_u32 s31, s82, 0x18800
    buffer_load_dwordx4 v4, s[8:11], s31 offen lds
    s_add_u32 m0, s83, 0x18c00
    s_add_u32 s31, s82, 0x18c00
    buffer_load_dwordx4 v5, s[8:11], s31 offen lds
    s_add_u32 m0, s83, 0x1c000
    s_add_u32 s31, s82, 0x1c000
    buffer_load_dwordx4 v2, s[8:11], s31 offen lds
    s_add_u32 m0, s83, 0x1c400
    s_add_u32 s31, s82, 0x1c400
    buffer_load_dwordx4 v3, s[8:11], s31 offen lds
    s_add_u32 m0, s83, 0x1c800
    s_add_u32 s31, s82, 0x1c800
    buffer_load_dwordx4 v4, s[8:11], s31 offen lds
    s_add_u32 m0, s83, 0x1cc00
    s_add_u32 s31, s82, 0x1cc00
    buffer_load_dwordx4 v5, s[8:11], s31 offen lds
    v_lshrrev_b32 v1, 2, v0
    v_and_b32 v2, 7, v1
    v_lshlrev_b32 v2, 5, v2
    v_lshl_add_u32 v1, v1, 10, v2
    v_and_b32 v3, 3, v0
    v_lshl_add_u32 v1, v3, 3, v1
    s_and_b32 s30, s20, 1
    s_lshl_b32 s30, s30, 9
    v_add_u32 v1, s30, v1
    v_xor_b32 v8, 0, v1
    v_add_u32 v16, 0x10000, v8
    v_xor_b32 v9, 32, v1
    v_add_u32 v17, 0x10000, v9
    v_xor_b32 v10, 64, v1
    v_add_u32 v18, 0x10000, v10
    v_xor_b32 v11, 96, v1
    v_add_u32 v19, 0x10000, v11
    v_xor_b32 v12, 128, v1
    v_add_u32 v20, 0x10000, v12
    v_xor_b32 v13, 160, v1
    v_add_u32 v21, 0x10000, v13
    v_xor_b32 v14, 192, v1
    v_add_u32 v22, 0x10000, v14
    v_xor_b32 v15, 224, v1
    v_add_u32 v23, 0x10000, v15
    s_sub_u32 s25, s23, 2
    s_cmp_lt_u32 s25, 4
    s_cselect_b32 s26, 13, 12
    s_mov_b32 s27, 0
    s_mov_b32 s28, s25
    s_mov_b32 s35, 0x3e0293ee
    s_lshr_b32 s30, s20, 1
    s_lshl_b32 s31, s30, 4
    v_and_b32 v1, 15, v0
    v_add_u32 v2, s31, v1
    v_lshrrev_b32 v3, 4, v0
    v_lshlrev_b32 v4, 2, v3
    v_add_u32 v5, 0, v4
    v_cmp_le_u32 s[66:67], v5, v2
    v_add_u32 v5, 1, v4
    v_cmp_le_u32 s[68:69], v5, v2
    v_add_u32 v5, 2, v4
    v_cmp_le_u32 s[70:71], v5, v2
    v_add_u32 v5, 3, v4
    v_cmp_le_u32 s[72:73], v5, v2
    v_add_u32 v5, 16, v4
    v_cmp_le_u32 s[74:75], v5, v2
    v_add_u32 v5, 17, v4
    v_cmp_le_u32 s[76:77], v5, v2
    v_add_u32 v5, 18, v4
    v_cmp_le_u32 s[78:79], v5, v2
    v_add_u32 v5, 19, v4
    v_cmp_le_u32 s[80:81], v5, v2
    v_lshlrev_b32 v5, 4, v1
    v_lshl_add_u32 v241, v3, 10, v5
    v_lshlrev_b32 v5, 10, v1
    v_lshl_add_u32 v242, v3, 5, v5
    v_and_b32 v5, 1, v0
    v_lshlrev_b32 v5, 4, v5
    v_mov_b32 v6, 0x3f80
    v_lshlrev_b32 v6, v5, v6
    v_lshrrev_b32 v5, 1, v1
    v_cmp_eq_u32 vcc, 0, v5
    s_nop 1
    v_cndmask_b32 v236, 0, v6, vcc
    v_cmp_eq_u32 vcc, 1, v5
    s_nop 1
    v_cndmask_b32 v237, 0, v6, vcc
    v_cmp_eq_u32 vcc, 2, v5
    s_nop 1
    v_cndmask_b32 v238, 0, v6, vcc
    v_cmp_eq_u32 vcc, 3, v5
    s_nop 1
    v_cndmask_b32 v239, 0, v6, vcc
    s_lshl_b32 s31, s25, 5
    s_add_u32 s31, s31, s21
    s_lshl_b32 s33, s31, 13
    s_add_u32 s33, s33, 0x3200000
    s_lshl_b32 s32, s31, 14
    s_add_u32 s32, s32, 0x1200000
    s_lshl_b32 s29, s31, 13
    s_lshl_b32 s31, s30, 12
    s_add_u32 s29, s29, s31
    s_add_u32 s29, s29, 0x200000
    s_lshl_b32 s31, s21, 10
    s_add_u32 s83, s31, 0x5600100
    s_lshl_b32 s82, s25, 21
    s_add_u32 s82, s82, 0x4400000
    s_add_u32 s34, s82, s31
    s_and_b32 s31, s20, 1
    s_lshl_b32 s31, s31, 19
    s_add_u32 s34, s34, s31
    s_lshl_b32 s31, s30, 15
    s_add_u32 s34, s34, s31
    s_lshl_b32 s31, s21, 15
    s_add_u32 s82, s82, s31
    s_lshl_b32 s31, s20, 8
    s_add_u32 s82, s82, s31
    s_lshl_b32 s86, s25, 9
    s_add_u32 s86, s86, 0x5608000
    s_lshl_b32 s31, s20, 7
    s_add_u32 s85, s86, s31
    s_lshl_b32 s31, s21, 2
    s_add_u32 s85, s85, s31
    s_and_b32 s31, s21, 1
    s_lshl_b32 s31, s31, 8
    s_add_u32 s86, s86, s31
    s_lshr_b32 s31, s21, 4
    s_lshl_b32 s31, s31, 7
    s_add_u32 s86, s86, s31
    s_lshl_b32 s87, s25, 15
    s_and_b32 s31, s21, 1
    s_lshl_b32 s31, s31, 14
    s_add_u32 s87, s87, s31
    s_lshr_b32 s31, s21, 1
    s_lshl_b32 s31, s31, 6
    s_add_u32 s87, s87, s31
    s_lshl_b32 s31, s20, 3
    s_add_u32 s87, s87, s31
    s_mov_b32 s88, 0
    s_mov_b32 s89, s87
    v_min_u32 v5, 12, v0
    v_mul_u32_u24 v5, 5, v5
    v_add_u32 v5, s25, v5
    v_min_u32 v5, 63, v5
    v_lshrrev_b32 v5, 1, v5
    v_lshlrev_b32 v244, 10, v5
    s_lshl_b32 s31, s20, 13
    v_lshlrev_b32 v5, 3, v0
    v_add_u32 v245, s31, v5
    s_lshl_b32 s31, s20, 11
    v_add_u32 v246, s31, v240
    s_mov_b32 s84, 0x5600140
    s_waitcnt vmcnt(0)
    s_barrier
    ds_read_b64_tr_b16 a[0:1], v8 offset:0
    ds_read_b64_tr_b16 a[16:17], v9 offset:0
    ds_read_b64_tr_b16 a[32:33], v10 offset:0
    ds_read_b64_tr_b16 a[48:49], v11 offset:0
    ds_read_b64_tr_b16 a[64:65], v12 offset:0
    ds_read_b64_tr_b16 a[80:81], v13 offset:0
    ds_read_b64_tr_b16 a[96:97], v14 offset:0
    ds_read_b64_tr_b16 a[112:113], v15 offset:0
    ds_read_b64_tr_b16 a[128:129], v8 offset:256
    ds_read_b64_tr_b16 a[144:145], v9 offset:256
    ds_read_b64_tr_b16 a[160:161], v10 offset:256
    ds_read_b64_tr_b16 a[176:177], v11 offset:256
    ds_read_b64_tr_b16 a[192:193], v12 offset:256
    ds_read_b64_tr_b16 a[208:209], v13 offset:256
    ds_read_b64_tr_b16 a[224:225], v14 offset:256
    ds_read_b64_tr_b16 a[240:241], v15 offset:256
    ds_read_b64_tr_b16 a[2:3], v8 offset:16384
    ds_read_b64_tr_b16 a[18:19], v9 offset:16384
    ds_read_b64_tr_b16 a[34:35], v10 offset:16384
    ds_read_b64_tr_b16 a[50:51], v11 offset:16384
    ds_read_b64_tr_b16 a[66:67], v12 offset:16384
    ds_read_b64_tr_b16 a[82:83], v13 offset:16384
    ds_read_b64_tr_b16 a[98:99], v14 offset:16384
    ds_read_b64_tr_b16 a[114:115], v15 offset:16384
    ds_read_b64_tr_b16 a[130:131], v8 offset:16640
    ds_read_b64_tr_b16 a[146:147], v9 offset:16640
    ds_read_b64_tr_b16 a[162:163], v10 offset:16640
    ds_read_b64_tr_b16 a[178:179], v11 offset:16640
    ds_read_b64_tr_b16 a[194:195], v12 offset:16640
    ds_read_b64_tr_b16 a[210:211], v13 offset:16640
    ds_read_b64_tr_b16 a[226:227], v14 offset:16640
    ds_read_b64_tr_b16 a[242:243], v15 offset:16640
    ds_read_b64_tr_b16 a[4:5], v8 offset:32768
    ds_read_b64_tr_b16 a[20:21], v9 offset:32768
    ds_read_b64_tr_b16 a[36:37], v10 offset:32768
    ds_read_b64_tr_b16 a[52:53], v11 offset:32768
    ds_read_b64_tr_b16 a[68:69], v12 offset:32768
    ds_read_b64_tr_b16 a[84:85], v13 offset:32768
    ds_read_b64_tr_b16 a[100:101], v14 offset:32768
    ds_read_b64_tr_b16 a[116:117], v15 offset:32768
    ds_read_b64_tr_b16 a[132:133], v8 offset:33024
    ds_read_b64_tr_b16 a[148:149], v9 offset:33024
    ds_read_b64_tr_b16 a[164:165], v10 offset:33024
    ds_read_b64_tr_b16 a[180:181], v11 offset:33024
    ds_read_b64_tr_b16 a[196:197], v12 offset:33024
    ds_read_b64_tr_b16 a[212:213], v13 offset:33024
    ds_read_b64_tr_b16 a[228:229], v14 offset:33024
    ds_read_b64_tr_b16 a[244:245], v15 offset:33024
    ds_read_b64_tr_b16 a[6:7], v8 offset:49152
    ds_read_b64_tr_b16 a[22:23], v9 offset:49152
    ds_read_b64_tr_b16 a[38:39], v10 offset:49152
    ds_read_b64_tr_b16 a[54:55], v11 offset:49152
    ds_read_b64_tr_b16 a[70:71], v12 offset:49152
    ds_read_b64_tr_b16 a[86:87], v13 offset:49152
    ds_read_b64_tr_b16 a[102:103], v14 offset:49152
    ds_read_b64_tr_b16 a[118:119], v15 offset:49152
    ds_read_b64_tr_b16 a[134:135], v8 offset:49408
    ds_read_b64_tr_b16 a[150:151], v9 offset:49408
    ds_read_b64_tr_b16 a[166:167], v10 offset:49408
    ds_read_b64_tr_b16 a[182:183], v11 offset:49408
    ds_read_b64_tr_b16 a[198:199], v12 offset:49408
    ds_read_b64_tr_b16 a[214:215], v13 offset:49408
    ds_read_b64_tr_b16 a[230:231], v14 offset:49408
    ds_read_b64_tr_b16 a[246:247], v15 offset:49408
    ds_read_b64_tr_b16 a[8:9], v16 offset:0
    ds_read_b64_tr_b16 a[24:25], v17 offset:0
    ds_read_b64_tr_b16 a[40:41], v18 offset:0
    ds_read_b64_tr_b16 a[56:57], v19 offset:0
    ds_read_b64_tr_b16 a[72:73], v20 offset:0
    ds_read_b64_tr_b16 a[88:89], v21 offset:0
    ds_read_b64_tr_b16 a[104:105], v22 offset:0
    ds_read_b64_tr_b16 a[120:121], v23 offset:0
    ds_read_b64_tr_b16 a[136:137], v16 offset:256
    ds_read_b64_tr_b16 a[152:153], v17 offset:256
    ds_read_b64_tr_b16 a[168:169], v18 offset:256
    ds_read_b64_tr_b16 a[184:185], v19 offset:256
    ds_read_b64_tr_b16 a[200:201], v20 offset:256
    ds_read_b64_tr_b16 a[216:217], v21 offset:256
    ds_read_b64_tr_b16 a[232:233], v22 offset:256
    ds_read_b64_tr_b16 a[248:249], v23 offset:256
    ds_read_b64_tr_b16 a[10:11], v16 offset:16384
    ds_read_b64_tr_b16 a[26:27], v17 offset:16384
    ds_read_b64_tr_b16 a[42:43], v18 offset:16384
    ds_read_b64_tr_b16 a[58:59], v19 offset:16384
    ds_read_b64_tr_b16 a[74:75], v20 offset:16384
    ds_read_b64_tr_b16 a[90:91], v21 offset:16384
    ds_read_b64_tr_b16 a[106:107], v22 offset:16384
    ds_read_b64_tr_b16 a[122:123], v23 offset:16384
    ds_read_b64_tr_b16 a[138:139], v16 offset:16640
    ds_read_b64_tr_b16 a[154:155], v17 offset:16640
    ds_read_b64_tr_b16 a[170:171], v18 offset:16640
    ds_read_b64_tr_b16 a[186:187], v19 offset:16640
    ds_read_b64_tr_b16 a[202:203], v20 offset:16640
    ds_read_b64_tr_b16 a[218:219], v21 offset:16640
    ds_read_b64_tr_b16 a[234:235], v22 offset:16640
    ds_read_b64_tr_b16 a[250:251], v23 offset:16640
    ds_read_b64_tr_b16 a[12:13], v16 offset:32768
    ds_read_b64_tr_b16 a[28:29], v17 offset:32768
    ds_read_b64_tr_b16 a[44:45], v18 offset:32768
    ds_read_b64_tr_b16 a[60:61], v19 offset:32768
    ds_read_b64_tr_b16 a[76:77], v20 offset:32768
    ds_read_b64_tr_b16 a[92:93], v21 offset:32768
    ds_read_b64_tr_b16 a[108:109], v22 offset:32768
    ds_read_b64_tr_b16 a[124:125], v23 offset:32768
    ds_read_b64_tr_b16 a[140:141], v16 offset:33024
    ds_read_b64_tr_b16 a[156:157], v17 offset:33024
    ds_read_b64_tr_b16 a[172:173], v18 offset:33024
    ds_read_b64_tr_b16 a[188:189], v19 offset:33024
    ds_read_b64_tr_b16 a[204:205], v20 offset:33024
    ds_read_b64_tr_b16 a[220:221], v21 offset:33024
    ds_read_b64_tr_b16 a[236:237], v22 offset:33024
    ds_read_b64_tr_b16 a[252:253], v23 offset:33024
    ds_read_b64_tr_b16 a[14:15], v16 offset:49152
    ds_read_b64_tr_b16 a[30:31], v17 offset:49152
    ds_read_b64_tr_b16 a[46:47], v18 offset:49152
    ds_read_b64_tr_b16 a[62:63], v19 offset:49152
    ds_read_b64_tr_b16 a[78:79], v20 offset:49152
    ds_read_b64_tr_b16 a[94:95], v21 offset:49152
    ds_read_b64_tr_b16 a[110:111], v22 offset:49152
    ds_read_b64_tr_b16 a[126:127], v23 offset:49152
    ds_read_b64_tr_b16 a[142:143], v16 offset:49408
    ds_read_b64_tr_b16 a[158:159], v17 offset:49408
    ds_read_b64_tr_b16 a[174:175], v18 offset:49408
    ds_read_b64_tr_b16 a[190:191], v19 offset:49408
    ds_read_b64_tr_b16 a[206:207], v20 offset:49408
    ds_read_b64_tr_b16 a[222:223], v21 offset:49408
    ds_read_b64_tr_b16 a[238:239], v22 offset:49408
    ds_read_b64_tr_b16 a[254:255], v23 offset:49408
    s_mov_b32 s8, s60
    s_mov_b32 s9, s61
    s_mov_b32 s10, 0x200000
    s_mov_b32 s11, 0x00020000
    s_mov_b32 s16, s36
    s_mov_b32 s17, s37
    s_mov_b32 s18, 0x200000
    s_mov_b32 s19, 0x00020000
    s_lshl_b32 s30, s21, 10
    s_add_u32 s30, s30, 0x5600080
    v_lshrrev_b32 v130, 4, v240
    v_min_u32 v130, 23, v130
    v_cmp_gt_u32 vcc, 16, v130
    s_nop 1
    v_cndmask_b32 v131, 10, 11, vcc
    v_lshlrev_b32 v130, 2, v130
L_AKV:
    buffer_load_dword v132, v130, s[4:7], s30 offen sc1
    s_waitcnt vmcnt(0)
    v_cmp_gt_u32 vcc, v131, v132
    s_cbranch_vccz L_AKV2
    s_sleep 8
    s_sub_u32 s24, s24, 1
    s_cbranch_scc1 L_ABORT
    s_branch L_AKV
L_AKV2:
    s_waitcnt lgkmcnt(0)
    s_barrier
    buffer_load_dwordx4 v[0:3], v240, s[4:7], s29 offen offset:0 sc1
    buffer_load_dwordx4 v[4:7], v240, s[4:7], s29 offen offset:1024 sc1
    buffer_load_dwordx4 v[8:11], v240, s[4:7], s29 offen offset:2048 sc1
    buffer_load_dwordx4 v[12:15], v240, s[4:7], s29 offen offset:3072 sc1
    s_mov_b32 s30, s32
    buffer_load_dwordx4 v[16:19], v240, s[4:7], s30 offen offset:0 sc1
    buffer_load_dwordx4 v[20:23], v240, s[4:7], s30 offen offset:1024 sc1
    buffer_load_dwordx4 v[48:51], v240, s[4:7], s30 offen offset:2048 sc1
    buffer_load_dwordx4 v[52:55], v240, s[4:7], s30 offen offset:3072 sc1
    s_add_u32 s30, s30, 4096
    buffer_load_dwordx4 v[24:27], v240, s[4:7], s30 offen offset:0 sc1
    buffer_load_dwordx4 v[28:31], v240, s[4:7], s30 offen offset:1024 sc1
    buffer_load_dwordx4 v[56:59], v240, s[4:7], s30 offen offset:2048 sc1
    buffer_load_dwordx4 v[60:63], v240, s[4:7], s30 offen offset:3072 sc1
    s_add_u32 s30, s30, 4096
    buffer_load_dwordx4 v[32:35], v240, s[4:7], s30 offen offset:0 sc1
    buffer_load_dwordx4 v[36:39], v240, s[4:7], s30 offen offset:1024 sc1
    buffer_load_dwordx4 v[64:67], v240, s[4:7], s30 offen offset:2048 sc1
    buffer_load_dwordx4 v[68:71], v240, s[4:7], s30 offen offset:3072 sc1
    s_add_u32 s30, s30, 4096
    buffer_load_dwordx4 v[40:43], v240, s[4:7], s30 offen offset:0 sc1
    buffer_load_dwordx4 v[44:47], v240, s[4:7], s30 offen offset:1024 sc1
    buffer_load_dwordx4 v[72:75], v240, s[4:7], s30 offen offset:2048 sc1
    buffer_load_dwordx4 v[76:79], v240, s[4:7], s30 offen offset:3072 sc1
L_AU:
    s_waitcnt vmcnt(0)
    v_mfma_f32_16x16x32_bf16 v[112:115], v[16:19], v[0:3], 0
    v_mfma_f32_16x16x32_bf16 v[116:119], v[20:23], v[0:3], 0
    v_mfma_f32_16x16x32_bf16 v[112:115], v[24:27], v[4:7], v[112:115]
    v_mfma_f32_16x16x32_bf16 v[116:119], v[28:31], v[4:7], v[116:119]
    v_mfma_f32_16x16x32_bf16 v[112:115], v[32:35], v[8:11], v[112:115]
    v_mfma_f32_16x16x32_bf16 v[116:119], v[36:39], v[8:11], v[116:119]
    v_mfma_f32_16x16x32_bf16 v[112:115], v[40:43], v[12:15], v[112:115]
    v_mfma_f32_16x16x32_bf16 v[116:119], v[44:47], v[12:15], v[116:119]
L_AM:
    buffer_load_dwordx4 v[132:135], off, s[4:7], s83 sc1
    buffer_load_dword v136, v244, s[4:7], s84 offen sc1
    s_min_u32 s31, s28, 62
    s_waitcnt vmcnt(0)
    v_cmp_ne_u32 vcc, 0, v136
    v_min_u32 v132, v132, v133
    v_min3_u32 v132, v132, v134, v135
    s_mov_b32 s90, vcc_lo
    s_cmp_ge_u32 s28, 61
    s_cselect_b32 s31, 57, s31
    v_cmp_ge_u32 vcc, s31, v132
    s_cbranch_vccnz L_AMR
L_AKM:
    s_lshl_b32 s30, s20, 11
    s_add_u32 s30, s30, s33
    buffer_load_dwordx4 v[140:143], v240, s[4:7], s30 offen offset:0 sc1
    buffer_load_dwordx4 v[144:147], v240, s[4:7], s30 offen offset:1024 sc1
    s_waitcnt vmcnt(0)
    s_cmp_ge_u32 s28, 61
    s_cbranch_scc0 L_AKM2
    v_max_u32 v130, v140, v144
    v_cmp_eq_u32 vcc, -1, v130
    s_cbranch_vccz L_AKM2
    s_sub_u32 s24, s24, 1
    s_cbranch_scc1 L_ABORT
    s_branch L_AKM
L_AKM2:
    ds_write_b128 v246, v[140:143] offset:32768
    ds_write_b128 v246, v[144:147] offset:33792
    s_lshr_b32 s30, s90, s27
    s_and_b32 s30, s30, 1
    s_cmp_eq_u32 s88, s27
    s_cselect_b32 s91, s30, 0
    v_mov_b32 v130, 0xff7fffff
    v_cndmask_b32 v112, v130, v112, s[66:67]
    v_cndmask_b32 v113, v130, v113, s[68:69]
    v_cndmask_b32 v114, v130, v114, s[70:71]
    v_cndmask_b32 v115, v130, v115, s[72:73]
    v_cndmask_b32 v116, v130, v116, s[74:75]
    v_cndmask_b32 v117, v130, v117, s[76:77]
    v_cndmask_b32 v118, v130, v118, s[78:79]
    v_cndmask_b32 v119, v130, v119, s[80:81]
    v_max3_f32 v130, v112, v113, v114
    v_max3_f32 v131, v115, v116, v117
    v_max3_f32 v130, v130, v118, v119
    v_max_f32 v130, v130, v131
    s_waitcnt lgkmcnt(0)
    s_barrier
    ds_read_b128 v[80:83], v240 offset:32768
    ds_read_b128 v[84:87], v240 offset:34816
    ds_read_b128 v[88:91], v240 offset:36864
    ds_read_b128 v[92:95], v240 offset:38912
    ds_read_b128 v[96:99], v240 offset:33792
    ds_read_b128 v[100:103], v240 offset:35840
    ds_read_b128 v[104:107], v240 offset:37888
    ds_read_b128 v[108:111], v240 offset:39936
    s_waitcnt lgkmcnt(7)
    v_mfma_f32_16x16x32_bf16 v[120:123], v[80:83], v[0:3], 0
    s_waitcnt lgkmcnt(6)
    v_mfma_f32_16x16x32_bf16 v[120:123], v[84:87], v[4:7], v[120:123]
    s_waitcnt lgkmcnt(5)
    v_mfma_f32_16x16x32_bf16 v[120:123], v[88:91], v[8:11], v[120:123]
    s_waitcnt lgkmcnt(4)
    v_mfma_f32_16x16x32_bf16 v[120:123], v[92:95], v[12:15], v[120:123]
    s_nop 7
    v_max3_f32 v130, v130, v120, v121
    v_mov_b32 v131, v130
    s_nop 1
    v_permlane16_swap_b32 v130, v131
    v_max_f32 v130, v130, v131
    v_mov_b32 v131, v130
    s_nop 1
    v_permlane32_swap_b32 v130, v131
    v_max_f32 v130, v130, v131
    v_mul_f32 v130, s35, v130
    v_fma_f32 v112, v112, s35, -v130
    v_fma_f32 v113, v113, s35, -v130
    v_fma_f32 v114, v114, s35, -v130
    v_fma_f32 v115, v115, s35, -v130
    v_fma_f32 v116, v116, s35, -v130
    v_fma_f32 v117, v117, s35, -v130
    v_fma_f32 v118, v118, s35, -v130
    v_fma_f32 v119, v119, s35, -v130
    v_fma_f32 v120, v120, s35, -v130
    v_fma_f32 v121, v121, s35, -v130
    v_exp_f32 v112, v112
    v_exp_f32 v113, v113
    v_exp_f32 v114, v114
    v_exp_f32 v115, v115
    v_exp_f32 v116, v116
    v_exp_f32 v117, v117
    v_exp_f32 v118, v118
    v_exp_f32 v119, v119
    v_exp_f32 v120, v120
    v_exp_f32 v121, v121
    v_cvt_pk_bf16_f32 v124, v112, v113
    v_cvt_pk_bf16_f32 v125, v114, v115
    v_cvt_pk_bf16_f32 v126, v116, v117
    v_cvt_pk_bf16_f32 v127, v118, v119
    v_cvt_pk_bf16_f32 v128, v120, v121
    v_cvt_pk_bf16_f32 v129, v120, v121
    s_waitcnt vmcnt(0) lgkmcnt(0)
    s_cmp_eq_u32 s91, 0
    s_cbranch_scc1 L_ANX
    s_mov_b32 exec_hi, 0
    s_add_u32 s30, s87, 0x5400000
    buffer_load_dwordx2 v[248:249], v242, s[16:19], s87 offen
    buffer_load_dwordx2 v[250:251], v242, s[4:7], s30 offen sc1
    s_mov_b32 exec_hi, -1
L_ANX:
    v_mfma_f32_16x16x32_bf16 v[140:143], v[48:51], v[124:127], 0
    v_add_f32 v130, v112, v113
    v_mfma_f32_16x16x32_bf16 v[144:147], v[52:55], v[124:127], 0
    v_add_f32 v130, v130, v114
    v_mfma_f32_16x16x32_bf16 v[148:151], v[56:59], v[124:127], 0
    v_add_f32 v130, v130, v115
    v_mfma_f32_16x16x32_bf16 v[152:155], v[60:63], v[124:127], 0
    v_add_f32 v130, v130, v116
    v_mfma_f32_16x16x32_bf16 v[156:159], v[64:67], v[124:127], 0
    v_add_f32 v130, v130, v117
    v_mfma_f32_16x16x32_bf16 v[160:163], v[68:71], v[124:127], 0
    v_add_f32 v130, v130, v118
    v_mfma_f32_16x16x32_bf16 v[164:167], v[72:75], v[124:127], 0
    v_add_f32 v130, v130, v119
    v_mfma_f32_16x16x32_bf16 v[168:171], v[76:79], v[124:127], 0
    v_add_f32 v130, v130, v120
    v_add_f32 v130, v130, v121
    v_mfma_f32_16x16x16_bf16 v[140:143], v[96:97], v[128:129], v[140:143]
    v_mfma_f32_16x16x16_bf16 v[144:147], v[98:99], v[128:129], v[144:147]
    v_mfma_f32_16x16x16_bf16 v[148:151], v[100:101], v[128:129], v[148:151]
    v_mfma_f32_16x16x16_bf16 v[152:155], v[102:103], v[128:129], v[152:155]
    v_mfma_f32_16x16x16_bf16 v[156:159], v[104:105], v[128:129], v[156:159]
    v_mfma_f32_16x16x16_bf16 v[160:163], v[106:107], v[128:129], v[160:163]
    v_mfma_f32_16x16x16_bf16 v[164:167], v[108:109], v[128:129], v[164:167]
    v_mfma_f32_16x16x16_bf16 v[168:171], v[110:111], v[128:129], v[168:171]
    v_mov_b32 v131, v130
    s_nop 1
    v_permlane16_swap_b32 v130, v131
    v_add_f32 v130, v130, v131
    v_mov_b32 v131, v130
    s_nop 1
    v_permlane32_swap_b32 v130, v131
    v_add_f32 v130, v130, v131
    v_rcp_f32 v130, v130
    s_add_u32 s30, s27, 1
    s_cmp_ge_u32 s30, s26
    s_cbranch_scc1 L_ANP
    s_add_u32 s29, s29, 0x140000
    s_add_u32 s32, s32, 0x280000
    buffer_load_dwordx4 v[0:3], v240, s[4:7], s29 offen offset:0 sc1
    buffer_load_dwordx4 v[4:7], v240, s[4:7], s29 offen offset:1024 sc1
    buffer_load_dwordx4 v[8:11], v240, s[4:7], s29 offen offset:2048 sc1
    buffer_load_dwordx4 v[12:15], v240, s[4:7], s29 offen offset:3072 sc1
    s_mov_b32 s30, s32
    buffer_load_dwordx4 v[16:19], v240, s[4:7], s30 offen offset:0 sc1
    buffer_load_dwordx4 v[20:23], v240, s[4:7], s30 offen offset:1024 sc1
    buffer_load_dwordx4 v[48:51], v240, s[4:7], s30 offen offset:2048 sc1
    buffer_load_dwordx4 v[52:55], v240, s[4:7], s30 offen offset:3072 sc1
    s_add_u32 s30, s30, 4096
    buffer_load_dwordx4 v[24:27], v240, s[4:7], s30 offen offset:0 sc1
    buffer_load_dwordx4 v[28:31], v240, s[4:7], s30 offen offset:1024 sc1
    buffer_load_dwordx4 v[56:59], v240, s[4:7], s30 offen offset:2048 sc1
    buffer_load_dwordx4 v[60:63], v240, s[4:7], s30 offen offset:3072 sc1
    s_add_u32 s30, s30, 4096
    buffer_load_dwordx4 v[32:35], v240, s[4:7], s30 offen offset:0 sc1
    buffer_load_dwordx4 v[36:39], v240, s[4:7], s30 offen offset:1024 sc1
    buffer_load_dwordx4 v[64:67], v240, s[4:7], s30 offen offset:2048 sc1
    buffer_load_dwordx4 v[68:71], v240, s[4:7], s30 offen offset:3072 sc1
    s_add_u32 s30, s30, 4096
    buffer_load_dwordx4 v[40:43], v240, s[4:7], s30 offen offset:0 sc1
    buffer_load_dwordx4 v[44:47], v240, s[4:7], s30 offen offset:1024 sc1
    buffer_load_dwordx4 v[72:75], v240, s[4:7], s30 offen offset:2048 sc1
    buffer_load_dwordx4 v[76:79], v240, s[4:7], s30 offen offset:3072 sc1
L_ANP:
    v_pk_mul_f32 v[140:141], v[140:141], v[130:131] op_sel_hi:[1,0]
    v_pk_mul_f32 v[142:143], v[142:143], v[130:131] op_sel_hi:[1,0]
    v_pk_mul_f32 v[144:145], v[144:145], v[130:131] op_sel_hi:[1,0]
    v_pk_mul_f32 v[146:147], v[146:147], v[130:131] op_sel_hi:[1,0]
    v_pk_mul_f32 v[148:149], v[148:149], v[130:131] op_sel_hi:[1,0]
    v_pk_mul_f32 v[150:151], v[150:151], v[130:131] op_sel_hi:[1,0]
    v_pk_mul_f32 v[152:153], v[152:153], v[130:131] op_sel_hi:[1,0]
    v_pk_mul_f32 v[154:155], v[154:155], v[130:131] op_sel_hi:[1,0]
    v_pk_mul_f32 v[156:157], v[156:157], v[130:131] op_sel_hi:[1,0]
    v_pk_mul_f32 v[158:159], v[158:159], v[130:131] op_sel_hi:[1,0]
    v_pk_mul_f32 v[160:161], v[160:161], v[130:131] op_sel_hi:[1,0]
    v_pk_mul_f32 v[162:163], v[162:163], v[130:131] op_sel_hi:[1,0]
    v_pk_mul_f32 v[164:165], v[164:165], v[130:131] op_sel_hi:[1,0]
    v_pk_mul_f32 v[166:167], v[166:167], v[130:131] op_sel_hi:[1,0]
    v_pk_mul_f32 v[168:169], v[168:169], v[130:131] op_sel_hi:[1,0]
    v_pk_mul_f32 v[170:171], v[170:171], v[130:131] op_sel_hi:[1,0]
    v_cvt_pk_bf16_f32 v172, v140, v141
    v_cvt_pk_bf16_f32 v173, v142, v143
    v_cvt_pk_bf16_f32 v174, v144, v145
    v_cvt_pk_bf16_f32 v175, v146, v147
    v_cvt_pk_bf16_f32 v176, v148, v149
    v_cvt_pk_bf16_f32 v177, v150, v151
    v_cvt_pk_bf16_f32 v178, v152, v153
    v_cvt_pk_bf16_f32 v179, v154, v155
    v_cvt_pk_bf16_f32 v180, v156, v157
    v_cvt_pk_bf16_f32 v181, v158, v159
    v_cvt_pk_bf16_f32 v182, v160, v161
    v_cvt_pk_bf16_f32 v183, v162, v163
    v_cvt_pk_bf16_f32 v184, v164, v165
    v_cvt_pk_bf16_f32 v185, v166, v167
    v_cvt_pk_bf16_f32 v186, v168, v169
    v_cvt_pk_bf16_f32 v187, v170, v171
    s_mov_b32 s30, s34
    s_barrier
    s_sub_u32 s31, s28, 54
    s_cmp_lt_u32 s31, 7
    s_cbranch_scc1 L_AWT
    v_mfma_f32_16x16x32_bf16 v[188:191], a[0:3], v[172:175], 0
    v_mfma_f32_16x16x32_bf16 v[192:195], a[16:19], v[172:175], 0
    v_mfma_f32_16x16x32_bf16 v[188:191], a[4:7], v[176:179], v[188:191]
    v_mfma_f32_16x16x32_bf16 v[192:195], a[20:23], v[176:179], v[192:195]
    v_mfma_f32_16x16x32_bf16 v[188:191], a[8:11], v[180:183], v[188:191]
    v_mfma_f32_16x16x32_bf16 v[192:195], a[24:27], v[180:183], v[192:195]
    v_mfma_f32_16x16x32_bf16 v[188:191], a[12:15], v[184:187], v[188:191]
    v_mfma_f32_16x16x32_bf16 v[192:195], a[28:31], v[184:187], v[192:195]
    v_mfma_f32_16x16x32_bf16 v[196:199], a[32:35], v[172:175], 0
    v_mfma_f32_16x16x32_bf16 v[200:203], a[48:51], v[172:175], 0
    v_mfma_f32_16x16x32_bf16 v[196:199], a[36:39], v[176:179], v[196:199]
    v_cvt_pk_bf16_f32 v220, v188, v189
    v_mfma_f32_16x16x32_bf16 v[200:203], a[52:55], v[176:179], v[200:203]
    v_cvt_pk_bf16_f32 v221, v190, v191
    v_mfma_f32_16x16x32_bf16 v[196:199], a[40:43], v[180:183], v[196:199]
    v_cvt_pk_bf16_f32 v222, v192, v193
    v_mfma_f32_16x16x32_bf16 v[200:203], a[56:59], v[180:183], v[200:203]
    v_cvt_pk_bf16_f32 v223, v194, v195
    v_mfma_f32_16x16x32_bf16 v[196:199], a[44:47], v[184:187], v[196:199]
    buffer_store_dwordx4 v[220:223], v240, s[4:7], s30 offen
    v_mfma_f32_16x16x32_bf16 v[200:203], a[60:63], v[184:187], v[200:203]
    s_add_u32 s30, s30, 0x10000
    v_mfma_f32_16x16x32_bf16 v[204:207], a[64:67], v[172:175], 0
    v_mfma_f32_16x16x32_bf16 v[208:211], a[80:83], v[172:175], 0
    v_mfma_f32_16x16x32_bf16 v[204:207], a[68:71], v[176:179], v[204:207]
    v_cvt_pk_bf16_f32 v224, v196, v197
    v_mfma_f32_16x16x32_bf16 v[208:211], a[84:87], v[176:179], v[208:211]
    v_cvt_pk_bf16_f32 v225, v198, v199
    v_mfma_f32_16x16x32_bf16 v[204:207], a[72:75], v[180:183], v[204:207]
    v_cvt_pk_bf16_f32 v226, v200, v201
    v_mfma_f32_16x16x32_bf16 v[208:211], a[88:91], v[180:183], v[208:211]
    v_cvt_pk_bf16_f32 v227, v202, v203
    v_mfma_f32_16x16x32_bf16 v[204:207], a[76:79], v[184:187], v[204:207]
    buffer_store_dwordx4 v[224:227], v240, s[4:7], s30 offen
    v_mfma_f32_16x16x32_bf16 v[208:211], a[92:95], v[184:187], v[208:211]
    s_add_u32 s30, s30, 0x10000
    v_mfma_f32_16x16x32_bf16 v[212:215], a[96:99], v[172:175], 0
    v_mfma_f32_16x16x32_bf16 v[216:219], a[112:115], v[172:175], 0
    v_mfma_f32_16x16x32_bf16 v[212:215], a[100:103], v[176:179], v[212:215]
    v_cvt_pk_bf16_f32 v228, v204, v205
    v_mfma_f32_16x16x32_bf16 v[216:219], a[116:119], v[176:179], v[216:219]
    v_cvt_pk_bf16_f32 v229, v206, v207
    v_mfma_f32_16x16x32_bf16 v[212:215], a[104:107], v[180:183], v[212:215]
    v_cvt_pk_bf16_f32 v230, v208, v209
    v_mfma_f32_16x16x32_bf16 v[216:219], a[120:123], v[180:183], v[216:219]
    v_cvt_pk_bf16_f32 v231, v210, v211
    v_mfma_f32_16x16x32_bf16 v[212:215], a[108:111], v[184:187], v[212:215]
    buffer_store_dwordx4 v[228:231], v240, s[4:7], s30 offen
    v_mfma_f32_16x16x32_bf16 v[216:219], a[124:127], v[184:187], v[216:219]
    s_add_u32 s30, s30, 0x10000
    v_mfma_f32_16x16x32_bf16 v[188:191], a[128:131], v[172:175], 0
    v_mfma_f32_16x16x32_bf16 v[192:195], a[144:147], v[172:175], 0
    v_mfma_f32_16x16x32_bf16 v[188:191], a[132:135], v[176:179], v[188:191]
    v_cvt_pk_bf16_f32 v232, v212, v213
    v_mfma_f32_16x16x32_bf16 v[192:195], a[148:151], v[176:179], v[192:195]
    v_cvt_pk_bf16_f32 v233, v214, v215
    v_mfma_f32_16x16x32_bf16 v[188:191], a[136:139], v[180:183], v[188:191]
    v_cvt_pk_bf16_f32 v234, v216, v217
    v_mfma_f32_16x16x32_bf16 v[192:195], a[152:155], v[180:183], v[192:195]
    v_cvt_pk_bf16_f32 v235, v218, v219
    v_mfma_f32_16x16x32_bf16 v[188:191], a[140:143], v[184:187], v[188:191]
    buffer_store_dwordx4 v[232:235], v240, s[4:7], s30 offen
    v_mfma_f32_16x16x32_bf16 v[192:195], a[156:159], v[184:187], v[192:195]
    s_add_u32 s30, s30, 0x10000
    v_mfma_f32_16x16x32_bf16 v[196:199], a[160:163], v[172:175], 0
    v_mfma_f32_16x16x32_bf16 v[200:203], a[176:179], v[172:175], 0
    v_mfma_f32_16x16x32_bf16 v[196:199], a[164:167], v[176:179], v[196:199]
    v_cvt_pk_bf16_f32 v220, v188, v189
    v_mfma_f32_16x16x32_bf16 v[200:203], a[180:183], v[176:179], v[200:203]
    v_cvt_pk_bf16_f32 v221, v190, v191
    v_mfma_f32_16x16x32_bf16 v[196:199], a[168:171], v[180:183], v[196:199]
    v_cvt_pk_bf16_f32 v222, v192, v193
    v_mfma_f32_16x16x32_bf16 v[200:203], a[184:187], v[180:183], v[200:203]
    v_cvt_pk_bf16_f32 v223, v194, v195
    v_mfma_f32_16x16x32_bf16 v[196:199], a[172:175], v[184:187], v[196:199]
    buffer_store_dwordx4 v[220:223], v240, s[4:7], s30 offen
    v_mfma_f32_16x16x32_bf16 v[200:203], a[188:191], v[184:187], v[200:203]
    s_add_u32 s30, s30, 0x10000
    v_mfma_f32_16x16x32_bf16 v[204:207], a[192:195], v[172:175], 0
    v_mfma_f32_16x16x32_bf16 v[208:211], a[208:211], v[172:175], 0
    v_mfma_f32_16x16x32_bf16 v[204:207], a[196:199], v[176:179], v[204:207]
    v_cvt_pk_bf16_f32 v224, v196, v197
    v_mfma_f32_16x16x32_bf16 v[208:211], a[212:215], v[176:179], v[208:211]
    v_cvt_pk_bf16_f32 v225, v198, v199
    v_mfma_f32_16x16x32_bf16 v[204:207], a[200:203], v[180:183], v[204:207]
    v_cvt_pk_bf16_f32 v226, v200, v201
    v_mfma_f32_16x16x32_bf16 v[208:211], a[216:219], v[180:183], v[208:211]
    v_cvt_pk_bf16_f32 v227, v202, v203
    v_mfma_f32_16x16x32_bf16 v[204:207], a[204:207], v[184:187], v[204:207]
    buffer_store_dwordx4 v[224:227], v240, s[4:7], s30 offen
    v_mfma_f32_16x16x32_bf16 v[208:211], a[220:223], v[184:187], v[208:211]
    s_add_u32 s30, s30, 0x10000
    v_mfma_f32_16x16x32_bf16 v[212:215], a[224:227], v[172:175], 0
    v_mfma_f32_16x16x32_bf16 v[216:219], a[240:243], v[172:175], 0
    v_mfma_f32_16x16x32_bf16 v[212:215], a[228:231], v[176:179], v[212:215]
    v_cvt_pk_bf16_f32 v228, v204, v205
    v_mfma_f32_16x16x32_bf16 v[216:219], a[244:247], v[176:179], v[216:219]
    v_cvt_pk_bf16_f32 v229, v206, v207
    v_mfma_f32_16x16x32_bf16 v[212:215], a[232:235], v[180:183], v[212:215]
    v_cvt_pk_bf16_f32 v230, v208, v209
    v_mfma_f32_16x16x32_bf16 v[216:219], a[248:251], v[180:183], v[216:219]
    v_cvt_pk_bf16_f32 v231, v210, v211
    v_mfma_f32_16x16x32_bf16 v[212:215], a[236:239], v[184:187], v[212:215]
    buffer_store_dwordx4 v[228:231], v240, s[4:7], s30 offen
    v_mfma_f32_16x16x32_bf16 v[216:219], a[252:255], v[184:187], v[216:219]
    s_add_u32 s30, s30, 0x10000
    s_nop 2
    v_cvt_pk_bf16_f32 v232, v212, v213
    v_cvt_pk_bf16_f32 v233, v214, v215
    s_nop 1
    v_cvt_pk_bf16_f32 v234, v216, v217
    v_cvt_pk_bf16_f32 v235, v218, v219
    buffer_store_dwordx4 v[232:235], v240, s[4:7], s30 offen
    s_add_u32 s30, s30, 0x10000
L_AWT2:
    s_add_u32 s27, s27, 1
    v_mov_b32 v130, s27
    v_lshrrev_b32 v243, 2, v240
    v_and_b32 v243, 0x7c, v243
    s_waitcnt vmcnt(0)
    s_mov_b64 exec, 1
    buffer_store_dword v130, off, s[4:7], s85
    s_mov_b64 exec, -1
L_AF:
    buffer_load_dword v131, v243, s[4:7], s86 offen sc1
    s_waitcnt vmcnt(0)
    v_cmp_gt_u32 vcc, s27, v131
    s_cbranch_vccnz L_AFR
    s_mov_b32 s30, s82
    buffer_load_dwordx4 v[140:143], v241, s[4:7], s30 offen offset:0 sc1
    s_add_u32 s30, s30, 4096
    buffer_load_dwordx4 v[144:147], v241, s[4:7], s30 offen offset:0 sc1
    s_add_u32 s30, s30, 4096
    buffer_load_dwordx4 v[148:151], v241, s[4:7], s30 offen offset:0 sc1
    s_add_u32 s30, s30, 4096
    buffer_load_dwordx4 v[152:155], v241, s[4:7], s30 offen offset:0 sc1
    s_add_u32 s30, s30, 4096
    buffer_load_dwordx4 v[156:159], v241, s[4:7], s30 offen offset:0 sc1
    s_add_u32 s30, s30, 4096
    buffer_load_dwordx4 v[160:163], v241, s[4:7], s30 offen offset:0 sc1
    s_add_u32 s30, s30, 4096
    buffer_load_dwordx4 v[164:167], v241, s[4:7], s30 offen offset:0 sc1
    s_add_u32 s30, s30, 4096
    buffer_load_dwordx4 v[168:171], v241, s[4:7], s30 offen offset:0 sc1
    v_lshlrev_b32 v220, 16, v248
    v_and_b32 v221, 0xffff0000, v248
    v_lshlrev_b32 v222, 16, v249
    v_and_b32 v223, 0xffff0000, v249
    v_lshlrev_b32 v224, 16, v250
    v_and_b32 v225, 0xffff0000, v250
    v_lshlrev_b32 v226, 16, v251
    v_and_b32 v227, 0xffff0000, v251
    s_waitcnt vmcnt(7)
    v_mfma_f32_16x16x32_bf16 v[112:115], v[236:239], v[140:143], 0
    s_waitcnt vmcnt(6)
    v_mfma_f32_16x16x32_bf16 v[112:115], v[236:239], v[144:147], v[112:115]
    s_waitcnt vmcnt(5)
    v_mfma_f32_16x16x32_bf16 v[112:115], v[236:239], v[148:151], v[112:115]
    s_waitcnt vmcnt(4)
    v_mfma_f32_16x16x32_bf16 v[112:115], v[236:239], v[152:155], v[112:115]
    s_waitcnt vmcnt(3)
    v_mfma_f32_16x16x32_bf16 v[112:115], v[236:239], v[156:159], v[112:115]
    s_waitcnt vmcnt(2)
    v_mfma_f32_16x16x32_bf16 v[112:115], v[236:239], v[160:163], v[112:115]
    s_waitcnt vmcnt(1)
    v_mfma_f32_16x16x32_bf16 v[112:115], v[236:239], v[164:167], v[112:115]
    s_waitcnt vmcnt(0)
    v_mfma_f32_16x16x32_bf16 v[112:115], v[236:239], v[168:171], v[112:115]
    s_nop 7
    v_cvt_pk_bf16_f32 v130, v112, v113
    v_cvt_pk_bf16_f32 v131, v114, v115
    s_cmp_eq_u32 s91, 0
    s_cbranch_scc1 L_AST
    v_lshlrev_b32 v112, 16, v130
    v_and_b32 v113, 0xffff0000, v130
    v_lshlrev_b32 v114, 16, v131
    v_and_b32 v115, 0xffff0000, v131
    v_mul_f32 v112, v112, v224
    v_mul_f32 v113, v113, v225
    v_mul_f32 v114, v114, v226
    v_mul_f32 v115, v115, v227
    v_cvt_pk_bf16_f32 v130, v112, v113
    v_cvt_pk_bf16_f32 v131, v114, v115
    v_lshlrev_b32 v112, 16, v130
    v_and_b32 v113, 0xffff0000, v130
    v_lshlrev_b32 v114, 16, v131
    v_and_b32 v115, 0xffff0000, v131
    v_add_f32 v112, v112, v220
    v_add_f32 v113, v113, v221
    v_add_f32 v114, v114, v222
    v_add_f32 v115, v115, v223
    v_cvt_pk_bf16_f32 v130, v112, v113
    v_cvt_pk_bf16_f32 v131, v114, v115
    s_mov_b32 exec_hi, 0
    buffer_store_dwordx2 v[130:131], v242, s[8:11], s87 offen
    s_mov_b32 exec_hi, -1
    s_add_u32 s88, s88, 1
    s_add_u32 s89, s89, 0x28000
L_ANEXT:
    s_add_u32 s28, s28, 5
    s_add_u32 s33, s33, 0x140000
    s_add_u32 s87, s87, 0x28000
    s_xor_b32 s34, s34, 0x100000
    s_xor_b32 s82, s82, 0x100000
    s_cmp_lt_u32 s27, s26
    s_cbranch_scc1 L_AU
L_ADR:
    s_cmp_ge_u32 s88, s26
    s_cbranch_scc1 L_AEND
    buffer_load_dword v136, v244, s[4:7], s84 offen sc1
    s_waitcnt vmcnt(0)
    v_cmp_ne_u32 vcc, 0, v136
    s_mov_b32 s91, -1
    s_mov_b32 s90, vcc_lo
    s_branch L_AMR2
L_AST:
    s_sub_u32 s30, s27, 1
    s_lshl_b32 s30, s30, 9
    v_add_u32 v112, s30, v245
    ds_write_b64 v112, v[130:131]
    s_branch L_ANEXT
L_AMR:
    s_mov_b32 s91, 0
L_AMR2:
    s_cmp_ge_u32 s88, s27
    s_cbranch_scc1 L_AMW
    s_lshr_b32 s30, s90, s88
    s_bitcmp1_b32 s30, 0
    s_cbranch_scc0 L_AMW
    s_lshl_b32 s30, s88, 9
    v_add_u32 v188, s30, v245
    ds_read_b64 v[190:191], v188
    s_mov_b32 exec_hi, 0
    s_add_u32 s30, s89, 0x5400000
    buffer_load_dwordx2 v[192:193], v242, s[16:19], s89 offen
    buffer_load_dwordx2 v[194:195], v242, s[4:7], s30 offen sc1
    s_mov_b32 exec_hi, -1
    s_waitcnt vmcnt(0) lgkmcnt(0)
    v_lshlrev_b32 v220, 16, v192
    v_and_b32 v221, 0xffff0000, v192
    v_lshlrev_b32 v222, 16, v193
    v_and_b32 v223, 0xffff0000, v193
    v_lshlrev_b32 v224, 16, v194
    v_and_b32 v225, 0xffff0000, v194
    v_lshlrev_b32 v226, 16, v195
    v_and_b32 v227, 0xffff0000, v195
    v_lshlrev_b32 v196, 16, v190
    v_and_b32 v197, 0xffff0000, v190
    v_lshlrev_b32 v198, 16, v191
    v_and_b32 v199, 0xffff0000, v191
    v_mul_f32 v196, v196, v224
    v_mul_f32 v197, v197, v225
    v_mul_f32 v198, v198, v226
    v_mul_f32 v199, v199, v227
    v_cvt_pk_bf16_f32 v190, v196, v197
    v_cvt_pk_bf16_f32 v191, v198, v199
    v_lshlrev_b32 v196, 16, v190
    v_and_b32 v197, 0xffff0000, v190
    v_lshlrev_b32 v198, 16, v191
    v_and_b32 v199, 0xffff0000, v191
    v_add_f32 v196, v196, v220
    v_add_f32 v197, v197, v221
    v_add_f32 v198, v198, v222
    v_add_f32 v199, v199, v223
    v_cvt_pk_bf16_f32 v190, v196, v197
    v_cvt_pk_bf16_f32 v191, v198, v199
    s_mov_b32 exec_hi, 0
    buffer_store_dwordx2 v[190:191], v242, s[8:11], s89 offen
    s_mov_b32 exec_hi, -1
    s_add_u32 s88, s88, 1
    s_add_u32 s89, s89, 0x28000
    s_cmp_eq_u32 s91, 0
    s_cbranch_scc1 L_AMR2
    s_cmp_lt_u32 s88, s26
    s_cbranch_scc1 L_AMR2
    s_branch L_AEND
L_AMW:
    s_sleep 2
    s_sub_u32 s24, s24, 1
    s_cbranch_scc1 L_ABORT
    s_cmp_eq_u32 s91, 0
    s_cbranch_scc1 L_AM
    s_branch L_ADR
L_AWT:
    v_mfma_f32_16x16x32_bf16 v[188:191], a[0:3], v[172:175], 0
    v_mfma_f32_16x16x32_bf16 v[192:195], a[16:19], v[172:175], 0
    v_mfma_f32_16x16x32_bf16 v[188:191], a[4:7], v[176:179], v[188:191]
    v_mfma_f32_16x16x32_bf16 v[192:195], a[20:23], v[176:179], v[192:195]
    v_mfma_f32_16x16x32_bf16 v[188:191], a[8:11], v[180:183], v[188:191]
    v_mfma_f32_16x16x32_bf16 v[192:195], a[24:27], v[180:183], v[192:195]
    v_mfma_f32_16x16x32_bf16 v[188:191], a[12:15], v[184:187], v[188:191]
    v_mfma_f32_16x16x32_bf16 v[192:195], a[28:31], v[184:187], v[192:195]
    v_mfma_f32_16x16x32_bf16 v[196:199], a[32:35], v[172:175], 0
    v_mfma_f32_16x16x32_bf16 v[200:203], a[48:51], v[172:175], 0
    v_mfma_f32_16x16x32_bf16 v[196:199], a[36:39], v[176:179], v[196:199]
    v_cvt_pk_bf16_f32 v220, v188, v189
    v_mfma_f32_16x16x32_bf16 v[200:203], a[52:55], v[176:179], v[200:203]
    v_cvt_pk_bf16_f32 v221, v190, v191
    v_mfma_f32_16x16x32_bf16 v[196:199], a[40:43], v[180:183], v[196:199]
    v_cvt_pk_bf16_f32 v222, v192, v193
    v_mfma_f32_16x16x32_bf16 v[200:203], a[56:59], v[180:183], v[200:203]
    v_cvt_pk_bf16_f32 v223, v194, v195
    v_mfma_f32_16x16x32_bf16 v[196:199], a[44:47], v[184:187], v[196:199]
    buffer_store_dwordx4 v[220:223], v240, s[4:7], s30 offen sc1
    v_mfma_f32_16x16x32_bf16 v[200:203], a[60:63], v[184:187], v[200:203]
    s_add_u32 s30, s30, 0x10000
    v_mfma_f32_16x16x32_bf16 v[204:207], a[64:67], v[172:175], 0
    v_mfma_f32_16x16x32_bf16 v[208:211], a[80:83], v[172:175], 0
    v_mfma_f32_16x16x32_bf16 v[204:207], a[68:71], v[176:179], v[204:207]
    v_cvt_pk_bf16_f32 v224, v196, v197
    v_mfma_f32_16x16x32_bf16 v[208:211], a[84:87], v[176:179], v[208:211]
    v_cvt_pk_bf16_f32 v225, v198, v199
    v_mfma_f32_16x16x32_bf16 v[204:207], a[72:75], v[180:183], v[204:207]
    v_cvt_pk_bf16_f32 v226, v200, v201
    v_mfma_f32_16x16x32_bf16 v[208:211], a[88:91], v[180:183], v[208:211]
    v_cvt_pk_bf16_f32 v227, v202, v203
    v_mfma_f32_16x16x32_bf16 v[204:207], a[76:79], v[184:187], v[204:207]
    buffer_store_dwordx4 v[224:227], v240, s[4:7], s30 offen sc1
    v_mfma_f32_16x16x32_bf16 v[208:211], a[92:95], v[184:187], v[208:211]
    s_add_u32 s30, s30, 0x10000
    v_mfma_f32_16x16x32_bf16 v[212:215], a[96:99], v[172:175], 0
    v_mfma_f32_16x16x32_bf16 v[216:219], a[112:115], v[172:175], 0
    v_mfma_f32_16x16x32_bf16 v[212:215], a[100:103], v[176:179], v[212:215]
    v_cvt_pk_bf16_f32 v228, v204, v205
    v_mfma_f32_16x16x32_bf16 v[216:219], a[116:119], v[176:179], v[216:219]
    v_cvt_pk_bf16_f32 v229, v206, v207
    v_mfma_f32_16x16x32_bf16 v[212:215], a[104:107], v[180:183], v[212:215]
    v_cvt_pk_bf16_f32 v230, v208, v209
    v_mfma_f32_16x16x32_bf16 v[216:219], a[120:123], v[180:183], v[216:219]
    v_cvt_pk_bf16_f32 v231, v210, v211
    v_mfma_f32_16x16x32_bf16 v[212:215], a[108:111], v[184:187], v[212:215]
    buffer_store_dwordx4 v[228:231], v240, s[4:7], s30 offen sc1
    v_mfma_f32_16x16x32_bf16 v[216:219], a[124:127], v[184:187], v[216:219]
    s_add_u32 s30, s30, 0x10000
    v_mfma_f32_16x16x32_bf16 v[188:191], a[128:131], v[172:175], 0
    v_mfma_f32_16x16x32_bf16 v[192:195], a[144:147], v[172:175], 0
    v_mfma_f32_16x16x32_bf16 v[188:191], a[132:135], v[176:179], v[188:191]
    v_cvt_pk_bf16_f32 v232, v212, v213
    v_mfma_f32_16x16x32_bf16 v[192:195], a[148:151], v[176:179], v[192:195]
    v_cvt_pk_bf16_f32 v233, v214, v215
    v_mfma_f32_16x16x32_bf16 v[188:191], a[136:139], v[180:183], v[188:191]
    v_cvt_pk_bf16_f32 v234, v216, v217
    v_mfma_f32_16x16x32_bf16 v[192:195], a[152:155], v[180:183], v[192:195]
    v_cvt_pk_bf16_f32 v235, v218, v219
    v_mfma_f32_16x16x32_bf16 v[188:191], a[140:143], v[184:187], v[188:191]
    buffer_store_dwordx4 v[232:235], v240, s[4:7], s30 offen sc1
    v_mfma_f32_16x16x32_bf16 v[192:195], a[156:159], v[184:187], v[192:195]
    s_add_u32 s30, s30, 0x10000
    v_mfma_f32_16x16x32_bf16 v[196:199], a[160:163], v[172:175], 0
    v_mfma_f32_16x16x32_bf16 v[200:203], a[176:179], v[172:175], 0
    v_mfma_f32_16x16x32_bf16 v[196:199], a[164:167], v[176:179], v[196:199]
    v_cvt_pk_bf16_f32 v220, v188, v189
    v_mfma_f32_16x16x32_bf16 v[200:203], a[180:183], v[176:179], v[200:203]
    v_cvt_pk_bf16_f32 v221, v190, v191
    v_mfma_f32_16x16x32_bf16 v[196:199], a[168:171], v[180:183], v[196:199]
    v_cvt_pk_bf16_f32 v222, v192, v193
    v_mfma_f32_16x16x32_bf16 v[200:203], a[184:187], v[180:183], v[200:203]
    v_cvt_pk_bf16_f32 v223, v194, v195
    v_mfma_f32_16x16x32_bf16 v[196:199], a[172:175], v[184:187], v[196:199]
    buffer_store_dwordx4 v[220:223], v240, s[4:7], s30 offen sc1
    v_mfma_f32_16x16x32_bf16 v[200:203], a[188:191], v[184:187], v[200:203]
    s_add_u32 s30, s30, 0x10000
    v_mfma_f32_16x16x32_bf16 v[204:207], a[192:195], v[172:175], 0
    v_mfma_f32_16x16x32_bf16 v[208:211], a[208:211], v[172:175], 0
    v_mfma_f32_16x16x32_bf16 v[204:207], a[196:199], v[176:179], v[204:207]
    v_cvt_pk_bf16_f32 v224, v196, v197
    v_mfma_f32_16x16x32_bf16 v[208:211], a[212:215], v[176:179], v[208:211]
    v_cvt_pk_bf16_f32 v225, v198, v199
    v_mfma_f32_16x16x32_bf16 v[204:207], a[200:203], v[180:183], v[204:207]
    v_cvt_pk_bf16_f32 v226, v200, v201
    v_mfma_f32_16x16x32_bf16 v[208:211], a[216:219], v[180:183], v[208:211]
    v_cvt_pk_bf16_f32 v227, v202, v203
    v_mfma_f32_16x16x32_bf16 v[204:207], a[204:207], v[184:187], v[204:207]
    buffer_store_dwordx4 v[224:227], v240, s[4:7], s30 offen sc1
    v_mfma_f32_16x16x32_bf16 v[208:211], a[220:223], v[184:187], v[208:211]
    s_add_u32 s30, s30, 0x10000
    v_mfma_f32_16x16x32_bf16 v[212:215], a[224:227], v[172:175], 0
    v_mfma_f32_16x16x32_bf16 v[216:219], a[240:243], v[172:175], 0
    v_mfma_f32_16x16x32_bf16 v[212:215], a[228:231], v[176:179], v[212:215]
    v_cvt_pk_bf16_f32 v228, v204, v205
    v_mfma_f32_16x16x32_bf16 v[216:219], a[244:247], v[176:179], v[216:219]
    v_cvt_pk_bf16_f32 v229, v206, v207
    v_mfma_f32_16x16x32_bf16 v[212:215], a[232:235], v[180:183], v[212:215]
    v_cvt_pk_bf16_f32 v230, v208, v209
    v_mfma_f32_16x16x32_bf16 v[216:219], a[248:251], v[180:183], v[216:219]
    v_cvt_pk_bf16_f32 v231, v210, v211
    v_mfma_f32_16x16x32_bf16 v[212:215], a[236:239], v[184:187], v[212:215]
    buffer_store_dwordx4 v[228:231], v240, s[4:7], s30 offen sc1
    v_mfma_f32_16x16x32_bf16 v[216:219], a[252:255], v[184:187], v[216:219]
    s_add_u32 s30, s30, 0x10000
    s_nop 2
    v_cvt_pk_bf16_f32 v232, v212, v213
    v_cvt_pk_bf16_f32 v233, v214, v215
    s_nop 1
    v_cvt_pk_bf16_f32 v234, v216, v217
    v_cvt_pk_bf16_f32 v235, v218, v219
    buffer_store_dwordx4 v[232:235], v240, s[4:7], s30 offen sc1
    s_add_u32 s30, s30, 0x10000
    s_branch L_AWT2
L_AFR:
    s_sub_u32 s24, s24, 1
    s_cbranch_scc1 L_ABORT
    s_branch L_AF
L_AEND:
    s_waitcnt vmcnt(0)
    s_endpgm
L_ROLEB:
    s_lshl_b32 s25, s20, 14
    s_add_u32 s25, s25, 98304
    s_lshl_b32 s28, s21, 16
    s_mov_b32 s34, 0xbdd2d3e8
    s_mov_b32 s35, 0xbdd2d3e8
    s_mov_b32 s16, s36
    s_mov_b32 s17, s37
    s_mov_b32 s18, 0x200000
    s_mov_b32 s19, 0x00020000
    v_lshrrev_b32 v1, 4, v0
    s_lshl_b32 s30, s20, 2
    v_add_u32 v1, s30, v1
    v_and_b32 v2, 15, v0
    v_lshlrev_b32 v3, 10, v1
    v_lshl_add_u32 v122, v2, 4, v3
    s_sub_u32 s30, s28, 2048
    v_add_u32 v120, s30, v122
    v_xor_b32 v4, v2, v1
    v_lshl_add_u32 v121, v4, 4, v3
    buffer_load_dwordx4 v[96:99], v120, s[16:19], 0 offen offset:0
    buffer_load_dwordx4 v[100:103], v120, s[16:19], 0 offen offset:256
    buffer_load_dwordx4 v[104:107], v120, s[16:19], 0 offen offset:512
    buffer_load_dwordx4 v[108:111], v120, s[16:19], 0 offen offset:768
    s_lshl_b32 s30, s21, 2
    s_add_u32 s30, s30, s20
    s_lshl_b32 s30, s30, 13
    v_lshlrev_b32 v5, 7, v0
    s_mov_b32 s8, s52
    s_mov_b32 s9, s53
    s_mov_b32 s10, 0x80000
    s_mov_b32 s11, 0x00020000
    s_lshr_b32 s31, s30, 1
    v_lshrrev_b32 v6, 1, v5
    buffer_load_dword v7, v6, s[8:11], s31 offen
    s_mov_b32 s8, s54
    s_mov_b32 s9, s55
    s_mov_b32 s10, 0x80000
    s_mov_b32 s11, 0x00020000
    s_lshr_b32 s31, s30, 1
    v_lshrrev_b32 v6, 1, v5
    buffer_load_dword v7, v6, s[8:11], s31 offen
    v_lshrrev_b32 v1, 4, v0
    v_lshlrev_b32 v3, 2, v1
    v_xor_b32 v3, v3, v2
    v_lshlrev_b32 v3, 4, v3
    v_lshl_add_u32 v60, v1, 10, v3
    v_lshrrev_b32 v3, 3, v0
    v_mul_u32_u24 v3, 2752, v3
    v_and_b32 v4, 7, v0
    v_and_b32 v6, 1, v1
    v_lshlrev_b32 v6, 2, v6
    v_xor_b32 v4, v4, v6
    v_lshl_add_u32 v61, v4, 4, v3
    s_mov_b32 s8, s52
    s_mov_b32 s9, s53
    s_mov_b32 s10, 0x80000
    s_mov_b32 s11, 0x00020000
    s_lshl_b32 s26, s20, 8
    s_sub_u32 s26, s26, 4096
    s_add_u32 m0, s25, 0
    s_add_u32 s26, s26, 4096
    buffer_load_dwordx4 v60, s[8:11], s26 offen lds
    s_add_u32 m0, s25, 1024
    s_add_u32 s26, s26, 4096
    buffer_load_dwordx4 v60, s[8:11], s26 offen lds
    s_add_u32 m0, s25, 2048
    s_add_u32 s26, s26, 4096
    buffer_load_dwordx4 v60, s[8:11], s26 offen lds
    s_add_u32 m0, s25, 3072
    s_add_u32 s26, s26, 4096
    buffer_load_dwordx4 v60, s[8:11], s26 offen lds
    s_add_u32 m0, s25, 4096
    s_add_u32 s26, s26, 4096
    buffer_load_dwordx4 v60, s[8:11], s26 offen lds
    s_add_u32 m0, s25, 5120
    s_add_u32 s26, s26, 4096
    buffer_load_dwordx4 v60, s[8:11], s26 offen lds
    s_add_u32 m0, s25, 6144
    s_add_u32 s26, s26, 4096
    buffer_load_dwordx4 v60, s[8:11], s26 offen lds
    s_add_u32 m0, s25, 7168
    s_add_u32 s26, s26, 4096
    buffer_load_dwordx4 v60, s[8:11], s26 offen lds
    s_add_u32 m0, s25, 8192
    s_add_u32 s26, s26, 4096
    buffer_load_dwordx4 v60, s[8:11], s26 offen lds
    s_add_u32 m0, s25, 9216
    s_add_u32 s26, s26, 4096
    buffer_load_dwordx4 v60, s[8:11], s26 offen lds
    s_add_u32 m0, s25, 10240
    s_add_u32 s26, s26, 4096
    buffer_load_dwordx4 v60, s[8:11], s26 offen lds
    s_add_u32 m0, s25, 11264
    s_add_u32 s26, s26, 4096
    buffer_load_dwordx4 v60, s[8:11], s26 offen lds
    s_mov_b32 s27, 0
    s_waitcnt vmcnt(14)
L_BLN:
    v_mov_b32 v16, v96
    v_mov_b32 v17, v97
    v_mov_b32 v18, v98
    v_mov_b32 v19, v99
    v_mov_b32 v20, v100
    v_mov_b32 v21, v101
    v_mov_b32 v22, v102
    v_mov_b32 v23, v103
    v_mov_b32 v24, v104
    v_mov_b32 v25, v105
    v_mov_b32 v26, v106
    v_mov_b32 v27, v107
    v_mov_b32 v28, v108
    v_mov_b32 v29, v109
    v_mov_b32 v30, v110
    v_mov_b32 v31, v111
    v_add_u32 v120, 0x4000, v120
    buffer_load_dwordx4 v[96:99], v120, s[16:19], 0 offen offset:0
    buffer_load_dwordx4 v[100:103], v120, s[16:19], 0 offen offset:256
    buffer_load_dwordx4 v[104:107], v120, s[16:19], 0 offen offset:512
    buffer_load_dwordx4 v[108:111], v120, s[16:19], 0 offen offset:768
    v_lshlrev_b32 v64, 16, v16
    v_and_b32 v65, 0xffff0000, v16
    v_lshlrev_b32 v66, 16, v17
    v_and_b32 v67, 0xffff0000, v17
    v_lshlrev_b32 v68, 16, v18
    v_and_b32 v69, 0xffff0000, v18
    v_lshlrev_b32 v70, 16, v19
    v_and_b32 v71, 0xffff0000, v19
    v_lshlrev_b32 v72, 16, v20
    v_and_b32 v73, 0xffff0000, v20
    v_lshlrev_b32 v74, 16, v21
    v_and_b32 v75, 0xffff0000, v21
    v_lshlrev_b32 v76, 16, v22
    v_and_b32 v77, 0xffff0000, v22
    v_lshlrev_b32 v78, 16, v23
    v_and_b32 v79, 0xffff0000, v23
    v_lshlrev_b32 v80, 16, v24
    v_and_b32 v81, 0xffff0000, v24
    v_lshlrev_b32 v82, 16, v25
    v_and_b32 v83, 0xffff0000, v25
    v_lshlrev_b32 v84, 16, v26
    v_and_b32 v85, 0xffff0000, v26
    v_lshlrev_b32 v86, 16, v27
    v_and_b32 v87, 0xffff0000, v27
    v_lshlrev_b32 v88, 16, v28
    v_and_b32 v89, 0xffff0000, v28
    v_lshlrev_b32 v90, 16, v29
    v_and_b32 v91, 0xffff0000, v29
    v_lshlrev_b32 v92, 16, v30
    v_and_b32 v93, 0xffff0000, v30
    v_lshlrev_b32 v94, 16, v31
    v_and_b32 v95, 0xffff0000, v31
    v_pk_add_f32 v[112:113], v[64:65], v[66:67]
    v_pk_add_f32 v[114:115], v[68:69], v[70:71]
    v_pk_add_f32 v[112:113], v[112:113], v[72:73]
    v_pk_add_f32 v[114:115], v[114:115], v[74:75]
    v_pk_add_f32 v[112:113], v[112:113], v[76:77]
    v_pk_add_f32 v[114:115], v[114:115], v[78:79]
    v_pk_add_f32 v[112:113], v[112:113], v[80:81]
    v_pk_add_f32 v[114:115], v[114:115], v[82:83]
    v_pk_add_f32 v[112:113], v[112:113], v[84:85]
    v_pk_add_f32 v[114:115], v[114:115], v[86:87]
    v_pk_add_f32 v[112:113], v[112:113], v[88:89]
    v_pk_add_f32 v[114:115], v[114:115], v[90:91]
    v_pk_add_f32 v[112:113], v[112:113], v[92:93]
    v_pk_add_f32 v[114:115], v[114:115], v[94:95]
    v_pk_add_f32 v[112:113], v[112:113], v[114:115]
    v_add_f32 v112, v112, v113
    s_nop 1
    v_add_f32_dpp v112, v112, v112 row_ror:8 row_mask:0xf bank_mask:0xf
    s_nop 1
    v_add_f32_dpp v112, v112, v112 row_ror:4 row_mask:0xf bank_mask:0xf
    s_nop 1
    v_add_f32_dpp v112, v112, v112 row_ror:2 row_mask:0xf bank_mask:0xf
    s_nop 1
    v_add_f32_dpp v112, v112, v112 row_ror:1 row_mask:0xf bank_mask:0xf
    v_mul_f32 v112, 0x3b000000, v112
    v_pk_add_f32 v[114:115], v[64:65], v[112:113] op_sel_hi:[1,0] neg_lo:[0,1] neg_hi:[0,1]
    v_pk_mul_f32 v[116:117], v[114:115], v[114:115]
    v_pk_add_f32 v[114:115], v[66:67], v[112:113] op_sel_hi:[1,0] neg_lo:[0,1] neg_hi:[0,1]
    v_pk_mul_f32 v[118:119], v[114:115], v[114:115]
    v_pk_add_f32 v[114:115], v[68:69], v[112:113] op_sel_hi:[1,0] neg_lo:[0,1] neg_hi:[0,1]
    v_pk_fma_f32 v[116:117], v[114:115], v[114:115], v[116:117]
    v_pk_add_f32 v[114:115], v[70:71], v[112:113] op_sel_hi:[1,0] neg_lo:[0,1] neg_hi:[0,1]
    v_pk_fma_f32 v[118:119], v[114:115], v[114:115], v[118:119]
    v_pk_add_f32 v[114:115], v[72:73], v[112:113] op_sel_hi:[1,0] neg_lo:[0,1] neg_hi:[0,1]
    v_pk_fma_f32 v[116:117], v[114:115], v[114:115], v[116:117]
    v_pk_add_f32 v[114:115], v[74:75], v[112:113] op_sel_hi:[1,0] neg_lo:[0,1] neg_hi:[0,1]
    v_pk_fma_f32 v[118:119], v[114:115], v[114:115], v[118:119]
    v_pk_add_f32 v[114:115], v[76:77], v[112:113] op_sel_hi:[1,0] neg_lo:[0,1] neg_hi:[0,1]
    v_pk_fma_f32 v[116:117], v[114:115], v[114:115], v[116:117]
    v_pk_add_f32 v[114:115], v[78:79], v[112:113] op_sel_hi:[1,0] neg_lo:[0,1] neg_hi:[0,1]
    v_pk_fma_f32 v[118:119], v[114:115], v[114:115], v[118:119]
    v_pk_add_f32 v[114:115], v[80:81], v[112:113] op_sel_hi:[1,0] neg_lo:[0,1] neg_hi:[0,1]
    v_pk_fma_f32 v[116:117], v[114:115], v[114:115], v[116:117]
    v_pk_add_f32 v[114:115], v[82:83], v[112:113] op_sel_hi:[1,0] neg_lo:[0,1] neg_hi:[0,1]
    v_pk_fma_f32 v[118:119], v[114:115], v[114:115], v[118:119]
    v_pk_add_f32 v[114:115], v[84:85], v[112:113] op_sel_hi:[1,0] neg_lo:[0,1] neg_hi:[0,1]
    v_pk_fma_f32 v[116:117], v[114:115], v[114:115], v[116:117]
    v_pk_add_f32 v[114:115], v[86:87], v[112:113] op_sel_hi:[1,0] neg_lo:[0,1] neg_hi:[0,1]
    v_pk_fma_f32 v[118:119], v[114:115], v[114:115], v[118:119]
    v_pk_add_f32 v[114:115], v[88:89], v[112:113] op_sel_hi:[1,0] neg_lo:[0,1] neg_hi:[0,1]
    v_pk_fma_f32 v[116:117], v[114:115], v[114:115], v[116:117]
    v_pk_add_f32 v[114:115], v[90:91], v[112:113] op_sel_hi:[1,0] neg_lo:[0,1] neg_hi:[0,1]
    v_pk_fma_f32 v[118:119], v[114:115], v[114:115], v[118:119]
    v_pk_add_f32 v[114:115], v[92:93], v[112:113] op_sel_hi:[1,0] neg_lo:[0,1] neg_hi:[0,1]
    v_pk_fma_f32 v[116:117], v[114:115], v[114:115], v[116:117]
    v_pk_add_f32 v[114:115], v[94:95], v[112:113] op_sel_hi:[1,0] neg_lo:[0,1] neg_hi:[0,1]
    v_pk_fma_f32 v[118:119], v[114:115], v[114:115], v[118:119]
    v_pk_add_f32 v[116:117], v[116:117], v[118:119]
    v_add_f32 v116, v116, v117
    s_nop 1
    v_add_f32_dpp v116, v116, v116 row_ror:8 row_mask:0xf bank_mask:0xf
    s_nop 1
    v_add_f32_dpp v116, v116, v116 row_ror:4 row_mask:0xf bank_mask:0xf
    s_nop 1
    v_add_f32_dpp v116, v116, v116 row_ror:2 row_mask:0xf bank_mask:0xf
    s_nop 1
    v_add_f32_dpp v116, v116, v116 row_ror:1 row_mask:0xf bank_mask:0xf
    v_mul_f32 v116, 0x3b000000, v116
    v_cvt_pk_bf16_f32 v112, v112, v112
    v_lshlrev_b32 v112, 16, v112
    v_cvt_pk_bf16_f32 v116, v116, v116
    v_lshlrev_b32 v116, 16, v116
    v_add_f32 v116, 0x3727c5ac, v116
    v_cvt_pk_bf16_f32 v116, v116, v116
    v_lshlrev_b32 v116, 16, v116
    v_sqrt_f32 v116, v116
    s_nop 0
    v_cvt_pk_bf16_f32 v116, v116, v116
    v_lshlrev_b32 v116, 16, v116
    v_rcp_f32 v116, v116
    v_pk_add_f32 v[114:115], v[64:65], v[112:113] op_sel_hi:[1,0] neg_lo:[0,1] neg_hi:[0,1]
    v_cvt_pk_bf16_f32 v115, v114, v115
    v_lshlrev_b32 v114, 16, v115
    v_and_b32 v115, 0xffff0000, v115
    v_pk_mul_f32 v[114:115], v[114:115], v[116:117] op_sel_hi:[1,0]
    v_cvt_pk_bf16_f32 v16, v114, v115
    v_pk_add_f32 v[118:119], v[66:67], v[112:113] op_sel_hi:[1,0] neg_lo:[0,1] neg_hi:[0,1]
    v_cvt_pk_bf16_f32 v119, v118, v119
    v_lshlrev_b32 v118, 16, v119
    v_and_b32 v119, 0xffff0000, v119
    v_pk_mul_f32 v[118:119], v[118:119], v[116:117] op_sel_hi:[1,0]
    v_cvt_pk_bf16_f32 v17, v118, v119
    v_pk_add_f32 v[114:115], v[68:69], v[112:113] op_sel_hi:[1,0] neg_lo:[0,1] neg_hi:[0,1]
    v_cvt_pk_bf16_f32 v115, v114, v115
    v_lshlrev_b32 v114, 16, v115
    v_and_b32 v115, 0xffff0000, v115
    v_pk_mul_f32 v[114:115], v[114:115], v[116:117] op_sel_hi:[1,0]
    v_cvt_pk_bf16_f32 v18, v114, v115
    v_pk_add_f32 v[118:119], v[70:71], v[112:113] op_sel_hi:[1,0] neg_lo:[0,1] neg_hi:[0,1]
    v_cvt_pk_bf16_f32 v119, v118, v119
    v_lshlrev_b32 v118, 16, v119
    v_and_b32 v119, 0xffff0000, v119
    v_pk_mul_f32 v[118:119], v[118:119], v[116:117] op_sel_hi:[1,0]
    v_cvt_pk_bf16_f32 v19, v118, v119
    v_pk_add_f32 v[114:115], v[72:73], v[112:113] op_sel_hi:[1,0] neg_lo:[0,1] neg_hi:[0,1]
    v_cvt_pk_bf16_f32 v115, v114, v115
    v_lshlrev_b32 v114, 16, v115
    v_and_b32 v115, 0xffff0000, v115
    v_pk_mul_f32 v[114:115], v[114:115], v[116:117] op_sel_hi:[1,0]
    v_cvt_pk_bf16_f32 v20, v114, v115
    v_pk_add_f32 v[118:119], v[74:75], v[112:113] op_sel_hi:[1,0] neg_lo:[0,1] neg_hi:[0,1]
    v_cvt_pk_bf16_f32 v119, v118, v119
    v_lshlrev_b32 v118, 16, v119
    v_and_b32 v119, 0xffff0000, v119
    v_pk_mul_f32 v[118:119], v[118:119], v[116:117] op_sel_hi:[1,0]
    v_cvt_pk_bf16_f32 v21, v118, v119
    v_pk_add_f32 v[114:115], v[76:77], v[112:113] op_sel_hi:[1,0] neg_lo:[0,1] neg_hi:[0,1]
    v_cvt_pk_bf16_f32 v115, v114, v115
    v_lshlrev_b32 v114, 16, v115
    v_and_b32 v115, 0xffff0000, v115
    v_pk_mul_f32 v[114:115], v[114:115], v[116:117] op_sel_hi:[1,0]
    v_cvt_pk_bf16_f32 v22, v114, v115
    v_pk_add_f32 v[118:119], v[78:79], v[112:113] op_sel_hi:[1,0] neg_lo:[0,1] neg_hi:[0,1]
    v_cvt_pk_bf16_f32 v119, v118, v119
    v_lshlrev_b32 v118, 16, v119
    v_and_b32 v119, 0xffff0000, v119
    v_pk_mul_f32 v[118:119], v[118:119], v[116:117] op_sel_hi:[1,0]
    v_cvt_pk_bf16_f32 v23, v118, v119
    v_pk_add_f32 v[114:115], v[80:81], v[112:113] op_sel_hi:[1,0] neg_lo:[0,1] neg_hi:[0,1]
    v_cvt_pk_bf16_f32 v115, v114, v115
    v_lshlrev_b32 v114, 16, v115
    v_and_b32 v115, 0xffff0000, v115
    v_pk_mul_f32 v[114:115], v[114:115], v[116:117] op_sel_hi:[1,0]
    v_cvt_pk_bf16_f32 v24, v114, v115
    v_pk_add_f32 v[118:119], v[82:83], v[112:113] op_sel_hi:[1,0] neg_lo:[0,1] neg_hi:[0,1]
    v_cvt_pk_bf16_f32 v119, v118, v119
    v_lshlrev_b32 v118, 16, v119
    v_and_b32 v119, 0xffff0000, v119
    v_pk_mul_f32 v[118:119], v[118:119], v[116:117] op_sel_hi:[1,0]
    v_cvt_pk_bf16_f32 v25, v118, v119
    v_pk_add_f32 v[114:115], v[84:85], v[112:113] op_sel_hi:[1,0] neg_lo:[0,1] neg_hi:[0,1]
    v_cvt_pk_bf16_f32 v115, v114, v115
    v_lshlrev_b32 v114, 16, v115
    v_and_b32 v115, 0xffff0000, v115
    v_pk_mul_f32 v[114:115], v[114:115], v[116:117] op_sel_hi:[1,0]
    v_cvt_pk_bf16_f32 v26, v114, v115
    v_pk_add_f32 v[118:119], v[86:87], v[112:113] op_sel_hi:[1,0] neg_lo:[0,1] neg_hi:[0,1]
    v_cvt_pk_bf16_f32 v119, v118, v119
    v_lshlrev_b32 v118, 16, v119
    v_and_b32 v119, 0xffff0000, v119
    v_pk_mul_f32 v[118:119], v[118:119], v[116:117] op_sel_hi:[1,0]
    v_cvt_pk_bf16_f32 v27, v118, v119
    v_pk_add_f32 v[114:115], v[88:89], v[112:113] op_sel_hi:[1,0] neg_lo:[0,1] neg_hi:[0,1]
    v_cvt_pk_bf16_f32 v115, v114, v115
    v_lshlrev_b32 v114, 16, v115
    v_and_b32 v115, 0xffff0000, v115
    v_pk_mul_f32 v[114:115], v[114:115], v[116:117] op_sel_hi:[1,0]
    v_cvt_pk_bf16_f32 v28, v114, v115
    v_pk_add_f32 v[118:119], v[90:91], v[112:113] op_sel_hi:[1,0] neg_lo:[0,1] neg_hi:[0,1]
    v_cvt_pk_bf16_f32 v119, v118, v119
    v_lshlrev_b32 v118, 16, v119
    v_and_b32 v119, 0xffff0000, v119
    v_pk_mul_f32 v[118:119], v[118:119], v[116:117] op_sel_hi:[1,0]
    v_cvt_pk_bf16_f32 v29, v118, v119
    v_pk_add_f32 v[114:115], v[92:93], v[112:113] op_sel_hi:[1,0] neg_lo:[0,1] neg_hi:[0,1]
    v_cvt_pk_bf16_f32 v115, v114, v115
    v_lshlrev_b32 v114, 16, v115
    v_and_b32 v115, 0xffff0000, v115
    v_pk_mul_f32 v[114:115], v[114:115], v[116:117] op_sel_hi:[1,0]
    v_cvt_pk_bf16_f32 v30, v114, v115
    v_pk_add_f32 v[118:119], v[94:95], v[112:113] op_sel_hi:[1,0] neg_lo:[0,1] neg_hi:[0,1]
    v_cvt_pk_bf16_f32 v119, v118, v119
    v_lshlrev_b32 v118, 16, v119
    v_and_b32 v119, 0xffff0000, v119
    v_pk_mul_f32 v[118:119], v[118:119], v[116:117] op_sel_hi:[1,0]
    v_cvt_pk_bf16_f32 v31, v118, v119
    v_subrev_u32 v1, 0x4000, v120
    v_subrev_u32 v2, s28, v1
    v_cmp_gt_u32 vcc, 0x10000, v2
    s_nop 1
    v_cndmask_b32 v1, -1, v1, vcc
    v_and_b32 v1, 0x7ffffff0, v1
    s_mov_b32 s30, 0x5000000
    buffer_store_dwordx4 v[16:19], v1, s[4:7], s30 offen offset:0 sc1
    buffer_store_dwordx4 v[20:23], v1, s[4:7], s30 offen offset:256 sc1
    buffer_store_dwordx4 v[24:27], v1, s[4:7], s30 offen offset:512 sc1
    buffer_store_dwordx4 v[28:31], v1, s[4:7], s30 offen offset:768 sc1
    v_lshlrev_b32 v64, 16, v16
    v_and_b32 v65, 0xffff0000, v16
    v_lshlrev_b32 v66, 16, v17
    v_and_b32 v67, 0xffff0000, v17
    v_lshlrev_b32 v68, 16, v18
    v_and_b32 v69, 0xffff0000, v18
    v_lshlrev_b32 v70, 16, v19
    v_and_b32 v71, 0xffff0000, v19
    v_lshlrev_b32 v72, 16, v20
    v_and_b32 v73, 0xffff0000, v20
    v_lshlrev_b32 v74, 16, v21
    v_and_b32 v75, 0xffff0000, v21
    v_lshlrev_b32 v76, 16, v22
    v_and_b32 v77, 0xffff0000, v22
    v_lshlrev_b32 v78, 16, v23
    v_and_b32 v79, 0xffff0000, v23
    v_lshlrev_b32 v80, 16, v24
    v_and_b32 v81, 0xffff0000, v24
    v_lshlrev_b32 v82, 16, v25
    v_and_b32 v83, 0xffff0000, v25
    v_lshlrev_b32 v84, 16, v26
    v_and_b32 v85, 0xffff0000, v26
    v_lshlrev_b32 v86, 16, v27
    v_and_b32 v87, 0xffff0000, v27
    v_lshlrev_b32 v88, 16, v28
    v_and_b32 v89, 0xffff0000, v28
    v_lshlrev_b32 v90, 16, v29
    v_and_b32 v91, 0xffff0000, v29
    v_lshlrev_b32 v92, 16, v30
    v_and_b32 v93, 0xffff0000, v30
    v_lshlrev_b32 v94, 16, v31
    v_and_b32 v95, 0xffff0000, v31
    v_pk_add_f32 v[112:113], v[64:65], v[66:67]
    v_pk_add_f32 v[114:115], v[68:69], v[70:71]
    v_pk_add_f32 v[112:113], v[112:113], v[72:73]
    v_pk_add_f32 v[114:115], v[114:115], v[74:75]
    v_pk_add_f32 v[112:113], v[112:113], v[76:77]
    v_pk_add_f32 v[114:115], v[114:115], v[78:79]
    v_pk_add_f32 v[112:113], v[112:113], v[80:81]
    v_pk_add_f32 v[114:115], v[114:115], v[82:83]
    v_pk_add_f32 v[112:113], v[112:113], v[84:85]
    v_pk_add_f32 v[114:115], v[114:115], v[86:87]
    v_pk_add_f32 v[112:113], v[112:113], v[88:89]
    v_pk_add_f32 v[114:115], v[114:115], v[90:91]
    v_pk_add_f32 v[112:113], v[112:113], v[92:93]
    v_pk_add_f32 v[114:115], v[114:115], v[94:95]
    v_pk_add_f32 v[112:113], v[112:113], v[114:115]
    v_add_f32 v112, v112, v113
    s_nop 1
    v_add_f32_dpp v112, v112, v112 row_ror:8 row_mask:0xf bank_mask:0xf
    s_nop 1
    v_add_f32_dpp v112, v112, v112 row_ror:4 row_mask:0xf bank_mask:0xf
    s_nop 1
    v_add_f32_dpp v112, v112, v112 row_ror:2 row_mask:0xf bank_mask:0xf
    s_nop 1
    v_add_f32_dpp v112, v112, v112 row_ror:1 row_mask:0xf bank_mask:0xf
    v_mul_f32 v112, 0x3b000000, v112
    v_pk_add_f32 v[114:115], v[64:65], v[112:113] op_sel_hi:[1,0] neg_lo:[0,1] neg_hi:[0,1]
    v_pk_mul_f32 v[116:117], v[114:115], v[114:115]
    v_pk_add_f32 v[114:115], v[66:67], v[112:113] op_sel_hi:[1,0] neg_lo:[0,1] neg_hi:[0,1]
    v_pk_mul_f32 v[118:119], v[114:115], v[114:115]
    v_pk_add_f32 v[114:115], v[68:69], v[112:113] op_sel_hi:[1,0] neg_lo:[0,1] neg_hi:[0,1]
    v_pk_fma_f32 v[116:117], v[114:115], v[114:115], v[116:117]
    v_pk_add_f32 v[114:115], v[70:71], v[112:113] op_sel_hi:[1,0] neg_lo:[0,1] neg_hi:[0,1]
    v_pk_fma_f32 v[118:119], v[114:115], v[114:115], v[118:119]
    v_pk_add_f32 v[114:115], v[72:73], v[112:113] op_sel_hi:[1,0] neg_lo:[0,1] neg_hi:[0,1]
    v_pk_fma_f32 v[116:117], v[114:115], v[114:115], v[116:117]
    v_pk_add_f32 v[114:115], v[74:75], v[112:113] op_sel_hi:[1,0] neg_lo:[0,1] neg_hi:[0,1]
    v_pk_fma_f32 v[118:119], v[114:115], v[114:115], v[118:119]
    v_pk_add_f32 v[114:115], v[76:77], v[112:113] op_sel_hi:[1,0] neg_lo:[0,1] neg_hi:[0,1]
    v_pk_fma_f32 v[116:117], v[114:115], v[114:115], v[116:117]
    v_pk_add_f32 v[114:115], v[78:79], v[112:113] op_sel_hi:[1,0] neg_lo:[0,1] neg_hi:[0,1]
    v_pk_fma_f32 v[118:119], v[114:115], v[114:115], v[118:119]
    v_pk_add_f32 v[114:115], v[80:81], v[112:113] op_sel_hi:[1,0] neg_lo:[0,1] neg_hi:[0,1]
    v_pk_fma_f32 v[116:117], v[114:115], v[114:115], v[116:117]
    v_pk_add_f32 v[114:115], v[82:83], v[112:113] op_sel_hi:[1,0] neg_lo:[0,1] neg_hi:[0,1]
    v_pk_fma_f32 v[118:119], v[114:115], v[114:115], v[118:119]
    v_pk_add_f32 v[114:115], v[84:85], v[112:113] op_sel_hi:[1,0] neg_lo:[0,1] neg_hi:[0,1]
    v_pk_fma_f32 v[116:117], v[114:115], v[114:115], v[116:117]
    v_pk_add_f32 v[114:115], v[86:87], v[112:113] op_sel_hi:[1,0] neg_lo:[0,1] neg_hi:[0,1]
    v_pk_fma_f32 v[118:119], v[114:115], v[114:115], v[118:119]
    v_pk_add_f32 v[114:115], v[88:89], v[112:113] op_sel_hi:[1,0] neg_lo:[0,1] neg_hi:[0,1]
    v_pk_fma_f32 v[116:117], v[114:115], v[114:115], v[116:117]
    v_pk_add_f32 v[114:115], v[90:91], v[112:113] op_sel_hi:[1,0] neg_lo:[0,1] neg_hi:[0,1]
    v_pk_fma_f32 v[118:119], v[114:115], v[114:115], v[118:119]
    v_pk_add_f32 v[114:115], v[92:93], v[112:113] op_sel_hi:[1,0] neg_lo:[0,1] neg_hi:[0,1]
    v_pk_fma_f32 v[116:117], v[114:115], v[114:115], v[116:117]
    v_pk_add_f32 v[114:115], v[94:95], v[112:113] op_sel_hi:[1,0] neg_lo:[0,1] neg_hi:[0,1]
    v_pk_fma_f32 v[118:119], v[114:115], v[114:115], v[118:119]
    v_pk_add_f32 v[116:117], v[116:117], v[118:119]
    v_add_f32 v116, v116, v117
    s_nop 1
    v_add_f32_dpp v116, v116, v116 row_ror:8 row_mask:0xf bank_mask:0xf
    s_nop 1
    v_add_f32_dpp v116, v116, v116 row_ror:4 row_mask:0xf bank_mask:0xf
    s_nop 1
    v_add_f32_dpp v116, v116, v116 row_ror:2 row_mask:0xf bank_mask:0xf
    s_nop 1
    v_add_f32_dpp v116, v116, v116 row_ror:1 row_mask:0xf bank_mask:0xf
    v_mul_f32 v116, 0x3b000000, v116
    v_cvt_pk_bf16_f32 v112, v112, v112
    v_lshlrev_b32 v112, 16, v112
    v_cvt_pk_bf16_f32 v116, v116, v116
    v_lshlrev_b32 v116, 16, v116
    v_add_f32 v116, 0x3727c5ac, v116
    v_cvt_pk_bf16_f32 v116, v116, v116
    v_lshlrev_b32 v116, 16, v116
    v_sqrt_f32 v116, v116
    s_nop 0
    v_cvt_pk_bf16_f32 v116, v116, v116
    v_lshlrev_b32 v116, 16, v116
    v_rcp_f32 v116, v116
    v_pk_add_f32 v[114:115], v[64:65], v[112:113] op_sel_hi:[1,0] neg_lo:[0,1] neg_hi:[0,1]
    v_cvt_pk_bf16_f32 v115, v114, v115
    v_lshlrev_b32 v114, 16, v115
    v_and_b32 v115, 0xffff0000, v115
    v_pk_mul_f32 v[114:115], v[114:115], v[116:117] op_sel_hi:[1,0]
    v_cvt_pk_bf16_f32 v32, v114, v115
    v_pk_add_f32 v[118:119], v[66:67], v[112:113] op_sel_hi:[1,0] neg_lo:[0,1] neg_hi:[0,1]
    v_cvt_pk_bf16_f32 v119, v118, v119
    v_lshlrev_b32 v118, 16, v119
    v_and_b32 v119, 0xffff0000, v119
    v_pk_mul_f32 v[118:119], v[118:119], v[116:117] op_sel_hi:[1,0]
    v_cvt_pk_bf16_f32 v33, v118, v119
    v_pk_add_f32 v[114:115], v[68:69], v[112:113] op_sel_hi:[1,0] neg_lo:[0,1] neg_hi:[0,1]
    v_cvt_pk_bf16_f32 v115, v114, v115
    v_lshlrev_b32 v114, 16, v115
    v_and_b32 v115, 0xffff0000, v115
    v_pk_mul_f32 v[114:115], v[114:115], v[116:117] op_sel_hi:[1,0]
    v_cvt_pk_bf16_f32 v34, v114, v115
    v_pk_add_f32 v[118:119], v[70:71], v[112:113] op_sel_hi:[1,0] neg_lo:[0,1] neg_hi:[0,1]
    v_cvt_pk_bf16_f32 v119, v118, v119
    v_lshlrev_b32 v118, 16, v119
    v_and_b32 v119, 0xffff0000, v119
    v_pk_mul_f32 v[118:119], v[118:119], v[116:117] op_sel_hi:[1,0]
    v_cvt_pk_bf16_f32 v35, v118, v119
    v_pk_add_f32 v[114:115], v[72:73], v[112:113] op_sel_hi:[1,0] neg_lo:[0,1] neg_hi:[0,1]
    v_cvt_pk_bf16_f32 v115, v114, v115
    v_lshlrev_b32 v114, 16, v115
    v_and_b32 v115, 0xffff0000, v115
    v_pk_mul_f32 v[114:115], v[114:115], v[116:117] op_sel_hi:[1,0]
    v_cvt_pk_bf16_f32 v36, v114, v115
    v_pk_add_f32 v[118:119], v[74:75], v[112:113] op_sel_hi:[1,0] neg_lo:[0,1] neg_hi:[0,1]
    v_cvt_pk_bf16_f32 v119, v118, v119
    v_lshlrev_b32 v118, 16, v119
    v_and_b32 v119, 0xffff0000, v119
    v_pk_mul_f32 v[118:119], v[118:119], v[116:117] op_sel_hi:[1,0]
    v_cvt_pk_bf16_f32 v37, v118, v119
    v_pk_add_f32 v[114:115], v[76:77], v[112:113] op_sel_hi:[1,0] neg_lo:[0,1] neg_hi:[0,1]
    v_cvt_pk_bf16_f32 v115, v114, v115
    v_lshlrev_b32 v114, 16, v115
    v_and_b32 v115, 0xffff0000, v115
    v_pk_mul_f32 v[114:115], v[114:115], v[116:117] op_sel_hi:[1,0]
    v_cvt_pk_bf16_f32 v38, v114, v115
    v_pk_add_f32 v[118:119], v[78:79], v[112:113] op_sel_hi:[1,0] neg_lo:[0,1] neg_hi:[0,1]
    v_cvt_pk_bf16_f32 v119, v118, v119
    v_lshlrev_b32 v118, 16, v119
    v_and_b32 v119, 0xffff0000, v119
    v_pk_mul_f32 v[118:119], v[118:119], v[116:117] op_sel_hi:[1,0]
    v_cvt_pk_bf16_f32 v39, v118, v119
    v_pk_add_f32 v[114:115], v[80:81], v[112:113] op_sel_hi:[1,0] neg_lo:[0,1] neg_hi:[0,1]
    v_cvt_pk_bf16_f32 v115, v114, v115
    v_lshlrev_b32 v114, 16, v115
    v_and_b32 v115, 0xffff0000, v115
    v_pk_mul_f32 v[114:115], v[114:115], v[116:117] op_sel_hi:[1,0]
    v_cvt_pk_bf16_f32 v40, v114, v115
    v_pk_add_f32 v[118:119], v[82:83], v[112:113] op_sel_hi:[1,0] neg_lo:[0,1] neg_hi:[0,1]
    v_cvt_pk_bf16_f32 v119, v118, v119
    v_lshlrev_b32 v118, 16, v119
    v_and_b32 v119, 0xffff0000, v119
    v_pk_mul_f32 v[118:119], v[118:119], v[116:117] op_sel_hi:[1,0]
    v_cvt_pk_bf16_f32 v41, v118, v119
    v_pk_add_f32 v[114:115], v[84:85], v[112:113] op_sel_hi:[1,0] neg_lo:[0,1] neg_hi:[0,1]
    v_cvt_pk_bf16_f32 v115, v114, v115
    v_lshlrev_b32 v114, 16, v115
    v_and_b32 v115, 0xffff0000, v115
    v_pk_mul_f32 v[114:115], v[114:115], v[116:117] op_sel_hi:[1,0]
    v_cvt_pk_bf16_f32 v42, v114, v115
    v_pk_add_f32 v[118:119], v[86:87], v[112:113] op_sel_hi:[1,0] neg_lo:[0,1] neg_hi:[0,1]
    v_cvt_pk_bf16_f32 v119, v118, v119
    v_lshlrev_b32 v118, 16, v119
    v_and_b32 v119, 0xffff0000, v119
    v_pk_mul_f32 v[118:119], v[118:119], v[116:117] op_sel_hi:[1,0]
    v_cvt_pk_bf16_f32 v43, v118, v119
    v_pk_add_f32 v[114:115], v[88:89], v[112:113] op_sel_hi:[1,0] neg_lo:[0,1] neg_hi:[0,1]
    v_cvt_pk_bf16_f32 v115, v114, v115
    v_lshlrev_b32 v114, 16, v115
    v_and_b32 v115, 0xffff0000, v115
    v_pk_mul_f32 v[114:115], v[114:115], v[116:117] op_sel_hi:[1,0]
    v_cvt_pk_bf16_f32 v44, v114, v115
    v_pk_add_f32 v[118:119], v[90:91], v[112:113] op_sel_hi:[1,0] neg_lo:[0,1] neg_hi:[0,1]
    v_cvt_pk_bf16_f32 v119, v118, v119
    v_lshlrev_b32 v118, 16, v119
    v_and_b32 v119, 0xffff0000, v119
    v_pk_mul_f32 v[118:119], v[118:119], v[116:117] op_sel_hi:[1,0]
    v_cvt_pk_bf16_f32 v45, v118, v119
    v_pk_add_f32 v[114:115], v[92:93], v[112:113] op_sel_hi:[1,0] neg_lo:[0,1] neg_hi:[0,1]
    v_cvt_pk_bf16_f32 v115, v114, v115
    v_lshlrev_b32 v114, 16, v115
    v_and_b32 v115, 0xffff0000, v115
    v_pk_mul_f32 v[114:115], v[114:115], v[116:117] op_sel_hi:[1,0]
    v_cvt_pk_bf16_f32 v46, v114, v115
    v_pk_add_f32 v[118:119], v[94:95], v[112:113] op_sel_hi:[1,0] neg_lo:[0,1] neg_hi:[0,1]
    v_cvt_pk_bf16_f32 v119, v118, v119
    v_lshlrev_b32 v118, 16, v119
    v_and_b32 v119, 0xffff0000, v119
    v_pk_mul_f32 v[118:119], v[118:119], v[116:117] op_sel_hi:[1,0]
    v_cvt_pk_bf16_f32 v47, v118, v119
    ds_write_b128 v121, v[32:35] offset:0
    ds_write_b128 v121, v[36:39] offset:256
    ds_write_b128 v121, v[40:43] offset:512
    ds_write_b128 v121, v[44:47] offset:768
    v_add_u32 v121, 0x4000, v121
    s_add_u32 s27, s27, 1
    s_cmp_eq_u32 s20, 0
    s_cselect_b32 s30, 5, 4
    s_cmp_lt_u32 s27, s30
    s_waitcnt vmcnt(4)
    s_cbranch_scc1 L_BLN
    s_mov_b32 s30, 0x04000301
    s_lshl_b32 s31, s20, 3
    s_lshr_b32 s30, s30, s31
    s_and_b32 s69, s30, 7
    v_mbcnt_lo_u32_b32 v0, -1, 0
    v_mbcnt_hi_u32_b32 v0, -1, v0
    v_and_b32 v1, 31, v0
    v_add_u32 v1, s69, v1
    v_lshrrev_b32 v2, 5, v0
    v_and_b32 v3, 15, v1
    v_xor_b32 v2, v2, v3
    v_lshlrev_b32 v2, 4, v2
    v_lshl_add_u32 v1, v1, 10, v2
    v_xor_b32 v48, 0, v1
    v_xor_b32 v49, 32, v1
    v_xor_b32 v50, 64, v1
    v_xor_b32 v51, 96, v1
    v_xor_b32 v52, 128, v1
    v_xor_b32 v53, 160, v1
    v_xor_b32 v54, 192, v1
    v_xor_b32 v55, 224, v1
    v_mbcnt_lo_u32_b32 v0, -1, 0
    v_mbcnt_hi_u32_b32 v0, -1, v0
    v_bfe_u32 v1, v0, 2, 2
    v_lshrrev_b32 v2, 5, v0
    v_lshl_add_u32 v2, v2, 3, v1
    v_lshlrev_b32 v2, 8, v2
    v_lshl_add_u32 v2, v1, 6, v2
    v_bfe_u32 v1, v0, 4, 1
    v_lshl_add_u32 v2, v1, 5, v2
    v_and_b32 v1, 3, v0
    v_lshl_add_u32 v2, v1, 3, v2
    v_add_u32 v2, s25, v2
    v_xor_b32 v56, 0, v2
    v_xor_b32 v57, 64, v2
    v_xor_b32 v58, 128, v2
    v_xor_b32 v59, 192, v2
    s_mov_b32 s68, 0
    s_waitcnt lgkmcnt(0)
    s_barrier
L_B12:
    s_waitcnt vmcnt(8)
    ds_read_b128 v[32:35], v48 offset:0
    ds_read_b128 v[36:39], v48 offset:32768
    ds_read_b64_tr_b16 v[0:1], v56 offset:0
    ds_read_b64_tr_b16 v[2:3], v56 offset:1024
    ds_read_b64_tr_b16 v[4:5], v57 offset:0
    ds_read_b64_tr_b16 v[6:7], v57 offset:1024
    ds_read_b64_tr_b16 v[8:9], v58 offset:0
    ds_read_b64_tr_b16 v[10:11], v58 offset:1024
    ds_read_b64_tr_b16 v[12:13], v59 offset:0
    ds_read_b64_tr_b16 v[14:15], v59 offset:1024
    s_waitcnt lgkmcnt(0)
    v_mfma_f32_32x32x16_bf16 v[128:143], v[0:3], v[32:35], 0
    s_add_u32 m0, s25, 12288
    s_add_u32 s26, s26, 4096
    buffer_load_dwordx4 v60, s[8:11], s26 offen lds
    v_mfma_f32_32x32x16_bf16 v[144:159], v[0:3], v[36:39], 0
    s_add_u32 m0, s25, 13312
    s_add_u32 s26, s26, 4096
    buffer_load_dwordx4 v60, s[8:11], s26 offen lds
    v_mfma_f32_32x32x16_bf16 v[160:175], v[4:7], v[32:35], 0
    s_add_u32 m0, s25, 14336
    s_add_u32 s26, s26, 4096
    buffer_load_dwordx4 v60, s[8:11], s26 offen lds
    v_mfma_f32_32x32x16_bf16 v[176:191], v[4:7], v[36:39], 0
    s_add_u32 m0, s25, 15360
    s_add_u32 s26, s26, 4096
    buffer_load_dwordx4 v60, s[8:11], s26 offen lds
    s_waitcnt vmcnt(8)
    ds_read_b128 v[40:43], v49 offset:0
    ds_read_b128 v[44:47], v49 offset:32768
    v_mfma_f32_32x32x16_bf16 v[192:207], v[8:11], v[32:35], 0
    ds_read_b64_tr_b16 v[16:17], v56 offset:4096
    ds_read_b64_tr_b16 v[18:19], v56 offset:5120
    v_mfma_f32_32x32x16_bf16 v[208:223], v[8:11], v[36:39], 0
    ds_read_b64_tr_b16 v[20:21], v57 offset:4096
    ds_read_b64_tr_b16 v[22:23], v57 offset:5120
    v_mfma_f32_32x32x16_bf16 v[224:239], v[12:15], v[32:35], 0
    ds_read_b64_tr_b16 v[24:25], v58 offset:4096
    ds_read_b64_tr_b16 v[26:27], v58 offset:5120
    v_mfma_f32_32x32x16_bf16 v[240:255], v[12:15], v[36:39], 0
    ds_read_b64_tr_b16 v[28:29], v59 offset:4096
    ds_read_b64_tr_b16 v[30:31], v59 offset:5120
    s_waitcnt lgkmcnt(0)
    v_mfma_f32_32x32x16_bf16 v[128:143], v[16:19], v[40:43], v[128:143]
    s_add_u32 m0, s25, 0
    s_add_u32 s26, s26, 4096
    buffer_load_dwordx4 v60, s[8:11], s26 offen lds
    v_mfma_f32_32x32x16_bf16 v[144:159], v[16:19], v[44:47], v[144:159]
    s_add_u32 m0, s25, 1024
    s_add_u32 s26, s26, 4096
    buffer_load_dwordx4 v60, s[8:11], s26 offen lds
    v_mfma_f32_32x32x16_bf16 v[160:175], v[20:23], v[40:43], v[160:175]
    s_add_u32 m0, s25, 2048
    s_add_u32 s26, s26, 4096
    buffer_load_dwordx4 v60, s[8:11], s26 offen lds
    v_mfma_f32_32x32x16_bf16 v[176:191], v[20:23], v[44:47], v[176:191]
    s_add_u32 m0, s25, 3072
    s_add_u32 s26, s26, 4096
    buffer_load_dwordx4 v60, s[8:11], s26 offen lds
    s_waitcnt vmcnt(8)
    ds_read_b128 v[32:35], v50 offset:0
    ds_read_b128 v[36:39], v50 offset:32768
    v_mfma_f32_32x32x16_bf16 v[192:207], v[24:27], v[40:43], v[192:207]
    ds_read_b64_tr_b16 v[0:1], v56 offset:8192
    ds_read_b64_tr_b16 v[2:3], v56 offset:9216
    v_mfma_f32_32x32x16_bf16 v[208:223], v[24:27], v[44:47], v[208:223]
    ds_read_b64_tr_b16 v[4:5], v57 offset:8192
    ds_read_b64_tr_b16 v[6:7], v57 offset:9216
    v_mfma_f32_32x32x16_bf16 v[224:239], v[28:31], v[40:43], v[224:239]
    ds_read_b64_tr_b16 v[8:9], v58 offset:8192
    ds_read_b64_tr_b16 v[10:11], v58 offset:9216
    v_mfma_f32_32x32x16_bf16 v[240:255], v[28:31], v[44:47], v[240:255]
    ds_read_b64_tr_b16 v[12:13], v59 offset:8192
    ds_read_b64_tr_b16 v[14:15], v59 offset:9216
    s_waitcnt lgkmcnt(0)
    v_mfma_f32_32x32x16_bf16 v[128:143], v[0:3], v[32:35], v[128:143]
    s_add_u32 m0, s25, 4096
    s_add_u32 s26, s26, 4096
    buffer_load_dwordx4 v60, s[8:11], s26 offen lds
    v_mfma_f32_32x32x16_bf16 v[144:159], v[0:3], v[36:39], v[144:159]
    s_add_u32 m0, s25, 5120
    s_add_u32 s26, s26, 4096
    buffer_load_dwordx4 v60, s[8:11], s26 offen lds
    v_mfma_f32_32x32x16_bf16 v[160:175], v[4:7], v[32:35], v[160:175]
    s_add_u32 m0, s25, 6144
    s_add_u32 s26, s26, 4096
    buffer_load_dwordx4 v60, s[8:11], s26 offen lds
    v_mfma_f32_32x32x16_bf16 v[176:191], v[4:7], v[36:39], v[176:191]
    s_add_u32 m0, s25, 7168
    s_add_u32 s26, s26, 4096
    buffer_load_dwordx4 v60, s[8:11], s26 offen lds
    s_waitcnt vmcnt(8)
    ds_read_b128 v[40:43], v51 offset:0
    ds_read_b128 v[44:47], v51 offset:32768
    v_mfma_f32_32x32x16_bf16 v[192:207], v[8:11], v[32:35], v[192:207]
    ds_read_b64_tr_b16 v[16:17], v56 offset:12288
    ds_read_b64_tr_b16 v[18:19], v56 offset:13312
    v_mfma_f32_32x32x16_bf16 v[208:223], v[8:11], v[36:39], v[208:223]
    ds_read_b64_tr_b16 v[20:21], v57 offset:12288
    ds_read_b64_tr_b16 v[22:23], v57 offset:13312
    v_mfma_f32_32x32x16_bf16 v[224:239], v[12:15], v[32:35], v[224:239]
    ds_read_b64_tr_b16 v[24:25], v58 offset:12288
    ds_read_b64_tr_b16 v[26:27], v58 offset:13312
    v_mfma_f32_32x32x16_bf16 v[240:255], v[12:15], v[36:39], v[240:255]
    ds_read_b64_tr_b16 v[28:29], v59 offset:12288
    ds_read_b64_tr_b16 v[30:31], v59 offset:13312
    s_waitcnt lgkmcnt(0)
    v_mfma_f32_32x32x16_bf16 v[128:143], v[16:19], v[40:43], v[128:143]
    s_add_u32 m0, s25, 8192
    s_add_u32 s26, s26, 4096
    buffer_load_dwordx4 v60, s[8:11], s26 offen lds
    v_mfma_f32_32x32x16_bf16 v[144:159], v[16:19], v[44:47], v[144:159]
    s_add_u32 m0, s25, 9216
    s_add_u32 s26, s26, 4096
    buffer_load_dwordx4 v60, s[8:11], s26 offen lds
    v_mfma_f32_32x32x16_bf16 v[160:175], v[20:23], v[40:43], v[160:175]
    s_add_u32 m0, s25, 10240
    s_add_u32 s26, s26, 4096
    buffer_load_dwordx4 v60, s[8:11], s26 offen lds
    v_mfma_f32_32x32x16_bf16 v[176:191], v[20:23], v[44:47], v[176:191]
    s_add_u32 m0, s25, 11264
    s_add_u32 s26, s26, 4096
    buffer_load_dwordx4 v60, s[8:11], s26 offen lds
    s_waitcnt vmcnt(8)
    ds_read_b128 v[32:35], v52 offset:0
    ds_read_b128 v[36:39], v52 offset:32768
    v_mfma_f32_32x32x16_bf16 v[192:207], v[24:27], v[40:43], v[192:207]
    ds_read_b64_tr_b16 v[0:1], v56 offset:0
    ds_read_b64_tr_b16 v[2:3], v56 offset:1024
    v_mfma_f32_32x32x16_bf16 v[208:223], v[24:27], v[44:47], v[208:223]
    ds_read_b64_tr_b16 v[4:5], v57 offset:0
    ds_read_b64_tr_b16 v[6:7], v57 offset:1024
    v_mfma_f32_32x32x16_bf16 v[224:239], v[28:31], v[40:43], v[224:239]
    ds_read_b64_tr_b16 v[8:9], v58 offset:0
    ds_read_b64_tr_b16 v[10:11], v58 offset:1024
    v_mfma_f32_32x32x16_bf16 v[240:255], v[28:31], v[44:47], v[240:255]
    ds_read_b64_tr_b16 v[12:13], v59 offset:0
    ds_read_b64_tr_b16 v[14:15], v59 offset:1024
    s_waitcnt lgkmcnt(0)
    v_mfma_f32_32x32x16_bf16 v[128:143], v[0:3], v[32:35], v[128:143]
    s_add_u32 m0, s25, 12288
    s_add_u32 s26, s26, 4096
    buffer_load_dwordx4 v60, s[8:11], s26 offen lds
    v_mfma_f32_32x32x16_bf16 v[144:159], v[0:3], v[36:39], v[144:159]
    s_add_u32 m0, s25, 13312
    s_add_u32 s26, s26, 4096
    buffer_load_dwordx4 v60, s[8:11], s26 offen lds
    v_mfma_f32_32x32x16_bf16 v[160:175], v[4:7], v[32:35], v[160:175]
    s_add_u32 m0, s25, 14336
    s_add_u32 s26, s26, 4096
    buffer_load_dwordx4 v60, s[8:11], s26 offen lds
    v_mfma_f32_32x32x16_bf16 v[176:191], v[4:7], v[36:39], v[176:191]
    s_add_u32 m0, s25, 15360
    s_add_u32 s26, s26, 4096
    buffer_load_dwordx4 v60, s[8:11], s26 offen lds
    s_waitcnt vmcnt(8)
    ds_read_b128 v[40:43], v53 offset:0
    ds_read_b128 v[44:47], v53 offset:32768
    v_mfma_f32_32x32x16_bf16 v[192:207], v[8:11], v[32:35], v[192:207]
    ds_read_b64_tr_b16 v[16:17], v56 offset:4096
    ds_read_b64_tr_b16 v[18:19], v56 offset:5120
    v_mfma_f32_32x32x16_bf16 v[208:223], v[8:11], v[36:39], v[208:223]
    ds_read_b64_tr_b16 v[20:21], v57 offset:4096
    ds_read_b64_tr_b16 v[22:23], v57 offset:5120
    v_mfma_f32_32x32x16_bf16 v[224:239], v[12:15], v[32:35], v[224:239]
    ds_read_b64_tr_b16 v[24:25], v58 offset:4096
    ds_read_b64_tr_b16 v[26:27], v58 offset:5120
    v_mfma_f32_32x32x16_bf16 v[240:255], v[12:15], v[36:39], v[240:255]
    ds_read_b64_tr_b16 v[28:29], v59 offset:4096
    ds_read_b64_tr_b16 v[30:31], v59 offset:5120
    s_waitcnt lgkmcnt(0)
    v_mfma_f32_32x32x16_bf16 v[128:143], v[16:19], v[40:43], v[128:143]
    s_add_u32 m0, s25, 0
    s_add_u32 s26, s26, 4096
    buffer_load_dwordx4 v60, s[8:11], s26 offen lds
    v_mfma_f32_32x32x16_bf16 v[144:159], v[16:19], v[44:47], v[144:159]
    s_add_u32 m0, s25, 1024
    s_add_u32 s26, s26, 4096
    buffer_load_dwordx4 v60, s[8:11], s26 offen lds
    v_mfma_f32_32x32x16_bf16 v[160:175], v[20:23], v[40:43], v[160:175]
    s_add_u32 m0, s25, 2048
    s_add_u32 s26, s26, 4096
    buffer_load_dwordx4 v60, s[8:11], s26 offen lds
    v_mfma_f32_32x32x16_bf16 v[176:191], v[20:23], v[44:47], v[176:191]
    s_add_u32 m0, s25, 3072
    s_add_u32 s26, s26, 4096
    buffer_load_dwordx4 v60, s[8:11], s26 offen lds
    s_waitcnt vmcnt(8)
    ds_read_b128 v[32:35], v54 offset:0
    ds_read_b128 v[36:39], v54 offset:32768
    v_mfma_f32_32x32x16_bf16 v[192:207], v[24:27], v[40:43], v[192:207]
    ds_read_b64_tr_b16 v[0:1], v56 offset:8192
    ds_read_b64_tr_b16 v[2:3], v56 offset:9216
    v_mfma_f32_32x32x16_bf16 v[208:223], v[24:27], v[44:47], v[208:223]
    ds_read_b64_tr_b16 v[4:5], v57 offset:8192
    ds_read_b64_tr_b16 v[6:7], v57 offset:9216
    v_mfma_f32_32x32x16_bf16 v[224:239], v[28:31], v[40:43], v[224:239]
    ds_read_b64_tr_b16 v[8:9], v58 offset:8192
    ds_read_b64_tr_b16 v[10:11], v58 offset:9216
    v_mfma_f32_32x32x16_bf16 v[240:255], v[28:31], v[44:47], v[240:255]
    ds_read_b64_tr_b16 v[12:13], v59 offset:8192
    ds_read_b64_tr_b16 v[14:15], v59 offset:9216
    s_waitcnt lgkmcnt(0)
    v_mfma_f32_32x32x16_bf16 v[128:143], v[0:3], v[32:35], v[128:143]
    s_add_u32 m0, s25, 4096
    s_add_u32 s26, s26, 4096
    buffer_load_dwordx4 v60, s[8:11], s26 offen lds
    v_mfma_f32_32x32x16_bf16 v[144:159], v[0:3], v[36:39], v[144:159]
    s_add_u32 m0, s25, 5120
    s_add_u32 s26, s26, 4096
    buffer_load_dwordx4 v60, s[8:11], s26 offen lds
    v_mfma_f32_32x32x16_bf16 v[160:175], v[4:7], v[32:35], v[160:175]
    s_add_u32 m0, s25, 6144
    s_add_u32 s26, s26, 4096
    buffer_load_dwordx4 v60, s[8:11], s26 offen lds
    v_mfma_f32_32x32x16_bf16 v[176:191], v[4:7], v[36:39], v[176:191]
    s_add_u32 m0, s25, 7168
    s_add_u32 s26, s26, 4096
    buffer_load_dwordx4 v60, s[8:11], s26 offen lds
    s_waitcnt vmcnt(8)
    ds_read_b128 v[40:43], v55 offset:0
    ds_read_b128 v[44:47], v55 offset:32768
    v_mfma_f32_32x32x16_bf16 v[192:207], v[8:11], v[32:35], v[192:207]
    ds_read_b64_tr_b16 v[16:17], v56 offset:12288
    ds_read_b64_tr_b16 v[18:19], v56 offset:13312
    v_mfma_f32_32x32x16_bf16 v[208:223], v[8:11], v[36:39], v[208:223]
    ds_read_b64_tr_b16 v[20:21], v57 offset:12288
    ds_read_b64_tr_b16 v[22:23], v57 offset:13312
    v_mfma_f32_32x32x16_bf16 v[224:239], v[12:15], v[32:35], v[224:239]
    ds_read_b64_tr_b16 v[24:25], v58 offset:12288
    ds_read_b64_tr_b16 v[26:27], v58 offset:13312
    v_mfma_f32_32x32x16_bf16 v[240:255], v[12:15], v[36:39], v[240:255]
    ds_read_b64_tr_b16 v[28:29], v59 offset:12288
    ds_read_b64_tr_b16 v[30:31], v59 offset:13312
    s_waitcnt lgkmcnt(0)
    v_mfma_f32_32x32x16_bf16 v[128:143], v[16:19], v[40:43], v[128:143]
    s_add_u32 m0, s25, 8192
    s_add_u32 s26, s26, 4096
    buffer_load_dwordx4 v60, s[8:11], s26 offen lds
    v_mfma_f32_32x32x16_bf16 v[144:159], v[16:19], v[44:47], v[144:159]
    s_add_u32 m0, s25, 9216
    s_add_u32 s26, s26, 4096
    buffer_load_dwordx4 v60, s[8:11], s26 offen lds
    v_mfma_f32_32x32x16_bf16 v[160:175], v[20:23], v[40:43], v[160:175]
    s_add_u32 m0, s25, 10240
    s_add_u32 s26, s26, 4096
    buffer_load_dwordx4 v60, s[8:11], s26 offen lds
    v_mfma_f32_32x32x16_bf16 v[176:191], v[20:23], v[44:47], v[176:191]
    s_add_u32 m0, s25, 11264
    s_add_u32 s26, s26, 4096
    buffer_load_dwordx4 v60, s[8:11], s26 offen lds
    s_waitcnt vmcnt(8)
    ds_read_b128 v[32:35], v48 offset:256
    ds_read_b128 v[36:39], v48 offset:33024
    v_mfma_f32_32x32x16_bf16 v[192:207], v[24:27], v[40:43], v[192:207]
    ds_read_b64_tr_b16 v[0:1], v56 offset:0
    ds_read_b64_tr_b16 v[2:3], v56 offset:1024
    v_mfma_f32_32x32x16_bf16 v[208:223], v[24:27], v[44:47], v[208:223]
    ds_read_b64_tr_b16 v[4:5], v57 offset:0
    ds_read_b64_tr_b16 v[6:7], v57 offset:1024
    v_mfma_f32_32x32x16_bf16 v[224:239], v[28:31], v[40:43], v[224:239]
    ds_read_b64_tr_b16 v[8:9], v58 offset:0
    ds_read_b64_tr_b16 v[10:11], v58 offset:1024
    v_mfma_f32_32x32x16_bf16 v[240:255], v[28:31], v[44:47], v[240:255]
    ds_read_b64_tr_b16 v[12:13], v59 offset:0
    ds_read_b64_tr_b16 v[14:15], v59 offset:1024
    s_waitcnt lgkmcnt(0)
    v_mfma_f32_32x32x16_bf16 v[128:143], v[0:3], v[32:35], v[128:143]
    s_add_u32 m0, s25, 12288
    s_add_u32 s26, s26, 4096
    buffer_load_dwordx4 v60, s[8:11], s26 offen lds
    v_mfma_f32_32x32x16_bf16 v[144:159], v[0:3], v[36:39], v[144:159]
    s_add_u32 m0, s25, 13312
    s_add_u32 s26, s26, 4096
    buffer_load_dwordx4 v60, s[8:11], s26 offen lds
    v_mfma_f32_32x32x16_bf16 v[160:175], v[4:7], v[32:35], v[160:175]
    s_add_u32 m0, s25, 14336
    s_add_u32 s26, s26, 4096
    buffer_load_dwordx4 v60, s[8:11], s26 offen lds
    v_mfma_f32_32x32x16_bf16 v[176:191], v[4:7], v[36:39], v[176:191]
    s_add_u32 m0, s25, 15360
    s_add_u32 s26, s26, 4096
    buffer_load_dwordx4 v60, s[8:11], s26 offen lds
    s_waitcnt vmcnt(8)
    ds_read_b128 v[40:43], v49 offset:256
    ds_read_b128 v[44:47], v49 offset:33024
    v_mfma_f32_32x32x16_bf16 v[192:207], v[8:11], v[32:35], v[192:207]
    ds_read_b64_tr_b16 v[16:17], v56 offset:4096
    ds_read_b64_tr_b16 v[18:19], v56 offset:5120
    v_mfma_f32_32x32x16_bf16 v[208:223], v[8:11], v[36:39], v[208:223]
    ds_read_b64_tr_b16 v[20:21], v57 offset:4096
    ds_read_b64_tr_b16 v[22:23], v57 offset:5120
    v_mfma_f32_32x32x16_bf16 v[224:239], v[12:15], v[32:35], v[224:239]
    ds_read_b64_tr_b16 v[24:25], v58 offset:4096
    ds_read_b64_tr_b16 v[26:27], v58 offset:5120
    v_mfma_f32_32x32x16_bf16 v[240:255], v[12:15], v[36:39], v[240:255]
    ds_read_b64_tr_b16 v[28:29], v59 offset:4096
    ds_read_b64_tr_b16 v[30:31], v59 offset:5120
    s_waitcnt lgkmcnt(0)
    v_mfma_f32_32x32x16_bf16 v[128:143], v[16:19], v[40:43], v[128:143]
    s_add_u32 m0, s25, 0
    s_add_u32 s26, s26, 4096
    buffer_load_dwordx4 v60, s[8:11], s26 offen lds
    v_mfma_f32_32x32x16_bf16 v[144:159], v[16:19], v[44:47], v[144:159]
    s_add_u32 m0, s25, 1024
    s_add_u32 s26, s26, 4096
    buffer_load_dwordx4 v60, s[8:11], s26 offen lds
    v_mfma_f32_32x32x16_bf16 v[160:175], v[20:23], v[40:43], v[160:175]
    s_add_u32 m0, s25, 2048
    s_add_u32 s26, s26, 4096
    buffer_load_dwordx4 v60, s[8:11], s26 offen lds
    v_mfma_f32_32x32x16_bf16 v[176:191], v[20:23], v[44:47], v[176:191]
    s_add_u32 m0, s25, 3072
    s_add_u32 s26, s26, 4096
    buffer_load_dwordx4 v60, s[8:11], s26 offen lds
    s_waitcnt vmcnt(8)
    ds_read_b128 v[32:35], v50 offset:256
    ds_read_b128 v[36:39], v50 offset:33024
    v_mfma_f32_32x32x16_bf16 v[192:207], v[24:27], v[40:43], v[192:207]
    ds_read_b64_tr_b16 v[0:1], v56 offset:8192
    ds_read_b64_tr_b16 v[2:3], v56 offset:9216
    v_mfma_f32_32x32x16_bf16 v[208:223], v[24:27], v[44:47], v[208:223]
    ds_read_b64_tr_b16 v[4:5], v57 offset:8192
    ds_read_b64_tr_b16 v[6:7], v57 offset:9216
    v_mfma_f32_32x32x16_bf16 v[224:239], v[28:31], v[40:43], v[224:239]
    ds_read_b64_tr_b16 v[8:9], v58 offset:8192
    ds_read_b64_tr_b16 v[10:11], v58 offset:9216
    v_mfma_f32_32x32x16_bf16 v[240:255], v[28:31], v[44:47], v[240:255]
    ds_read_b64_tr_b16 v[12:13], v59 offset:8192
    ds_read_b64_tr_b16 v[14:15], v59 offset:9216
    s_waitcnt lgkmcnt(0)
    v_mfma_f32_32x32x16_bf16 v[128:143], v[0:3], v[32:35], v[128:143]
    s_add_u32 m0, s25, 4096
    s_add_u32 s26, s26, 4096
    buffer_load_dwordx4 v60, s[8:11], s26 offen lds
    v_mfma_f32_32x32x16_bf16 v[144:159], v[0:3], v[36:39], v[144:159]
    s_add_u32 m0, s25, 5120
    s_add_u32 s26, s26, 4096
    buffer_load_dwordx4 v60, s[8:11], s26 offen lds
    v_mfma_f32_32x32x16_bf16 v[160:175], v[4:7], v[32:35], v[160:175]
    s_add_u32 m0, s25, 6144
    s_add_u32 s26, s26, 4096
    buffer_load_dwordx4 v60, s[8:11], s26 offen lds
    v_mfma_f32_32x32x16_bf16 v[176:191], v[4:7], v[36:39], v[176:191]
    s_add_u32 m0, s25, 7168
    s_add_u32 s26, s26, 4096
    buffer_load_dwordx4 v60, s[8:11], s26 offen lds
    s_waitcnt vmcnt(8)
    ds_read_b128 v[40:43], v51 offset:256
    ds_read_b128 v[44:47], v51 offset:33024
    v_mfma_f32_32x32x16_bf16 v[192:207], v[8:11], v[32:35], v[192:207]
    ds_read_b64_tr_b16 v[16:17], v56 offset:12288
    ds_read_b64_tr_b16 v[18:19], v56 offset:13312
    v_mfma_f32_32x32x16_bf16 v[208:223], v[8:11], v[36:39], v[208:223]
    ds_read_b64_tr_b16 v[20:21], v57 offset:12288
    ds_read_b64_tr_b16 v[22:23], v57 offset:13312
    v_mfma_f32_32x32x16_bf16 v[224:239], v[12:15], v[32:35], v[224:239]
    ds_read_b64_tr_b16 v[24:25], v58 offset:12288
    ds_read_b64_tr_b16 v[26:27], v58 offset:13312
    v_mfma_f32_32x32x16_bf16 v[240:255], v[12:15], v[36:39], v[240:255]
    ds_read_b64_tr_b16 v[28:29], v59 offset:12288
    ds_read_b64_tr_b16 v[30:31], v59 offset:13312
    s_waitcnt lgkmcnt(0)
    v_mfma_f32_32x32x16_bf16 v[128:143], v[16:19], v[40:43], v[128:143]
    s_add_u32 m0, s25, 8192
    s_add_u32 s26, s26, 4096
    buffer_load_dwordx4 v60, s[8:11], s26 offen lds
    v_mfma_f32_32x32x16_bf16 v[144:159], v[16:19], v[44:47], v[144:159]
    s_add_u32 m0, s25, 9216
    s_add_u32 s26, s26, 4096
    buffer_load_dwordx4 v60, s[8:11], s26 offen lds
    v_mfma_f32_32x32x16_bf16 v[160:175], v[20:23], v[40:43], v[160:175]
    s_add_u32 m0, s25, 10240
    s_add_u32 s26, s26, 4096
    buffer_load_dwordx4 v60, s[8:11], s26 offen lds
    v_mfma_f32_32x32x16_bf16 v[176:191], v[20:23], v[44:47], v[176:191]
    s_add_u32 m0, s25, 11264
    s_add_u32 s26, s26, 4096
    buffer_load_dwordx4 v60, s[8:11], s26 offen lds
    s_waitcnt vmcnt(8)
    ds_read_b128 v[32:35], v52 offset:256
    ds_read_b128 v[36:39], v52 offset:33024
    v_mfma_f32_32x32x16_bf16 v[192:207], v[24:27], v[40:43], v[192:207]
    ds_read_b64_tr_b16 v[0:1], v56 offset:0
    ds_read_b64_tr_b16 v[2:3], v56 offset:1024
    v_mfma_f32_32x32x16_bf16 v[208:223], v[24:27], v[44:47], v[208:223]
    ds_read_b64_tr_b16 v[4:5], v57 offset:0
    ds_read_b64_tr_b16 v[6:7], v57 offset:1024
    v_mfma_f32_32x32x16_bf16 v[224:239], v[28:31], v[40:43], v[224:239]
    ds_read_b64_tr_b16 v[8:9], v58 offset:0
    ds_read_b64_tr_b16 v[10:11], v58 offset:1024
    v_mfma_f32_32x32x16_bf16 v[240:255], v[28:31], v[44:47], v[240:255]
    ds_read_b64_tr_b16 v[12:13], v59 offset:0
    ds_read_b64_tr_b16 v[14:15], v59 offset:1024
    s_waitcnt lgkmcnt(0)
    v_mfma_f32_32x32x16_bf16 v[128:143], v[0:3], v[32:35], v[128:143]
    s_add_u32 m0, s25, 12288
    s_add_u32 s26, s26, 4096
    buffer_load_dwordx4 v60, s[8:11], s26 offen lds
    v_mfma_f32_32x32x16_bf16 v[144:159], v[0:3], v[36:39], v[144:159]
    s_add_u32 m0, s25, 13312
    s_add_u32 s26, s26, 4096
    buffer_load_dwordx4 v60, s[8:11], s26 offen lds
    v_mfma_f32_32x32x16_bf16 v[160:175], v[4:7], v[32:35], v[160:175]
    s_add_u32 m0, s25, 14336
    s_add_u32 s26, s26, 4096
    buffer_load_dwordx4 v60, s[8:11], s26 offen lds
    v_mfma_f32_32x32x16_bf16 v[176:191], v[4:7], v[36:39], v[176:191]
    s_add_u32 m0, s25, 15360
    s_add_u32 s26, s26, 4096
    buffer_load_dwordx4 v60, s[8:11], s26 offen lds
    s_waitcnt vmcnt(8)
    ds_read_b128 v[40:43], v53 offset:256
    ds_read_b128 v[44:47], v53 offset:33024
    v_mfma_f32_32x32x16_bf16 v[192:207], v[8:11], v[32:35], v[192:207]
    ds_read_b64_tr_b16 v[16:17], v56 offset:4096
    ds_read_b64_tr_b16 v[18:19], v56 offset:5120
    v_mfma_f32_32x32x16_bf16 v[208:223], v[8:11], v[36:39], v[208:223]
    ds_read_b64_tr_b16 v[20:21], v57 offset:4096
    ds_read_b64_tr_b16 v[22:23], v57 offset:5120
    v_mfma_f32_32x32x16_bf16 v[224:239], v[12:15], v[32:35], v[224:239]
    ds_read_b64_tr_b16 v[24:25], v58 offset:4096
    ds_read_b64_tr_b16 v[26:27], v58 offset:5120
    v_mfma_f32_32x32x16_bf16 v[240:255], v[12:15], v[36:39], v[240:255]
    ds_read_b64_tr_b16 v[28:29], v59 offset:4096
    ds_read_b64_tr_b16 v[30:31], v59 offset:5120
    s_waitcnt lgkmcnt(0)
    v_mfma_f32_32x32x16_bf16 v[128:143], v[16:19], v[40:43], v[128:143]
    s_add_u32 m0, s25, 0
    s_add_u32 s26, s26, 4096
    buffer_load_dwordx4 v60, s[8:11], s26 offen lds
    v_mfma_f32_32x32x16_bf16 v[144:159], v[16:19], v[44:47], v[144:159]
    s_add_u32 m0, s25, 1024
    s_add_u32 s26, s26, 4096
    buffer_load_dwordx4 v60, s[8:11], s26 offen lds
    v_mfma_f32_32x32x16_bf16 v[160:175], v[20:23], v[40:43], v[160:175]
    s_add_u32 m0, s25, 2048
    s_add_u32 s26, s26, 4096
    buffer_load_dwordx4 v60, s[8:11], s26 offen lds
    v_mfma_f32_32x32x16_bf16 v[176:191], v[20:23], v[44:47], v[176:191]
    s_add_u32 m0, s25, 3072
    s_add_u32 s26, s26, 4096
    buffer_load_dwordx4 v60, s[8:11], s26 offen lds
    s_waitcnt vmcnt(8)
    ds_read_b128 v[32:35], v54 offset:256
    ds_read_b128 v[36:39], v54 offset:33024
    v_mfma_f32_32x32x16_bf16 v[192:207], v[24:27], v[40:43], v[192:207]
    ds_read_b64_tr_b16 v[0:1], v56 offset:8192
    ds_read_b64_tr_b16 v[2:3], v56 offset:9216
    v_mfma_f32_32x32x16_bf16 v[208:223], v[24:27], v[44:47], v[208:223]
    ds_read_b64_tr_b16 v[4:5], v57 offset:8192
    ds_read_b64_tr_b16 v[6:7], v57 offset:9216
    v_mfma_f32_32x32x16_bf16 v[224:239], v[28:31], v[40:43], v[224:239]
    ds_read_b64_tr_b16 v[8:9], v58 offset:8192
    ds_read_b64_tr_b16 v[10:11], v58 offset:9216
    v_mfma_f32_32x32x16_bf16 v[240:255], v[28:31], v[44:47], v[240:255]
    ds_read_b64_tr_b16 v[12:13], v59 offset:8192
    ds_read_b64_tr_b16 v[14:15], v59 offset:9216
    s_waitcnt lgkmcnt(0)
    v_mfma_f32_32x32x16_bf16 v[128:143], v[0:3], v[32:35], v[128:143]
    s_add_u32 m0, s25, 4096
    s_add_u32 s26, s26, 4096
    buffer_load_dwordx4 v60, s[8:11], s26 offen lds
    v_mfma_f32_32x32x16_bf16 v[144:159], v[0:3], v[36:39], v[144:159]
    s_add_u32 m0, s25, 5120
    s_add_u32 s26, s26, 4096
    buffer_load_dwordx4 v60, s[8:11], s26 offen lds
    v_mfma_f32_32x32x16_bf16 v[160:175], v[4:7], v[32:35], v[160:175]
    s_add_u32 m0, s25, 6144
    s_add_u32 s26, s26, 4096
    buffer_load_dwordx4 v60, s[8:11], s26 offen lds
    v_mfma_f32_32x32x16_bf16 v[176:191], v[4:7], v[36:39], v[176:191]
    s_add_u32 m0, s25, 7168
    s_add_u32 s26, s26, 4096
    buffer_load_dwordx4 v60, s[8:11], s26 offen lds
    s_waitcnt vmcnt(8)
    ds_read_b128 v[40:43], v55 offset:256
    ds_read_b128 v[44:47], v55 offset:33024
    v_mfma_f32_32x32x16_bf16 v[192:207], v[8:11], v[32:35], v[192:207]
    ds_read_b64_tr_b16 v[16:17], v56 offset:12288
    ds_read_b64_tr_b16 v[18:19], v56 offset:13312
    v_mfma_f32_32x32x16_bf16 v[208:223], v[8:11], v[36:39], v[208:223]
    ds_read_b64_tr_b16 v[20:21], v57 offset:12288
    ds_read_b64_tr_b16 v[22:23], v57 offset:13312
    v_mfma_f32_32x32x16_bf16 v[224:239], v[12:15], v[32:35], v[224:239]
    ds_read_b64_tr_b16 v[24:25], v58 offset:12288
    ds_read_b64_tr_b16 v[26:27], v58 offset:13312
    v_mfma_f32_32x32x16_bf16 v[240:255], v[12:15], v[36:39], v[240:255]
    ds_read_b64_tr_b16 v[28:29], v59 offset:12288
    ds_read_b64_tr_b16 v[30:31], v59 offset:13312
    s_waitcnt lgkmcnt(0)
    v_mfma_f32_32x32x16_bf16 v[128:143], v[16:19], v[40:43], v[128:143]
    s_add_u32 m0, s25, 8192
    s_add_u32 s26, s26, 4096
    buffer_load_dwordx4 v60, s[8:11], s26 offen lds
    v_mfma_f32_32x32x16_bf16 v[144:159], v[16:19], v[44:47], v[144:159]
    s_add_u32 m0, s25, 9216
    s_add_u32 s26, s26, 4096
    buffer_load_dwordx4 v60, s[8:11], s26 offen lds
    v_mfma_f32_32x32x16_bf16 v[160:175], v[20:23], v[40:43], v[160:175]
    s_add_u32 m0, s25, 10240
    s_add_u32 s26, s26, 4096
    buffer_load_dwordx4 v60, s[8:11], s26 offen lds
    v_mfma_f32_32x32x16_bf16 v[176:191], v[20:23], v[44:47], v[176:191]
    s_add_u32 m0, s25, 11264
    s_add_u32 s26, s26, 4096
    buffer_load_dwordx4 v60, s[8:11], s26 offen lds
    s_waitcnt vmcnt(8)
    ds_read_b128 v[32:35], v48 offset:512
    ds_read_b128 v[36:39], v48 offset:33280
    v_mfma_f32_32x32x16_bf16 v[192:207], v[24:27], v[40:43], v[192:207]
    ds_read_b64_tr_b16 v[0:1], v56 offset:0
    ds_read_b64_tr_b16 v[2:3], v56 offset:1024
    v_mfma_f32_32x32x16_bf16 v[208:223], v[24:27], v[44:47], v[208:223]
    ds_read_b64_tr_b16 v[4:5], v57 offset:0
    ds_read_b64_tr_b16 v[6:7], v57 offset:1024
    v_mfma_f32_32x32x16_bf16 v[224:239], v[28:31], v[40:43], v[224:239]
    ds_read_b64_tr_b16 v[8:9], v58 offset:0
    ds_read_b64_tr_b16 v[10:11], v58 offset:1024
    v_mfma_f32_32x32x16_bf16 v[240:255], v[28:31], v[44:47], v[240:255]
    ds_read_b64_tr_b16 v[12:13], v59 offset:0
    ds_read_b64_tr_b16 v[14:15], v59 offset:1024
    s_waitcnt lgkmcnt(0)
    v_mfma_f32_32x32x16_bf16 v[128:143], v[0:3], v[32:35], v[128:143]
    s_add_u32 m0, s25, 12288
    s_add_u32 s26, s26, 4096
    buffer_load_dwordx4 v60, s[8:11], s26 offen lds
    v_mfma_f32_32x32x16_bf16 v[144:159], v[0:3], v[36:39], v[144:159]
    s_add_u32 m0, s25, 13312
    s_add_u32 s26, s26, 4096
    buffer_load_dwordx4 v60, s[8:11], s26 offen lds
    v_mfma_f32_32x32x16_bf16 v[160:175], v[4:7], v[32:35], v[160:175]
    s_add_u32 m0, s25, 14336
    s_add_u32 s26, s26, 4096
    buffer_load_dwordx4 v60, s[8:11], s26 offen lds
    v_mfma_f32_32x32x16_bf16 v[176:191], v[4:7], v[36:39], v[176:191]
    s_add_u32 m0, s25, 15360
    s_add_u32 s26, s26, 4096
    buffer_load_dwordx4 v60, s[8:11], s26 offen lds
    s_waitcnt vmcnt(8)
    ds_read_b128 v[40:43], v49 offset:512
    ds_read_b128 v[44:47], v49 offset:33280
    v_mfma_f32_32x32x16_bf16 v[192:207], v[8:11], v[32:35], v[192:207]
    ds_read_b64_tr_b16 v[16:17], v56 offset:4096
    ds_read_b64_tr_b16 v[18:19], v56 offset:5120
    v_mfma_f32_32x32x16_bf16 v[208:223], v[8:11], v[36:39], v[208:223]
    ds_read_b64_tr_b16 v[20:21], v57 offset:4096
    ds_read_b64_tr_b16 v[22:23], v57 offset:5120
    v_mfma_f32_32x32x16_bf16 v[224:239], v[12:15], v[32:35], v[224:239]
    ds_read_b64_tr_b16 v[24:25], v58 offset:4096
    ds_read_b64_tr_b16 v[26:27], v58 offset:5120
    v_mfma_f32_32x32x16_bf16 v[240:255], v[12:15], v[36:39], v[240:255]
    ds_read_b64_tr_b16 v[28:29], v59 offset:4096
    ds_read_b64_tr_b16 v[30:31], v59 offset:5120
    s_waitcnt lgkmcnt(0)
    v_mfma_f32_32x32x16_bf16 v[128:143], v[16:19], v[40:43], v[128:143]
    s_add_u32 m0, s25, 0
    s_add_u32 s26, s26, 4096
    buffer_load_dwordx4 v60, s[8:11], s26 offen lds
    v_mfma_f32_32x32x16_bf16 v[144:159], v[16:19], v[44:47], v[144:159]
    s_add_u32 m0, s25, 1024
    s_add_u32 s26, s26, 4096
    buffer_load_dwordx4 v60, s[8:11], s26 offen lds
    v_mfma_f32_32x32x16_bf16 v[160:175], v[20:23], v[40:43], v[160:175]
    s_add_u32 m0, s25, 2048
    s_add_u32 s26, s26, 4096
    buffer_load_dwordx4 v60, s[8:11], s26 offen lds
    v_mfma_f32_32x32x16_bf16 v[176:191], v[20:23], v[44:47], v[176:191]
    s_add_u32 m0, s25, 3072
    s_add_u32 s26, s26, 4096
    buffer_load_dwordx4 v60, s[8:11], s26 offen lds
    s_waitcnt vmcnt(8)
    ds_read_b128 v[32:35], v50 offset:512
    ds_read_b128 v[36:39], v50 offset:33280
    v_mfma_f32_32x32x16_bf16 v[192:207], v[24:27], v[40:43], v[192:207]
    ds_read_b64_tr_b16 v[0:1], v56 offset:8192
    ds_read_b64_tr_b16 v[2:3], v56 offset:9216
    v_mfma_f32_32x32x16_bf16 v[208:223], v[24:27], v[44:47], v[208:223]
    ds_read_b64_tr_b16 v[4:5], v57 offset:8192
    ds_read_b64_tr_b16 v[6:7], v57 offset:9216
    v_mfma_f32_32x32x16_bf16 v[224:239], v[28:31], v[40:43], v[224:239]
    ds_read_b64_tr_b16 v[8:9], v58 offset:8192
    ds_read_b64_tr_b16 v[10:11], v58 offset:9216
    v_mfma_f32_32x32x16_bf16 v[240:255], v[28:31], v[44:47], v[240:255]
    ds_read_b64_tr_b16 v[12:13], v59 offset:8192
    ds_read_b64_tr_b16 v[14:15], v59 offset:9216
    s_waitcnt lgkmcnt(0)
    v_mfma_f32_32x32x16_bf16 v[128:143], v[0:3], v[32:35], v[128:143]
    s_add_u32 m0, s25, 4096
    s_add_u32 s26, s26, 4096
    buffer_load_dwordx4 v60, s[8:11], s26 offen lds
    v_mfma_f32_32x32x16_bf16 v[144:159], v[0:3], v[36:39], v[144:159]
    s_add_u32 m0, s25, 5120
    s_add_u32 s26, s26, 4096
    buffer_load_dwordx4 v60, s[8:11], s26 offen lds
    v_mfma_f32_32x32x16_bf16 v[160:175], v[4:7], v[32:35], v[160:175]
    s_add_u32 m0, s25, 6144
    s_add_u32 s26, s26, 4096
    buffer_load_dwordx4 v60, s[8:11], s26 offen lds
    v_mfma_f32_32x32x16_bf16 v[176:191], v[4:7], v[36:39], v[176:191]
    s_add_u32 m0, s25, 7168
    s_add_u32 s26, s26, 4096
    buffer_load_dwordx4 v60, s[8:11], s26 offen lds
    s_waitcnt vmcnt(8)
    ds_read_b128 v[40:43], v51 offset:512
    ds_read_b128 v[44:47], v51 offset:33280
    v_mfma_f32_32x32x16_bf16 v[192:207], v[8:11], v[32:35], v[192:207]
    ds_read_b64_tr_b16 v[16:17], v56 offset:12288
    ds_read_b64_tr_b16 v[18:19], v56 offset:13312
    v_mfma_f32_32x32x16_bf16 v[208:223], v[8:11], v[36:39], v[208:223]
    ds_read_b64_tr_b16 v[20:21], v57 offset:12288
    ds_read_b64_tr_b16 v[22:23], v57 offset:13312
    v_mfma_f32_32x32x16_bf16 v[224:239], v[12:15], v[32:35], v[224:239]
    ds_read_b64_tr_b16 v[24:25], v58 offset:12288
    ds_read_b64_tr_b16 v[26:27], v58 offset:13312
    v_mfma_f32_32x32x16_bf16 v[240:255], v[12:15], v[36:39], v[240:255]
    ds_read_b64_tr_b16 v[28:29], v59 offset:12288
    ds_read_b64_tr_b16 v[30:31], v59 offset:13312
    s_waitcnt lgkmcnt(0)
    v_mfma_f32_32x32x16_bf16 v[128:143], v[16:19], v[40:43], v[128:143]
    s_add_u32 m0, s25, 8192
    s_add_u32 s26, s26, 4096
    buffer_load_dwordx4 v60, s[8:11], s26 offen lds
    v_mfma_f32_32x32x16_bf16 v[144:159], v[16:19], v[44:47], v[144:159]
    s_add_u32 m0, s25, 9216
    s_add_u32 s26, s26, 4096
    buffer_load_dwordx4 v60, s[8:11], s26 offen lds
    v_mfma_f32_32x32x16_bf16 v[160:175], v[20:23], v[40:43], v[160:175]
    s_add_u32 m0, s25, 10240
    s_add_u32 s26, s26, 4096
    buffer_load_dwordx4 v60, s[8:11], s26 offen lds
    v_mfma_f32_32x32x16_bf16 v[176:191], v[20:23], v[44:47], v[176:191]
    s_add_u32 m0, s25, 11264
    s_add_u32 s26, s26, 4096
    buffer_load_dwordx4 v60, s[8:11], s26 offen lds
    s_waitcnt vmcnt(8)
    ds_read_b128 v[32:35], v52 offset:512
    ds_read_b128 v[36:39], v52 offset:33280
    v_mfma_f32_32x32x16_bf16 v[192:207], v[24:27], v[40:43], v[192:207]
    ds_read_b64_tr_b16 v[0:1], v56 offset:0
    ds_read_b64_tr_b16 v[2:3], v56 offset:1024
    v_mfma_f32_32x32x16_bf16 v[208:223], v[24:27], v[44:47], v[208:223]
    ds_read_b64_tr_b16 v[4:5], v57 offset:0
    ds_read_b64_tr_b16 v[6:7], v57 offset:1024
    v_mfma_f32_32x32x16_bf16 v[224:239], v[28:31], v[40:43], v[224:239]
    ds_read_b64_tr_b16 v[8:9], v58 offset:0
    ds_read_b64_tr_b16 v[10:11], v58 offset:1024
    v_mfma_f32_32x32x16_bf16 v[240:255], v[28:31], v[44:47], v[240:255]
    ds_read_b64_tr_b16 v[12:13], v59 offset:0
    ds_read_b64_tr_b16 v[14:15], v59 offset:1024
    s_waitcnt lgkmcnt(0)
    v_mfma_f32_32x32x16_bf16 v[128:143], v[0:3], v[32:35], v[128:143]
    s_add_u32 m0, s25, 12288
    s_add_u32 s26, s26, 4096
    buffer_load_dwordx4 v60, s[8:11], s26 offen lds
    v_mfma_f32_32x32x16_bf16 v[144:159], v[0:3], v[36:39], v[144:159]
    s_add_u32 m0, s25, 13312
    s_add_u32 s26, s26, 4096
    buffer_load_dwordx4 v60, s[8:11], s26 offen lds
    v_mfma_f32_32x32x16_bf16 v[160:175], v[4:7], v[32:35], v[160:175]
    s_add_u32 m0, s25, 14336
    s_add_u32 s26, s26, 4096
    buffer_load_dwordx4 v60, s[8:11], s26 offen lds
    v_mfma_f32_32x32x16_bf16 v[176:191], v[4:7], v[36:39], v[176:191]
    s_add_u32 m0, s25, 15360
    s_add_u32 s26, s26, 4096
    buffer_load_dwordx4 v60, s[8:11], s26 offen lds
    s_waitcnt vmcnt(8)
    ds_read_b128 v[40:43], v53 offset:512
    ds_read_b128 v[44:47], v53 offset:33280
    v_mfma_f32_32x32x16_bf16 v[192:207], v[8:11], v[32:35], v[192:207]
    ds_read_b64_tr_b16 v[16:17], v56 offset:4096
    ds_read_b64_tr_b16 v[18:19], v56 offset:5120
    v_mfma_f32_32x32x16_bf16 v[208:223], v[8:11], v[36:39], v[208:223]
    ds_read_b64_tr_b16 v[20:21], v57 offset:4096
    ds_read_b64_tr_b16 v[22:23], v57 offset:5120
    v_mfma_f32_32x32x16_bf16 v[224:239], v[12:15], v[32:35], v[224:239]
    ds_read_b64_tr_b16 v[24:25], v58 offset:4096
    ds_read_b64_tr_b16 v[26:27], v58 offset:5120
    v_mfma_f32_32x32x16_bf16 v[240:255], v[12:15], v[36:39], v[240:255]
    ds_read_b64_tr_b16 v[28:29], v59 offset:4096
    ds_read_b64_tr_b16 v[30:31], v59 offset:5120
    s_waitcnt lgkmcnt(0)
    v_mfma_f32_32x32x16_bf16 v[128:143], v[16:19], v[40:43], v[128:143]
    s_add_u32 m0, s25, 0
    s_add_u32 s26, s26, 4096
    buffer_load_dwordx4 v60, s[8:11], s26 offen lds
    v_mfma_f32_32x32x16_bf16 v[144:159], v[16:19], v[44:47], v[144:159]
    s_add_u32 m0, s25, 1024
    s_add_u32 s26, s26, 4096
    buffer_load_dwordx4 v60, s[8:11], s26 offen lds
    v_mfma_f32_32x32x16_bf16 v[160:175], v[20:23], v[40:43], v[160:175]
    s_add_u32 m0, s25, 2048
    s_add_u32 s26, s26, 4096
    buffer_load_dwordx4 v60, s[8:11], s26 offen lds
    v_mfma_f32_32x32x16_bf16 v[176:191], v[20:23], v[44:47], v[176:191]
    s_add_u32 m0, s25, 3072
    s_add_u32 s26, s26, 4096
    buffer_load_dwordx4 v60, s[8:11], s26 offen lds
    s_waitcnt vmcnt(8)
    ds_read_b128 v[32:35], v54 offset:512
    ds_read_b128 v[36:39], v54 offset:33280
    v_mfma_f32_32x32x16_bf16 v[192:207], v[24:27], v[40:43], v[192:207]
    ds_read_b64_tr_b16 v[0:1], v56 offset:8192
    ds_read_b64_tr_b16 v[2:3], v56 offset:9216
    v_mfma_f32_32x32x16_bf16 v[208:223], v[24:27], v[44:47], v[208:223]
    ds_read_b64_tr_b16 v[4:5], v57 offset:8192
    ds_read_b64_tr_b16 v[6:7], v57 offset:9216
    v_mfma_f32_32x32x16_bf16 v[224:239], v[28:31], v[40:43], v[224:239]
    ds_read_b64_tr_b16 v[8:9], v58 offset:8192
    ds_read_b64_tr_b16 v[10:11], v58 offset:9216
    v_mfma_f32_32x32x16_bf16 v[240:255], v[28:31], v[44:47], v[240:255]
    ds_read_b64_tr_b16 v[12:13], v59 offset:8192
    ds_read_b64_tr_b16 v[14:15], v59 offset:9216
    s_waitcnt lgkmcnt(0)
    v_mfma_f32_32x32x16_bf16 v[128:143], v[0:3], v[32:35], v[128:143]
    s_add_u32 m0, s25, 4096
    s_add_u32 s26, s26, 4096
    buffer_load_dwordx4 v60, s[8:11], s26 offen lds
    v_mfma_f32_32x32x16_bf16 v[144:159], v[0:3], v[36:39], v[144:159]
    s_add_u32 m0, s25, 5120
    s_add_u32 s26, s26, 4096
    buffer_load_dwordx4 v60, s[8:11], s26 offen lds
    v_mfma_f32_32x32x16_bf16 v[160:175], v[4:7], v[32:35], v[160:175]
    s_add_u32 m0, s25, 6144
    s_add_u32 s26, s26, 4096
    buffer_load_dwordx4 v60, s[8:11], s26 offen lds
    v_mfma_f32_32x32x16_bf16 v[176:191], v[4:7], v[36:39], v[176:191]
    s_add_u32 m0, s25, 7168
    s_add_u32 s26, s26, 4096
    buffer_load_dwordx4 v60, s[8:11], s26 offen lds
    s_waitcnt vmcnt(8)
    ds_read_b128 v[40:43], v55 offset:512
    ds_read_b128 v[44:47], v55 offset:33280
    v_mfma_f32_32x32x16_bf16 v[192:207], v[8:11], v[32:35], v[192:207]
    ds_read_b64_tr_b16 v[16:17], v56 offset:12288
    ds_read_b64_tr_b16 v[18:19], v56 offset:13312
    v_mfma_f32_32x32x16_bf16 v[208:223], v[8:11], v[36:39], v[208:223]
    ds_read_b64_tr_b16 v[20:21], v57 offset:12288
    ds_read_b64_tr_b16 v[22:23], v57 offset:13312
    v_mfma_f32_32x32x16_bf16 v[224:239], v[12:15], v[32:35], v[224:239]
    ds_read_b64_tr_b16 v[24:25], v58 offset:12288
    ds_read_b64_tr_b16 v[26:27], v58 offset:13312
    v_mfma_f32_32x32x16_bf16 v[240:255], v[12:15], v[36:39], v[240:255]
    ds_read_b64_tr_b16 v[28:29], v59 offset:12288
    ds_read_b64_tr_b16 v[30:31], v59 offset:13312
    s_waitcnt lgkmcnt(0)
    v_mfma_f32_32x32x16_bf16 v[128:143], v[16:19], v[40:43], v[128:143]
    s_add_u32 m0, s25, 8192
    s_add_u32 s26, s26, 4096
    buffer_load_dwordx4 v60, s[8:11], s26 offen lds
    v_mfma_f32_32x32x16_bf16 v[144:159], v[16:19], v[44:47], v[144:159]
    s_add_u32 m0, s25, 9216
    s_add_u32 s26, s26, 4096
    buffer_load_dwordx4 v60, s[8:11], s26 offen lds
    v_mfma_f32_32x32x16_bf16 v[160:175], v[20:23], v[40:43], v[160:175]
    s_add_u32 m0, s25, 10240
    s_add_u32 s26, s26, 4096
    buffer_load_dwordx4 v60, s[8:11], s26 offen lds
    v_mfma_f32_32x32x16_bf16 v[176:191], v[20:23], v[44:47], v[176:191]
    s_add_u32 m0, s25, 11264
    s_add_u32 s26, s26, 4096
    buffer_load_dwordx4 v60, s[8:11], s26 offen lds
    s_waitcnt vmcnt(8)
    ds_read_b128 v[32:35], v48 offset:768
    ds_read_b128 v[36:39], v48 offset:33536
    v_mfma_f32_32x32x16_bf16 v[192:207], v[24:27], v[40:43], v[192:207]
    ds_read_b64_tr_b16 v[0:1], v56 offset:0
    ds_read_b64_tr_b16 v[2:3], v56 offset:1024
    v_mfma_f32_32x32x16_bf16 v[208:223], v[24:27], v[44:47], v[208:223]
    ds_read_b64_tr_b16 v[4:5], v57 offset:0
    ds_read_b64_tr_b16 v[6:7], v57 offset:1024
    v_mfma_f32_32x32x16_bf16 v[224:239], v[28:31], v[40:43], v[224:239]
    ds_read_b64_tr_b16 v[8:9], v58 offset:0
    ds_read_b64_tr_b16 v[10:11], v58 offset:1024
    v_mfma_f32_32x32x16_bf16 v[240:255], v[28:31], v[44:47], v[240:255]
    ds_read_b64_tr_b16 v[12:13], v59 offset:0
    ds_read_b64_tr_b16 v[14:15], v59 offset:1024
    s_waitcnt lgkmcnt(0)
    v_mfma_f32_32x32x16_bf16 v[128:143], v[0:3], v[32:35], v[128:143]
    s_add_u32 m0, s25, 12288
    s_add_u32 s26, s26, 4096
    buffer_load_dwordx4 v60, s[8:11], s26 offen lds
    v_mfma_f32_32x32x16_bf16 v[144:159], v[0:3], v[36:39], v[144:159]
    s_add_u32 m0, s25, 13312
    s_add_u32 s26, s26, 4096
    buffer_load_dwordx4 v60, s[8:11], s26 offen lds
    v_mfma_f32_32x32x16_bf16 v[160:175], v[4:7], v[32:35], v[160:175]
    s_add_u32 m0, s25, 14336
    s_add_u32 s26, s26, 4096
    buffer_load_dwordx4 v60, s[8:11], s26 offen lds
    v_mfma_f32_32x32x16_bf16 v[176:191], v[4:7], v[36:39], v[176:191]
    s_add_u32 m0, s25, 15360
    s_add_u32 s26, s26, 4096
    buffer_load_dwordx4 v60, s[8:11], s26 offen lds
    s_waitcnt vmcnt(8)
    ds_read_b128 v[40:43], v49 offset:768
    ds_read_b128 v[44:47], v49 offset:33536
    v_mfma_f32_32x32x16_bf16 v[192:207], v[8:11], v[32:35], v[192:207]
    ds_read_b64_tr_b16 v[16:17], v56 offset:4096
    ds_read_b64_tr_b16 v[18:19], v56 offset:5120
    v_mfma_f32_32x32x16_bf16 v[208:223], v[8:11], v[36:39], v[208:223]
    ds_read_b64_tr_b16 v[20:21], v57 offset:4096
    ds_read_b64_tr_b16 v[22:23], v57 offset:5120
    v_mfma_f32_32x32x16_bf16 v[224:239], v[12:15], v[32:35], v[224:239]
    ds_read_b64_tr_b16 v[24:25], v58 offset:4096
    ds_read_b64_tr_b16 v[26:27], v58 offset:5120
    v_mfma_f32_32x32x16_bf16 v[240:255], v[12:15], v[36:39], v[240:255]
    ds_read_b64_tr_b16 v[28:29], v59 offset:4096
    ds_read_b64_tr_b16 v[30:31], v59 offset:5120
    s_waitcnt lgkmcnt(0)
    v_mfma_f32_32x32x16_bf16 v[128:143], v[16:19], v[40:43], v[128:143]
    s_add_u32 m0, s25, 0
    s_add_u32 s26, s26, 4096
    buffer_load_dwordx4 v60, s[8:11], s26 offen lds
    v_mfma_f32_32x32x16_bf16 v[144:159], v[16:19], v[44:47], v[144:159]
    s_add_u32 m0, s25, 1024
    s_add_u32 s26, s26, 4096
    buffer_load_dwordx4 v60, s[8:11], s26 offen lds
    v_mfma_f32_32x32x16_bf16 v[160:175], v[20:23], v[40:43], v[160:175]
    s_add_u32 m0, s25, 2048
    s_add_u32 s26, s26, 4096
    buffer_load_dwordx4 v60, s[8:11], s26 offen lds
    v_mfma_f32_32x32x16_bf16 v[176:191], v[20:23], v[44:47], v[176:191]
    s_add_u32 m0, s25, 3072
    s_add_u32 s26, s26, 4096
    buffer_load_dwordx4 v60, s[8:11], s26 offen lds
    s_waitcnt vmcnt(8)
    ds_read_b128 v[32:35], v50 offset:768
    ds_read_b128 v[36:39], v50 offset:33536
    v_mfma_f32_32x32x16_bf16 v[192:207], v[24:27], v[40:43], v[192:207]
    ds_read_b64_tr_b16 v[0:1], v56 offset:8192
    ds_read_b64_tr_b16 v[2:3], v56 offset:9216
    v_mfma_f32_32x32x16_bf16 v[208:223], v[24:27], v[44:47], v[208:223]
    ds_read_b64_tr_b16 v[4:5], v57 offset:8192
    ds_read_b64_tr_b16 v[6:7], v57 offset:9216
    v_mfma_f32_32x32x16_bf16 v[224:239], v[28:31], v[40:43], v[224:239]
    ds_read_b64_tr_b16 v[8:9], v58 offset:8192
    ds_read_b64_tr_b16 v[10:11], v58 offset:9216
    v_mfma_f32_32x32x16_bf16 v[240:255], v[28:31], v[44:47], v[240:255]
    ds_read_b64_tr_b16 v[12:13], v59 offset:8192
    ds_read_b64_tr_b16 v[14:15], v59 offset:9216
    s_waitcnt lgkmcnt(0)
    v_mfma_f32_32x32x16_bf16 v[128:143], v[0:3], v[32:35], v[128:143]
    s_add_u32 m0, s25, 4096
    s_add_u32 s26, s26, 4096
    buffer_load_dwordx4 v60, s[8:11], s26 offen lds
    v_mfma_f32_32x32x16_bf16 v[144:159], v[0:3], v[36:39], v[144:159]
    s_add_u32 m0, s25, 5120
    s_add_u32 s26, s26, 4096
    buffer_load_dwordx4 v60, s[8:11], s26 offen lds
    v_mfma_f32_32x32x16_bf16 v[160:175], v[4:7], v[32:35], v[160:175]
    s_add_u32 m0, s25, 6144
    s_add_u32 s26, s26, 4096
    buffer_load_dwordx4 v60, s[8:11], s26 offen lds
    v_mfma_f32_32x32x16_bf16 v[176:191], v[4:7], v[36:39], v[176:191]
    s_add_u32 m0, s25, 7168
    s_add_u32 s26, s26, 4096
    buffer_load_dwordx4 v60, s[8:11], s26 offen lds
    s_waitcnt vmcnt(8)
    ds_read_b128 v[40:43], v51 offset:768
    ds_read_b128 v[44:47], v51 offset:33536
    v_mfma_f32_32x32x16_bf16 v[192:207], v[8:11], v[32:35], v[192:207]
    ds_read_b64_tr_b16 v[16:17], v56 offset:12288
    ds_read_b64_tr_b16 v[18:19], v56 offset:13312
    v_mfma_f32_32x32x16_bf16 v[208:223], v[8:11], v[36:39], v[208:223]
    ds_read_b64_tr_b16 v[20:21], v57 offset:12288
    ds_read_b64_tr_b16 v[22:23], v57 offset:13312
    v_mfma_f32_32x32x16_bf16 v[224:239], v[12:15], v[32:35], v[224:239]
    ds_read_b64_tr_b16 v[24:25], v58 offset:12288
    ds_read_b64_tr_b16 v[26:27], v58 offset:13312
    v_mfma_f32_32x32x16_bf16 v[240:255], v[12:15], v[36:39], v[240:255]
    ds_read_b64_tr_b16 v[28:29], v59 offset:12288
    ds_read_b64_tr_b16 v[30:31], v59 offset:13312
    s_waitcnt lgkmcnt(0)
    v_mfma_f32_32x32x16_bf16 v[128:143], v[16:19], v[40:43], v[128:143]
    s_add_u32 m0, s25, 8192
    s_add_u32 s26, s26, 4096
    buffer_load_dwordx4 v60, s[8:11], s26 offen lds
    v_mfma_f32_32x32x16_bf16 v[144:159], v[16:19], v[44:47], v[144:159]
    s_add_u32 m0, s25, 9216
    s_add_u32 s26, s26, 4096
    buffer_load_dwordx4 v60, s[8:11], s26 offen lds
    v_mfma_f32_32x32x16_bf16 v[160:175], v[20:23], v[40:43], v[160:175]
    s_add_u32 m0, s25, 10240
    s_add_u32 s26, s26, 4096
    buffer_load_dwordx4 v60, s[8:11], s26 offen lds
    v_mfma_f32_32x32x16_bf16 v[176:191], v[20:23], v[44:47], v[176:191]
    s_add_u32 m0, s25, 11264
    s_add_u32 s26, s26, 4096
    buffer_load_dwordx4 v60, s[8:11], s26 offen lds
    s_waitcnt vmcnt(8)
    ds_read_b128 v[32:35], v52 offset:768
    ds_read_b128 v[36:39], v52 offset:33536
    v_mfma_f32_32x32x16_bf16 v[192:207], v[24:27], v[40:43], v[192:207]
    ds_read_b64_tr_b16 v[0:1], v56 offset:0
    ds_read_b64_tr_b16 v[2:3], v56 offset:1024
    v_mfma_f32_32x32x16_bf16 v[208:223], v[24:27], v[44:47], v[208:223]
    ds_read_b64_tr_b16 v[4:5], v57 offset:0
    ds_read_b64_tr_b16 v[6:7], v57 offset:1024
    v_mfma_f32_32x32x16_bf16 v[224:239], v[28:31], v[40:43], v[224:239]
    ds_read_b64_tr_b16 v[8:9], v58 offset:0
    ds_read_b64_tr_b16 v[10:11], v58 offset:1024
    v_mfma_f32_32x32x16_bf16 v[240:255], v[28:31], v[44:47], v[240:255]
    ds_read_b64_tr_b16 v[12:13], v59 offset:0
    ds_read_b64_tr_b16 v[14:15], v59 offset:1024
    s_waitcnt lgkmcnt(0)
    v_mfma_f32_32x32x16_bf16 v[128:143], v[0:3], v[32:35], v[128:143]
    s_add_u32 m0, s25, 12288
    s_add_u32 s26, s26, 4096
    buffer_load_dwordx4 v60, s[8:11], s26 offen lds
    v_mfma_f32_32x32x16_bf16 v[144:159], v[0:3], v[36:39], v[144:159]
    s_add_u32 m0, s25, 13312
    s_add_u32 s26, s26, 4096
    buffer_load_dwordx4 v60, s[8:11], s26 offen lds
    v_mfma_f32_32x32x16_bf16 v[160:175], v[4:7], v[32:35], v[160:175]
    s_add_u32 m0, s25, 14336
    s_add_u32 s26, s26, 4096
    buffer_load_dwordx4 v60, s[8:11], s26 offen lds
    v_mfma_f32_32x32x16_bf16 v[176:191], v[4:7], v[36:39], v[176:191]
    s_add_u32 m0, s25, 15360
    s_add_u32 s26, s26, 4096
    buffer_load_dwordx4 v60, s[8:11], s26 offen lds
    s_waitcnt vmcnt(8)
    ds_read_b128 v[40:43], v53 offset:768
    ds_read_b128 v[44:47], v53 offset:33536
    v_mfma_f32_32x32x16_bf16 v[192:207], v[8:11], v[32:35], v[192:207]
    ds_read_b64_tr_b16 v[16:17], v56 offset:4096
    ds_read_b64_tr_b16 v[18:19], v56 offset:5120
    v_mfma_f32_32x32x16_bf16 v[208:223], v[8:11], v[36:39], v[208:223]
    ds_read_b64_tr_b16 v[20:21], v57 offset:4096
    ds_read_b64_tr_b16 v[22:23], v57 offset:5120
    v_mfma_f32_32x32x16_bf16 v[224:239], v[12:15], v[32:35], v[224:239]
    ds_read_b64_tr_b16 v[24:25], v58 offset:4096
    ds_read_b64_tr_b16 v[26:27], v58 offset:5120
    v_mfma_f32_32x32x16_bf16 v[240:255], v[12:15], v[36:39], v[240:255]
    ds_read_b64_tr_b16 v[28:29], v59 offset:4096
    ds_read_b64_tr_b16 v[30:31], v59 offset:5120
    s_waitcnt lgkmcnt(0)
    v_mfma_f32_32x32x16_bf16 v[128:143], v[16:19], v[40:43], v[128:143]
    v_mfma_f32_32x32x16_bf16 v[144:159], v[16:19], v[44:47], v[144:159]
    v_mfma_f32_32x32x16_bf16 v[160:175], v[20:23], v[40:43], v[160:175]
    v_mfma_f32_32x32x16_bf16 v[176:191], v[20:23], v[44:47], v[176:191]
    s_waitcnt vmcnt(4)
    ds_read_b128 v[32:35], v54 offset:768
    ds_read_b128 v[36:39], v54 offset:33536
    v_mfma_f32_32x32x16_bf16 v[192:207], v[24:27], v[40:43], v[192:207]
    ds_read_b64_tr_b16 v[0:1], v56 offset:8192
    ds_read_b64_tr_b16 v[2:3], v56 offset:9216
    v_mfma_f32_32x32x16_bf16 v[208:223], v[24:27], v[44:47], v[208:223]
    ds_read_b64_tr_b16 v[4:5], v57 offset:8192
    ds_read_b64_tr_b16 v[6:7], v57 offset:9216
    v_mfma_f32_32x32x16_bf16 v[224:239], v[28:31], v[40:43], v[224:239]
    ds_read_b64_tr_b16 v[8:9], v58 offset:8192
    ds_read_b64_tr_b16 v[10:11], v58 offset:9216
    v_mfma_f32_32x32x16_bf16 v[240:255], v[28:31], v[44:47], v[240:255]
    ds_read_b64_tr_b16 v[12:13], v59 offset:8192
    ds_read_b64_tr_b16 v[14:15], v59 offset:9216
    s_waitcnt lgkmcnt(0)
    v_mfma_f32_32x32x16_bf16 v[128:143], v[0:3], v[32:35], v[128:143]
    v_mfma_f32_32x32x16_bf16 v[144:159], v[0:3], v[36:39], v[144:159]
    v_mfma_f32_32x32x16_bf16 v[160:175], v[4:7], v[32:35], v[160:175]
    v_mfma_f32_32x32x16_bf16 v[176:191], v[4:7], v[36:39], v[176:191]
    s_waitcnt vmcnt(0)
    ds_read_b128 v[40:43], v55 offset:768
    ds_read_b128 v[44:47], v55 offset:33536
    v_mfma_f32_32x32x16_bf16 v[192:207], v[8:11], v[32:35], v[192:207]
    ds_read_b64_tr_b16 v[16:17], v56 offset:12288
    ds_read_b64_tr_b16 v[18:19], v56 offset:13312
    v_mfma_f32_32x32x16_bf16 v[208:223], v[8:11], v[36:39], v[208:223]
    ds_read_b64_tr_b16 v[20:21], v57 offset:12288
    ds_read_b64_tr_b16 v[22:23], v57 offset:13312
    v_mfma_f32_32x32x16_bf16 v[224:239], v[12:15], v[32:35], v[224:239]
    ds_read_b64_tr_b16 v[24:25], v58 offset:12288
    ds_read_b64_tr_b16 v[26:27], v58 offset:13312
    v_mfma_f32_32x32x16_bf16 v[240:255], v[12:15], v[36:39], v[240:255]
    ds_read_b64_tr_b16 v[28:29], v59 offset:12288
    ds_read_b64_tr_b16 v[30:31], v59 offset:13312
    s_waitcnt lgkmcnt(0)
    v_mfma_f32_32x32x16_bf16 v[128:143], v[16:19], v[40:43], v[128:143]
    v_mfma_f32_32x32x16_bf16 v[144:159], v[16:19], v[44:47], v[144:159]
    v_mfma_f32_32x32x16_bf16 v[160:175], v[20:23], v[40:43], v[160:175]
    v_mfma_f32_32x32x16_bf16 v[176:191], v[20:23], v[44:47], v[176:191]
    v_mfma_f32_32x32x16_bf16 v[192:207], v[24:27], v[40:43], v[192:207]
    v_mfma_f32_32x32x16_bf16 v[208:223], v[24:27], v[44:47], v[208:223]
    v_mfma_f32_32x32x16_bf16 v[224:239], v[28:31], v[40:43], v[224:239]
    v_mfma_f32_32x32x16_bf16 v[240:255], v[28:31], v[44:47], v[240:255]
    s_cmp_lg_u32 s68, 0
    s_cbranch_scc1 L_BN2
    s_mov_b32 s8, s54
    s_mov_b32 s9, s55
    s_lshl_b32 s26, s20, 8
    s_sub_u32 s26, s26, 4096
    s_add_u32 m0, s25, 0
    s_add_u32 s26, s26, 4096
    buffer_load_dwordx4 v60, s[8:11], s26 offen lds
    s_add_u32 m0, s25, 1024
    s_add_u32 s26, s26, 4096
    buffer_load_dwordx4 v60, s[8:11], s26 offen lds
    s_add_u32 m0, s25, 2048
    s_add_u32 s26, s26, 4096
    buffer_load_dwordx4 v60, s[8:11], s26 offen lds
    s_add_u32 m0, s25, 3072
    s_add_u32 s26, s26, 4096
    buffer_load_dwordx4 v60, s[8:11], s26 offen lds
    s_add_u32 m0, s25, 4096
    s_add_u32 s26, s26, 4096
    buffer_load_dwordx4 v60, s[8:11], s26 offen lds
    s_add_u32 m0, s25, 5120
    s_add_u32 s26, s26, 4096
    buffer_load_dwordx4 v60, s[8:11], s26 offen lds
    s_add_u32 m0, s25, 6144
    s_add_u32 s26, s26, 4096
    buffer_load_dwordx4 v60, s[8:11], s26 offen lds
    s_add_u32 m0, s25, 7168
    s_add_u32 s26, s26, 4096
    buffer_load_dwordx4 v60, s[8:11], s26 offen lds
    s_add_u32 m0, s25, 8192
    s_add_u32 s26, s26, 4096
    buffer_load_dwordx4 v60, s[8:11], s26 offen lds
    s_add_u32 m0, s25, 9216
    s_add_u32 s26, s26, 4096
    buffer_load_dwordx4 v60, s[8:11], s26 offen lds
    s_add_u32 m0, s25, 10240
    s_add_u32 s26, s26, 4096
    buffer_load_dwordx4 v60, s[8:11], s26 offen lds
    s_add_u32 m0, s25, 11264
    s_add_u32 s26, s26, 4096
    buffer_load_dwordx4 v60, s[8:11], s26 offen lds
    s_branch L_BDUMP
L_BN2:
    s_mov_b32 s8, s56
    s_mov_b32 s9, s57
    s_mov_b32 s10, 0x158000
    s_mov_b32 s11, 0x00020000
    s_lshl_b32 s66, s20, 7
    s_sub_u32 s66, s66, 22016
    s_add_u32 m0, s25, 0
    s_add_u32 s66, s66, 22016
    buffer_load_dwordx4 v61, s[8:11], s66 offen lds
    s_add_u32 m0, s25, 1024
    s_add_u32 s66, s66, 22016
    buffer_load_dwordx4 v61, s[8:11], s66 offen lds
    s_add_u32 m0, s25, 2048
    s_add_u32 s66, s66, 22016
    buffer_load_dwordx4 v61, s[8:11], s66 offen lds
    s_add_u32 m0, s25, 3072
    s_add_u32 s66, s66, 22016
    buffer_load_dwordx4 v61, s[8:11], s66 offen lds
    s_add_u32 m0, s25, 4096
    s_add_u32 s66, s66, 22016
    buffer_load_dwordx4 v61, s[8:11], s66 offen lds
    s_add_u32 m0, s25, 5120
    s_add_u32 s66, s66, 22016
    buffer_load_dwordx4 v61, s[8:11], s66 offen lds
    s_add_u32 m0, s25, 6144
    s_add_u32 s66, s66, 22016
    buffer_load_dwordx4 v61, s[8:11], s66 offen lds
    s_add_u32 m0, s25, 7168
    s_add_u32 s66, s66, 22016
    buffer_load_dwordx4 v61, s[8:11], s66 offen lds
    s_add_u32 m0, s25, 8192
    s_add_u32 s66, s66, 22016
    buffer_load_dwordx4 v61, s[8:11], s66 offen lds
    s_add_u32 m0, s25, 9216
    s_add_u32 s66, s66, 22016
    buffer_load_dwordx4 v61, s[8:11], s66 offen lds
    s_add_u32 m0, s25, 10240
    s_add_u32 s66, s66, 22016
    buffer_load_dwordx4 v61, s[8:11], s66 offen lds
    s_add_u32 m0, s25, 11264
    s_add_u32 s66, s66, 22016
    buffer_load_dwordx4 v61, s[8:11], s66 offen lds
L_BDUMP:
    v_mbcnt_lo_u32_b32 v0, -1, 0
    v_mbcnt_hi_u32_b32 v0, -1, v0
    v_and_b32 v1, 31, v0
    v_and_b32 v2, 15, v0
    s_lshl_b32 s30, s20, 4
    s_and_b32 s31, s30, 15
    v_xor_b32 v2, s31, v2
    v_lshlrev_b32 v2, 4, v2
    v_lshl_add_u32 v2, v1, 10, v2
    v_lshrrev_b32 v1, 5, v0
    v_lshl_add_u32 v2, v1, 3, v2
    s_lshr_b32 s30, s30, 4
    s_lshl_b32 s30, s30, 8
    s_add_u32 s30, s30, 0x0
    v_add_u32 v40, s30, v2
    v_cvt_pk_bf16_f32 v128, v128, v129
    v_cvt_pk_bf16_f32 v129, v130, v131
    v_cvt_pk_bf16_f32 v130, v132, v133
    v_cvt_pk_bf16_f32 v131, v134, v135
    v_cvt_pk_bf16_f32 v132, v136, v137
    v_cvt_pk_bf16_f32 v133, v138, v139
    v_cvt_pk_bf16_f32 v134, v140, v141
    v_cvt_pk_bf16_f32 v135, v142, v143
    v_cvt_pk_bf16_f32 v144, v144, v145
    v_cvt_pk_bf16_f32 v145, v146, v147
    v_cvt_pk_bf16_f32 v146, v148, v149
    v_cvt_pk_bf16_f32 v147, v150, v151
    v_cvt_pk_bf16_f32 v148, v152, v153
    v_cvt_pk_bf16_f32 v149, v154, v155
    v_cvt_pk_bf16_f32 v150, v156, v157
    v_cvt_pk_bf16_f32 v151, v158, v159
    v_cvt_pk_bf16_f32 v160, v160, v161
    v_cvt_pk_bf16_f32 v161, v162, v163
    v_cvt_pk_bf16_f32 v162, v164, v165
    v_cvt_pk_bf16_f32 v163, v166, v167
    v_cvt_pk_bf16_f32 v164, v168, v169
    v_cvt_pk_bf16_f32 v165, v170, v171
    v_cvt_pk_bf16_f32 v166, v172, v173
    v_cvt_pk_bf16_f32 v167, v174, v175
    v_cvt_pk_bf16_f32 v176, v176, v177
    v_cvt_pk_bf16_f32 v177, v178, v179
    v_cvt_pk_bf16_f32 v178, v180, v181
    v_cvt_pk_bf16_f32 v179, v182, v183
    v_cvt_pk_bf16_f32 v180, v184, v185
    v_cvt_pk_bf16_f32 v181, v186, v187
    v_cvt_pk_bf16_f32 v182, v188, v189
    v_cvt_pk_bf16_f32 v183, v190, v191
    v_cvt_pk_bf16_f32 v192, v192, v193
    v_cvt_pk_bf16_f32 v193, v194, v195
    v_cvt_pk_bf16_f32 v194, v196, v197
    v_cvt_pk_bf16_f32 v195, v198, v199
    v_cvt_pk_bf16_f32 v196, v200, v201
    v_cvt_pk_bf16_f32 v197, v202, v203
    v_cvt_pk_bf16_f32 v198, v204, v205
    v_cvt_pk_bf16_f32 v199, v206, v207
    v_cvt_pk_bf16_f32 v208, v208, v209
    v_cvt_pk_bf16_f32 v209, v210, v211
    v_cvt_pk_bf16_f32 v210, v212, v213
    v_cvt_pk_bf16_f32 v211, v214, v215
    v_cvt_pk_bf16_f32 v212, v216, v217
    v_cvt_pk_bf16_f32 v213, v218, v219
    v_cvt_pk_bf16_f32 v214, v220, v221
    v_cvt_pk_bf16_f32 v215, v222, v223
    v_cvt_pk_bf16_f32 v224, v224, v225
    v_cvt_pk_bf16_f32 v225, v226, v227
    v_cvt_pk_bf16_f32 v226, v228, v229
    v_cvt_pk_bf16_f32 v227, v230, v231
    v_cvt_pk_bf16_f32 v228, v232, v233
    v_cvt_pk_bf16_f32 v229, v234, v235
    v_cvt_pk_bf16_f32 v230, v236, v237
    v_cvt_pk_bf16_f32 v231, v238, v239
    v_cvt_pk_bf16_f32 v240, v240, v241
    v_cvt_pk_bf16_f32 v241, v242, v243
    v_cvt_pk_bf16_f32 v242, v244, v245
    v_cvt_pk_bf16_f32 v243, v246, v247
    v_cvt_pk_bf16_f32 v244, v248, v249
    v_cvt_pk_bf16_f32 v245, v250, v251
    v_cvt_pk_bf16_f32 v246, v252, v253
    v_cvt_pk_bf16_f32 v247, v254, v255
    s_barrier
    v_xor_b32 v1, 0, v40
    ds_write_b64 v1, v[128:129] offset:0
    ds_write_b64 v1, v[144:145] offset:32768
    v_xor_b32 v1, 16, v40
    ds_write_b64 v1, v[130:131] offset:0
    ds_write_b64 v1, v[146:147] offset:32768
    v_xor_b32 v1, 32, v40
    ds_write_b64 v1, v[132:133] offset:0
    ds_write_b64 v1, v[148:149] offset:32768
    v_xor_b32 v1, 48, v40
    ds_write_b64 v1, v[134:135] offset:0
    ds_write_b64 v1, v[150:151] offset:32768
    v_xor_b32 v1, 64, v40
    ds_write_b64 v1, v[160:161] offset:0
    ds_write_b64 v1, v[176:177] offset:32768
    v_xor_b32 v1, 80, v40
    ds_write_b64 v1, v[162:163] offset:0
    ds_write_b64 v1, v[178:179] offset:32768
    v_xor_b32 v1, 96, v40
    ds_write_b64 v1, v[164:165] offset:0
    ds_write_b64 v1, v[180:181] offset:32768
    v_xor_b32 v1, 112, v40
    ds_write_b64 v1, v[166:167] offset:0
    ds_write_b64 v1, v[182:183] offset:32768
    v_xor_b32 v1, 128, v40
    ds_write_b64 v1, v[192:193] offset:0
    ds_write_b64 v1, v[208:209] offset:32768
    v_xor_b32 v1, 144, v40
    ds_write_b64 v1, v[194:195] offset:0
    ds_write_b64 v1, v[210:211] offset:32768
    v_xor_b32 v1, 160, v40
    ds_write_b64 v1, v[196:197] offset:0
    ds_write_b64 v1, v[212:213] offset:32768
    v_xor_b32 v1, 176, v40
    ds_write_b64 v1, v[198:199] offset:0
    ds_write_b64 v1, v[214:215] offset:32768
    v_xor_b32 v1, 192, v40
    ds_write_b64 v1, v[224:225] offset:0
    ds_write_b64 v1, v[240:241] offset:32768
    v_xor_b32 v1, 208, v40
    ds_write_b64 v1, v[226:227] offset:0
    ds_write_b64 v1, v[242:243] offset:32768
    v_xor_b32 v1, 224, v40
    ds_write_b64 v1, v[228:229] offset:0
    ds_write_b64 v1, v[244:245] offset:32768
    v_xor_b32 v1, 240, v40
    ds_write_b64 v1, v[230:231] offset:0
    ds_write_b64 v1, v[246:247] offset:32768
    v_lshrrev_b32 v1, 4, v0
    s_lshl_b32 s30, s20, 2
    v_add_u32 v1, s30, v1
    v_and_b32 v2, 15, v0
    v_lshlrev_b32 v3, 10, v1
    v_lshl_add_u32 v121, v2, 4, v3
    v_xor_b32 v4, v2, v1
    v_lshl_add_u32 v120, v4, 4, v3
    s_add_u32 s78, s28, 0x5000000
    s_mov_b32 s27, 0
    v_mov_b32 v62, 0xc0135761
    s_cmp_eq_u32 s68, 0
    s_cbranch_scc1 L_BR0
    buffer_load_dwordx4 v[96:99], v121, s[4:7], s78 offen offset:0 sc1
    buffer_load_dwordx4 v[100:103], v121, s[4:7], s78 offen offset:256 sc1
    buffer_load_dwordx4 v[104:107], v121, s[4:7], s78 offen offset:512 sc1
    buffer_load_dwordx4 v[108:111], v121, s[4:7], s78 offen offset:768 sc1
L_BR0:
    s_waitcnt lgkmcnt(0)
    s_barrier
L_BROW:
    ds_read_b128 v[16:19], v120 offset:0
    ds_read_b128 v[20:23], v120 offset:256
    ds_read_b128 v[24:27], v120 offset:512
    ds_read_b128 v[28:31], v120 offset:768
    s_cmp_eq_u32 s68, 0
    s_cbranch_scc0 L_BR1
    s_waitcnt lgkmcnt(0)
    v_lshlrev_b32 v64, 16, v16
    v_and_b32 v65, 0xffff0000, v16
    v_lshlrev_b32 v66, 16, v17
    v_and_b32 v67, 0xffff0000, v17
    v_pk_mul_f32 v[72:73], v[64:65], v[64:65]
    v_pk_fma_f32 v[72:73], v[72:73], s[34:35], v[62:63] op_sel_hi:[1,0,0]
    v_pk_mul_f32 v[72:73], v[72:73], v[64:65]
    v_pk_mul_f32 v[76:77], v[66:67], v[66:67]
    v_pk_fma_f32 v[76:77], v[76:77], s[34:35], v[62:63] op_sel_hi:[1,0,0]
    v_pk_mul_f32 v[76:77], v[76:77], v[66:67]
    v_exp_f32 v72, v72
    v_exp_f32 v73, v73
    v_exp_f32 v76, v76
    v_exp_f32 v77, v77
    v_pk_add_f32 v[72:73], v[72:73], 1.0 op_sel_hi:[1,0]
    v_pk_add_f32 v[76:77], v[76:77], 1.0 op_sel_hi:[1,0]
    v_rcp_f32 v72, v72
    v_rcp_f32 v73, v73
    v_rcp_f32 v76, v76
    v_rcp_f32 v77, v77
    v_pk_mul_f32 v[72:73], v[72:73], v[64:65]
    v_cvt_pk_bf16_f32 v32, v72, v73
    v_pk_mul_f32 v[76:77], v[76:77], v[66:67]
    v_cvt_pk_bf16_f32 v33, v76, v77
    v_lshlrev_b32 v64, 16, v18
    v_and_b32 v65, 0xffff0000, v18
    v_lshlrev_b32 v66, 16, v19
    v_and_b32 v67, 0xffff0000, v19
    v_pk_mul_f32 v[72:73], v[64:65], v[64:65]
    v_pk_fma_f32 v[72:73], v[72:73], s[34:35], v[62:63] op_sel_hi:[1,0,0]
    v_pk_mul_f32 v[72:73], v[72:73], v[64:65]
    v_pk_mul_f32 v[76:77], v[66:67], v[66:67]
    v_pk_fma_f32 v[76:77], v[76:77], s[34:35], v[62:63] op_sel_hi:[1,0,0]
    v_pk_mul_f32 v[76:77], v[76:77], v[66:67]
    v_exp_f32 v72, v72
    v_exp_f32 v73, v73
    v_exp_f32 v76, v76
    v_exp_f32 v77, v77
    v_pk_add_f32 v[72:73], v[72:73], 1.0 op_sel_hi:[1,0]
    v_pk_add_f32 v[76:77], v[76:77], 1.0 op_sel_hi:[1,0]
    v_rcp_f32 v72, v72
    v_rcp_f32 v73, v73
    v_rcp_f32 v76, v76
    v_rcp_f32 v77, v77
    v_pk_mul_f32 v[72:73], v[72:73], v[64:65]
    v_cvt_pk_bf16_f32 v34, v72, v73
    v_pk_mul_f32 v[76:77], v[76:77], v[66:67]
    v_cvt_pk_bf16_f32 v35, v76, v77
    v_lshlrev_b32 v64, 16, v20
    v_and_b32 v65, 0xffff0000, v20
    v_lshlrev_b32 v66, 16, v21
    v_and_b32 v67, 0xffff0000, v21
    v_pk_mul_f32 v[72:73], v[64:65], v[64:65]
    v_pk_fma_f32 v[72:73], v[72:73], s[34:35], v[62:63] op_sel_hi:[1,0,0]
    v_pk_mul_f32 v[72:73], v[72:73], v[64:65]
    v_pk_mul_f32 v[76:77], v[66:67], v[66:67]
    v_pk_fma_f32 v[76:77], v[76:77], s[34:35], v[62:63] op_sel_hi:[1,0,0]
    v_pk_mul_f32 v[76:77], v[76:77], v[66:67]
    v_exp_f32 v72, v72
    v_exp_f32 v73, v73
    v_exp_f32 v76, v76
    v_exp_f32 v77, v77
    v_pk_add_f32 v[72:73], v[72:73], 1.0 op_sel_hi:[1,0]
    v_pk_add_f32 v[76:77], v[76:77], 1.0 op_sel_hi:[1,0]
    v_rcp_f32 v72, v72
    v_rcp_f32 v73, v73
    v_rcp_f32 v76, v76
    v_rcp_f32 v77, v77
    v_pk_mul_f32 v[72:73], v[72:73], v[64:65]
    v_cvt_pk_bf16_f32 v36, v72, v73
    v_pk_mul_f32 v[76:77], v[76:77], v[66:67]
    v_cvt_pk_bf16_f32 v37, v76, v77
    v_lshlrev_b32 v64, 16, v22
    v_and_b32 v65, 0xffff0000, v22
    v_lshlrev_b32 v66, 16, v23
    v_and_b32 v67, 0xffff0000, v23
    v_pk_mul_f32 v[72:73], v[64:65], v[64:65]
    v_pk_fma_f32 v[72:73], v[72:73], s[34:35], v[62:63] op_sel_hi:[1,0,0]
    v_pk_mul_f32 v[72:73], v[72:73], v[64:65]
    v_pk_mul_f32 v[76:77], v[66:67], v[66:67]
    v_pk_fma_f32 v[76:77], v[76:77], s[34:35], v[62:63] op_sel_hi:[1,0,0]
    v_pk_mul_f32 v[76:77], v[76:77], v[66:67]
    v_exp_f32 v72, v72
    v_exp_f32 v73, v73
    v_exp_f32 v76, v76
    v_exp_f32 v77, v77
    v_pk_add_f32 v[72:73], v[72:73], 1.0 op_sel_hi:[1,0]
    v_pk_add_f32 v[76:77], v[76:77], 1.0 op_sel_hi:[1,0]
    v_rcp_f32 v72, v72
    v_rcp_f32 v73, v73
    v_rcp_f32 v76, v76
    v_rcp_f32 v77, v77
    v_pk_mul_f32 v[72:73], v[72:73], v[64:65]
    v_cvt_pk_bf16_f32 v38, v72, v73
    v_pk_mul_f32 v[76:77], v[76:77], v[66:67]
    v_cvt_pk_bf16_f32 v39, v76, v77
    v_lshlrev_b32 v64, 16, v24
    v_and_b32 v65, 0xffff0000, v24
    v_lshlrev_b32 v66, 16, v25
    v_and_b32 v67, 0xffff0000, v25
    v_pk_mul_f32 v[72:73], v[64:65], v[64:65]
    v_pk_fma_f32 v[72:73], v[72:73], s[34:35], v[62:63] op_sel_hi:[1,0,0]
    v_pk_mul_f32 v[72:73], v[72:73], v[64:65]
    v_pk_mul_f32 v[76:77], v[66:67], v[66:67]
    v_pk_fma_f32 v[76:77], v[76:77], s[34:35], v[62:63] op_sel_hi:[1,0,0]
    v_pk_mul_f32 v[76:77], v[76:77], v[66:67]
    v_exp_f32 v72, v72
    v_exp_f32 v73, v73
    v_exp_f32 v76, v76
    v_exp_f32 v77, v77
    v_pk_add_f32 v[72:73], v[72:73], 1.0 op_sel_hi:[1,0]
    v_pk_add_f32 v[76:77], v[76:77], 1.0 op_sel_hi:[1,0]
    v_rcp_f32 v72, v72
    v_rcp_f32 v73, v73
    v_rcp_f32 v76, v76
    v_rcp_f32 v77, v77
    v_pk_mul_f32 v[72:73], v[72:73], v[64:65]
    v_cvt_pk_bf16_f32 v40, v72, v73
    v_pk_mul_f32 v[76:77], v[76:77], v[66:67]
    v_cvt_pk_bf16_f32 v41, v76, v77
    v_lshlrev_b32 v64, 16, v26
    v_and_b32 v65, 0xffff0000, v26
    v_lshlrev_b32 v66, 16, v27
    v_and_b32 v67, 0xffff0000, v27
    v_pk_mul_f32 v[72:73], v[64:65], v[64:65]
    v_pk_fma_f32 v[72:73], v[72:73], s[34:35], v[62:63] op_sel_hi:[1,0,0]
    v_pk_mul_f32 v[72:73], v[72:73], v[64:65]
    v_pk_mul_f32 v[76:77], v[66:67], v[66:67]
    v_pk_fma_f32 v[76:77], v[76:77], s[34:35], v[62:63] op_sel_hi:[1,0,0]
    v_pk_mul_f32 v[76:77], v[76:77], v[66:67]
    v_exp_f32 v72, v72
    v_exp_f32 v73, v73
    v_exp_f32 v76, v76
    v_exp_f32 v77, v77
    v_pk_add_f32 v[72:73], v[72:73], 1.0 op_sel_hi:[1,0]
    v_pk_add_f32 v[76:77], v[76:77], 1.0 op_sel_hi:[1,0]
    v_rcp_f32 v72, v72
    v_rcp_f32 v73, v73
    v_rcp_f32 v76, v76
    v_rcp_f32 v77, v77
    v_pk_mul_f32 v[72:73], v[72:73], v[64:65]
    v_cvt_pk_bf16_f32 v42, v72, v73
    v_pk_mul_f32 v[76:77], v[76:77], v[66:67]
    v_cvt_pk_bf16_f32 v43, v76, v77
    v_lshlrev_b32 v64, 16, v28
    v_and_b32 v65, 0xffff0000, v28
    v_lshlrev_b32 v66, 16, v29
    v_and_b32 v67, 0xffff0000, v29
    v_pk_mul_f32 v[72:73], v[64:65], v[64:65]
    v_pk_fma_f32 v[72:73], v[72:73], s[34:35], v[62:63] op_sel_hi:[1,0,0]
    v_pk_mul_f32 v[72:73], v[72:73], v[64:65]
    v_pk_mul_f32 v[76:77], v[66:67], v[66:67]
    v_pk_fma_f32 v[76:77], v[76:77], s[34:35], v[62:63] op_sel_hi:[1,0,0]
    v_pk_mul_f32 v[76:77], v[76:77], v[66:67]
    v_exp_f32 v72, v72
    v_exp_f32 v73, v73
    v_exp_f32 v76, v76
    v_exp_f32 v77, v77
    v_pk_add_f32 v[72:73], v[72:73], 1.0 op_sel_hi:[1,0]
    v_pk_add_f32 v[76:77], v[76:77], 1.0 op_sel_hi:[1,0]
    v_rcp_f32 v72, v72
    v_rcp_f32 v73, v73
    v_rcp_f32 v76, v76
    v_rcp_f32 v77, v77
    v_pk_mul_f32 v[72:73], v[72:73], v[64:65]
    v_cvt_pk_bf16_f32 v44, v72, v73
    v_pk_mul_f32 v[76:77], v[76:77], v[66:67]
    v_cvt_pk_bf16_f32 v45, v76, v77
    v_lshlrev_b32 v64, 16, v30
    v_and_b32 v65, 0xffff0000, v30
    v_lshlrev_b32 v66, 16, v31
    v_and_b32 v67, 0xffff0000, v31
    v_pk_mul_f32 v[72:73], v[64:65], v[64:65]
    v_pk_fma_f32 v[72:73], v[72:73], s[34:35], v[62:63] op_sel_hi:[1,0,0]
    v_pk_mul_f32 v[72:73], v[72:73], v[64:65]
    v_pk_mul_f32 v[76:77], v[66:67], v[66:67]
    v_pk_fma_f32 v[76:77], v[76:77], s[34:35], v[62:63] op_sel_hi:[1,0,0]
    v_pk_mul_f32 v[76:77], v[76:77], v[66:67]
    v_exp_f32 v72, v72
    v_exp_f32 v73, v73
    v_exp_f32 v76, v76
    v_exp_f32 v77, v77
    v_pk_add_f32 v[72:73], v[72:73], 1.0 op_sel_hi:[1,0]
    v_pk_add_f32 v[76:77], v[76:77], 1.0 op_sel_hi:[1,0]
    v_rcp_f32 v72, v72
    v_rcp_f32 v73, v73
    v_rcp_f32 v76, v76
    v_rcp_f32 v77, v77
    v_pk_mul_f32 v[72:73], v[72:73], v[64:65]
    v_cvt_pk_bf16_f32 v46, v72, v73
    v_pk_mul_f32 v[76:77], v[76:77], v[66:67]
    v_cvt_pk_bf16_f32 v47, v76, v77
    s_branch L_BRW
L_BR1:
    s_waitcnt vmcnt(0) lgkmcnt(0)
    v_lshlrev_b32 v64, 16, v16
    v_and_b32 v65, 0xffff0000, v16
    v_lshlrev_b32 v66, 16, v96
    v_and_b32 v67, 0xffff0000, v96
    v_pk_add_f32 v[64:65], v[64:65], v[66:67]
    v_cvt_pk_bf16_f32 v16, v64, v65
    v_lshlrev_b32 v68, 16, v17
    v_and_b32 v69, 0xffff0000, v17
    v_lshlrev_b32 v70, 16, v97
    v_and_b32 v71, 0xffff0000, v97
    v_pk_add_f32 v[68:69], v[68:69], v[70:71]
    v_cvt_pk_bf16_f32 v17, v68, v69
    v_lshlrev_b32 v64, 16, v18
    v_and_b32 v65, 0xffff0000, v18
    v_lshlrev_b32 v66, 16, v98
    v_and_b32 v67, 0xffff0000, v98
    v_pk_add_f32 v[64:65], v[64:65], v[66:67]
    v_cvt_pk_bf16_f32 v18, v64, v65
    v_lshlrev_b32 v68, 16, v19
    v_and_b32 v69, 0xffff0000, v19
    v_lshlrev_b32 v70, 16, v99
    v_and_b32 v71, 0xffff0000, v99
    v_pk_add_f32 v[68:69], v[68:69], v[70:71]
    v_cvt_pk_bf16_f32 v19, v68, v69
    v_lshlrev_b32 v64, 16, v20
    v_and_b32 v65, 0xffff0000, v20
    v_lshlrev_b32 v66, 16, v100
    v_and_b32 v67, 0xffff0000, v100
    v_pk_add_f32 v[64:65], v[64:65], v[66:67]
    v_cvt_pk_bf16_f32 v20, v64, v65
    v_lshlrev_b32 v68, 16, v21
    v_and_b32 v69, 0xffff0000, v21
    v_lshlrev_b32 v70, 16, v101
    v_and_b32 v71, 0xffff0000, v101
    v_pk_add_f32 v[68:69], v[68:69], v[70:71]
    v_cvt_pk_bf16_f32 v21, v68, v69
    v_lshlrev_b32 v64, 16, v22
    v_and_b32 v65, 0xffff0000, v22
    v_lshlrev_b32 v66, 16, v102
    v_and_b32 v67, 0xffff0000, v102
    v_pk_add_f32 v[64:65], v[64:65], v[66:67]
    v_cvt_pk_bf16_f32 v22, v64, v65
    v_lshlrev_b32 v68, 16, v23
    v_and_b32 v69, 0xffff0000, v23
    v_lshlrev_b32 v70, 16, v103
    v_and_b32 v71, 0xffff0000, v103
    v_pk_add_f32 v[68:69], v[68:69], v[70:71]
    v_cvt_pk_bf16_f32 v23, v68, v69
    v_lshlrev_b32 v64, 16, v24
    v_and_b32 v65, 0xffff0000, v24
    v_lshlrev_b32 v66, 16, v104
    v_and_b32 v67, 0xffff0000, v104
    v_pk_add_f32 v[64:65], v[64:65], v[66:67]
    v_cvt_pk_bf16_f32 v24, v64, v65
    v_lshlrev_b32 v68, 16, v25
    v_and_b32 v69, 0xffff0000, v25
    v_lshlrev_b32 v70, 16, v105
    v_and_b32 v71, 0xffff0000, v105
    v_pk_add_f32 v[68:69], v[68:69], v[70:71]
    v_cvt_pk_bf16_f32 v25, v68, v69
    v_lshlrev_b32 v64, 16, v26
    v_and_b32 v65, 0xffff0000, v26
    v_lshlrev_b32 v66, 16, v106
    v_and_b32 v67, 0xffff0000, v106
    v_pk_add_f32 v[64:65], v[64:65], v[66:67]
    v_cvt_pk_bf16_f32 v26, v64, v65
    v_lshlrev_b32 v68, 16, v27
    v_and_b32 v69, 0xffff0000, v27
    v_lshlrev_b32 v70, 16, v107
    v_and_b32 v71, 0xffff0000, v107
    v_pk_add_f32 v[68:69], v[68:69], v[70:71]
    v_cvt_pk_bf16_f32 v27, v68, v69
    v_lshlrev_b32 v64, 16, v28
    v_and_b32 v65, 0xffff0000, v28
    v_lshlrev_b32 v66, 16, v108
    v_and_b32 v67, 0xffff0000, v108
    v_pk_add_f32 v[64:65], v[64:65], v[66:67]
    v_cvt_pk_bf16_f32 v28, v64, v65
    v_lshlrev_b32 v68, 16, v29
    v_and_b32 v69, 0xffff0000, v29
    v_lshlrev_b32 v70, 16, v109
    v_and_b32 v71, 0xffff0000, v109
    v_pk_add_f32 v[68:69], v[68:69], v[70:71]
    v_cvt_pk_bf16_f32 v29, v68, v69
    v_lshlrev_b32 v64, 16, v30
    v_and_b32 v65, 0xffff0000, v30
    v_lshlrev_b32 v66, 16, v110
    v_and_b32 v67, 0xffff0000, v110
    v_pk_add_f32 v[64:65], v[64:65], v[66:67]
    v_cvt_pk_bf16_f32 v30, v64, v65
    v_lshlrev_b32 v68, 16, v31
    v_and_b32 v69, 0xffff0000, v31
    v_lshlrev_b32 v70, 16, v111
    v_and_b32 v71, 0xffff0000, v111
    v_pk_add_f32 v[68:69], v[68:69], v[70:71]
    v_cvt_pk_bf16_f32 v31, v68, v69
    s_mov_b32 s31, s78
    s_add_u32 s78, s78, 0x4000
    buffer_load_dwordx4 v[96:99], v121, s[4:7], s78 offen offset:0 sc1
    buffer_load_dwordx4 v[100:103], v121, s[4:7], s78 offen offset:256 sc1
    buffer_load_dwordx4 v[104:107], v121, s[4:7], s78 offen offset:512 sc1
    buffer_load_dwordx4 v[108:111], v121, s[4:7], s78 offen offset:768 sc1
    s_cmp_eq_u32 s68, 1
    s_cbranch_scc0 L_BR2
    buffer_store_dwordx4 v[16:19], v121, s[4:7], s31 offen offset:0 sc1
    buffer_store_dwordx4 v[20:23], v121, s[4:7], s31 offen offset:256 sc1
    buffer_store_dwordx4 v[24:27], v121, s[4:7], s31 offen offset:512 sc1
    buffer_store_dwordx4 v[28:31], v121, s[4:7], s31 offen offset:768 sc1
    v_lshlrev_b32 v64, 16, v16
    v_and_b32 v65, 0xffff0000, v16
    v_lshlrev_b32 v66, 16, v17
    v_and_b32 v67, 0xffff0000, v17
    v_lshlrev_b32 v68, 16, v18
    v_and_b32 v69, 0xffff0000, v18
    v_lshlrev_b32 v70, 16, v19
    v_and_b32 v71, 0xffff0000, v19
    v_lshlrev_b32 v72, 16, v20
    v_and_b32 v73, 0xffff0000, v20
    v_lshlrev_b32 v74, 16, v21
    v_and_b32 v75, 0xffff0000, v21
    v_lshlrev_b32 v76, 16, v22
    v_and_b32 v77, 0xffff0000, v22
    v_lshlrev_b32 v78, 16, v23
    v_and_b32 v79, 0xffff0000, v23
    v_lshlrev_b32 v80, 16, v24
    v_and_b32 v81, 0xffff0000, v24
    v_lshlrev_b32 v82, 16, v25
    v_and_b32 v83, 0xffff0000, v25
    v_lshlrev_b32 v84, 16, v26
    v_and_b32 v85, 0xffff0000, v26
    v_lshlrev_b32 v86, 16, v27
    v_and_b32 v87, 0xffff0000, v27
    v_lshlrev_b32 v88, 16, v28
    v_and_b32 v89, 0xffff0000, v28
    v_lshlrev_b32 v90, 16, v29
    v_and_b32 v91, 0xffff0000, v29
    v_lshlrev_b32 v92, 16, v30
    v_and_b32 v93, 0xffff0000, v30
    v_lshlrev_b32 v94, 16, v31
    v_and_b32 v95, 0xffff0000, v31
    v_pk_add_f32 v[112:113], v[64:65], v[66:67]
    v_pk_add_f32 v[114:115], v[68:69], v[70:71]
    v_pk_add_f32 v[112:113], v[112:113], v[72:73]
    v_pk_add_f32 v[114:115], v[114:115], v[74:75]
    v_pk_add_f32 v[112:113], v[112:113], v[76:77]
    v_pk_add_f32 v[114:115], v[114:115], v[78:79]
    v_pk_add_f32 v[112:113], v[112:113], v[80:81]
    v_pk_add_f32 v[114:115], v[114:115], v[82:83]
    v_pk_add_f32 v[112:113], v[112:113], v[84:85]
    v_pk_add_f32 v[114:115], v[114:115], v[86:87]
    v_pk_add_f32 v[112:113], v[112:113], v[88:89]
    v_pk_add_f32 v[114:115], v[114:115], v[90:91]
    v_pk_add_f32 v[112:113], v[112:113], v[92:93]
    v_pk_add_f32 v[114:115], v[114:115], v[94:95]
    v_pk_add_f32 v[112:113], v[112:113], v[114:115]
    v_add_f32 v112, v112, v113
    s_nop 1
    v_add_f32_dpp v112, v112, v112 row_ror:8 row_mask:0xf bank_mask:0xf
    s_nop 1
    v_add_f32_dpp v112, v112, v112 row_ror:4 row_mask:0xf bank_mask:0xf
    s_nop 1
    v_add_f32_dpp v112, v112, v112 row_ror:2 row_mask:0xf bank_mask:0xf
    s_nop 1
    v_add_f32_dpp v112, v112, v112 row_ror:1 row_mask:0xf bank_mask:0xf
    v_mul_f32 v112, 0x3b000000, v112
    v_pk_add_f32 v[114:115], v[64:65], v[112:113] op_sel_hi:[1,0] neg_lo:[0,1] neg_hi:[0,1]
    v_pk_mul_f32 v[116:117], v[114:115], v[114:115]
    v_pk_add_f32 v[114:115], v[66:67], v[112:113] op_sel_hi:[1,0] neg_lo:[0,1] neg_hi:[0,1]
    v_pk_mul_f32 v[118:119], v[114:115], v[114:115]
    v_pk_add_f32 v[114:115], v[68:69], v[112:113] op_sel_hi:[1,0] neg_lo:[0,1] neg_hi:[0,1]
    v_pk_fma_f32 v[116:117], v[114:115], v[114:115], v[116:117]
    v_pk_add_f32 v[114:115], v[70:71], v[112:113] op_sel_hi:[1,0] neg_lo:[0,1] neg_hi:[0,1]
    v_pk_fma_f32 v[118:119], v[114:115], v[114:115], v[118:119]
    v_pk_add_f32 v[114:115], v[72:73], v[112:113] op_sel_hi:[1,0] neg_lo:[0,1] neg_hi:[0,1]
    v_pk_fma_f32 v[116:117], v[114:115], v[114:115], v[116:117]
    v_pk_add_f32 v[114:115], v[74:75], v[112:113] op_sel_hi:[1,0] neg_lo:[0,1] neg_hi:[0,1]
    v_pk_fma_f32 v[118:119], v[114:115], v[114:115], v[118:119]
    v_pk_add_f32 v[114:115], v[76:77], v[112:113] op_sel_hi:[1,0] neg_lo:[0,1] neg_hi:[0,1]
    v_pk_fma_f32 v[116:117], v[114:115], v[114:115], v[116:117]
    v_pk_add_f32 v[114:115], v[78:79], v[112:113] op_sel_hi:[1,0] neg_lo:[0,1] neg_hi:[0,1]
    v_pk_fma_f32 v[118:119], v[114:115], v[114:115], v[118:119]
    v_pk_add_f32 v[114:115], v[80:81], v[112:113] op_sel_hi:[1,0] neg_lo:[0,1] neg_hi:[0,1]
    v_pk_fma_f32 v[116:117], v[114:115], v[114:115], v[116:117]
    v_pk_add_f32 v[114:115], v[82:83], v[112:113] op_sel_hi:[1,0] neg_lo:[0,1] neg_hi:[0,1]
    v_pk_fma_f32 v[118:119], v[114:115], v[114:115], v[118:119]
    v_pk_add_f32 v[114:115], v[84:85], v[112:113] op_sel_hi:[1,0] neg_lo:[0,1] neg_hi:[0,1]
    v_pk_fma_f32 v[116:117], v[114:115], v[114:115], v[116:117]
    v_pk_add_f32 v[114:115], v[86:87], v[112:113] op_sel_hi:[1,0] neg_lo:[0,1] neg_hi:[0,1]
    v_pk_fma_f32 v[118:119], v[114:115], v[114:115], v[118:119]
    v_pk_add_f32 v[114:115], v[88:89], v[112:113] op_sel_hi:[1,0] neg_lo:[0,1] neg_hi:[0,1]
    v_pk_fma_f32 v[116:117], v[114:115], v[114:115], v[116:117]
    v_pk_add_f32 v[114:115], v[90:91], v[112:113] op_sel_hi:[1,0] neg_lo:[0,1] neg_hi:[0,1]
    v_pk_fma_f32 v[118:119], v[114:115], v[114:115], v[118:119]
    v_pk_add_f32 v[114:115], v[92:93], v[112:113] op_sel_hi:[1,0] neg_lo:[0,1] neg_hi:[0,1]
    v_pk_fma_f32 v[116:117], v[114:115], v[114:115], v[116:117]
    v_pk_add_f32 v[114:115], v[94:95], v[112:113] op_sel_hi:[1,0] neg_lo:[0,1] neg_hi:[0,1]
    v_pk_fma_f32 v[118:119], v[114:115], v[114:115], v[118:119]
    v_pk_add_f32 v[116:117], v[116:117], v[118:119]
    v_add_f32 v116, v116, v117
    s_nop 1
    v_add_f32_dpp v116, v116, v116 row_ror:8 row_mask:0xf bank_mask:0xf
    s_nop 1
    v_add_f32_dpp v116, v116, v116 row_ror:4 row_mask:0xf bank_mask:0xf
    s_nop 1
    v_add_f32_dpp v116, v116, v116 row_ror:2 row_mask:0xf bank_mask:0xf
    s_nop 1
    v_add_f32_dpp v116, v116, v116 row_ror:1 row_mask:0xf bank_mask:0xf
    v_mul_f32 v116, 0x3b000000, v116
    v_cvt_pk_bf16_f32 v112, v112, v112
    v_lshlrev_b32 v112, 16, v112
    v_cvt_pk_bf16_f32 v116, v116, v116
    v_lshlrev_b32 v116, 16, v116
    v_add_f32 v116, 0x3727c5ac, v116
    v_cvt_pk_bf16_f32 v116, v116, v116
    v_lshlrev_b32 v116, 16, v116
    v_sqrt_f32 v116, v116
    s_nop 0
    v_cvt_pk_bf16_f32 v116, v116, v116
    v_lshlrev_b32 v116, 16, v116
    v_rcp_f32 v116, v116
    v_pk_add_f32 v[114:115], v[64:65], v[112:113] op_sel_hi:[1,0] neg_lo:[0,1] neg_hi:[0,1]
    v_cvt_pk_bf16_f32 v115, v114, v115
    v_lshlrev_b32 v114, 16, v115
    v_and_b32 v115, 0xffff0000, v115
    v_pk_mul_f32 v[114:115], v[114:115], v[116:117] op_sel_hi:[1,0]
    v_cvt_pk_bf16_f32 v32, v114, v115
    v_pk_add_f32 v[118:119], v[66:67], v[112:113] op_sel_hi:[1,0] neg_lo:[0,1] neg_hi:[0,1]
    v_cvt_pk_bf16_f32 v119, v118, v119
    v_lshlrev_b32 v118, 16, v119
    v_and_b32 v119, 0xffff0000, v119
    v_pk_mul_f32 v[118:119], v[118:119], v[116:117] op_sel_hi:[1,0]
    v_cvt_pk_bf16_f32 v33, v118, v119
    v_pk_add_f32 v[114:115], v[68:69], v[112:113] op_sel_hi:[1,0] neg_lo:[0,1] neg_hi:[0,1]
    v_cvt_pk_bf16_f32 v115, v114, v115
    v_lshlrev_b32 v114, 16, v115
    v_and_b32 v115, 0xffff0000, v115
    v_pk_mul_f32 v[114:115], v[114:115], v[116:117] op_sel_hi:[1,0]
    v_cvt_pk_bf16_f32 v34, v114, v115
    v_pk_add_f32 v[118:119], v[70:71], v[112:113] op_sel_hi:[1,0] neg_lo:[0,1] neg_hi:[0,1]
    v_cvt_pk_bf16_f32 v119, v118, v119
    v_lshlrev_b32 v118, 16, v119
    v_and_b32 v119, 0xffff0000, v119
    v_pk_mul_f32 v[118:119], v[118:119], v[116:117] op_sel_hi:[1,0]
    v_cvt_pk_bf16_f32 v35, v118, v119
    v_pk_add_f32 v[114:115], v[72:73], v[112:113] op_sel_hi:[1,0] neg_lo:[0,1] neg_hi:[0,1]
    v_cvt_pk_bf16_f32 v115, v114, v115
    v_lshlrev_b32 v114, 16, v115
    v_and_b32 v115, 0xffff0000, v115
    v_pk_mul_f32 v[114:115], v[114:115], v[116:117] op_sel_hi:[1,0]
    v_cvt_pk_bf16_f32 v36, v114, v115
    v_pk_add_f32 v[118:119], v[74:75], v[112:113] op_sel_hi:[1,0] neg_lo:[0,1] neg_hi:[0,1]
    v_cvt_pk_bf16_f32 v119, v118, v119
    v_lshlrev_b32 v118, 16, v119
    v_and_b32 v119, 0xffff0000, v119
    v_pk_mul_f32 v[118:119], v[118:119], v[116:117] op_sel_hi:[1,0]
    v_cvt_pk_bf16_f32 v37, v118, v119
    v_pk_add_f32 v[114:115], v[76:77], v[112:113] op_sel_hi:[1,0] neg_lo:[0,1] neg_hi:[0,1]
    v_cvt_pk_bf16_f32 v115, v114, v115
    v_lshlrev_b32 v114, 16, v115
    v_and_b32 v115, 0xffff0000, v115
    v_pk_mul_f32 v[114:115], v[114:115], v[116:117] op_sel_hi:[1,0]
    v_cvt_pk_bf16_f32 v38, v114, v115
    v_pk_add_f32 v[118:119], v[78:79], v[112:113] op_sel_hi:[1,0] neg_lo:[0,1] neg_hi:[0,1]
    v_cvt_pk_bf16_f32 v119, v118, v119
    v_lshlrev_b32 v118, 16, v119
    v_and_b32 v119, 0xffff0000, v119
    v_pk_mul_f32 v[118:119], v[118:119], v[116:117] op_sel_hi:[1,0]
    v_cvt_pk_bf16_f32 v39, v118, v119
    v_pk_add_f32 v[114:115], v[80:81], v[112:113] op_sel_hi:[1,0] neg_lo:[0,1] neg_hi:[0,1]
    v_cvt_pk_bf16_f32 v115, v114, v115
    v_lshlrev_b32 v114, 16, v115
    v_and_b32 v115, 0xffff0000, v115
    v_pk_mul_f32 v[114:115], v[114:115], v[116:117] op_sel_hi:[1,0]
    v_cvt_pk_bf16_f32 v40, v114, v115
    v_pk_add_f32 v[118:119], v[82:83], v[112:113] op_sel_hi:[1,0] neg_lo:[0,1] neg_hi:[0,1]
    v_cvt_pk_bf16_f32 v119, v118, v119
    v_lshlrev_b32 v118, 16, v119
    v_and_b32 v119, 0xffff0000, v119
    v_pk_mul_f32 v[118:119], v[118:119], v[116:117] op_sel_hi:[1,0]
    v_cvt_pk_bf16_f32 v41, v118, v119
    v_pk_add_f32 v[114:115], v[84:85], v[112:113] op_sel_hi:[1,0] neg_lo:[0,1] neg_hi:[0,1]
    v_cvt_pk_bf16_f32 v115, v114, v115
    v_lshlrev_b32 v114, 16, v115
    v_and_b32 v115, 0xffff0000, v115
    v_pk_mul_f32 v[114:115], v[114:115], v[116:117] op_sel_hi:[1,0]
    v_cvt_pk_bf16_f32 v42, v114, v115
    v_pk_add_f32 v[118:119], v[86:87], v[112:113] op_sel_hi:[1,0] neg_lo:[0,1] neg_hi:[0,1]
    v_cvt_pk_bf16_f32 v119, v118, v119
    v_lshlrev_b32 v118, 16, v119
    v_and_b32 v119, 0xffff0000, v119
    v_pk_mul_f32 v[118:119], v[118:119], v[116:117] op_sel_hi:[1,0]
    v_cvt_pk_bf16_f32 v43, v118, v119
    v_pk_add_f32 v[114:115], v[88:89], v[112:113] op_sel_hi:[1,0] neg_lo:[0,1] neg_hi:[0,1]
    v_cvt_pk_bf16_f32 v115, v114, v115
    v_lshlrev_b32 v114, 16, v115
    v_and_b32 v115, 0xffff0000, v115
    v_pk_mul_f32 v[114:115], v[114:115], v[116:117] op_sel_hi:[1,0]
    v_cvt_pk_bf16_f32 v44, v114, v115
    v_pk_add_f32 v[118:119], v[90:91], v[112:113] op_sel_hi:[1,0] neg_lo:[0,1] neg_hi:[0,1]
    v_cvt_pk_bf16_f32 v119, v118, v119
    v_lshlrev_b32 v118, 16, v119
    v_and_b32 v119, 0xffff0000, v119
    v_pk_mul_f32 v[118:119], v[118:119], v[116:117] op_sel_hi:[1,0]
    v_cvt_pk_bf16_f32 v45, v118, v119
    v_pk_add_f32 v[114:115], v[92:93], v[112:113] op_sel_hi:[1,0] neg_lo:[0,1] neg_hi:[0,1]
    v_cvt_pk_bf16_f32 v115, v114, v115
    v_lshlrev_b32 v114, 16, v115
    v_and_b32 v115, 0xffff0000, v115
    v_pk_mul_f32 v[114:115], v[114:115], v[116:117] op_sel_hi:[1,0]
    v_cvt_pk_bf16_f32 v46, v114, v115
    v_pk_add_f32 v[118:119], v[94:95], v[112:113] op_sel_hi:[1,0] neg_lo:[0,1] neg_hi:[0,1]
    v_cvt_pk_bf16_f32 v119, v118, v119
    v_lshlrev_b32 v118, 16, v119
    v_and_b32 v119, 0xffff0000, v119
    v_pk_mul_f32 v[118:119], v[118:119], v[116:117] op_sel_hi:[1,0]
    v_cvt_pk_bf16_f32 v47, v118, v119
L_BRW:
    ds_write_b128 v120, v[32:35] offset:0
    ds_write_b128 v120, v[36:39] offset:256
    ds_write_b128 v120, v[40:43] offset:512
    ds_write_b128 v120, v[44:47] offset:768
    s_branch L_BRN
L_BR2:
    v_lshlrev_b32 v64, 16, v16
    v_and_b32 v65, 0xffff0000, v16
    v_lshlrev_b32 v66, 16, v17
    v_and_b32 v67, 0xffff0000, v17
    v_pk_mul_f32 v[72:73], v[64:65], s[34:35] op_sel_hi:[1,0]
    v_pk_mul_f32 v[76:77], v[66:67], s[34:35] op_sel_hi:[1,0]
    v_exp_f32 v72, v72
    v_exp_f32 v73, v73
    v_exp_f32 v76, v76
    v_exp_f32 v77, v77
    v_pk_add_f32 v[72:73], v[72:73], 1.0 op_sel_hi:[1,0]
    v_pk_add_f32 v[76:77], v[76:77], 1.0 op_sel_hi:[1,0]
    v_rcp_f32 v72, v72
    v_rcp_f32 v73, v73
    v_rcp_f32 v76, v76
    v_rcp_f32 v77, v77
    v_pk_mul_f32 v[72:73], v[72:73], v[64:65]
    v_cvt_pk_bf16_f32 v32, v72, v73
    v_pk_mul_f32 v[76:77], v[76:77], v[66:67]
    v_cvt_pk_bf16_f32 v33, v76, v77
    v_lshlrev_b32 v64, 16, v18
    v_and_b32 v65, 0xffff0000, v18
    v_lshlrev_b32 v66, 16, v19
    v_and_b32 v67, 0xffff0000, v19
    v_pk_mul_f32 v[72:73], v[64:65], s[34:35] op_sel_hi:[1,0]
    v_pk_mul_f32 v[76:77], v[66:67], s[34:35] op_sel_hi:[1,0]
    v_exp_f32 v72, v72
    v_exp_f32 v73, v73
    v_exp_f32 v76, v76
    v_exp_f32 v77, v77
    v_pk_add_f32 v[72:73], v[72:73], 1.0 op_sel_hi:[1,0]
    v_pk_add_f32 v[76:77], v[76:77], 1.0 op_sel_hi:[1,0]
    v_rcp_f32 v72, v72
    v_rcp_f32 v73, v73
    v_rcp_f32 v76, v76
    v_rcp_f32 v77, v77
    v_pk_mul_f32 v[72:73], v[72:73], v[64:65]
    v_cvt_pk_bf16_f32 v34, v72, v73
    v_pk_mul_f32 v[76:77], v[76:77], v[66:67]
    v_cvt_pk_bf16_f32 v35, v76, v77
    v_lshlrev_b32 v64, 16, v20
    v_and_b32 v65, 0xffff0000, v20
    v_lshlrev_b32 v66, 16, v21
    v_and_b32 v67, 0xffff0000, v21
    v_pk_mul_f32 v[72:73], v[64:65], s[34:35] op_sel_hi:[1,0]
    v_pk_mul_f32 v[76:77], v[66:67], s[34:35] op_sel_hi:[1,0]
    v_exp_f32 v72, v72
    v_exp_f32 v73, v73
    v_exp_f32 v76, v76
    v_exp_f32 v77, v77
    v_pk_add_f32 v[72:73], v[72:73], 1.0 op_sel_hi:[1,0]
    v_pk_add_f32 v[76:77], v[76:77], 1.0 op_sel_hi:[1,0]
    v_rcp_f32 v72, v72
    v_rcp_f32 v73, v73
    v_rcp_f32 v76, v76
    v_rcp_f32 v77, v77
    v_pk_mul_f32 v[72:73], v[72:73], v[64:65]
    v_cvt_pk_bf16_f32 v36, v72, v73
    v_pk_mul_f32 v[76:77], v[76:77], v[66:67]
    v_cvt_pk_bf16_f32 v37, v76, v77
    v_lshlrev_b32 v64, 16, v22
    v_and_b32 v65, 0xffff0000, v22
    v_lshlrev_b32 v66, 16, v23
    v_and_b32 v67, 0xffff0000, v23
    v_pk_mul_f32 v[72:73], v[64:65], s[34:35] op_sel_hi:[1,0]
    v_pk_mul_f32 v[76:77], v[66:67], s[34:35] op_sel_hi:[1,0]
    v_exp_f32 v72, v72
    v_exp_f32 v73, v73
    v_exp_f32 v76, v76
    v_exp_f32 v77, v77
    v_pk_add_f32 v[72:73], v[72:73], 1.0 op_sel_hi:[1,0]
    v_pk_add_f32 v[76:77], v[76:77], 1.0 op_sel_hi:[1,0]
    v_rcp_f32 v72, v72
    v_rcp_f32 v73, v73
    v_rcp_f32 v76, v76
    v_rcp_f32 v77, v77
    v_pk_mul_f32 v[72:73], v[72:73], v[64:65]
    v_cvt_pk_bf16_f32 v38, v72, v73
    v_pk_mul_f32 v[76:77], v[76:77], v[66:67]
    v_cvt_pk_bf16_f32 v39, v76, v77
    v_lshlrev_b32 v64, 16, v24
    v_and_b32 v65, 0xffff0000, v24
    v_lshlrev_b32 v66, 16, v25
    v_and_b32 v67, 0xffff0000, v25
    v_pk_mul_f32 v[72:73], v[64:65], s[34:35] op_sel_hi:[1,0]
    v_pk_mul_f32 v[76:77], v[66:67], s[34:35] op_sel_hi:[1,0]
    v_exp_f32 v72, v72
    v_exp_f32 v73, v73
    v_exp_f32 v76, v76
    v_exp_f32 v77, v77
    v_pk_add_f32 v[72:73], v[72:73], 1.0 op_sel_hi:[1,0]
    v_pk_add_f32 v[76:77], v[76:77], 1.0 op_sel_hi:[1,0]
    v_rcp_f32 v72, v72
    v_rcp_f32 v73, v73
    v_rcp_f32 v76, v76
    v_rcp_f32 v77, v77
    v_pk_mul_f32 v[72:73], v[72:73], v[64:65]
    v_cvt_pk_bf16_f32 v40, v72, v73
    v_pk_mul_f32 v[76:77], v[76:77], v[66:67]
    v_cvt_pk_bf16_f32 v41, v76, v77
    v_lshlrev_b32 v64, 16, v26
    v_and_b32 v65, 0xffff0000, v26
    v_lshlrev_b32 v66, 16, v27
    v_and_b32 v67, 0xffff0000, v27
    v_pk_mul_f32 v[72:73], v[64:65], s[34:35] op_sel_hi:[1,0]
    v_pk_mul_f32 v[76:77], v[66:67], s[34:35] op_sel_hi:[1,0]
    v_exp_f32 v72, v72
    v_exp_f32 v73, v73
    v_exp_f32 v76, v76
    v_exp_f32 v77, v77
    v_pk_add_f32 v[72:73], v[72:73], 1.0 op_sel_hi:[1,0]
    v_pk_add_f32 v[76:77], v[76:77], 1.0 op_sel_hi:[1,0]
    v_rcp_f32 v72, v72
    v_rcp_f32 v73, v73
    v_rcp_f32 v76, v76
    v_rcp_f32 v77, v77
    v_pk_mul_f32 v[72:73], v[72:73], v[64:65]
    v_cvt_pk_bf16_f32 v42, v72, v73
    v_pk_mul_f32 v[76:77], v[76:77], v[66:67]
    v_cvt_pk_bf16_f32 v43, v76, v77
    v_lshlrev_b32 v64, 16, v28
    v_and_b32 v65, 0xffff0000, v28
    v_lshlrev_b32 v66, 16, v29
    v_and_b32 v67, 0xffff0000, v29
    v_pk_mul_f32 v[72:73], v[64:65], s[34:35] op_sel_hi:[1,0]
    v_pk_mul_f32 v[76:77], v[66:67], s[34:35] op_sel_hi:[1,0]
    v_exp_f32 v72, v72
    v_exp_f32 v73, v73
    v_exp_f32 v76, v76
    v_exp_f32 v77, v77
    v_pk_add_f32 v[72:73], v[72:73], 1.0 op_sel_hi:[1,0]
    v_pk_add_f32 v[76:77], v[76:77], 1.0 op_sel_hi:[1,0]
    v_rcp_f32 v72, v72
    v_rcp_f32 v73, v73
    v_rcp_f32 v76, v76
    v_rcp_f32 v77, v77
    v_pk_mul_f32 v[72:73], v[72:73], v[64:65]
    v_cvt_pk_bf16_f32 v44, v72, v73
    v_pk_mul_f32 v[76:77], v[76:77], v[66:67]
    v_cvt_pk_bf16_f32 v45, v76, v77
    v_lshlrev_b32 v64, 16, v30
    v_and_b32 v65, 0xffff0000, v30
    v_lshlrev_b32 v66, 16, v31
    v_and_b32 v67, 0xffff0000, v31
    v_pk_mul_f32 v[72:73], v[64:65], s[34:35] op_sel_hi:[1,0]
    v_pk_mul_f32 v[76:77], v[66:67], s[34:35] op_sel_hi:[1,0]
    v_exp_f32 v72, v72
    v_exp_f32 v73, v73
    v_exp_f32 v76, v76
    v_exp_f32 v77, v77
    v_pk_add_f32 v[72:73], v[72:73], 1.0 op_sel_hi:[1,0]
    v_pk_add_f32 v[76:77], v[76:77], 1.0 op_sel_hi:[1,0]
    v_rcp_f32 v72, v72
    v_rcp_f32 v73, v73
    v_rcp_f32 v76, v76
    v_rcp_f32 v77, v77
    v_pk_mul_f32 v[72:73], v[72:73], v[64:65]
    v_cvt_pk_bf16_f32 v46, v72, v73
    v_pk_mul_f32 v[76:77], v[76:77], v[66:67]
    v_cvt_pk_bf16_f32 v47, v76, v77
    s_add_u32 s31, s31, 0x400000
    buffer_store_dwordx4 v[32:35], v121, s[4:7], s31 offen offset:0 sc1
    buffer_store_dwordx4 v[36:39], v121, s[4:7], s31 offen offset:256 sc1
    buffer_store_dwordx4 v[40:43], v121, s[4:7], s31 offen offset:512 sc1
    buffer_store_dwordx4 v[44:47], v121, s[4:7], s31 offen offset:768 sc1
L_BRN:
    v_add_u32 v120, 0x4000, v120
    s_add_u32 s27, s27, 1
    s_cmp_lt_u32 s27, 4
    s_cbranch_scc1 L_BROW
    s_cmp_eq_u32 s68, 2
    s_cbranch_scc1 L_BFIN
    s_cmp_eq_u32 s68, 1
    s_cbranch_scc1 L_B2E
    v_mbcnt_lo_u32_b32 v0, -1, 0
    v_mbcnt_hi_u32_b32 v0, -1, v0
    v_and_b32 v1, 31, v0
    v_lshrrev_b32 v2, 5, v0
    v_and_b32 v3, 15, v1
    v_xor_b32 v2, v2, v3
    v_lshlrev_b32 v2, 4, v2
    v_lshl_add_u32 v1, v1, 10, v2
    v_xor_b32 v48, 0, v1
    v_xor_b32 v49, 32, v1
    v_xor_b32 v50, 64, v1
    v_xor_b32 v51, 96, v1
    v_xor_b32 v52, 128, v1
    v_xor_b32 v53, 160, v1
    v_xor_b32 v54, 192, v1
    v_xor_b32 v55, 224, v1
    s_lshl_b32 s30, s21, 2
    s_add_u32 s30, s30, s20
    s_lshl_b32 s30, s30, 13
    v_lshlrev_b32 v5, 7, v0
    s_mov_b32 s16, s56
    s_mov_b32 s17, s57
    s_mov_b32 s18, 0x158000
    s_mov_b32 s19, 0x00020000
    buffer_load_dword v7, v5, s[16:19], s30 offen
    s_add_u32 s31, s30, 0x100000
    buffer_load_dword v7, v5, s[16:19], s31 offen
    s_mov_b32 s16, s58
    s_mov_b32 s17, s59
    s_mov_b32 s18, 0x158000
    s_mov_b32 s19, 0x00020000
    buffer_load_dword v7, v5, s[16:19], s30 offen
    s_add_u32 s31, s30, 0x100000
    buffer_load_dword v7, v5, s[16:19], s31 offen
    s_waitcnt vmcnt(0)
    s_mov_b32 s68, 1
    s_waitcnt lgkmcnt(0)
    s_barrier
    s_branch L_B12
L_B2E:
    s_mov_b32 s29, 0
    s_lshl_b32 s67, s20, 8
    s_sub_u32 s67, s67, 4096
    v_mov_b64 v[2:3], 0
    s_nop 1
    v_mfma_f32_32x32x8_bf16 v[128:143], v[2:3], v[2:3], 0
    v_mfma_f32_32x32x8_bf16 v[144:159], v[2:3], v[2:3], 0
    v_mfma_f32_32x32x8_bf16 v[160:175], v[2:3], v[2:3], 0
    v_mfma_f32_32x32x8_bf16 v[176:191], v[2:3], v[2:3], 0
    v_mfma_f32_32x32x8_bf16 v[192:207], v[2:3], v[2:3], 0
    v_mfma_f32_32x32x8_bf16 v[208:223], v[2:3], v[2:3], 0
    v_mfma_f32_32x32x8_bf16 v[224:239], v[2:3], v[2:3], 0
    v_mfma_f32_32x32x8_bf16 v[240:255], v[2:3], v[2:3], 0
    s_waitcnt vmcnt(0) lgkmcnt(0)
    s_barrier
L_B34:
    v_mbcnt_lo_u32_b32 v0, -1, 0
    v_mbcnt_hi_u32_b32 v0, -1, v0
    v_and_b32 v1, 31, v0
    v_lshrrev_b32 v2, 5, v0
    v_and_b32 v3, 15, v1
    v_xor_b32 v2, v2, v3
    v_lshlrev_b32 v2, 4, v2
    v_lshl_add_u32 v1, v1, 10, v2
    v_xor_b32 v48, 0, v1
    v_xor_b32 v49, 32, v1
    v_xor_b32 v50, 64, v1
    v_xor_b32 v51, 96, v1
    v_xor_b32 v52, 128, v1
    v_xor_b32 v53, 160, v1
    v_xor_b32 v54, 192, v1
    v_xor_b32 v55, 224, v1
    v_mbcnt_lo_u32_b32 v0, -1, 0
    v_mbcnt_hi_u32_b32 v0, -1, v0
    v_bfe_u32 v1, v0, 2, 2
    v_lshrrev_b32 v2, 5, v0
    v_lshl_add_u32 v2, v2, 3, v1
    v_lshlrev_b32 v2, 7, v2
    v_lshrrev_b32 v1, 1, v1
    v_lshl_add_u32 v2, v1, 6, v2
    v_bfe_u32 v1, v0, 4, 1
    v_lshl_add_u32 v2, v1, 5, v2
    v_and_b32 v1, 3, v0
    v_lshl_add_u32 v2, v1, 3, v2
    v_add_u32 v2, s25, v2
    v_xor_b32 v56, 0, v2
    v_xor_b32 v57, 64, v2
    s_waitcnt vmcnt(8)
    ds_read_b64_tr_b16 v[0:1], v56 offset:0
    ds_read_b64_tr_b16 v[2:3], v56 offset:512
    ds_read_b64_tr_b16 v[4:5], v57 offset:0
    ds_read_b64_tr_b16 v[6:7], v57 offset:512
    ds_read_b64_tr_b16 v[8:9], v56 offset:2048
    ds_read_b64_tr_b16 v[10:11], v56 offset:2560
    ds_read_b64_tr_b16 v[12:13], v57 offset:2048
    ds_read_b64_tr_b16 v[14:15], v57 offset:2560
    ds_read_b128 v[32:35], v48 offset:0
    ds_read_b128 v[36:39], v48 offset:32768
    s_waitcnt lgkmcnt(0)
    v_mfma_f32_32x32x16_bf16 v[64:79], v[0:3], v[32:35], 0
    ds_read_b128 v[40:43], v49 offset:0
    ds_read_b128 v[44:47], v49 offset:32768
    s_add_u32 m0, s25, 12288
    s_add_u32 s66, s66, 22016
    buffer_load_dwordx4 v61, s[8:11], s66 offen lds
    v_mfma_f32_32x32x16_bf16 v[80:95], v[0:3], v[36:39], 0
    s_add_u32 m0, s25, 13312
    s_add_u32 s66, s66, 22016
    buffer_load_dwordx4 v61, s[8:11], s66 offen lds
    v_mfma_f32_32x32x16_bf16 v[96:111], v[4:7], v[32:35], 0
    s_add_u32 m0, s25, 14336
    s_add_u32 s66, s66, 22016
    buffer_load_dwordx4 v61, s[8:11], s66 offen lds
    v_mfma_f32_32x32x16_bf16 v[112:127], v[4:7], v[36:39], 0
    s_add_u32 m0, s25, 15360
    s_add_u32 s66, s66, 22016
    buffer_load_dwordx4 v61, s[8:11], s66 offen lds
    s_waitcnt lgkmcnt(0)
    v_mfma_f32_32x32x16_bf16 v[64:79], v[8:11], v[40:43], v[64:79]
    ds_read_b128 v[32:35], v50 offset:0
    ds_read_b128 v[36:39], v50 offset:32768
    s_waitcnt vmcnt(8)
    ds_read_b64_tr_b16 v[16:17], v56 offset:4096
    ds_read_b64_tr_b16 v[18:19], v56 offset:4608
    ds_read_b64_tr_b16 v[20:21], v57 offset:4096
    ds_read_b64_tr_b16 v[22:23], v57 offset:4608
    v_mfma_f32_32x32x16_bf16 v[80:95], v[8:11], v[44:47], v[80:95]
    ds_read_b64_tr_b16 v[24:25], v56 offset:6144
    ds_read_b64_tr_b16 v[26:27], v56 offset:6656
    ds_read_b64_tr_b16 v[28:29], v57 offset:6144
    ds_read_b64_tr_b16 v[30:31], v57 offset:6656
    v_mfma_f32_32x32x16_bf16 v[96:111], v[12:15], v[40:43], v[96:111]
    v_mfma_f32_32x32x16_bf16 v[112:127], v[12:15], v[44:47], v[112:127]
    s_waitcnt lgkmcnt(0)
    v_mfma_f32_32x32x16_bf16 v[64:79], v[16:19], v[32:35], v[64:79]
    ds_read_b128 v[40:43], v51 offset:0
    ds_read_b128 v[44:47], v51 offset:32768
    s_add_u32 m0, s25, 0
    s_add_u32 s66, s66, 22016
    buffer_load_dwordx4 v61, s[8:11], s66 offen lds
    v_mfma_f32_32x32x16_bf16 v[80:95], v[16:19], v[36:39], v[80:95]
    s_add_u32 m0, s25, 1024
    s_add_u32 s66, s66, 22016
    buffer_load_dwordx4 v61, s[8:11], s66 offen lds
    v_mfma_f32_32x32x16_bf16 v[96:111], v[20:23], v[32:35], v[96:111]
    s_add_u32 m0, s25, 2048
    s_add_u32 s66, s66, 22016
    buffer_load_dwordx4 v61, s[8:11], s66 offen lds
    v_mfma_f32_32x32x16_bf16 v[112:127], v[20:23], v[36:39], v[112:127]
    s_add_u32 m0, s25, 3072
    s_add_u32 s66, s66, 22016
    buffer_load_dwordx4 v61, s[8:11], s66 offen lds
    s_waitcnt lgkmcnt(0)
    v_mfma_f32_32x32x16_bf16 v[64:79], v[24:27], v[40:43], v[64:79]
    ds_read_b128 v[32:35], v52 offset:0
    ds_read_b128 v[36:39], v52 offset:32768
    s_waitcnt vmcnt(8)
    ds_read_b64_tr_b16 v[0:1], v56 offset:8192
    ds_read_b64_tr_b16 v[2:3], v56 offset:8704
    ds_read_b64_tr_b16 v[4:5], v57 offset:8192
    ds_read_b64_tr_b16 v[6:7], v57 offset:8704
    v_mfma_f32_32x32x16_bf16 v[80:95], v[24:27], v[44:47], v[80:95]
    ds_read_b64_tr_b16 v[8:9], v56 offset:10240
    ds_read_b64_tr_b16 v[10:11], v56 offset:10752
    ds_read_b64_tr_b16 v[12:13], v57 offset:10240
    ds_read_b64_tr_b16 v[14:15], v57 offset:10752
    v_mfma_f32_32x32x16_bf16 v[96:111], v[28:31], v[40:43], v[96:111]
    v_mfma_f32_32x32x16_bf16 v[112:127], v[28:31], v[44:47], v[112:127]
    s_waitcnt lgkmcnt(0)
    v_mfma_f32_32x32x16_bf16 v[64:79], v[0:3], v[32:35], v[64:79]
    ds_read_b128 v[40:43], v53 offset:0
    ds_read_b128 v[44:47], v53 offset:32768
    s_add_u32 m0, s25, 4096
    s_add_u32 s66, s66, 22016
    buffer_load_dwordx4 v61, s[8:11], s66 offen lds
    v_mfma_f32_32x32x16_bf16 v[80:95], v[0:3], v[36:39], v[80:95]
    s_add_u32 m0, s25, 5120
    s_add_u32 s66, s66, 22016
    buffer_load_dwordx4 v61, s[8:11], s66 offen lds
    v_mfma_f32_32x32x16_bf16 v[96:111], v[4:7], v[32:35], v[96:111]
    s_add_u32 m0, s25, 6144
    s_add_u32 s66, s66, 22016
    buffer_load_dwordx4 v61, s[8:11], s66 offen lds
    v_mfma_f32_32x32x16_bf16 v[112:127], v[4:7], v[36:39], v[112:127]
    s_add_u32 m0, s25, 7168
    s_add_u32 s66, s66, 22016
    buffer_load_dwordx4 v61, s[8:11], s66 offen lds
    s_waitcnt lgkmcnt(0)
    v_mfma_f32_32x32x16_bf16 v[64:79], v[8:11], v[40:43], v[64:79]
    ds_read_b128 v[32:35], v54 offset:0
    ds_read_b128 v[36:39], v54 offset:32768
    s_waitcnt vmcnt(8)
    ds_read_b64_tr_b16 v[16:17], v56 offset:12288
    ds_read_b64_tr_b16 v[18:19], v56 offset:12800
    ds_read_b64_tr_b16 v[20:21], v57 offset:12288
    ds_read_b64_tr_b16 v[22:23], v57 offset:12800
    v_mfma_f32_32x32x16_bf16 v[80:95], v[8:11], v[44:47], v[80:95]
    ds_read_b64_tr_b16 v[24:25], v56 offset:14336
    ds_read_b64_tr_b16 v[26:27], v56 offset:14848
    ds_read_b64_tr_b16 v[28:29], v57 offset:14336
    ds_read_b64_tr_b16 v[30:31], v57 offset:14848
    v_mfma_f32_32x32x16_bf16 v[96:111], v[12:15], v[40:43], v[96:111]
    v_mfma_f32_32x32x16_bf16 v[112:127], v[12:15], v[44:47], v[112:127]
    s_waitcnt lgkmcnt(0)
    v_mfma_f32_32x32x16_bf16 v[64:79], v[16:19], v[32:35], v[64:79]
    ds_read_b128 v[40:43], v55 offset:0
    ds_read_b128 v[44:47], v55 offset:32768
    s_add_u32 m0, s25, 8192
    s_add_u32 s66, s66, 22016
    buffer_load_dwordx4 v61, s[8:11], s66 offen lds
    v_mfma_f32_32x32x16_bf16 v[80:95], v[16:19], v[36:39], v[80:95]
    s_add_u32 m0, s25, 9216
    s_add_u32 s66, s66, 22016
    buffer_load_dwordx4 v61, s[8:11], s66 offen lds
    v_mfma_f32_32x32x16_bf16 v[96:111], v[20:23], v[32:35], v[96:111]
    s_add_u32 m0, s25, 10240
    s_add_u32 s66, s66, 22016
    buffer_load_dwordx4 v61, s[8:11], s66 offen lds
    v_mfma_f32_32x32x16_bf16 v[112:127], v[20:23], v[36:39], v[112:127]
    s_add_u32 m0, s25, 11264
    s_add_u32 s66, s66, 22016
    buffer_load_dwordx4 v61, s[8:11], s66 offen lds
    s_waitcnt lgkmcnt(0)
    v_mfma_f32_32x32x16_bf16 v[64:79], v[24:27], v[40:43], v[64:79]
    ds_read_b128 v[32:35], v48 offset:256
    ds_read_b128 v[36:39], v48 offset:33024
    s_waitcnt vmcnt(8)
    ds_read_b64_tr_b16 v[0:1], v56 offset:0
    ds_read_b64_tr_b16 v[2:3], v56 offset:512
    ds_read_b64_tr_b16 v[4:5], v57 offset:0
    ds_read_b64_tr_b16 v[6:7], v57 offset:512
    v_mfma_f32_32x32x16_bf16 v[80:95], v[24:27], v[44:47], v[80:95]
    ds_read_b64_tr_b16 v[8:9], v56 offset:2048
    ds_read_b64_tr_b16 v[10:11], v56 offset:2560
    ds_read_b64_tr_b16 v[12:13], v57 offset:2048
    ds_read_b64_tr_b16 v[14:15], v57 offset:2560
    v_mfma_f32_32x32x16_bf16 v[96:111], v[28:31], v[40:43], v[96:111]
    v_mfma_f32_32x32x16_bf16 v[112:127], v[28:31], v[44:47], v[112:127]
    s_waitcnt lgkmcnt(0)
    v_mfma_f32_32x32x16_bf16 v[64:79], v[0:3], v[32:35], v[64:79]
    ds_read_b128 v[40:43], v49 offset:256
    ds_read_b128 v[44:47], v49 offset:33024
    s_add_u32 m0, s25, 12288
    s_add_u32 s66, s66, 22016
    buffer_load_dwordx4 v61, s[8:11], s66 offen lds
    v_mfma_f32_32x32x16_bf16 v[80:95], v[0:3], v[36:39], v[80:95]
    s_add_u32 m0, s25, 13312
    s_add_u32 s66, s66, 22016
    buffer_load_dwordx4 v61, s[8:11], s66 offen lds
    v_mfma_f32_32x32x16_bf16 v[96:111], v[4:7], v[32:35], v[96:111]
    s_add_u32 m0, s25, 14336
    s_add_u32 s66, s66, 22016
    buffer_load_dwordx4 v61, s[8:11], s66 offen lds
    v_mfma_f32_32x32x16_bf16 v[112:127], v[4:7], v[36:39], v[112:127]
    s_add_u32 m0, s25, 15360
    s_add_u32 s66, s66, 22016
    buffer_load_dwordx4 v61, s[8:11], s66 offen lds
    s_waitcnt lgkmcnt(0)
    v_mfma_f32_32x32x16_bf16 v[64:79], v[8:11], v[40:43], v[64:79]
    ds_read_b128 v[32:35], v50 offset:256
    ds_read_b128 v[36:39], v50 offset:33024
    s_waitcnt vmcnt(8)
    ds_read_b64_tr_b16 v[16:17], v56 offset:4096
    ds_read_b64_tr_b16 v[18:19], v56 offset:4608
    ds_read_b64_tr_b16 v[20:21], v57 offset:4096
    ds_read_b64_tr_b16 v[22:23], v57 offset:4608
    v_mfma_f32_32x32x16_bf16 v[80:95], v[8:11], v[44:47], v[80:95]
    ds_read_b64_tr_b16 v[24:25], v56 offset:6144
    ds_read_b64_tr_b16 v[26:27], v56 offset:6656
    ds_read_b64_tr_b16 v[28:29], v57 offset:6144
    ds_read_b64_tr_b16 v[30:31], v57 offset:6656
    v_mfma_f32_32x32x16_bf16 v[96:111], v[12:15], v[40:43], v[96:111]
    v_mfma_f32_32x32x16_bf16 v[112:127], v[12:15], v[44:47], v[112:127]
    s_waitcnt lgkmcnt(0)
    v_mfma_f32_32x32x16_bf16 v[64:79], v[16:19], v[32:35], v[64:79]
    ds_read_b128 v[40:43], v51 offset:256
    ds_read_b128 v[44:47], v51 offset:33024
    s_add_u32 m0, s25, 0
    s_add_u32 s66, s66, 22016
    buffer_load_dwordx4 v61, s[8:11], s66 offen lds
    v_mfma_f32_32x32x16_bf16 v[80:95], v[16:19], v[36:39], v[80:95]
    s_add_u32 m0, s25, 1024
    s_add_u32 s66, s66, 22016
    buffer_load_dwordx4 v61, s[8:11], s66 offen lds
    v_mfma_f32_32x32x16_bf16 v[96:111], v[20:23], v[32:35], v[96:111]
    s_add_u32 m0, s25, 2048
    s_add_u32 s66, s66, 22016
    buffer_load_dwordx4 v61, s[8:11], s66 offen lds
    v_mfma_f32_32x32x16_bf16 v[112:127], v[20:23], v[36:39], v[112:127]
    s_add_u32 m0, s25, 3072
    s_add_u32 s66, s66, 22016
    buffer_load_dwordx4 v61, s[8:11], s66 offen lds
    s_waitcnt lgkmcnt(0)
    v_mfma_f32_32x32x16_bf16 v[64:79], v[24:27], v[40:43], v[64:79]
    ds_read_b128 v[32:35], v52 offset:256
    ds_read_b128 v[36:39], v52 offset:33024
    s_waitcnt vmcnt(8)
    ds_read_b64_tr_b16 v[0:1], v56 offset:8192
    ds_read_b64_tr_b16 v[2:3], v56 offset:8704
    ds_read_b64_tr_b16 v[4:5], v57 offset:8192
    ds_read_b64_tr_b16 v[6:7], v57 offset:8704
    v_mfma_f32_32x32x16_bf16 v[80:95], v[24:27], v[44:47], v[80:95]
    ds_read_b64_tr_b16 v[8:9], v56 offset:10240
    ds_read_b64_tr_b16 v[10:11], v56 offset:10752
    ds_read_b64_tr_b16 v[12:13], v57 offset:10240
    ds_read_b64_tr_b16 v[14:15], v57 offset:10752
    v_mfma_f32_32x32x16_bf16 v[96:111], v[28:31], v[40:43], v[96:111]
    v_mfma_f32_32x32x16_bf16 v[112:127], v[28:31], v[44:47], v[112:127]
    s_waitcnt lgkmcnt(0)
    v_mfma_f32_32x32x16_bf16 v[64:79], v[0:3], v[32:35], v[64:79]
    ds_read_b128 v[40:43], v53 offset:256
    ds_read_b128 v[44:47], v53 offset:33024
    s_add_u32 m0, s25, 4096
    s_add_u32 s66, s66, 22016
    buffer_load_dwordx4 v61, s[8:11], s66 offen lds
    v_mfma_f32_32x32x16_bf16 v[80:95], v[0:3], v[36:39], v[80:95]
    s_add_u32 m0, s25, 5120
    s_add_u32 s66, s66, 22016
    buffer_load_dwordx4 v61, s[8:11], s66 offen lds
    v_mfma_f32_32x32x16_bf16 v[96:111], v[4:7], v[32:35], v[96:111]
    s_add_u32 m0, s25, 6144
    s_add_u32 s66, s66, 22016
    buffer_load_dwordx4 v61, s[8:11], s66 offen lds
    v_mfma_f32_32x32x16_bf16 v[112:127], v[4:7], v[36:39], v[112:127]
    s_add_u32 m0, s25, 7168
    s_add_u32 s66, s66, 22016
    buffer_load_dwordx4 v61, s[8:11], s66 offen lds
    s_waitcnt lgkmcnt(0)
    v_mfma_f32_32x32x16_bf16 v[64:79], v[8:11], v[40:43], v[64:79]
    ds_read_b128 v[32:35], v54 offset:256
    ds_read_b128 v[36:39], v54 offset:33024
    s_waitcnt vmcnt(8)
    ds_read_b64_tr_b16 v[16:17], v56 offset:12288
    ds_read_b64_tr_b16 v[18:19], v56 offset:12800
    ds_read_b64_tr_b16 v[20:21], v57 offset:12288
    ds_read_b64_tr_b16 v[22:23], v57 offset:12800
    v_mfma_f32_32x32x16_bf16 v[80:95], v[8:11], v[44:47], v[80:95]
    ds_read_b64_tr_b16 v[24:25], v56 offset:14336
    ds_read_b64_tr_b16 v[26:27], v56 offset:14848
    ds_read_b64_tr_b16 v[28:29], v57 offset:14336
    ds_read_b64_tr_b16 v[30:31], v57 offset:14848
    v_mfma_f32_32x32x16_bf16 v[96:111], v[12:15], v[40:43], v[96:111]
    v_mfma_f32_32x32x16_bf16 v[112:127], v[12:15], v[44:47], v[112:127]
    s_waitcnt lgkmcnt(0)
    v_mfma_f32_32x32x16_bf16 v[64:79], v[16:19], v[32:35], v[64:79]
    ds_read_b128 v[40:43], v55 offset:256
    ds_read_b128 v[44:47], v55 offset:33024
    s_add_u32 m0, s25, 8192
    s_add_u32 s66, s66, 22016
    buffer_load_dwordx4 v61, s[8:11], s66 offen lds
    v_mfma_f32_32x32x16_bf16 v[80:95], v[16:19], v[36:39], v[80:95]
    s_add_u32 m0, s25, 9216
    s_add_u32 s66, s66, 22016
    buffer_load_dwordx4 v61, s[8:11], s66 offen lds
    v_mfma_f32_32x32x16_bf16 v[96:111], v[20:23], v[32:35], v[96:111]
    s_add_u32 m0, s25, 10240
    s_add_u32 s66, s66, 22016
    buffer_load_dwordx4 v61, s[8:11], s66 offen lds
    v_mfma_f32_32x32x16_bf16 v[112:127], v[20:23], v[36:39], v[112:127]
    s_add_u32 m0, s25, 11264
    s_add_u32 s66, s66, 22016
    buffer_load_dwordx4 v61, s[8:11], s66 offen lds
    s_waitcnt lgkmcnt(0)
    v_mfma_f32_32x32x16_bf16 v[64:79], v[24:27], v[40:43], v[64:79]
    ds_read_b128 v[32:35], v48 offset:512
    ds_read_b128 v[36:39], v48 offset:33280
    s_waitcnt vmcnt(8)
    ds_read_b64_tr_b16 v[0:1], v56 offset:0
    ds_read_b64_tr_b16 v[2:3], v56 offset:512
    ds_read_b64_tr_b16 v[4:5], v57 offset:0
    ds_read_b64_tr_b16 v[6:7], v57 offset:512
    v_mfma_f32_32x32x16_bf16 v[80:95], v[24:27], v[44:47], v[80:95]
    ds_read_b64_tr_b16 v[8:9], v56 offset:2048
    ds_read_b64_tr_b16 v[10:11], v56 offset:2560
    ds_read_b64_tr_b16 v[12:13], v57 offset:2048
    ds_read_b64_tr_b16 v[14:15], v57 offset:2560
    v_mfma_f32_32x32x16_bf16 v[96:111], v[28:31], v[40:43], v[96:111]
    v_mfma_f32_32x32x16_bf16 v[112:127], v[28:31], v[44:47], v[112:127]
    s_waitcnt lgkmcnt(0)
    v_mfma_f32_32x32x16_bf16 v[64:79], v[0:3], v[32:35], v[64:79]
    ds_read_b128 v[40:43], v49 offset:512
    ds_read_b128 v[44:47], v49 offset:33280
    s_add_u32 m0, s25, 12288
    s_add_u32 s66, s66, 22016
    buffer_load_dwordx4 v61, s[8:11], s66 offen lds
    v_mfma_f32_32x32x16_bf16 v[80:95], v[0:3], v[36:39], v[80:95]
    s_add_u32 m0, s25, 13312
    s_add_u32 s66, s66, 22016
    buffer_load_dwordx4 v61, s[8:11], s66 offen lds
    v_mfma_f32_32x32x16_bf16 v[96:111], v[4:7], v[32:35], v[96:111]
    s_add_u32 m0, s25, 14336
    s_add_u32 s66, s66, 22016
    buffer_load_dwordx4 v61, s[8:11], s66 offen lds
    v_mfma_f32_32x32x16_bf16 v[112:127], v[4:7], v[36:39], v[112:127]
    s_add_u32 m0, s25, 15360
    s_add_u32 s66, s66, 22016
    buffer_load_dwordx4 v61, s[8:11], s66 offen lds
    s_waitcnt lgkmcnt(0)
    v_mfma_f32_32x32x16_bf16 v[64:79], v[8:11], v[40:43], v[64:79]
    ds_read_b128 v[32:35], v50 offset:512
    ds_read_b128 v[36:39], v50 offset:33280
    s_waitcnt vmcnt(8)
    ds_read_b64_tr_b16 v[16:17], v56 offset:4096
    ds_read_b64_tr_b16 v[18:19], v56 offset:4608
    ds_read_b64_tr_b16 v[20:21], v57 offset:4096
    ds_read_b64_tr_b16 v[22:23], v57 offset:4608
    v_mfma_f32_32x32x16_bf16 v[80:95], v[8:11], v[44:47], v[80:95]
    ds_read_b64_tr_b16 v[24:25], v56 offset:6144
    ds_read_b64_tr_b16 v[26:27], v56 offset:6656
    ds_read_b64_tr_b16 v[28:29], v57 offset:6144
    ds_read_b64_tr_b16 v[30:31], v57 offset:6656
    v_mfma_f32_32x32x16_bf16 v[96:111], v[12:15], v[40:43], v[96:111]
    v_mfma_f32_32x32x16_bf16 v[112:127], v[12:15], v[44:47], v[112:127]
    s_waitcnt lgkmcnt(0)
    v_mfma_f32_32x32x16_bf16 v[64:79], v[16:19], v[32:35], v[64:79]
    ds_read_b128 v[40:43], v51 offset:512
    ds_read_b128 v[44:47], v51 offset:33280
    s_add_u32 m0, s25, 0
    s_add_u32 s66, s66, 22016
    buffer_load_dwordx4 v61, s[8:11], s66 offen lds
    v_mfma_f32_32x32x16_bf16 v[80:95], v[16:19], v[36:39], v[80:95]
    s_add_u32 m0, s25, 1024
    s_add_u32 s66, s66, 22016
    buffer_load_dwordx4 v61, s[8:11], s66 offen lds
    v_mfma_f32_32x32x16_bf16 v[96:111], v[20:23], v[32:35], v[96:111]
    s_add_u32 m0, s25, 2048
    s_add_u32 s66, s66, 22016
    buffer_load_dwordx4 v61, s[8:11], s66 offen lds
    v_mfma_f32_32x32x16_bf16 v[112:127], v[20:23], v[36:39], v[112:127]
    s_add_u32 m0, s25, 3072
    s_add_u32 s66, s66, 22016
    buffer_load_dwordx4 v61, s[8:11], s66 offen lds
    s_waitcnt lgkmcnt(0)
    v_mfma_f32_32x32x16_bf16 v[64:79], v[24:27], v[40:43], v[64:79]
    ds_read_b128 v[32:35], v52 offset:512
    ds_read_b128 v[36:39], v52 offset:33280
    s_waitcnt vmcnt(8)
    ds_read_b64_tr_b16 v[0:1], v56 offset:8192
    ds_read_b64_tr_b16 v[2:3], v56 offset:8704
    ds_read_b64_tr_b16 v[4:5], v57 offset:8192
    ds_read_b64_tr_b16 v[6:7], v57 offset:8704
    v_mfma_f32_32x32x16_bf16 v[80:95], v[24:27], v[44:47], v[80:95]
    ds_read_b64_tr_b16 v[8:9], v56 offset:10240
    ds_read_b64_tr_b16 v[10:11], v56 offset:10752
    ds_read_b64_tr_b16 v[12:13], v57 offset:10240
    ds_read_b64_tr_b16 v[14:15], v57 offset:10752
    v_mfma_f32_32x32x16_bf16 v[96:111], v[28:31], v[40:43], v[96:111]
    v_mfma_f32_32x32x16_bf16 v[112:127], v[28:31], v[44:47], v[112:127]
    s_waitcnt lgkmcnt(0)
    v_mfma_f32_32x32x16_bf16 v[64:79], v[0:3], v[32:35], v[64:79]
    ds_read_b128 v[40:43], v53 offset:512
    ds_read_b128 v[44:47], v53 offset:33280
    s_add_u32 m0, s25, 4096
    s_add_u32 s66, s66, 22016
    buffer_load_dwordx4 v61, s[8:11], s66 offen lds
    v_mfma_f32_32x32x16_bf16 v[80:95], v[0:3], v[36:39], v[80:95]
    s_add_u32 m0, s25, 5120
    s_add_u32 s66, s66, 22016
    buffer_load_dwordx4 v61, s[8:11], s66 offen lds
    v_mfma_f32_32x32x16_bf16 v[96:111], v[4:7], v[32:35], v[96:111]
    s_add_u32 m0, s25, 6144
    s_add_u32 s66, s66, 22016
    buffer_load_dwordx4 v61, s[8:11], s66 offen lds
    v_mfma_f32_32x32x16_bf16 v[112:127], v[4:7], v[36:39], v[112:127]
    s_add_u32 m0, s25, 7168
    s_add_u32 s66, s66, 22016
    buffer_load_dwordx4 v61, s[8:11], s66 offen lds
    s_waitcnt lgkmcnt(0)
    v_mfma_f32_32x32x16_bf16 v[64:79], v[8:11], v[40:43], v[64:79]
    ds_read_b128 v[32:35], v54 offset:512
    ds_read_b128 v[36:39], v54 offset:33280
    s_waitcnt vmcnt(8)
    ds_read_b64_tr_b16 v[16:17], v56 offset:12288
    ds_read_b64_tr_b16 v[18:19], v56 offset:12800
    ds_read_b64_tr_b16 v[20:21], v57 offset:12288
    ds_read_b64_tr_b16 v[22:23], v57 offset:12800
    v_mfma_f32_32x32x16_bf16 v[80:95], v[8:11], v[44:47], v[80:95]
    ds_read_b64_tr_b16 v[24:25], v56 offset:14336
    ds_read_b64_tr_b16 v[26:27], v56 offset:14848
    ds_read_b64_tr_b16 v[28:29], v57 offset:14336
    ds_read_b64_tr_b16 v[30:31], v57 offset:14848
    v_mfma_f32_32x32x16_bf16 v[96:111], v[12:15], v[40:43], v[96:111]
    v_mfma_f32_32x32x16_bf16 v[112:127], v[12:15], v[44:47], v[112:127]
    s_waitcnt lgkmcnt(0)
    v_mfma_f32_32x32x16_bf16 v[64:79], v[16:19], v[32:35], v[64:79]
    ds_read_b128 v[40:43], v55 offset:512
    ds_read_b128 v[44:47], v55 offset:33280
    s_add_u32 m0, s25, 8192
    s_add_u32 s66, s66, 22016
    buffer_load_dwordx4 v61, s[8:11], s66 offen lds
    v_mfma_f32_32x32x16_bf16 v[80:95], v[16:19], v[36:39], v[80:95]
    s_add_u32 m0, s25, 9216
    s_add_u32 s66, s66, 22016
    buffer_load_dwordx4 v61, s[8:11], s66 offen lds
    v_mfma_f32_32x32x16_bf16 v[96:111], v[20:23], v[32:35], v[96:111]
    s_add_u32 m0, s25, 10240
    s_add_u32 s66, s66, 22016
    buffer_load_dwordx4 v61, s[8:11], s66 offen lds
    v_mfma_f32_32x32x16_bf16 v[112:127], v[20:23], v[36:39], v[112:127]
    s_add_u32 m0, s25, 11264
    s_add_u32 s66, s66, 22016
    buffer_load_dwordx4 v61, s[8:11], s66 offen lds
    s_waitcnt lgkmcnt(0)
    v_mfma_f32_32x32x16_bf16 v[64:79], v[24:27], v[40:43], v[64:79]
    ds_read_b128 v[32:35], v48 offset:768
    ds_read_b128 v[36:39], v48 offset:33536
    s_waitcnt vmcnt(8)
    ds_read_b64_tr_b16 v[0:1], v56 offset:0
    ds_read_b64_tr_b16 v[2:3], v56 offset:512
    ds_read_b64_tr_b16 v[4:5], v57 offset:0
    ds_read_b64_tr_b16 v[6:7], v57 offset:512
    v_mfma_f32_32x32x16_bf16 v[80:95], v[24:27], v[44:47], v[80:95]
    ds_read_b64_tr_b16 v[8:9], v56 offset:2048
    ds_read_b64_tr_b16 v[10:11], v56 offset:2560
    ds_read_b64_tr_b16 v[12:13], v57 offset:2048
    ds_read_b64_tr_b16 v[14:15], v57 offset:2560
    v_mfma_f32_32x32x16_bf16 v[96:111], v[28:31], v[40:43], v[96:111]
    v_mfma_f32_32x32x16_bf16 v[112:127], v[28:31], v[44:47], v[112:127]
    s_waitcnt lgkmcnt(0)
    v_mfma_f32_32x32x16_bf16 v[64:79], v[0:3], v[32:35], v[64:79]
    ds_read_b128 v[40:43], v49 offset:768
    ds_read_b128 v[44:47], v49 offset:33536
    s_add_u32 m0, s25, 12288
    s_add_u32 s66, s66, 22016
    buffer_load_dwordx4 v61, s[8:11], s66 offen lds
    v_mfma_f32_32x32x16_bf16 v[80:95], v[0:3], v[36:39], v[80:95]
    s_add_u32 m0, s25, 13312
    s_add_u32 s66, s66, 22016
    buffer_load_dwordx4 v61, s[8:11], s66 offen lds
    v_mfma_f32_32x32x16_bf16 v[96:111], v[4:7], v[32:35], v[96:111]
    s_add_u32 m0, s25, 14336
    s_add_u32 s66, s66, 22016
    buffer_load_dwordx4 v61, s[8:11], s66 offen lds
    v_mfma_f32_32x32x16_bf16 v[112:127], v[4:7], v[36:39], v[112:127]
    s_add_u32 m0, s25, 15360
    s_add_u32 s66, s66, 22016
    buffer_load_dwordx4 v61, s[8:11], s66 offen lds
    s_waitcnt lgkmcnt(0)
    v_mfma_f32_32x32x16_bf16 v[64:79], v[8:11], v[40:43], v[64:79]
    ds_read_b128 v[32:35], v50 offset:768
    ds_read_b128 v[36:39], v50 offset:33536
    s_waitcnt vmcnt(8)
    ds_read_b64_tr_b16 v[16:17], v56 offset:4096
    ds_read_b64_tr_b16 v[18:19], v56 offset:4608
    ds_read_b64_tr_b16 v[20:21], v57 offset:4096
    ds_read_b64_tr_b16 v[22:23], v57 offset:4608
    v_mfma_f32_32x32x16_bf16 v[80:95], v[8:11], v[44:47], v[80:95]
    ds_read_b64_tr_b16 v[24:25], v56 offset:6144
    ds_read_b64_tr_b16 v[26:27], v56 offset:6656
    ds_read_b64_tr_b16 v[28:29], v57 offset:6144
    ds_read_b64_tr_b16 v[30:31], v57 offset:6656
    v_mfma_f32_32x32x16_bf16 v[96:111], v[12:15], v[40:43], v[96:111]
    v_mfma_f32_32x32x16_bf16 v[112:127], v[12:15], v[44:47], v[112:127]
    s_waitcnt lgkmcnt(0)
    v_mfma_f32_32x32x16_bf16 v[64:79], v[16:19], v[32:35], v[64:79]
    ds_read_b128 v[40:43], v51 offset:768
    ds_read_b128 v[44:47], v51 offset:33536
    v_mfma_f32_32x32x16_bf16 v[80:95], v[16:19], v[36:39], v[80:95]
    v_mfma_f32_32x32x16_bf16 v[96:111], v[20:23], v[32:35], v[96:111]
    v_mfma_f32_32x32x16_bf16 v[112:127], v[20:23], v[36:39], v[112:127]
    s_waitcnt lgkmcnt(0)
    v_mfma_f32_32x32x16_bf16 v[64:79], v[24:27], v[40:43], v[64:79]
    ds_read_b128 v[32:35], v52 offset:768
    ds_read_b128 v[36:39], v52 offset:33536
    s_waitcnt vmcnt(4)
    ds_read_b64_tr_b16 v[0:1], v56 offset:8192
    ds_read_b64_tr_b16 v[2:3], v56 offset:8704
    ds_read_b64_tr_b16 v[4:5], v57 offset:8192
    ds_read_b64_tr_b16 v[6:7], v57 offset:8704
    v_mfma_f32_32x32x16_bf16 v[80:95], v[24:27], v[44:47], v[80:95]
    ds_read_b64_tr_b16 v[8:9], v56 offset:10240
    ds_read_b64_tr_b16 v[10:11], v56 offset:10752
    ds_read_b64_tr_b16 v[12:13], v57 offset:10240
    ds_read_b64_tr_b16 v[14:15], v57 offset:10752
    v_mfma_f32_32x32x16_bf16 v[96:111], v[28:31], v[40:43], v[96:111]
    v_mfma_f32_32x32x16_bf16 v[112:127], v[28:31], v[44:47], v[112:127]
    s_waitcnt lgkmcnt(0)
    v_mfma_f32_32x32x16_bf16 v[64:79], v[0:3], v[32:35], v[64:79]
    ds_read_b128 v[40:43], v53 offset:768
    ds_read_b128 v[44:47], v53 offset:33536
    v_mfma_f32_32x32x16_bf16 v[80:95], v[0:3], v[36:39], v[80:95]
    v_mfma_f32_32x32x16_bf16 v[96:111], v[4:7], v[32:35], v[96:111]
    v_mfma_f32_32x32x16_bf16 v[112:127], v[4:7], v[36:39], v[112:127]
    s_waitcnt lgkmcnt(0)
    v_mfma_f32_32x32x16_bf16 v[64:79], v[8:11], v[40:43], v[64:79]
    ds_read_b128 v[32:35], v54 offset:768
    ds_read_b128 v[36:39], v54 offset:33536
    s_waitcnt vmcnt(0)
    ds_read_b64_tr_b16 v[16:17], v56 offset:12288
    ds_read_b64_tr_b16 v[18:19], v56 offset:12800
    ds_read_b64_tr_b16 v[20:21], v57 offset:12288
    ds_read_b64_tr_b16 v[22:23], v57 offset:12800
    v_mfma_f32_32x32x16_bf16 v[80:95], v[8:11], v[44:47], v[80:95]
    ds_read_b64_tr_b16 v[24:25], v56 offset:14336
    ds_read_b64_tr_b16 v[26:27], v56 offset:14848
    ds_read_b64_tr_b16 v[28:29], v57 offset:14336
    ds_read_b64_tr_b16 v[30:31], v57 offset:14848
    v_mfma_f32_32x32x16_bf16 v[96:111], v[12:15], v[40:43], v[96:111]
    v_mfma_f32_32x32x16_bf16 v[112:127], v[12:15], v[44:47], v[112:127]
    s_waitcnt lgkmcnt(0)
    v_mfma_f32_32x32x16_bf16 v[64:79], v[16:19], v[32:35], v[64:79]
    ds_read_b128 v[40:43], v55 offset:768
    ds_read_b128 v[44:47], v55 offset:33536
    v_mfma_f32_32x32x16_bf16 v[80:95], v[16:19], v[36:39], v[80:95]
    v_mfma_f32_32x32x16_bf16 v[96:111], v[20:23], v[32:35], v[96:111]
    v_mfma_f32_32x32x16_bf16 v[112:127], v[20:23], v[36:39], v[112:127]
    s_waitcnt lgkmcnt(0)
    v_mfma_f32_32x32x16_bf16 v[64:79], v[24:27], v[40:43], v[64:79]
    v_mfma_f32_32x32x16_bf16 v[80:95], v[24:27], v[44:47], v[80:95]
    v_mfma_f32_32x32x16_bf16 v[96:111], v[28:31], v[40:43], v[96:111]
    v_mfma_f32_32x32x16_bf16 v[112:127], v[28:31], v[44:47], v[112:127]
    s_mov_b32 s8, s58
    s_mov_b32 s9, s59
    s_mov_b32 s26, s67
    s_add_u32 m0, s25, 0
    s_add_u32 s26, s26, 4096
    buffer_load_dwordx4 v60, s[8:11], s26 offen lds
    s_add_u32 m0, s25, 1024
    s_add_u32 s26, s26, 4096
    buffer_load_dwordx4 v60, s[8:11], s26 offen lds
    s_add_u32 m0, s25, 2048
    s_add_u32 s26, s26, 4096
    buffer_load_dwordx4 v60, s[8:11], s26 offen lds
    s_add_u32 m0, s25, 3072
    s_add_u32 s26, s26, 4096
    buffer_load_dwordx4 v60, s[8:11], s26 offen lds
    s_add_u32 m0, s25, 4096
    s_add_u32 s26, s26, 4096
    buffer_load_dwordx4 v60, s[8:11], s26 offen lds
    s_add_u32 m0, s25, 5120
    s_add_u32 s26, s26, 4096
    buffer_load_dwordx4 v60, s[8:11], s26 offen lds
    s_add_u32 m0, s25, 6144
    s_add_u32 s26, s26, 4096
    buffer_load_dwordx4 v60, s[8:11], s26 offen lds
    s_add_u32 m0, s25, 7168
    s_add_u32 s26, s26, 4096
    buffer_load_dwordx4 v60, s[8:11], s26 offen lds
    s_add_u32 m0, s25, 8192
    s_add_u32 s26, s26, 4096
    buffer_load_dwordx4 v60, s[8:11], s26 offen lds
    s_add_u32 m0, s25, 9216
    s_add_u32 s26, s26, 4096
    buffer_load_dwordx4 v60, s[8:11], s26 offen lds
    s_add_u32 m0, s25, 10240
    s_add_u32 s26, s26, 4096
    buffer_load_dwordx4 v60, s[8:11], s26 offen lds
    s_add_u32 m0, s25, 11264
    s_add_u32 s26, s26, 4096
    buffer_load_dwordx4 v60, s[8:11], s26 offen lds
    v_mov_b32 v62, 0xc0135761
    v_cvt_pk_bf16_f32 v0, v64, v65
    v_lshlrev_b32 v64, 16, v0
    v_and_b32 v65, 0xffff0000, v0
    v_pk_mul_f32 v[0:1], v[64:65], v[64:65]
    v_pk_fma_f32 v[0:1], v[0:1], s[34:35], v[62:63] op_sel_hi:[1,0,0]
    v_pk_mul_f32 v[0:1], v[0:1], v[64:65]
    v_cvt_pk_bf16_f32 v4, v66, v67
    v_lshlrev_b32 v66, 16, v4
    v_and_b32 v67, 0xffff0000, v4
    v_pk_mul_f32 v[4:5], v[66:67], v[66:67]
    v_pk_fma_f32 v[4:5], v[4:5], s[34:35], v[62:63] op_sel_hi:[1,0,0]
    v_pk_mul_f32 v[4:5], v[4:5], v[66:67]
    v_exp_f32 v0, v0
    v_exp_f32 v1, v1
    v_exp_f32 v4, v4
    v_exp_f32 v5, v5
    v_pk_add_f32 v[0:1], v[0:1], 1.0 op_sel_hi:[1,0]
    v_pk_add_f32 v[4:5], v[4:5], 1.0 op_sel_hi:[1,0]
    v_rcp_f32 v0, v0
    v_rcp_f32 v1, v1
    v_rcp_f32 v4, v4
    v_rcp_f32 v5, v5
    v_pk_mul_f32 v[0:1], v[0:1], v[64:65]
    v_cvt_pk_bf16_f32 v64, v0, v1
    v_pk_mul_f32 v[4:5], v[4:5], v[66:67]
    v_cvt_pk_bf16_f32 v65, v4, v5
    v_cvt_pk_bf16_f32 v0, v68, v69
    v_lshlrev_b32 v68, 16, v0
    v_and_b32 v69, 0xffff0000, v0
    v_pk_mul_f32 v[0:1], v[68:69], v[68:69]
    v_pk_fma_f32 v[0:1], v[0:1], s[34:35], v[62:63] op_sel_hi:[1,0,0]
    v_pk_mul_f32 v[0:1], v[0:1], v[68:69]
    v_cvt_pk_bf16_f32 v4, v70, v71
    v_lshlrev_b32 v70, 16, v4
    v_and_b32 v71, 0xffff0000, v4
    v_pk_mul_f32 v[4:5], v[70:71], v[70:71]
    v_pk_fma_f32 v[4:5], v[4:5], s[34:35], v[62:63] op_sel_hi:[1,0,0]
    v_pk_mul_f32 v[4:5], v[4:5], v[70:71]
    v_exp_f32 v0, v0
    v_exp_f32 v1, v1
    v_exp_f32 v4, v4
    v_exp_f32 v5, v5
    v_pk_add_f32 v[0:1], v[0:1], 1.0 op_sel_hi:[1,0]
    v_pk_add_f32 v[4:5], v[4:5], 1.0 op_sel_hi:[1,0]
    v_rcp_f32 v0, v0
    v_rcp_f32 v1, v1
    v_rcp_f32 v4, v4
    v_rcp_f32 v5, v5
    v_pk_mul_f32 v[0:1], v[0:1], v[68:69]
    v_cvt_pk_bf16_f32 v66, v0, v1
    v_pk_mul_f32 v[4:5], v[4:5], v[70:71]
    v_cvt_pk_bf16_f32 v67, v4, v5
    v_cvt_pk_bf16_f32 v0, v72, v73
    v_lshlrev_b32 v72, 16, v0
    v_and_b32 v73, 0xffff0000, v0
    v_pk_mul_f32 v[0:1], v[72:73], v[72:73]
    v_pk_fma_f32 v[0:1], v[0:1], s[34:35], v[62:63] op_sel_hi:[1,0,0]
    v_pk_mul_f32 v[0:1], v[0:1], v[72:73]
    v_cvt_pk_bf16_f32 v4, v74, v75
    v_lshlrev_b32 v74, 16, v4
    v_and_b32 v75, 0xffff0000, v4
    v_pk_mul_f32 v[4:5], v[74:75], v[74:75]
    v_pk_fma_f32 v[4:5], v[4:5], s[34:35], v[62:63] op_sel_hi:[1,0,0]
    v_pk_mul_f32 v[4:5], v[4:5], v[74:75]
    v_exp_f32 v0, v0
    v_exp_f32 v1, v1
    v_exp_f32 v4, v4
    v_exp_f32 v5, v5
    v_pk_add_f32 v[0:1], v[0:1], 1.0 op_sel_hi:[1,0]
    v_pk_add_f32 v[4:5], v[4:5], 1.0 op_sel_hi:[1,0]
    v_rcp_f32 v0, v0
    v_rcp_f32 v1, v1
    v_rcp_f32 v4, v4
    v_rcp_f32 v5, v5
    v_pk_mul_f32 v[0:1], v[0:1], v[72:73]
    v_cvt_pk_bf16_f32 v68, v0, v1
    v_pk_mul_f32 v[4:5], v[4:5], v[74:75]
    v_cvt_pk_bf16_f32 v69, v4, v5
    v_cvt_pk_bf16_f32 v0, v76, v77
    v_lshlrev_b32 v76, 16, v0
    v_and_b32 v77, 0xffff0000, v0
    v_pk_mul_f32 v[0:1], v[76:77], v[76:77]
    v_pk_fma_f32 v[0:1], v[0:1], s[34:35], v[62:63] op_sel_hi:[1,0,0]
    v_pk_mul_f32 v[0:1], v[0:1], v[76:77]
    v_cvt_pk_bf16_f32 v4, v78, v79
    v_lshlrev_b32 v78, 16, v4
    v_and_b32 v79, 0xffff0000, v4
    v_pk_mul_f32 v[4:5], v[78:79], v[78:79]
    v_pk_fma_f32 v[4:5], v[4:5], s[34:35], v[62:63] op_sel_hi:[1,0,0]
    v_pk_mul_f32 v[4:5], v[4:5], v[78:79]
    v_exp_f32 v0, v0
    v_exp_f32 v1, v1
    v_exp_f32 v4, v4
    v_exp_f32 v5, v5
    v_pk_add_f32 v[0:1], v[0:1], 1.0 op_sel_hi:[1,0]
    v_pk_add_f32 v[4:5], v[4:5], 1.0 op_sel_hi:[1,0]
    v_rcp_f32 v0, v0
    v_rcp_f32 v1, v1
    v_rcp_f32 v4, v4
    v_rcp_f32 v5, v5
    v_pk_mul_f32 v[0:1], v[0:1], v[76:77]
    v_cvt_pk_bf16_f32 v70, v0, v1
    v_pk_mul_f32 v[4:5], v[4:5], v[78:79]
    v_cvt_pk_bf16_f32 v71, v4, v5
    v_cvt_pk_bf16_f32 v0, v80, v81
    v_lshlrev_b32 v80, 16, v0
    v_and_b32 v81, 0xffff0000, v0
    v_pk_mul_f32 v[0:1], v[80:81], v[80:81]
    v_pk_fma_f32 v[0:1], v[0:1], s[34:35], v[62:63] op_sel_hi:[1,0,0]
    v_pk_mul_f32 v[0:1], v[0:1], v[80:81]
    v_cvt_pk_bf16_f32 v4, v82, v83
    v_lshlrev_b32 v82, 16, v4
    v_and_b32 v83, 0xffff0000, v4
    v_pk_mul_f32 v[4:5], v[82:83], v[82:83]
    v_pk_fma_f32 v[4:5], v[4:5], s[34:35], v[62:63] op_sel_hi:[1,0,0]
    v_pk_mul_f32 v[4:5], v[4:5], v[82:83]
    v_exp_f32 v0, v0
    v_exp_f32 v1, v1
    v_exp_f32 v4, v4
    v_exp_f32 v5, v5
    v_pk_add_f32 v[0:1], v[0:1], 1.0 op_sel_hi:[1,0]
    v_pk_add_f32 v[4:5], v[4:5], 1.0 op_sel_hi:[1,0]
    v_rcp_f32 v0, v0
    v_rcp_f32 v1, v1
    v_rcp_f32 v4, v4
    v_rcp_f32 v5, v5
    v_pk_mul_f32 v[0:1], v[0:1], v[80:81]
    v_cvt_pk_bf16_f32 v80, v0, v1
    v_pk_mul_f32 v[4:5], v[4:5], v[82:83]
    v_cvt_pk_bf16_f32 v81, v4, v5
    v_cvt_pk_bf16_f32 v0, v84, v85
    v_lshlrev_b32 v84, 16, v0
    v_and_b32 v85, 0xffff0000, v0
    v_pk_mul_f32 v[0:1], v[84:85], v[84:85]
    v_pk_fma_f32 v[0:1], v[0:1], s[34:35], v[62:63] op_sel_hi:[1,0,0]
    v_pk_mul_f32 v[0:1], v[0:1], v[84:85]
    v_cvt_pk_bf16_f32 v4, v86, v87
    v_lshlrev_b32 v86, 16, v4
    v_and_b32 v87, 0xffff0000, v4
    v_pk_mul_f32 v[4:5], v[86:87], v[86:87]
    v_pk_fma_f32 v[4:5], v[4:5], s[34:35], v[62:63] op_sel_hi:[1,0,0]
    v_pk_mul_f32 v[4:5], v[4:5], v[86:87]
    v_exp_f32 v0, v0
    v_exp_f32 v1, v1
    v_exp_f32 v4, v4
    v_exp_f32 v5, v5
    v_pk_add_f32 v[0:1], v[0:1], 1.0 op_sel_hi:[1,0]
    v_pk_add_f32 v[4:5], v[4:5], 1.0 op_sel_hi:[1,0]
    v_rcp_f32 v0, v0
    v_rcp_f32 v1, v1
    v_rcp_f32 v4, v4
    v_rcp_f32 v5, v5
    v_pk_mul_f32 v[0:1], v[0:1], v[84:85]
    v_cvt_pk_bf16_f32 v82, v0, v1
    v_pk_mul_f32 v[4:5], v[4:5], v[86:87]
    v_cvt_pk_bf16_f32 v83, v4, v5
    v_cvt_pk_bf16_f32 v0, v88, v89
    v_lshlrev_b32 v88, 16, v0
    v_and_b32 v89, 0xffff0000, v0
    v_pk_mul_f32 v[0:1], v[88:89], v[88:89]
    v_pk_fma_f32 v[0:1], v[0:1], s[34:35], v[62:63] op_sel_hi:[1,0,0]
    v_pk_mul_f32 v[0:1], v[0:1], v[88:89]
    v_cvt_pk_bf16_f32 v4, v90, v91
    v_lshlrev_b32 v90, 16, v4
    v_and_b32 v91, 0xffff0000, v4
    v_pk_mul_f32 v[4:5], v[90:91], v[90:91]
    v_pk_fma_f32 v[4:5], v[4:5], s[34:35], v[62:63] op_sel_hi:[1,0,0]
    v_pk_mul_f32 v[4:5], v[4:5], v[90:91]
    v_exp_f32 v0, v0
    v_exp_f32 v1, v1
    v_exp_f32 v4, v4
    v_exp_f32 v5, v5
    v_pk_add_f32 v[0:1], v[0:1], 1.0 op_sel_hi:[1,0]
    v_pk_add_f32 v[4:5], v[4:5], 1.0 op_sel_hi:[1,0]
    v_rcp_f32 v0, v0
    v_rcp_f32 v1, v1
    v_rcp_f32 v4, v4
    v_rcp_f32 v5, v5
    v_pk_mul_f32 v[0:1], v[0:1], v[88:89]
    v_cvt_pk_bf16_f32 v84, v0, v1
    v_pk_mul_f32 v[4:5], v[4:5], v[90:91]
    v_cvt_pk_bf16_f32 v85, v4, v5
    v_cvt_pk_bf16_f32 v0, v92, v93
    v_lshlrev_b32 v92, 16, v0
    v_and_b32 v93, 0xffff0000, v0
    v_pk_mul_f32 v[0:1], v[92:93], v[92:93]
    v_pk_fma_f32 v[0:1], v[0:1], s[34:35], v[62:63] op_sel_hi:[1,0,0]
    v_pk_mul_f32 v[0:1], v[0:1], v[92:93]
    v_cvt_pk_bf16_f32 v4, v94, v95
    v_lshlrev_b32 v94, 16, v4
    v_and_b32 v95, 0xffff0000, v4
    v_pk_mul_f32 v[4:5], v[94:95], v[94:95]
    v_pk_fma_f32 v[4:5], v[4:5], s[34:35], v[62:63] op_sel_hi:[1,0,0]
    v_pk_mul_f32 v[4:5], v[4:5], v[94:95]
    v_exp_f32 v0, v0
    v_exp_f32 v1, v1
    v_exp_f32 v4, v4
    v_exp_f32 v5, v5
    v_pk_add_f32 v[0:1], v[0:1], 1.0 op_sel_hi:[1,0]
    v_pk_add_f32 v[4:5], v[4:5], 1.0 op_sel_hi:[1,0]
    v_rcp_f32 v0, v0
    v_rcp_f32 v1, v1
    v_rcp_f32 v4, v4
    v_rcp_f32 v5, v5
    v_pk_mul_f32 v[0:1], v[0:1], v[92:93]
    v_cvt_pk_bf16_f32 v86, v0, v1
    v_pk_mul_f32 v[4:5], v[4:5], v[94:95]
    v_cvt_pk_bf16_f32 v87, v4, v5
    v_cvt_pk_bf16_f32 v0, v96, v97
    v_lshlrev_b32 v96, 16, v0
    v_and_b32 v97, 0xffff0000, v0
    v_pk_mul_f32 v[0:1], v[96:97], v[96:97]
    v_pk_fma_f32 v[0:1], v[0:1], s[34:35], v[62:63] op_sel_hi:[1,0,0]
    v_pk_mul_f32 v[0:1], v[0:1], v[96:97]
    v_cvt_pk_bf16_f32 v4, v98, v99
    v_lshlrev_b32 v98, 16, v4
    v_and_b32 v99, 0xffff0000, v4
    v_pk_mul_f32 v[4:5], v[98:99], v[98:99]
    v_pk_fma_f32 v[4:5], v[4:5], s[34:35], v[62:63] op_sel_hi:[1,0,0]
    v_pk_mul_f32 v[4:5], v[4:5], v[98:99]
    v_exp_f32 v0, v0
    v_exp_f32 v1, v1
    v_exp_f32 v4, v4
    v_exp_f32 v5, v5
    v_pk_add_f32 v[0:1], v[0:1], 1.0 op_sel_hi:[1,0]
    v_pk_add_f32 v[4:5], v[4:5], 1.0 op_sel_hi:[1,0]
    v_rcp_f32 v0, v0
    v_rcp_f32 v1, v1
    v_rcp_f32 v4, v4
    v_rcp_f32 v5, v5
    v_pk_mul_f32 v[0:1], v[0:1], v[96:97]
    v_cvt_pk_bf16_f32 v96, v0, v1
    v_pk_mul_f32 v[4:5], v[4:5], v[98:99]
    v_cvt_pk_bf16_f32 v97, v4, v5
    v_cvt_pk_bf16_f32 v0, v100, v101
    v_lshlrev_b32 v100, 16, v0
    v_and_b32 v101, 0xffff0000, v0
    v_pk_mul_f32 v[0:1], v[100:101], v[100:101]
    v_pk_fma_f32 v[0:1], v[0:1], s[34:35], v[62:63] op_sel_hi:[1,0,0]
    v_pk_mul_f32 v[0:1], v[0:1], v[100:101]
    v_cvt_pk_bf16_f32 v4, v102, v103
    v_lshlrev_b32 v102, 16, v4
    v_and_b32 v103, 0xffff0000, v4
    v_pk_mul_f32 v[4:5], v[102:103], v[102:103]
    v_pk_fma_f32 v[4:5], v[4:5], s[34:35], v[62:63] op_sel_hi:[1,0,0]
    v_pk_mul_f32 v[4:5], v[4:5], v[102:103]
    v_exp_f32 v0, v0
    v_exp_f32 v1, v1
    v_exp_f32 v4, v4
    v_exp_f32 v5, v5
    v_pk_add_f32 v[0:1], v[0:1], 1.0 op_sel_hi:[1,0]
    v_pk_add_f32 v[4:5], v[4:5], 1.0 op_sel_hi:[1,0]
    v_rcp_f32 v0, v0
    v_rcp_f32 v1, v1
    v_rcp_f32 v4, v4
    v_rcp_f32 v5, v5
    v_pk_mul_f32 v[0:1], v[0:1], v[100:101]
    v_cvt_pk_bf16_f32 v98, v0, v1
    v_pk_mul_f32 v[4:5], v[4:5], v[102:103]
    v_cvt_pk_bf16_f32 v99, v4, v5
    v_cvt_pk_bf16_f32 v0, v104, v105
    v_lshlrev_b32 v104, 16, v0
    v_and_b32 v105, 0xffff0000, v0
    v_pk_mul_f32 v[0:1], v[104:105], v[104:105]
    v_pk_fma_f32 v[0:1], v[0:1], s[34:35], v[62:63] op_sel_hi:[1,0,0]
    v_pk_mul_f32 v[0:1], v[0:1], v[104:105]
    v_cvt_pk_bf16_f32 v4, v106, v107
    v_lshlrev_b32 v106, 16, v4
    v_and_b32 v107, 0xffff0000, v4
    v_pk_mul_f32 v[4:5], v[106:107], v[106:107]
    v_pk_fma_f32 v[4:5], v[4:5], s[34:35], v[62:63] op_sel_hi:[1,0,0]
    v_pk_mul_f32 v[4:5], v[4:5], v[106:107]
    v_exp_f32 v0, v0
    v_exp_f32 v1, v1
    v_exp_f32 v4, v4
    v_exp_f32 v5, v5
    v_pk_add_f32 v[0:1], v[0:1], 1.0 op_sel_hi:[1,0]
    v_pk_add_f32 v[4:5], v[4:5], 1.0 op_sel_hi:[1,0]
    v_rcp_f32 v0, v0
    v_rcp_f32 v1, v1
    v_rcp_f32 v4, v4
    v_rcp_f32 v5, v5
    v_pk_mul_f32 v[0:1], v[0:1], v[104:105]
    v_cvt_pk_bf16_f32 v100, v0, v1
    v_pk_mul_f32 v[4:5], v[4:5], v[106:107]
    v_cvt_pk_bf16_f32 v101, v4, v5
    v_cvt_pk_bf16_f32 v0, v108, v109
    v_lshlrev_b32 v108, 16, v0
    v_and_b32 v109, 0xffff0000, v0
    v_pk_mul_f32 v[0:1], v[108:109], v[108:109]
    v_pk_fma_f32 v[0:1], v[0:1], s[34:35], v[62:63] op_sel_hi:[1,0,0]
    v_pk_mul_f32 v[0:1], v[0:1], v[108:109]
    v_cvt_pk_bf16_f32 v4, v110, v111
    v_lshlrev_b32 v110, 16, v4
    v_and_b32 v111, 0xffff0000, v4
    v_pk_mul_f32 v[4:5], v[110:111], v[110:111]
    v_pk_fma_f32 v[4:5], v[4:5], s[34:35], v[62:63] op_sel_hi:[1,0,0]
    v_pk_mul_f32 v[4:5], v[4:5], v[110:111]
    v_exp_f32 v0, v0
    v_exp_f32 v1, v1
    v_exp_f32 v4, v4
    v_exp_f32 v5, v5
    v_pk_add_f32 v[0:1], v[0:1], 1.0 op_sel_hi:[1,0]
    v_pk_add_f32 v[4:5], v[4:5], 1.0 op_sel_hi:[1,0]
    v_rcp_f32 v0, v0
    v_rcp_f32 v1, v1
    v_rcp_f32 v4, v4
    v_rcp_f32 v5, v5
    v_pk_mul_f32 v[0:1], v[0:1], v[108:109]
    v_cvt_pk_bf16_f32 v102, v0, v1
    v_pk_mul_f32 v[4:5], v[4:5], v[110:111]
    v_cvt_pk_bf16_f32 v103, v4, v5
    v_cvt_pk_bf16_f32 v0, v112, v113
    v_lshlrev_b32 v112, 16, v0
    v_and_b32 v113, 0xffff0000, v0
    v_pk_mul_f32 v[0:1], v[112:113], v[112:113]
    v_pk_fma_f32 v[0:1], v[0:1], s[34:35], v[62:63] op_sel_hi:[1,0,0]
    v_pk_mul_f32 v[0:1], v[0:1], v[112:113]
    v_cvt_pk_bf16_f32 v4, v114, v115
    v_lshlrev_b32 v114, 16, v4
    v_and_b32 v115, 0xffff0000, v4
    v_pk_mul_f32 v[4:5], v[114:115], v[114:115]
    v_pk_fma_f32 v[4:5], v[4:5], s[34:35], v[62:63] op_sel_hi:[1,0,0]
    v_pk_mul_f32 v[4:5], v[4:5], v[114:115]
    v_exp_f32 v0, v0
    v_exp_f32 v1, v1
    v_exp_f32 v4, v4
    v_exp_f32 v5, v5
    v_pk_add_f32 v[0:1], v[0:1], 1.0 op_sel_hi:[1,0]
    v_pk_add_f32 v[4:5], v[4:5], 1.0 op_sel_hi:[1,0]
    v_rcp_f32 v0, v0
    v_rcp_f32 v1, v1
    v_rcp_f32 v4, v4
    v_rcp_f32 v5, v5
    v_pk_mul_f32 v[0:1], v[0:1], v[112:113]
    v_cvt_pk_bf16_f32 v112, v0, v1
    v_pk_mul_f32 v[4:5], v[4:5], v[114:115]
    v_cvt_pk_bf16_f32 v113, v4, v5
    v_cvt_pk_bf16_f32 v0, v116, v117
    v_lshlrev_b32 v116, 16, v0
    v_and_b32 v117, 0xffff0000, v0
    v_pk_mul_f32 v[0:1], v[116:117], v[116:117]
    v_pk_fma_f32 v[0:1], v[0:1], s[34:35], v[62:63] op_sel_hi:[1,0,0]
    v_pk_mul_f32 v[0:1], v[0:1], v[116:117]
    v_cvt_pk_bf16_f32 v4, v118, v119
    v_lshlrev_b32 v118, 16, v4
    v_and_b32 v119, 0xffff0000, v4
    v_pk_mul_f32 v[4:5], v[118:119], v[118:119]
    v_pk_fma_f32 v[4:5], v[4:5], s[34:35], v[62:63] op_sel_hi:[1,0,0]
    v_pk_mul_f32 v[4:5], v[4:5], v[118:119]
    v_exp_f32 v0, v0
    v_exp_f32 v1, v1
    v_exp_f32 v4, v4
    v_exp_f32 v5, v5
    v_pk_add_f32 v[0:1], v[0:1], 1.0 op_sel_hi:[1,0]
    v_pk_add_f32 v[4:5], v[4:5], 1.0 op_sel_hi:[1,0]
    v_rcp_f32 v0, v0
    v_rcp_f32 v1, v1
    v_rcp_f32 v4, v4
    v_rcp_f32 v5, v5
    v_pk_mul_f32 v[0:1], v[0:1], v[116:117]
    v_cvt_pk_bf16_f32 v114, v0, v1
    v_pk_mul_f32 v[4:5], v[4:5], v[118:119]
    v_cvt_pk_bf16_f32 v115, v4, v5
    v_cvt_pk_bf16_f32 v0, v120, v121
    v_lshlrev_b32 v120, 16, v0
    v_and_b32 v121, 0xffff0000, v0
    v_pk_mul_f32 v[0:1], v[120:121], v[120:121]
    v_pk_fma_f32 v[0:1], v[0:1], s[34:35], v[62:63] op_sel_hi:[1,0,0]
    v_pk_mul_f32 v[0:1], v[0:1], v[120:121]
    v_cvt_pk_bf16_f32 v4, v122, v123
    v_lshlrev_b32 v122, 16, v4
    v_and_b32 v123, 0xffff0000, v4
    v_pk_mul_f32 v[4:5], v[122:123], v[122:123]
    v_pk_fma_f32 v[4:5], v[4:5], s[34:35], v[62:63] op_sel_hi:[1,0,0]
    v_pk_mul_f32 v[4:5], v[4:5], v[122:123]
    v_exp_f32 v0, v0
    v_exp_f32 v1, v1
    v_exp_f32 v4, v4
    v_exp_f32 v5, v5
    v_pk_add_f32 v[0:1], v[0:1], 1.0 op_sel_hi:[1,0]
    v_pk_add_f32 v[4:5], v[4:5], 1.0 op_sel_hi:[1,0]
    v_rcp_f32 v0, v0
    v_rcp_f32 v1, v1
    v_rcp_f32 v4, v4
    v_rcp_f32 v5, v5
    v_pk_mul_f32 v[0:1], v[0:1], v[120:121]
    v_cvt_pk_bf16_f32 v116, v0, v1
    v_pk_mul_f32 v[4:5], v[4:5], v[122:123]
    v_cvt_pk_bf16_f32 v117, v4, v5
    v_cvt_pk_bf16_f32 v0, v124, v125
    v_lshlrev_b32 v124, 16, v0
    v_and_b32 v125, 0xffff0000, v0
    v_pk_mul_f32 v[0:1], v[124:125], v[124:125]
    v_pk_fma_f32 v[0:1], v[0:1], s[34:35], v[62:63] op_sel_hi:[1,0,0]
    v_pk_mul_f32 v[0:1], v[0:1], v[124:125]
    v_cvt_pk_bf16_f32 v4, v126, v127
    v_lshlrev_b32 v126, 16, v4
    v_and_b32 v127, 0xffff0000, v4
    v_pk_mul_f32 v[4:5], v[126:127], v[126:127]
    v_pk_fma_f32 v[4:5], v[4:5], s[34:35], v[62:63] op_sel_hi:[1,0,0]
    v_pk_mul_f32 v[4:5], v[4:5], v[126:127]
    v_exp_f32 v0, v0
    v_exp_f32 v1, v1
    v_exp_f32 v4, v4
    v_exp_f32 v5, v5
    v_pk_add_f32 v[0:1], v[0:1], 1.0 op_sel_hi:[1,0]
    v_pk_add_f32 v[4:5], v[4:5], 1.0 op_sel_hi:[1,0]
    v_rcp_f32 v0, v0
    v_rcp_f32 v1, v1
    v_rcp_f32 v4, v4
    v_rcp_f32 v5, v5
    v_pk_mul_f32 v[0:1], v[0:1], v[124:125]
    v_cvt_pk_bf16_f32 v118, v0, v1
    v_pk_mul_f32 v[4:5], v[4:5], v[126:127]
    v_cvt_pk_bf16_f32 v119, v4, v5
    v_mbcnt_lo_u32_b32 v0, -1, 0
    v_mbcnt_hi_u32_b32 v0, -1, v0
    v_and_b32 v1, 31, v0
    v_and_b32 v2, 15, v0
    s_lshl_b32 s30, s20, 3
    s_and_b32 s31, s30, 15
    v_xor_b32 v2, s31, v2
    v_lshlrev_b32 v2, 4, v2
    v_lshl_add_u32 v2, v1, 9, v2
    v_lshrrev_b32 v1, 5, v0
    v_lshl_add_u32 v2, v1, 3, v2
    s_lshr_b32 s30, s30, 4
    s_lshl_b32 s30, s30, 8
    s_add_u32 s30, s30, 0x10000
    v_add_u32 v40, s30, v2
    s_barrier
    v_xor_b32 v1, 0, v40
    ds_write_b64 v1, v[64:65] offset:0
    ds_write_b64 v1, v[80:81] offset:16384
    v_xor_b32 v1, 16, v40
    ds_write_b64 v1, v[66:67] offset:0
    ds_write_b64 v1, v[82:83] offset:16384
    v_xor_b32 v1, 32, v40
    ds_write_b64 v1, v[68:69] offset:0
    ds_write_b64 v1, v[84:85] offset:16384
    v_xor_b32 v1, 48, v40
    ds_write_b64 v1, v[70:71] offset:0
    ds_write_b64 v1, v[86:87] offset:16384
    v_xor_b32 v1, 64, v40
    ds_write_b64 v1, v[96:97] offset:0
    ds_write_b64 v1, v[112:113] offset:16384
    v_xor_b32 v1, 80, v40
    ds_write_b64 v1, v[98:99] offset:0
    ds_write_b64 v1, v[114:115] offset:16384
    v_xor_b32 v1, 96, v40
    ds_write_b64 v1, v[100:101] offset:0
    ds_write_b64 v1, v[116:117] offset:16384
    v_xor_b32 v1, 112, v40
    ds_write_b64 v1, v[102:103] offset:0
    ds_write_b64 v1, v[118:119] offset:16384
    v_mbcnt_lo_u32_b32 v0, -1, 0
    v_mbcnt_hi_u32_b32 v0, -1, v0
    v_and_b32 v1, 31, v0
    v_lshrrev_b32 v2, 5, v0
    v_and_b32 v3, 15, v1
    v_xor_b32 v2, v2, v3
    v_lshlrev_b32 v2, 4, v2
    v_lshl_add_u32 v1, v1, 9, v2
    v_add_u32 v1, 0x10000, v1
    v_xor_b32 v48, 0, v1
    v_xor_b32 v49, 32, v1
    v_xor_b32 v50, 64, v1
    v_xor_b32 v51, 96, v1
    v_xor_b32 v52, 128, v1
    v_xor_b32 v53, 160, v1
    v_xor_b32 v54, 192, v1
    v_xor_b32 v55, 224, v1
    v_mbcnt_lo_u32_b32 v0, -1, 0
    v_mbcnt_hi_u32_b32 v0, -1, v0
    v_bfe_u32 v1, v0, 2, 2
    v_lshrrev_b32 v2, 5, v0
    v_lshl_add_u32 v2, v2, 3, v1
    v_lshlrev_b32 v2, 8, v2
    v_lshl_add_u32 v2, v1, 6, v2
    v_bfe_u32 v1, v0, 4, 1
    v_lshl_add_u32 v2, v1, 5, v2
    v_and_b32 v1, 3, v0
    v_lshl_add_u32 v2, v1, 3, v2
    v_add_u32 v2, s25, v2
    v_xor_b32 v56, 0, v2
    v_xor_b32 v57, 64, v2
    v_xor_b32 v58, 128, v2
    v_xor_b32 v59, 192, v2
    s_waitcnt lgkmcnt(0)
    s_barrier
    s_waitcnt vmcnt(8)
    ds_read_b128 v[32:35], v48 offset:0
    ds_read_b128 v[36:39], v48 offset:16384
    ds_read_b64_tr_b16 v[0:1], v56 offset:0
    ds_read_b64_tr_b16 v[2:3], v56 offset:1024
    ds_read_b64_tr_b16 v[4:5], v57 offset:0
    ds_read_b64_tr_b16 v[6:7], v57 offset:1024
    ds_read_b64_tr_b16 v[8:9], v58 offset:0
    ds_read_b64_tr_b16 v[10:11], v58 offset:1024
    ds_read_b64_tr_b16 v[12:13], v59 offset:0
    ds_read_b64_tr_b16 v[14:15], v59 offset:1024
    s_waitcnt lgkmcnt(0)
    v_mfma_f32_32x32x16_bf16 v[128:143], v[0:3], v[32:35], v[128:143]
    s_add_u32 m0, s25, 12288
    s_add_u32 s26, s26, 4096
    buffer_load_dwordx4 v60, s[8:11], s26 offen lds
    v_mfma_f32_32x32x16_bf16 v[144:159], v[0:3], v[36:39], v[144:159]
    s_add_u32 m0, s25, 13312
    s_add_u32 s26, s26, 4096
    buffer_load_dwordx4 v60, s[8:11], s26 offen lds
    v_mfma_f32_32x32x16_bf16 v[160:175], v[4:7], v[32:35], v[160:175]
    s_add_u32 m0, s25, 14336
    s_add_u32 s26, s26, 4096
    buffer_load_dwordx4 v60, s[8:11], s26 offen lds
    v_mfma_f32_32x32x16_bf16 v[176:191], v[4:7], v[36:39], v[176:191]
    s_add_u32 m0, s25, 15360
    s_add_u32 s26, s26, 4096
    buffer_load_dwordx4 v60, s[8:11], s26 offen lds
    s_waitcnt vmcnt(8)
    ds_read_b128 v[40:43], v49 offset:0
    ds_read_b128 v[44:47], v49 offset:16384
    v_mfma_f32_32x32x16_bf16 v[192:207], v[8:11], v[32:35], v[192:207]
    ds_read_b64_tr_b16 v[16:17], v56 offset:4096
    ds_read_b64_tr_b16 v[18:19], v56 offset:5120
    v_mfma_f32_32x32x16_bf16 v[208:223], v[8:11], v[36:39], v[208:223]
    ds_read_b64_tr_b16 v[20:21], v57 offset:4096
    ds_read_b64_tr_b16 v[22:23], v57 offset:5120
    v_mfma_f32_32x32x16_bf16 v[224:239], v[12:15], v[32:35], v[224:239]
    ds_read_b64_tr_b16 v[24:25], v58 offset:4096
    ds_read_b64_tr_b16 v[26:27], v58 offset:5120
    v_mfma_f32_32x32x16_bf16 v[240:255], v[12:15], v[36:39], v[240:255]
    ds_read_b64_tr_b16 v[28:29], v59 offset:4096
    ds_read_b64_tr_b16 v[30:31], v59 offset:5120
    s_waitcnt lgkmcnt(0)
    v_mfma_f32_32x32x16_bf16 v[128:143], v[16:19], v[40:43], v[128:143]
    s_add_u32 m0, s25, 0
    s_add_u32 s26, s26, 4096
    buffer_load_dwordx4 v60, s[8:11], s26 offen lds
    v_mfma_f32_32x32x16_bf16 v[144:159], v[16:19], v[44:47], v[144:159]
    s_add_u32 m0, s25, 1024
    s_add_u32 s26, s26, 4096
    buffer_load_dwordx4 v60, s[8:11], s26 offen lds
    v_mfma_f32_32x32x16_bf16 v[160:175], v[20:23], v[40:43], v[160:175]
    s_add_u32 m0, s25, 2048
    s_add_u32 s26, s26, 4096
    buffer_load_dwordx4 v60, s[8:11], s26 offen lds
    v_mfma_f32_32x32x16_bf16 v[176:191], v[20:23], v[44:47], v[176:191]
    s_add_u32 m0, s25, 3072
    s_add_u32 s26, s26, 4096
    buffer_load_dwordx4 v60, s[8:11], s26 offen lds
    s_waitcnt vmcnt(8)
    ds_read_b128 v[32:35], v50 offset:0
    ds_read_b128 v[36:39], v50 offset:16384
    v_mfma_f32_32x32x16_bf16 v[192:207], v[24:27], v[40:43], v[192:207]
    ds_read_b64_tr_b16 v[0:1], v56 offset:8192
    ds_read_b64_tr_b16 v[2:3], v56 offset:9216
    v_mfma_f32_32x32x16_bf16 v[208:223], v[24:27], v[44:47], v[208:223]
    ds_read_b64_tr_b16 v[4:5], v57 offset:8192
    ds_read_b64_tr_b16 v[6:7], v57 offset:9216
    v_mfma_f32_32x32x16_bf16 v[224:239], v[28:31], v[40:43], v[224:239]
    ds_read_b64_tr_b16 v[8:9], v58 offset:8192
    ds_read_b64_tr_b16 v[10:11], v58 offset:9216
    v_mfma_f32_32x32x16_bf16 v[240:255], v[28:31], v[44:47], v[240:255]
    ds_read_b64_tr_b16 v[12:13], v59 offset:8192
    ds_read_b64_tr_b16 v[14:15], v59 offset:9216
    s_waitcnt lgkmcnt(0)
    v_mfma_f32_32x32x16_bf16 v[128:143], v[0:3], v[32:35], v[128:143]
    s_add_u32 m0, s25, 4096
    s_add_u32 s26, s26, 4096
    buffer_load_dwordx4 v60, s[8:11], s26 offen lds
    v_mfma_f32_32x32x16_bf16 v[144:159], v[0:3], v[36:39], v[144:159]
    s_add_u32 m0, s25, 5120
    s_add_u32 s26, s26, 4096
    buffer_load_dwordx4 v60, s[8:11], s26 offen lds
    v_mfma_f32_32x32x16_bf16 v[160:175], v[4:7], v[32:35], v[160:175]
    s_add_u32 m0, s25, 6144
    s_add_u32 s26, s26, 4096
    buffer_load_dwordx4 v60, s[8:11], s26 offen lds
    v_mfma_f32_32x32x16_bf16 v[176:191], v[4:7], v[36:39], v[176:191]
    s_add_u32 m0, s25, 7168
    s_add_u32 s26, s26, 4096
    buffer_load_dwordx4 v60, s[8:11], s26 offen lds
    s_waitcnt vmcnt(8)
    ds_read_b128 v[40:43], v51 offset:0
    ds_read_b128 v[44:47], v51 offset:16384
    v_mfma_f32_32x32x16_bf16 v[192:207], v[8:11], v[32:35], v[192:207]
    ds_read_b64_tr_b16 v[16:17], v56 offset:12288
    ds_read_b64_tr_b16 v[18:19], v56 offset:13312
    v_mfma_f32_32x32x16_bf16 v[208:223], v[8:11], v[36:39], v[208:223]
    ds_read_b64_tr_b16 v[20:21], v57 offset:12288
    ds_read_b64_tr_b16 v[22:23], v57 offset:13312
    v_mfma_f32_32x32x16_bf16 v[224:239], v[12:15], v[32:35], v[224:239]
    ds_read_b64_tr_b16 v[24:25], v58 offset:12288
    ds_read_b64_tr_b16 v[26:27], v58 offset:13312
    v_mfma_f32_32x32x16_bf16 v[240:255], v[12:15], v[36:39], v[240:255]
    ds_read_b64_tr_b16 v[28:29], v59 offset:12288
    ds_read_b64_tr_b16 v[30:31], v59 offset:13312
    s_waitcnt lgkmcnt(0)
    v_mfma_f32_32x32x16_bf16 v[128:143], v[16:19], v[40:43], v[128:143]
    s_add_u32 m0, s25, 8192
    s_add_u32 s26, s26, 4096
    buffer_load_dwordx4 v60, s[8:11], s26 offen lds
    v_mfma_f32_32x32x16_bf16 v[144:159], v[16:19], v[44:47], v[144:159]
    s_add_u32 m0, s25, 9216
    s_add_u32 s26, s26, 4096
    buffer_load_dwordx4 v60, s[8:11], s26 offen lds
    v_mfma_f32_32x32x16_bf16 v[160:175], v[20:23], v[40:43], v[160:175]
    s_add_u32 m0, s25, 10240
    s_add_u32 s26, s26, 4096
    buffer_load_dwordx4 v60, s[8:11], s26 offen lds
    v_mfma_f32_32x32x16_bf16 v[176:191], v[20:23], v[44:47], v[176:191]
    s_add_u32 m0, s25, 11264
    s_add_u32 s26, s26, 4096
    buffer_load_dwordx4 v60, s[8:11], s26 offen lds
    s_waitcnt vmcnt(8)
    ds_read_b128 v[32:35], v52 offset:0
    ds_read_b128 v[36:39], v52 offset:16384
    v_mfma_f32_32x32x16_bf16 v[192:207], v[24:27], v[40:43], v[192:207]
    ds_read_b64_tr_b16 v[0:1], v56 offset:0
    ds_read_b64_tr_b16 v[2:3], v56 offset:1024
    v_mfma_f32_32x32x16_bf16 v[208:223], v[24:27], v[44:47], v[208:223]
    ds_read_b64_tr_b16 v[4:5], v57 offset:0
    ds_read_b64_tr_b16 v[6:7], v57 offset:1024
    v_mfma_f32_32x32x16_bf16 v[224:239], v[28:31], v[40:43], v[224:239]
    ds_read_b64_tr_b16 v[8:9], v58 offset:0
    ds_read_b64_tr_b16 v[10:11], v58 offset:1024
    v_mfma_f32_32x32x16_bf16 v[240:255], v[28:31], v[44:47], v[240:255]
    ds_read_b64_tr_b16 v[12:13], v59 offset:0
    ds_read_b64_tr_b16 v[14:15], v59 offset:1024
    s_waitcnt lgkmcnt(0)
    v_mfma_f32_32x32x16_bf16 v[128:143], v[0:3], v[32:35], v[128:143]
    s_add_u32 m0, s25, 12288
    s_add_u32 s26, s26, 4096
    buffer_load_dwordx4 v60, s[8:11], s26 offen lds
    v_mfma_f32_32x32x16_bf16 v[144:159], v[0:3], v[36:39], v[144:159]
    s_add_u32 m0, s25, 13312
    s_add_u32 s26, s26, 4096
    buffer_load_dwordx4 v60, s[8:11], s26 offen lds
    v_mfma_f32_32x32x16_bf16 v[160:175], v[4:7], v[32:35], v[160:175]
    s_add_u32 m0, s25, 14336
    s_add_u32 s26, s26, 4096
    buffer_load_dwordx4 v60, s[8:11], s26 offen lds
    v_mfma_f32_32x32x16_bf16 v[176:191], v[4:7], v[36:39], v[176:191]
    s_add_u32 m0, s25, 15360
    s_add_u32 s26, s26, 4096
    buffer_load_dwordx4 v60, s[8:11], s26 offen lds
    s_waitcnt vmcnt(8)
    ds_read_b128 v[40:43], v53 offset:0
    ds_read_b128 v[44:47], v53 offset:16384
    v_mfma_f32_32x32x16_bf16 v[192:207], v[8:11], v[32:35], v[192:207]
    ds_read_b64_tr_b16 v[16:17], v56 offset:4096
    ds_read_b64_tr_b16 v[18:19], v56 offset:5120
    v_mfma_f32_32x32x16_bf16 v[208:223], v[8:11], v[36:39], v[208:223]
    ds_read_b64_tr_b16 v[20:21], v57 offset:4096
    ds_read_b64_tr_b16 v[22:23], v57 offset:5120
    v_mfma_f32_32x32x16_bf16 v[224:239], v[12:15], v[32:35], v[224:239]
    ds_read_b64_tr_b16 v[24:25], v58 offset:4096
    ds_read_b64_tr_b16 v[26:27], v58 offset:5120
    v_mfma_f32_32x32x16_bf16 v[240:255], v[12:15], v[36:39], v[240:255]
    ds_read_b64_tr_b16 v[28:29], v59 offset:4096
    ds_read_b64_tr_b16 v[30:31], v59 offset:5120
    s_waitcnt lgkmcnt(0)
    v_mfma_f32_32x32x16_bf16 v[128:143], v[16:19], v[40:43], v[128:143]
    s_add_u32 m0, s25, 0
    s_add_u32 s26, s26, 4096
    buffer_load_dwordx4 v60, s[8:11], s26 offen lds
    v_mfma_f32_32x32x16_bf16 v[144:159], v[16:19], v[44:47], v[144:159]
    s_add_u32 m0, s25, 1024
    s_add_u32 s26, s26, 4096
    buffer_load_dwordx4 v60, s[8:11], s26 offen lds
    v_mfma_f32_32x32x16_bf16 v[160:175], v[20:23], v[40:43], v[160:175]
    s_add_u32 m0, s25, 2048
    s_add_u32 s26, s26, 4096
    buffer_load_dwordx4 v60, s[8:11], s26 offen lds
    v_mfma_f32_32x32x16_bf16 v[176:191], v[20:23], v[44:47], v[176:191]
    s_add_u32 m0, s25, 3072
    s_add_u32 s26, s26, 4096
    buffer_load_dwordx4 v60, s[8:11], s26 offen lds
    s_waitcnt vmcnt(8)
    ds_read_b128 v[32:35], v54 offset:0
    ds_read_b128 v[36:39], v54 offset:16384
    v_mfma_f32_32x32x16_bf16 v[192:207], v[24:27], v[40:43], v[192:207]
    ds_read_b64_tr_b16 v[0:1], v56 offset:8192
    ds_read_b64_tr_b16 v[2:3], v56 offset:9216
    v_mfma_f32_32x32x16_bf16 v[208:223], v[24:27], v[44:47], v[208:223]
    ds_read_b64_tr_b16 v[4:5], v57 offset:8192
    ds_read_b64_tr_b16 v[6:7], v57 offset:9216
    v_mfma_f32_32x32x16_bf16 v[224:239], v[28:31], v[40:43], v[224:239]
    ds_read_b64_tr_b16 v[8:9], v58 offset:8192
    ds_read_b64_tr_b16 v[10:11], v58 offset:9216
    v_mfma_f32_32x32x16_bf16 v[240:255], v[28:31], v[44:47], v[240:255]
    ds_read_b64_tr_b16 v[12:13], v59 offset:8192
    ds_read_b64_tr_b16 v[14:15], v59 offset:9216
    s_cmp_eq_u32 s29, 5
    s_cbranch_scc1 L_B4X
    s_waitcnt lgkmcnt(0)
    v_mfma_f32_32x32x16_bf16 v[128:143], v[0:3], v[32:35], v[128:143]
    s_add_u32 m0, s25, 4096
    s_add_u32 s26, s26, 4096
    buffer_load_dwordx4 v60, s[8:11], s26 offen lds
    v_mfma_f32_32x32x16_bf16 v[144:159], v[0:3], v[36:39], v[144:159]
    s_add_u32 m0, s25, 5120
    s_add_u32 s26, s26, 4096
    buffer_load_dwordx4 v60, s[8:11], s26 offen lds
    v_mfma_f32_32x32x16_bf16 v[160:175], v[4:7], v[32:35], v[160:175]
    s_add_u32 m0, s25, 6144
    s_add_u32 s26, s26, 4096
    buffer_load_dwordx4 v60, s[8:11], s26 offen lds
    v_mfma_f32_32x32x16_bf16 v[176:191], v[4:7], v[36:39], v[176:191]
    s_add_u32 m0, s25, 7168
    s_add_u32 s26, s26, 4096
    buffer_load_dwordx4 v60, s[8:11], s26 offen lds
    s_waitcnt vmcnt(8)
    ds_read_b128 v[40:43], v55 offset:0
    ds_read_b128 v[44:47], v55 offset:16384
    v_mfma_f32_32x32x16_bf16 v[192:207], v[8:11], v[32:35], v[192:207]
    ds_read_b64_tr_b16 v[16:17], v56 offset:12288
    ds_read_b64_tr_b16 v[18:19], v56 offset:13312
    v_mfma_f32_32x32x16_bf16 v[208:223], v[8:11], v[36:39], v[208:223]
    ds_read_b64_tr_b16 v[20:21], v57 offset:12288
    ds_read_b64_tr_b16 v[22:23], v57 offset:13312
    v_mfma_f32_32x32x16_bf16 v[224:239], v[12:15], v[32:35], v[224:239]
    ds_read_b64_tr_b16 v[24:25], v58 offset:12288
    ds_read_b64_tr_b16 v[26:27], v58 offset:13312
    v_mfma_f32_32x32x16_bf16 v[240:255], v[12:15], v[36:39], v[240:255]
    ds_read_b64_tr_b16 v[28:29], v59 offset:12288
    ds_read_b64_tr_b16 v[30:31], v59 offset:13312
    s_waitcnt lgkmcnt(0)
    v_mfma_f32_32x32x16_bf16 v[128:143], v[16:19], v[40:43], v[128:143]
    s_add_u32 m0, s25, 8192
    s_add_u32 s26, s26, 4096
    buffer_load_dwordx4 v60, s[8:11], s26 offen lds
    v_mfma_f32_32x32x16_bf16 v[144:159], v[16:19], v[44:47], v[144:159]
    s_add_u32 m0, s25, 9216
    s_add_u32 s26, s26, 4096
    buffer_load_dwordx4 v60, s[8:11], s26 offen lds
    v_mfma_f32_32x32x16_bf16 v[160:175], v[20:23], v[40:43], v[160:175]
    s_add_u32 m0, s25, 10240
    s_add_u32 s26, s26, 4096
    buffer_load_dwordx4 v60, s[8:11], s26 offen lds
    v_mfma_f32_32x32x16_bf16 v[176:191], v[20:23], v[44:47], v[176:191]
    s_add_u32 m0, s25, 11264
    s_add_u32 s26, s26, 4096
    buffer_load_dwordx4 v60, s[8:11], s26 offen lds
    s_waitcnt vmcnt(8)
    ds_read_b128 v[32:35], v48 offset:256
    ds_read_b128 v[36:39], v48 offset:16640
    v_mfma_f32_32x32x16_bf16 v[192:207], v[24:27], v[40:43], v[192:207]
    ds_read_b64_tr_b16 v[0:1], v56 offset:0
    ds_read_b64_tr_b16 v[2:3], v56 offset:1024
    v_mfma_f32_32x32x16_bf16 v[208:223], v[24:27], v[44:47], v[208:223]
    ds_read_b64_tr_b16 v[4:5], v57 offset:0
    ds_read_b64_tr_b16 v[6:7], v57 offset:1024
    v_mfma_f32_32x32x16_bf16 v[224:239], v[28:31], v[40:43], v[224:239]
    ds_read_b64_tr_b16 v[8:9], v58 offset:0
    ds_read_b64_tr_b16 v[10:11], v58 offset:1024
    v_mfma_f32_32x32x16_bf16 v[240:255], v[28:31], v[44:47], v[240:255]
    ds_read_b64_tr_b16 v[12:13], v59 offset:0
    ds_read_b64_tr_b16 v[14:15], v59 offset:1024
    s_waitcnt lgkmcnt(0)
    v_mfma_f32_32x32x16_bf16 v[128:143], v[0:3], v[32:35], v[128:143]
    s_add_u32 m0, s25, 12288
    s_add_u32 s26, s26, 4096
    buffer_load_dwordx4 v60, s[8:11], s26 offen lds
    v_mfma_f32_32x32x16_bf16 v[144:159], v[0:3], v[36:39], v[144:159]
    s_add_u32 m0, s25, 13312
    s_add_u32 s26, s26, 4096
    buffer_load_dwordx4 v60, s[8:11], s26 offen lds
    v_mfma_f32_32x32x16_bf16 v[160:175], v[4:7], v[32:35], v[160:175]
    s_add_u32 m0, s25, 14336
    s_add_u32 s26, s26, 4096
    buffer_load_dwordx4 v60, s[8:11], s26 offen lds
    v_mfma_f32_32x32x16_bf16 v[176:191], v[4:7], v[36:39], v[176:191]
    s_add_u32 m0, s25, 15360
    s_add_u32 s26, s26, 4096
    buffer_load_dwordx4 v60, s[8:11], s26 offen lds
    s_waitcnt vmcnt(8)
    ds_read_b128 v[40:43], v49 offset:256
    ds_read_b128 v[44:47], v49 offset:16640
    v_mfma_f32_32x32x16_bf16 v[192:207], v[8:11], v[32:35], v[192:207]
    ds_read_b64_tr_b16 v[16:17], v56 offset:4096
    ds_read_b64_tr_b16 v[18:19], v56 offset:5120
    v_mfma_f32_32x32x16_bf16 v[208:223], v[8:11], v[36:39], v[208:223]
    ds_read_b64_tr_b16 v[20:21], v57 offset:4096
    ds_read_b64_tr_b16 v[22:23], v57 offset:5120
    v_mfma_f32_32x32x16_bf16 v[224:239], v[12:15], v[32:35], v[224:239]
    ds_read_b64_tr_b16 v[24:25], v58 offset:4096
    ds_read_b64_tr_b16 v[26:27], v58 offset:5120
    v_mfma_f32_32x32x16_bf16 v[240:255], v[12:15], v[36:39], v[240:255]
    ds_read_b64_tr_b16 v[28:29], v59 offset:4096
    ds_read_b64_tr_b16 v[30:31], v59 offset:5120
    s_waitcnt lgkmcnt(0)
    v_mfma_f32_32x32x16_bf16 v[128:143], v[16:19], v[40:43], v[128:143]
    s_add_u32 m0, s25, 0
    s_add_u32 s26, s26, 4096
    buffer_load_dwordx4 v60, s[8:11], s26 offen lds
    v_mfma_f32_32x32x16_bf16 v[144:159], v[16:19], v[44:47], v[144:159]
    s_add_u32 m0, s25, 1024
    s_add_u32 s26, s26, 4096
    buffer_load_dwordx4 v60, s[8:11], s26 offen lds
    v_mfma_f32_32x32x16_bf16 v[160:175], v[20:23], v[40:43], v[160:175]
    s_add_u32 m0, s25, 2048
    s_add_u32 s26, s26, 4096
    buffer_load_dwordx4 v60, s[8:11], s26 offen lds
    v_mfma_f32_32x32x16_bf16 v[176:191], v[20:23], v[44:47], v[176:191]
    s_add_u32 m0, s25, 3072
    s_add_u32 s26, s26, 4096
    buffer_load_dwordx4 v60, s[8:11], s26 offen lds
    s_waitcnt vmcnt(8)
    ds_read_b128 v[32:35], v50 offset:256
    ds_read_b128 v[36:39], v50 offset:16640
    v_mfma_f32_32x32x16_bf16 v[192:207], v[24:27], v[40:43], v[192:207]
    ds_read_b64_tr_b16 v[0:1], v56 offset:8192
    ds_read_b64_tr_b16 v[2:3], v56 offset:9216
    v_mfma_f32_32x32x16_bf16 v[208:223], v[24:27], v[44:47], v[208:223]
    ds_read_b64_tr_b16 v[4:5], v57 offset:8192
    ds_read_b64_tr_b16 v[6:7], v57 offset:9216
    v_mfma_f32_32x32x16_bf16 v[224:239], v[28:31], v[40:43], v[224:239]
    ds_read_b64_tr_b16 v[8:9], v58 offset:8192
    ds_read_b64_tr_b16 v[10:11], v58 offset:9216
    v_mfma_f32_32x32x16_bf16 v[240:255], v[28:31], v[44:47], v[240:255]
    ds_read_b64_tr_b16 v[12:13], v59 offset:8192
    ds_read_b64_tr_b16 v[14:15], v59 offset:9216
    s_waitcnt lgkmcnt(0)
    v_mfma_f32_32x32x16_bf16 v[128:143], v[0:3], v[32:35], v[128:143]
    s_add_u32 m0, s25, 4096
    s_add_u32 s26, s26, 4096
    buffer_load_dwordx4 v60, s[8:11], s26 offen lds
    v_mfma_f32_32x32x16_bf16 v[144:159], v[0:3], v[36:39], v[144:159]
    s_add_u32 m0, s25, 5120
    s_add_u32 s26, s26, 4096
    buffer_load_dwordx4 v60, s[8:11], s26 offen lds
    v_mfma_f32_32x32x16_bf16 v[160:175], v[4:7], v[32:35], v[160:175]
    s_add_u32 m0, s25, 6144
    s_add_u32 s26, s26, 4096
    buffer_load_dwordx4 v60, s[8:11], s26 offen lds
    v_mfma_f32_32x32x16_bf16 v[176:191], v[4:7], v[36:39], v[176:191]
    s_add_u32 m0, s25, 7168
    s_add_u32 s26, s26, 4096
    buffer_load_dwordx4 v60, s[8:11], s26 offen lds
    s_waitcnt vmcnt(8)
    ds_read_b128 v[40:43], v51 offset:256
    ds_read_b128 v[44:47], v51 offset:16640
    v_mfma_f32_32x32x16_bf16 v[192:207], v[8:11], v[32:35], v[192:207]
    ds_read_b64_tr_b16 v[16:17], v56 offset:12288
    ds_read_b64_tr_b16 v[18:19], v56 offset:13312
    v_mfma_f32_32x32x16_bf16 v[208:223], v[8:11], v[36:39], v[208:223]
    ds_read_b64_tr_b16 v[20:21], v57 offset:12288
    ds_read_b64_tr_b16 v[22:23], v57 offset:13312
    v_mfma_f32_32x32x16_bf16 v[224:239], v[12:15], v[32:35], v[224:239]
    ds_read_b64_tr_b16 v[24:25], v58 offset:12288
    ds_read_b64_tr_b16 v[26:27], v58 offset:13312
    v_mfma_f32_32x32x16_bf16 v[240:255], v[12:15], v[36:39], v[240:255]
    ds_read_b64_tr_b16 v[28:29], v59 offset:12288
    ds_read_b64_tr_b16 v[30:31], v59 offset:13312
    s_waitcnt lgkmcnt(0)
    v_mfma_f32_32x32x16_bf16 v[128:143], v[16:19], v[40:43], v[128:143]
    s_add_u32 m0, s25, 8192
    s_add_u32 s26, s26, 4096
    buffer_load_dwordx4 v60, s[8:11], s26 offen lds
    v_mfma_f32_32x32x16_bf16 v[144:159], v[16:19], v[44:47], v[144:159]
    s_add_u32 m0, s25, 9216
    s_add_u32 s26, s26, 4096
    buffer_load_dwordx4 v60, s[8:11], s26 offen lds
    v_mfma_f32_32x32x16_bf16 v[160:175], v[20:23], v[40:43], v[160:175]
    s_add_u32 m0, s25, 10240
    s_add_u32 s26, s26, 4096
    buffer_load_dwordx4 v60, s[8:11], s26 offen lds
    v_mfma_f32_32x32x16_bf16 v[176:191], v[20:23], v[44:47], v[176:191]
    s_add_u32 m0, s25, 11264
    s_add_u32 s26, s26, 4096
    buffer_load_dwordx4 v60, s[8:11], s26 offen lds
    s_waitcnt vmcnt(8)
    ds_read_b128 v[32:35], v52 offset:256
    ds_read_b128 v[36:39], v52 offset:16640
    v_mfma_f32_32x32x16_bf16 v[192:207], v[24:27], v[40:43], v[192:207]
    ds_read_b64_tr_b16 v[0:1], v56 offset:0
    ds_read_b64_tr_b16 v[2:3], v56 offset:1024
    v_mfma_f32_32x32x16_bf16 v[208:223], v[24:27], v[44:47], v[208:223]
    ds_read_b64_tr_b16 v[4:5], v57 offset:0
    ds_read_b64_tr_b16 v[6:7], v57 offset:1024
    v_mfma_f32_32x32x16_bf16 v[224:239], v[28:31], v[40:43], v[224:239]
    ds_read_b64_tr_b16 v[8:9], v58 offset:0
    ds_read_b64_tr_b16 v[10:11], v58 offset:1024
    v_mfma_f32_32x32x16_bf16 v[240:255], v[28:31], v[44:47], v[240:255]
    ds_read_b64_tr_b16 v[12:13], v59 offset:0
    ds_read_b64_tr_b16 v[14:15], v59 offset:1024
    s_waitcnt lgkmcnt(0)
    v_mfma_f32_32x32x16_bf16 v[128:143], v[0:3], v[32:35], v[128:143]
    s_add_u32 m0, s25, 12288
    s_add_u32 s26, s26, 4096
    buffer_load_dwordx4 v60, s[8:11], s26 offen lds
    v_mfma_f32_32x32x16_bf16 v[144:159], v[0:3], v[36:39], v[144:159]
    s_add_u32 m0, s25, 13312
    s_add_u32 s26, s26, 4096
    buffer_load_dwordx4 v60, s[8:11], s26 offen lds
    v_mfma_f32_32x32x16_bf16 v[160:175], v[4:7], v[32:35], v[160:175]
    s_add_u32 m0, s25, 14336
    s_add_u32 s26, s26, 4096
    buffer_load_dwordx4 v60, s[8:11], s26 offen lds
    v_mfma_f32_32x32x16_bf16 v[176:191], v[4:7], v[36:39], v[176:191]
    s_add_u32 m0, s25, 15360
    s_add_u32 s26, s26, 4096
    buffer_load_dwordx4 v60, s[8:11], s26 offen lds
    s_waitcnt vmcnt(8)
    ds_read_b128 v[40:43], v53 offset:256
    ds_read_b128 v[44:47], v53 offset:16640
    v_mfma_f32_32x32x16_bf16 v[192:207], v[8:11], v[32:35], v[192:207]
    ds_read_b64_tr_b16 v[16:17], v56 offset:4096
    ds_read_b64_tr_b16 v[18:19], v56 offset:5120
    v_mfma_f32_32x32x16_bf16 v[208:223], v[8:11], v[36:39], v[208:223]
    ds_read_b64_tr_b16 v[20:21], v57 offset:4096
    ds_read_b64_tr_b16 v[22:23], v57 offset:5120
    v_mfma_f32_32x32x16_bf16 v[224:239], v[12:15], v[32:35], v[224:239]
    ds_read_b64_tr_b16 v[24:25], v58 offset:4096
    ds_read_b64_tr_b16 v[26:27], v58 offset:5120
    v_mfma_f32_32x32x16_bf16 v[240:255], v[12:15], v[36:39], v[240:255]
    ds_read_b64_tr_b16 v[28:29], v59 offset:4096
    ds_read_b64_tr_b16 v[30:31], v59 offset:5120
    s_waitcnt lgkmcnt(0)
    v_mfma_f32_32x32x16_bf16 v[128:143], v[16:19], v[40:43], v[128:143]
    v_mfma_f32_32x32x16_bf16 v[144:159], v[16:19], v[44:47], v[144:159]
    v_mfma_f32_32x32x16_bf16 v[160:175], v[20:23], v[40:43], v[160:175]
    v_mfma_f32_32x32x16_bf16 v[176:191], v[20:23], v[44:47], v[176:191]
    s_waitcnt vmcnt(4)
    ds_read_b128 v[32:35], v54 offset:256
    ds_read_b128 v[36:39], v54 offset:16640
    v_mfma_f32_32x32x16_bf16 v[192:207], v[24:27], v[40:43], v[192:207]
    ds_read_b64_tr_b16 v[0:1], v56 offset:8192
    ds_read_b64_tr_b16 v[2:3], v56 offset:9216
    v_mfma_f32_32x32x16_bf16 v[208:223], v[24:27], v[44:47], v[208:223]
    ds_read_b64_tr_b16 v[4:5], v57 offset:8192
    ds_read_b64_tr_b16 v[6:7], v57 offset:9216
    v_mfma_f32_32x32x16_bf16 v[224:239], v[28:31], v[40:43], v[224:239]
    ds_read_b64_tr_b16 v[8:9], v58 offset:8192
    ds_read_b64_tr_b16 v[10:11], v58 offset:9216
    v_mfma_f32_32x32x16_bf16 v[240:255], v[28:31], v[44:47], v[240:255]
    ds_read_b64_tr_b16 v[12:13], v59 offset:8192
    ds_read_b64_tr_b16 v[14:15], v59 offset:9216
    s_waitcnt lgkmcnt(0)
    v_mfma_f32_32x32x16_bf16 v[128:143], v[0:3], v[32:35], v[128:143]
    v_mfma_f32_32x32x16_bf16 v[144:159], v[0:3], v[36:39], v[144:159]
    v_mfma_f32_32x32x16_bf16 v[160:175], v[4:7], v[32:35], v[160:175]
    v_mfma_f32_32x32x16_bf16 v[176:191], v[4:7], v[36:39], v[176:191]
    s_waitcnt vmcnt(0)
    ds_read_b128 v[40:43], v55 offset:256
    ds_read_b128 v[44:47], v55 offset:16640
    v_mfma_f32_32x32x16_bf16 v[192:207], v[8:11], v[32:35], v[192:207]
    ds_read_b64_tr_b16 v[16:17], v56 offset:12288
    ds_read_b64_tr_b16 v[18:19], v56 offset:13312
    v_mfma_f32_32x32x16_bf16 v[208:223], v[8:11], v[36:39], v[208:223]
    ds_read_b64_tr_b16 v[20:21], v57 offset:12288
    ds_read_b64_tr_b16 v[22:23], v57 offset:13312
    v_mfma_f32_32x32x16_bf16 v[224:239], v[12:15], v[32:35], v[224:239]
    ds_read_b64_tr_b16 v[24:25], v58 offset:12288
    ds_read_b64_tr_b16 v[26:27], v58 offset:13312
    v_mfma_f32_32x32x16_bf16 v[240:255], v[12:15], v[36:39], v[240:255]
    ds_read_b64_tr_b16 v[28:29], v59 offset:12288
    ds_read_b64_tr_b16 v[30:31], v59 offset:13312
    s_waitcnt lgkmcnt(0)
    v_mfma_f32_32x32x16_bf16 v[128:143], v[16:19], v[40:43], v[128:143]
    v_mfma_f32_32x32x16_bf16 v[144:159], v[16:19], v[44:47], v[144:159]
    v_mfma_f32_32x32x16_bf16 v[160:175], v[20:23], v[40:43], v[160:175]
    v_mfma_f32_32x32x16_bf16 v[176:191], v[20:23], v[44:47], v[176:191]
    v_mfma_f32_32x32x16_bf16 v[192:207], v[24:27], v[40:43], v[192:207]
    v_mfma_f32_32x32x16_bf16 v[208:223], v[24:27], v[44:47], v[208:223]
    v_mfma_f32_32x32x16_bf16 v[224:239], v[28:31], v[40:43], v[224:239]
    v_mfma_f32_32x32x16_bf16 v[240:255], v[28:31], v[44:47], v[240:255]
    s_add_u32 s29, s29, 1
    s_add_u32 s67, s67, 0x40000
    s_mov_b32 s8, s56
    s_mov_b32 s9, s57
    s_lshl_b32 s66, s29, 9
    s_lshl_b32 s30, s20, 7
    s_add_u32 s66, s66, s30
    s_sub_u32 s66, s66, 22016
    s_add_u32 m0, s25, 0
    s_add_u32 s66, s66, 22016
    buffer_load_dwordx4 v61, s[8:11], s66 offen lds
    s_add_u32 m0, s25, 1024
    s_add_u32 s66, s66, 22016
    buffer_load_dwordx4 v61, s[8:11], s66 offen lds
    s_add_u32 m0, s25, 2048
    s_add_u32 s66, s66, 22016
    buffer_load_dwordx4 v61, s[8:11], s66 offen lds
    s_add_u32 m0, s25, 3072
    s_add_u32 s66, s66, 22016
    buffer_load_dwordx4 v61, s[8:11], s66 offen lds
    s_add_u32 m0, s25, 4096
    s_add_u32 s66, s66, 22016
    buffer_load_dwordx4 v61, s[8:11], s66 offen lds
    s_add_u32 m0, s25, 5120
    s_add_u32 s66, s66, 22016
    buffer_load_dwordx4 v61, s[8:11], s66 offen lds
    s_add_u32 m0, s25, 6144
    s_add_u32 s66, s66, 22016
    buffer_load_dwordx4 v61, s[8:11], s66 offen lds
    s_add_u32 m0, s25, 7168
    s_add_u32 s66, s66, 22016
    buffer_load_dwordx4 v61, s[8:11], s66 offen lds
    s_add_u32 m0, s25, 8192
    s_add_u32 s66, s66, 22016
    buffer_load_dwordx4 v61, s[8:11], s66 offen lds
    s_add_u32 m0, s25, 9216
    s_add_u32 s66, s66, 22016
    buffer_load_dwordx4 v61, s[8:11], s66 offen lds
    s_add_u32 m0, s25, 10240
    s_add_u32 s66, s66, 22016
    buffer_load_dwordx4 v61, s[8:11], s66 offen lds
    s_add_u32 m0, s25, 11264
    s_add_u32 s66, s66, 22016
    buffer_load_dwordx4 v61, s[8:11], s66 offen lds
    s_branch L_B34
L_B4X:
    s_mov_b32 s68, 2
    s_mov_b32 s34, 0xbfb8aa3b
    s_waitcnt vmcnt(0) lgkmcnt(0)
    s_branch L_BDUMP
L_BFIN:
    s_waitcnt vmcnt(0)
    s_barrier
    s_cmp_lg_u32 s20, 0
    s_cbranch_scc1 L_BEND
L_BINI:
    buffer_load_dword v1, off, s[12:15], 0 offset:32 sc1
    s_waitcnt vmcnt(0)
    v_readfirstlane_b32 s30, v1
    s_nop 0
    s_cmp_ge_u32 s30, 32
    s_cbranch_scc1 L_BINI2
    s_sub_u32 s24, s24, 1
    s_cbranch_scc1 L_ABORT
    s_branch L_BINI
L_BINI2:
    s_lshl_b32 s30, s21, 10
    s_add_u32 s30, s30, 0x5600140
    v_mov_b32 v1, 1
    s_mov_b64 exec, 1
    buffer_store_dword v1, off, s[4:7], s30 sc1
L_BEND:
    s_waitcnt vmcnt(0)
    s_endpgm
L_ABORT:
    s_mov_b64 exec, 1
    v_mov_b32 v1, 1
    buffer_atomic_add v1, off, s[12:15], 0 offset:40 sc1
    s_waitcnt vmcnt(0)
L_END:
    s_endpgm
.section .rodata,"a"
.p2align 6
.amdhsa_kernel recurrent_scan__memory_aug_recurrent_mem_tr__mixer_s_mlp__prompt_kernel
  .amdhsa_next_free_vgpr 512
  .amdhsa_next_free_sgpr 102
  .amdhsa_accum_offset 256
  .amdhsa_group_segment_fixed_size 0
  .amdhsa_kernarg_size 120
  .amdhsa_user_sgpr_count 2
  .amdhsa_user_sgpr_kernarg_segment_ptr 1
  .amdhsa_system_sgpr_workgroup_id_x 1
  .amdhsa_float_denorm_mode_32 3
.end_amdhsa_kernel
```
